```python
import torch

def _softmax(x, axis=-1):
    return torch.softmax(x, dim=axis)
def _gelu(x):
    return torch.nn.functional.gelu(x, approximate="tanh")
def _silu(x):
    return torch.nn.functional.silu(x)
def _sigmoid(x):
    return torch.sigmoid(x)
def _layernorm(x, axis=-1, eps=1e-5):
    m = x.mean(dim=axis, keepdim=True)
    v = x.var(dim=axis, keepdim=True, unbiased=False)
    return (x - m) / torch.sqrt(v + eps)
def _scatter_add(tgt, idx, src, axis=0):
    return tgt.clone().index_add_(axis, idx, src)
def _segment_sum(src, seg, n):
    out = torch.zeros((n,) + src.shape[1:], dtype=src.dtype)
    return out.index_add_(0, seg, src)
def _pad(x, pw):
    flat = tuple(v for pair in reversed(pw) for v in pair)
    return torch.nn.functional.pad(x, flat)

kernel_name = 'parallel_sum__compressed_kv_cla__dense_activation_gelu__prompt'

def setup_inputs():

    _w = (lambda a: (lambda t: t.to(torch.bfloat16) if t.is_floating_point() else t)(torch.as_tensor(a)))
    def _A_setup():
        B, H, Sq, Sk, D, M = 1, 32, 2048, 2048, 128, 640
        Dc = 4 * D
        return {
            "x": _w((lambda *s: torch.randn(*s, dtype=torch.bfloat16) * 0.05)(B, Sq, M)),
            "c_kv": _w((lambda *s: torch.randn(*s, dtype=torch.bfloat16) * 0.4)(B, Sk, Dc)),
            "w_q": _w((lambda *s: torch.randn(*s, dtype=torch.bfloat16) * 3.2)(M, H, D) * (M ** -0.5)),
            "w_uk": _w((lambda *s: torch.randn(*s, dtype=torch.bfloat16) * 3.2)(Dc, H, D) * (Dc ** -0.5)),
            "w_uv": _w((lambda *s: torch.randn(*s, dtype=torch.bfloat16) * 0.4)(Dc, H, D) * (Dc ** -0.5)),
            "w_o": _w((lambda *s: torch.randn(*s, dtype=torch.bfloat16) * 0.4)(H, D, M) * ((H * D) ** -0.5)),
        }
    _A_in = _A_setup()

    def _B_setup():
        B, S, D, F = 1, 2048, 640, 1728
        return {
            "x": _w((lambda *s: torch.randn(*s, dtype=torch.bfloat16) * 0.05)(B, S, D)),
            "w1": _w((lambda *s: torch.randn(*s, dtype=torch.bfloat16) * 0.4)(D, F) * (D ** -0.5)),
            "b1": _w((lambda *s: torch.randn(*s, dtype=torch.bfloat16) * 12.8)(F) * 0.01),
            "w2": _w((lambda *s: torch.randn(*s, dtype=torch.bfloat16) * 0.2)(F, D) * (F ** -0.5)),
            "b2": _w((lambda *s: torch.randn(*s, dtype=torch.bfloat16) * 1.6)(D) * 0.01),
        }
    _B_in = _B_setup()

    return {
        "A_x": _A_in["x"],
        "A_c_kv": _A_in["c_kv"],
        "A_w_q": _A_in["w_q"],
        "A_w_uk": _A_in["w_uk"],
        "A_w_uv": _A_in["w_uv"],
        "A_w_o": _A_in["w_o"],
        "B_x": _B_in["x"],
        "B_w1": _B_in["w1"],
        "B_b1": _B_in["b1"],
        "B_w2": _B_in["w2"],
        "B_b2": _B_in["b2"],
    }

def reference(A_x, A_c_kv, A_w_q, A_w_uk, A_w_uv, A_w_o, B_x, B_w1, B_b1, B_w2, B_b2):
    def _A_ref(x, c_kv, w_q, w_uk, w_uv, w_o):
        B, Sq, M = x.shape[0], x.shape[1], x.shape[2]
        Sk = c_kv.shape[1]
        H, D = w_q.shape[1], w_q.shape[2]
        q = torch.einsum("bqm,mhd->bhqd", x, w_q)
        k = torch.einsum("bkc,chd->bhkd", c_kv, w_uk)
        v = torch.einsum("bkc,chd->bhkd", c_kv, w_uv)
        scores = torch.einsum("bhqd,bhkd->bhqk", q, k) * (D ** -0.5)
        off = Sk - Sq
        qi = torch.arange(Sq)[:, None]
        kj = torch.arange(Sk)[None, :]
        cmask = kj <= (qi + off)
        scores = torch.where(cmask[None, None], scores, -1e9)
        p = _softmax(scores, axis=-1)
        ctx = torch.einsum("bhqk,bhkd->bhqd", p, v)
        return torch.einsum("bhqd,hdm->bqm", ctx, w_o)

    def _B_ref(x, w1, b1, w2, b2):
        h = torch.einsum("bsd,df->bsf", x, w1) + b1
        h = _gelu(h)
        return torch.einsum("bsf,fd->bsd", h, w2) + b2

    x = A_x
    xn = _layernorm(x, axis=-1)
    return x + _A_ref(xn, A_c_kv, A_w_q, A_w_uk, A_w_uv, A_w_o) + _B_ref(xn, B_w1, B_b1, B_w2, B_b2)
```

```asm
; @launch grid=(256,1,1) block=(256,1,1) lds=163840
.amdgcn_target "amdgcn-amd-amdhsa--gfx950"
.text
.globl parallel_sum__compressed_kv_cla__dense_activation_gelu__prompt_kernel
.p2align 8
.type parallel_sum__compressed_kv_cla__dense_activation_gelu__prompt_kernel,@function
parallel_sum__compressed_kv_cla__dense_activation_gelu__prompt_kernel:
  s_cmp_ge_u32 s2, 256
  s_cbranch_scc1 L_exit
  s_load_dwordx16 s[48:63], s[0:1], 0
  s_load_dwordx8 s[64:71], s[0:1], 64
  s_load_dwordx4 s[72:75], s[0:1], 96
  s_getpc_b64 s[32:33]
  s_movk_i32 s34, 4096
  s_mov_b32 s35, 0x20000
  v_lshlrev_b32 v127, 7, v0
  buffer_load_dword v127, v127, s[32:35], 0 offen
  v_lshrrev_b32 v56, 6, v0
  v_and_b32 v14, 63, v0
  v_readfirstlane_b32 s76, v56
  s_and_b32 s81, s2, 7
  s_bfe_u32 s82, s2, 0x20003
  s_lshl2_add_u32 s77, s81, s82
  s_lshr_b32 s78, s2, 5
  s_sub_u32 s79, 15, s78
  s_mov_b32 s80, s78
  v_lshlrev_b32 v1, 4, v14
  v_and_b32 v56, 15, v14
  v_lshrrev_b32 v57, 4, v14
  v_lshrrev_b32 v58, 1, v56
  v_xor_b32 v58, v58, v57
  v_and_b32 v59, 1, v56
  v_lshlrev_b32 v59, 4, v59
  v_lshl_add_u32 v59, v57, 13, v59
  v_lshl_add_u32 v2, v58, 5, v59
  v_xor_b32 v61, 0x80, v2
  v_add_u32 v3, 31744, v2
  v_add_u32 v4, 63488, v61
  v_add_u32 v5, 95232, v61
  v_lshrrev_b32 v58, 3, v14
  v_and_b32 v59, 7, v14
  v_lshrrev_b32 v62, 1, v58
  v_xor_b32 v59, v59, v62
  v_lshlrev_b32 v59, 4, v59
  v_lshl_add_u32 v6, v58, 10, v59
  v_xor_b32 v59, 64, v6
  v_add_u32 v7, 7168, v59
  v_add_u32 v8, 14336, v6
  v_add_u32 v9, 21504, v59
  s_lshl_b32 s3, s76, 14
  s_add_u32 s3, s3, 98304
  s_lshl_b32 s81, s76, 17
  s_lshl_b32 s82, s77, 8
  s_add_u32 s84, s81, s82
  s_lshl_b32 s85, s76, 12
  s_lshl2_add_u32 s81, s78, s76
  s_lshl_b32 s81, s81, 16
  s_mov_b32 s10, 4194304
  s_mov_b32 s11, 0x20000
  s_mov_b32 s22, 4194304
  s_mov_b32 s23, 0x20000
  s_waitcnt lgkmcnt(0)
  s_mov_b64 s[8:9], s[54:55]
  s_mov_b64 s[20:21], s[56:57]
  s_add_u32 s12, s50, s81
  s_addc_u32 s13, s51, 0
  s_mov_b32 s14, 65536
  s_mov_b32 s15, 0x20000
  s_mov_b32 s60, 0
  s_mov_b32 s61, 32768
  s_getpc_b64 s[32:33]
L_cpf_base:
  s_mov_b32 s34, L_code_end - L_cpf_base
  s_mov_b32 s35, 0x20000
  s_lshr_b32 s81, s2, 3
  s_lshl2_add_u32 s81, s81, s76
  s_mul_i32 s81, s81, 768
  v_lshlrev_b32 v58, 7, v14
  v_cmp_gt_u32 vcc, 6, v14
  v_mov_b32 v59, 2146435072
  s_nop 0
  v_cndmask_b32 v58, v59, v58, vcc
  buffer_load_dword v127, v58, s[32:35], s81 offen
  s_add_u32 m0, s85, 0
  s_nop 0
  buffer_load_dwordx4 v2, s[8:11], s84 offen offset:0 lds
  buffer_load_dwordx4 v3, s[8:11], s84 offen offset:1024 lds
  buffer_load_dwordx4 v4, s[8:11], s84 offen offset:2048 lds
  buffer_load_dwordx4 v5, s[8:11], s84 offen offset:3072 lds
  s_add_u32 m0, s3, 0
  s_nop 0
  buffer_load_dwordx4 v6, s[12:15], s60 offen offset:0 lds
  buffer_load_dwordx4 v7, s[12:15], s60 offen offset:1024 lds
  buffer_load_dwordx4 v8, s[12:15], s60 offen offset:2048 lds
  buffer_load_dwordx4 v9, s[12:15], s60 offen offset:3072 lds
  s_add_u32 s60, s60, 128
  s_add_u32 m0, s3, 4096
  s_nop 0
  buffer_load_dwordx4 v6, s[12:15], s61 offen offset:0 lds
  buffer_load_dwordx4 v7, s[12:15], s61 offen offset:1024 lds
  buffer_load_dwordx4 v8, s[12:15], s61 offen offset:2048 lds
  buffer_load_dwordx4 v9, s[12:15], s61 offen offset:3072 lds
  s_add_u32 s61, s61, 128
  s_add_u32 m0, s85, 16384
  s_nop 0
  buffer_load_dwordx4 v2, s[20:23], s84 offen offset:0 lds
  buffer_load_dwordx4 v3, s[20:23], s84 offen offset:1024 lds
  buffer_load_dwordx4 v4, s[20:23], s84 offen offset:2048 lds
  buffer_load_dwordx4 v5, s[20:23], s84 offen offset:3072 lds
  s_add_u32 s84, s84, 524288
  v_lshrrev_b32 v58, 1, v56
  v_xor_b32 v58, v58, v57
  v_lshlrev_b32 v58, 4, v58
  v_lshl_add_u32 v58, v56, 7, v58
  v_add_u32 v12, s3, v58
  v_xor_b32 v13, 64, v12
  v_lshrrev_b32 v58, 2, v56
  v_and_b32 v59, 1, v57
  v_lshl_or_b32 v59, v59, 2, v58
  v_lshl_add_u32 v60, v57, 3, v58
  v_and_b32 v61, 3, v56
  v_lshlrev_b32 v61, 3, v61
  v_lshl_add_u32 v62, v60, 8, v61
  v_lshl_add_u32 v16, v59, 5, v62
  v_xor_b32 v17, 32, v16
  v_xor_b32 v18, 64, v16
  v_xor_b32 v19, 96, v16
  v_xor_b32 v20, 128, v16
  v_xor_b32 v21, 160, v16
  v_xor_b32 v22, 192, v16
  v_xor_b32 v23, 224, v16
  s_mov_b64 exec, 0
  s_cmp_eq_u32 s76, 0
  s_cbranch_scc1 L_padA0
  s_cmp_eq_u32 s76, 1
  s_cbranch_scc1 L_padA1
  s_cmp_eq_u32 s76, 2
  s_cbranch_scc1 L_padA2
  s_branch L_padA3
  .p2align 12
L_warm_done:
  s_mov_b64 exec, -1
  s_add_u32 m0, s3, 8192
  s_nop 0
  buffer_load_dwordx4 v6, s[12:15], s60 offen offset:0 lds
  buffer_load_dwordx4 v7, s[12:15], s60 offen offset:1024 lds
  buffer_load_dwordx4 v8, s[12:15], s60 offen offset:2048 lds
  buffer_load_dwordx4 v9, s[12:15], s60 offen offset:3072 lds
  s_add_u32 s60, s60, 128
  s_add_u32 m0, s3, 12288
  s_nop 0
  buffer_load_dwordx4 v6, s[12:15], s61 offen offset:0 lds
  buffer_load_dwordx4 v7, s[12:15], s61 offen offset:1024 lds
  buffer_load_dwordx4 v8, s[12:15], s61 offen offset:2048 lds
  buffer_load_dwordx4 v9, s[12:15], s61 offen offset:3072 lds
  s_add_u32 s61, s61, 128
  v_lshrrev_b32 v58, 2, v14
  v_bfe_u32 v59, v14, 1, 1
  v_lshl_add_u32 v58, v58, 6, v59
  v_and_b32 v59, 1, v14
  v_lshlrev_b32 v60, 7, v59
  v_cmp_gt_u32 vcc, 12, v14
  v_lshl_add_u32 v58, v58, 13, v60
  v_mov_b32 v61, 2146435072
  s_lshl2_add_u32 s94, s78, s76
  s_lshl_b32 s94, s94, 6
  v_cndmask_b32 v117, v61, v58, vcc
  v_lshrrev_b32 v58, 1, v14
  v_lshlrev_b32 v58, 7, v58
  v_cmp_gt_u32 vcc, 6, v14
  v_lshl_add_u32 v58, v59, 10, v58
  s_add_u32 s94, s94, s77
  s_lshl_b32 s94, s94, 8
  v_cndmask_b32 v118, v61, v58, vcc
  s_add_u32 s94, s94, 524288
  s_lshl_b32 s95, s77, 11
  buffer_load_dword v127, v117, s[8:11], s94 offen
  buffer_load_dword v127, v117, s[20:23], s94 offen
  buffer_load_dword v127, v118, s[12:15], s95 offen offset:256
  s_add_u32 s94, s94, 1572864
  s_waitcnt vmcnt(15)
  s_barrier
  ds_read_b128 a[160:163], v12 offset:0
  ds_read_b128 a[164:167], v12 offset:2048
  ds_read_b128 a[168:171], v12 offset:4096
  ds_read_b128 a[172:175], v12 offset:6144
  ds_read_b128 a[176:179], v13 offset:0
  ds_read_b128 a[180:183], v13 offset:2048
  ds_read_b128 a[184:187], v13 offset:4096
  ds_read_b128 a[188:191], v13 offset:6144
  ds_read_b64_tr_b16 a[128:129], v16 offset:0
  ds_read_b64_tr_b16 a[130:131], v16 offset:1024
  ds_read_b64_tr_b16 a[132:133], v16 offset:8192
  ds_read_b64_tr_b16 a[134:135], v16 offset:9216
  ds_read_b64_tr_b16 a[136:137], v17 offset:0
  ds_read_b64_tr_b16 a[138:139], v17 offset:1024
  ds_read_b64_tr_b16 a[140:141], v17 offset:8192
  ds_read_b64_tr_b16 a[142:143], v17 offset:9216
  ds_read_b64_tr_b16 a[144:145], v18 offset:0
  ds_read_b64_tr_b16 a[146:147], v18 offset:1024
  ds_read_b64_tr_b16 a[148:149], v18 offset:8192
  ds_read_b64_tr_b16 a[150:151], v18 offset:9216
  s_waitcnt lgkmcnt(0)
  s_add_u32 m0, s85, 32768
  v_mfma_f32_16x16x32_bf16 a[0:3], a[128:131], a[160:163], 0
  buffer_load_dwordx4 v2, s[8:11], s84 offen offset:0 lds
  v_mfma_f32_16x16x32_bf16 a[0:3], a[132:135], a[176:179], a[0:3]
  s_add_u32 s40, s74, 73416704
  s_addc_u32 s41, s75, 0
  ds_read_b64_tr_b16 a[152:153], v19 offset:0
  ds_read_b64_tr_b16 a[154:155], v19 offset:1024
  v_mfma_f32_16x16x32_bf16 a[32:35], a[132:135], a[180:183], 0
  s_mov_b32 s42, 4096
  s_mov_b32 s43, 0x20000
  v_mfma_f32_16x16x32_bf16 a[32:35], a[128:131], a[164:167], a[32:35]
  buffer_load_dwordx4 v3, s[8:11], s84 offen offset:1024 lds
  v_mfma_f32_16x16x32_bf16 a[64:67], a[128:131], a[168:171], 0
  v_add_u32 v24, 0x10000, v16
  v_add_u32 v25, 0x10000, v17
  v_mfma_f32_16x16x32_bf16 a[64:67], a[132:135], a[184:187], a[64:67]
  ds_read_b64_tr_b16 a[156:157], v19 offset:8192
  ds_read_b64_tr_b16 a[158:159], v19 offset:9216
  v_mfma_f32_16x16x32_bf16 a[96:99], a[132:135], a[188:191], 0
  buffer_load_dwordx4 v4, s[8:11], s84 offen offset:2048 lds
  v_mfma_f32_16x16x32_bf16 a[96:99], a[128:131], a[172:175], a[96:99]
  v_add_u32 v26, 0x10000, v18
  v_add_u32 v27, 0x10000, v19
  v_mfma_f32_16x16x32_bf16 a[100:103], a[136:139], a[172:175], 0
  v_add_u32 v28, 0x10000, v20
  v_add_u32 v29, 0x10000, v21
  v_mfma_f32_16x16x32_bf16 a[100:103], a[140:143], a[188:191], a[100:103]
  ds_read_b64_tr_b16 a[128:129], v20 offset:0
  ds_read_b64_tr_b16 a[130:131], v20 offset:1024
  v_mfma_f32_16x16x32_bf16 a[68:71], a[140:143], a[184:187], 0
  buffer_load_dwordx4 v5, s[8:11], s84 offen offset:3072 lds
  v_mfma_f32_16x16x32_bf16 a[68:71], a[136:139], a[168:171], a[68:71]
  s_add_u32 m0, s85, 49152
  v_add_u32 v30, 0x10000, v22
  v_add_u32 v31, 0x10000, v23
  v_mfma_f32_16x16x32_bf16 a[36:39], a[136:139], a[164:167], 0
  v_mfma_f32_16x16x32_bf16 a[36:39], a[140:143], a[180:183], a[36:39]
  ds_read_b64_tr_b16 a[132:133], v20 offset:8192
  ds_read_b64_tr_b16 a[134:135], v20 offset:9216
  v_mfma_f32_16x16x32_bf16 a[4:7], a[140:143], a[176:179], 0
  buffer_load_dwordx4 v2, s[20:23], s84 offen offset:0 lds
  v_mfma_f32_16x16x32_bf16 a[4:7], a[136:139], a[160:163], a[4:7]
  v_mfma_f32_16x16x32_bf16 a[8:11], a[144:147], a[160:163], 0
  v_mfma_f32_16x16x32_bf16 a[8:11], a[148:151], a[176:179], a[8:11]
  buffer_load_dwordx4 v3, s[20:23], s84 offen offset:1024 lds
  v_mfma_f32_16x16x32_bf16 a[40:43], a[148:151], a[180:183], 0
  ds_read_b64_tr_b16 a[136:137], v21 offset:0
  ds_read_b64_tr_b16 a[138:139], v21 offset:1024
  v_mfma_f32_16x16x32_bf16 a[40:43], a[144:147], a[164:167], a[40:43]
  v_mfma_f32_16x16x32_bf16 a[72:75], a[144:147], a[168:171], 0
  buffer_load_dwordx4 v4, s[20:23], s84 offen offset:2048 lds
  v_mfma_f32_16x16x32_bf16 a[72:75], a[148:151], a[184:187], a[72:75]
  ds_read_b64_tr_b16 a[140:141], v21 offset:8192
  ds_read_b64_tr_b16 a[142:143], v21 offset:9216
  v_mfma_f32_16x16x32_bf16 a[104:107], a[148:151], a[188:191], 0
  v_mfma_f32_16x16x32_bf16 a[104:107], a[144:147], a[172:175], a[104:107]
  s_waitcnt lgkmcnt(10)
  buffer_load_dwordx4 v5, s[20:23], s84 offen offset:3072 lds
  s_add_u32 m0, s3, 0
  v_mfma_f32_16x16x32_bf16 a[108:111], a[152:155], a[172:175], 0
  s_waitcnt lgkmcnt(8)
  v_mfma_f32_16x16x32_bf16 a[108:111], a[156:159], a[188:191], a[108:111]
  s_add_u32 s84, s84, 524288
  ds_read_b64_tr_b16 a[144:145], v22 offset:0
  ds_read_b64_tr_b16 a[146:147], v22 offset:1024
  v_mfma_f32_16x16x32_bf16 a[76:79], a[156:159], a[184:187], 0
  buffer_load_dwordx4 v6, s[12:15], s60 offen offset:0 lds
  v_mfma_f32_16x16x32_bf16 a[76:79], a[152:155], a[168:171], a[76:79]
  v_mfma_f32_16x16x32_bf16 a[44:47], a[152:155], a[164:167], 0
  v_mfma_f32_16x16x32_bf16 a[44:47], a[156:159], a[180:183], a[44:47]
  buffer_load_dwordx4 v7, s[12:15], s60 offen offset:1024 lds
  v_mfma_f32_16x16x32_bf16 a[12:15], a[156:159], a[176:179], 0
  ds_read_b64_tr_b16 a[148:149], v22 offset:8192
  ds_read_b64_tr_b16 a[150:151], v22 offset:9216
  v_mfma_f32_16x16x32_bf16 a[12:15], a[152:155], a[160:163], a[12:15]
  s_waitcnt lgkmcnt(10)
  v_mfma_f32_16x16x32_bf16 a[16:19], a[128:131], a[160:163], 0
  s_waitcnt lgkmcnt(8)
  buffer_load_dwordx4 v8, s[12:15], s60 offen offset:2048 lds
  v_mfma_f32_16x16x32_bf16 a[16:19], a[132:135], a[176:179], a[16:19]
  ds_read_b64_tr_b16 a[152:153], v23 offset:0
  ds_read_b64_tr_b16 a[154:155], v23 offset:1024
  v_mfma_f32_16x16x32_bf16 a[48:51], a[132:135], a[180:183], 0
  v_mfma_f32_16x16x32_bf16 a[48:51], a[128:131], a[164:167], a[48:51]
  buffer_load_dwordx4 v9, s[12:15], s60 offen offset:3072 lds
  v_mfma_f32_16x16x32_bf16 a[80:83], a[128:131], a[168:171], 0
  s_add_u32 s60, s60, 128
  v_mfma_f32_16x16x32_bf16 a[80:83], a[132:135], a[184:187], a[80:83]
  s_add_u32 m0, s3, 4096
  ds_read_b64_tr_b16 a[156:157], v23 offset:8192
  ds_read_b64_tr_b16 a[158:159], v23 offset:9216
  v_mfma_f32_16x16x32_bf16 a[112:115], a[132:135], a[188:191], 0
  s_waitcnt vmcnt(23) lgkmcnt(10)
  buffer_load_dwordx4 v6, s[12:15], s61 offen offset:0 lds
  v_mfma_f32_16x16x32_bf16 a[112:115], a[128:131], a[172:175], a[112:115]
  s_barrier
  v_mfma_f32_16x16x32_bf16 a[116:119], a[136:139], a[172:175], 0
  s_waitcnt lgkmcnt(8)
  v_mfma_f32_16x16x32_bf16 a[116:119], a[140:143], a[188:191], a[116:119]
  buffer_load_dwordx4 v7, s[12:15], s61 offen offset:1024 lds
  v_mfma_f32_16x16x32_bf16 a[84:87], a[140:143], a[184:187], 0
  ds_read_b64_tr_b16 a[128:129], v16 offset:16384
  ds_read_b64_tr_b16 a[130:131], v16 offset:17408
  v_mfma_f32_16x16x32_bf16 a[84:87], a[136:139], a[168:171], a[84:87]
  v_mfma_f32_16x16x32_bf16 a[52:55], a[136:139], a[164:167], 0
  buffer_load_dwordx4 v8, s[12:15], s61 offen offset:2048 lds
  v_mfma_f32_16x16x32_bf16 a[52:55], a[140:143], a[180:183], a[52:55]
  ds_read_b64_tr_b16 a[132:133], v16 offset:24576
  ds_read_b64_tr_b16 a[134:135], v16 offset:25600
  v_mfma_f32_16x16x32_bf16 a[20:23], a[140:143], a[176:179], 0
  v_mfma_f32_16x16x32_bf16 a[20:23], a[136:139], a[160:163], a[20:23]
  s_waitcnt lgkmcnt(10)
  buffer_load_dwordx4 v9, s[12:15], s61 offen offset:3072 lds
  v_mfma_f32_16x16x32_bf16 a[24:27], a[144:147], a[160:163], 0
  s_waitcnt lgkmcnt(8)
  v_mfma_f32_16x16x32_bf16 a[24:27], a[148:151], a[176:179], a[24:27]
  s_add_u32 s61, s61, 128
  ds_read_b64_tr_b16 a[136:137], v17 offset:16384
  ds_read_b64_tr_b16 a[138:139], v17 offset:17408
  v_mfma_f32_16x16x32_bf16 a[56:59], a[148:151], a[180:183], 0
  buffer_load_dword v127, v117, s[8:11], s94 offen
  buffer_load_dword v127, v117, s[20:23], s94 offen
  buffer_load_dword v127, v118, s[12:15], s95 offen offset:640
  s_add_u32 s94, s94, 1572864
  v_mfma_f32_16x16x32_bf16 a[56:59], a[144:147], a[164:167], a[56:59]
  s_add_u32 m0, s85, 65536
  v_mfma_f32_16x16x32_bf16 a[88:91], a[144:147], a[168:171], 0
  v_mfma_f32_16x16x32_bf16 a[88:91], a[148:151], a[184:187], a[88:91]
  buffer_load_dwordx4 v2, s[8:11], s84 offen offset:0 lds
  v_mfma_f32_16x16x32_bf16 a[120:123], a[148:151], a[188:191], 0
  ds_read_b64_tr_b16 a[140:141], v17 offset:24576
  ds_read_b64_tr_b16 a[142:143], v17 offset:25600
  v_mfma_f32_16x16x32_bf16 a[120:123], a[144:147], a[172:175], a[120:123]
  s_waitcnt lgkmcnt(10)
  v_mfma_f32_16x16x32_bf16 a[124:127], a[152:155], a[172:175], 0
  s_waitcnt lgkmcnt(8)
  buffer_load_dwordx4 v3, s[8:11], s84 offen offset:1024 lds
  v_mfma_f32_16x16x32_bf16 a[124:127], a[156:159], a[188:191], a[124:127]
  ds_read_b64_tr_b16 a[144:145], v18 offset:16384
  ds_read_b64_tr_b16 a[146:147], v18 offset:17408
  v_mfma_f32_16x16x32_bf16 a[92:95], a[156:159], a[184:187], 0
  v_mfma_f32_16x16x32_bf16 a[92:95], a[152:155], a[168:171], a[92:95]
  buffer_load_dwordx4 v4, s[8:11], s84 offen offset:2048 lds
  v_mfma_f32_16x16x32_bf16 a[60:63], a[152:155], a[164:167], 0
  v_mfma_f32_16x16x32_bf16 a[60:63], a[156:159], a[180:183], a[60:63]
  ds_read_b64_tr_b16 a[148:149], v18 offset:24576
  ds_read_b64_tr_b16 a[150:151], v18 offset:25600
  v_mfma_f32_16x16x32_bf16 a[28:31], a[156:159], a[176:179], 0
  buffer_load_dwordx4 v5, s[8:11], s84 offen offset:3072 lds
  s_add_u32 m0, s85, 81920
  v_mfma_f32_16x16x32_bf16 a[28:31], a[152:155], a[160:163], a[28:31]
  s_waitcnt lgkmcnt(10)
  v_mfma_f32_16x16x32_bf16 v[128:131], a[160:163], a[128:131], 0
  s_waitcnt lgkmcnt(8)
  v_mfma_f32_16x16x32_bf16 v[128:131], a[176:179], a[132:135], v[128:131]
  buffer_load_dwordx4 v2, s[20:23], s84 offen offset:0 lds
  v_mfma_f32_16x16x32_bf16 v[132:135], a[180:183], a[132:135], 0
  s_waitcnt vmcnt(27)
  ds_read_b64_tr_b16 a[152:153], v19 offset:16384
  ds_read_b64_tr_b16 a[154:155], v19 offset:17408
  v_mfma_f32_16x16x32_bf16 v[132:135], a[164:167], a[128:131], v[132:135]
  ds_read_b128 a[192:195], v12 offset:8192
  v_mfma_f32_16x16x32_bf16 v[136:139], a[168:171], a[128:131], 0
  buffer_load_dwordx4 v3, s[20:23], s84 offen offset:1024 lds
  v_mfma_f32_16x16x32_bf16 v[136:139], a[184:187], a[132:135], v[136:139]
  ds_read_b64_tr_b16 a[156:157], v19 offset:24576
  ds_read_b64_tr_b16 a[158:159], v19 offset:25600
  v_mfma_f32_16x16x32_bf16 v[140:143], a[188:191], a[132:135], 0
  v_mfma_f32_16x16x32_bf16 v[140:143], a[172:175], a[128:131], v[140:143]
  s_waitcnt lgkmcnt(11)
  buffer_load_dwordx4 v4, s[20:23], s84 offen offset:2048 lds
  v_mfma_f32_16x16x32_bf16 v[156:159], a[172:175], a[136:139], 0
  s_waitcnt lgkmcnt(9)
  ds_read_b128 a[196:199], v12 offset:10240
  v_mfma_f32_16x16x32_bf16 v[156:159], a[188:191], a[140:143], v[156:159]
  ds_read_b64_tr_b16 a[128:129], v20 offset:16384
  ds_read_b64_tr_b16 a[130:131], v20 offset:17408
  v_mfma_f32_16x16x32_bf16 v[152:155], a[184:187], a[140:143], 0
  buffer_load_dwordx4 v5, s[20:23], s84 offen offset:3072 lds
  v_mfma_f32_16x16x32_bf16 v[152:155], a[168:171], a[136:139], v[152:155]
  s_add_u32 s84, s84, 524288
  ds_read_b128 a[200:203], v12 offset:12288
  v_mfma_f32_16x16x32_bf16 v[148:151], a[164:167], a[136:139], 0
  s_add_u32 m0, s85, 0
  v_mfma_f32_16x16x32_bf16 v[148:151], a[180:183], a[140:143], v[148:151]
  buffer_load_dword v127, v117, s[8:11], s94 offen
  v_mfma_f32_16x16x32_bf16 v[144:147], a[176:179], a[140:143], 0
  ds_read_b64_tr_b16 a[132:133], v20 offset:24576
  ds_read_b64_tr_b16 a[134:135], v20 offset:25600
  v_mfma_f32_16x16x32_bf16 v[144:147], a[160:163], a[136:139], v[144:147]
  s_waitcnt lgkmcnt(13)
  ds_read_b128 a[204:207], v12 offset:14336
  v_mfma_f32_16x16x32_bf16 v[160:163], a[160:163], a[144:147], 0
  s_waitcnt lgkmcnt(12)
  buffer_load_dword v127, v117, s[20:23], s94 offen
  v_mfma_f32_16x16x32_bf16 v[160:163], a[176:179], a[148:151], v[160:163]
  ds_read_b64_tr_b16 a[136:137], v21 offset:16384
  ds_read_b64_tr_b16 a[138:139], v21 offset:17408
  v_mfma_f32_16x16x32_bf16 v[164:167], a[180:183], a[148:151], 0
  v_mfma_f32_16x16x32_bf16 v[164:167], a[164:167], a[144:147], v[164:167]
  ds_read_b128 a[208:211], v13 offset:8192
  v_mfma_f32_16x16x32_bf16 v[168:171], a[168:171], a[144:147], 0
  buffer_load_dword v116, off, s[40:43], 0 offset:12 sc1
  v_mfma_f32_16x16x32_bf16 v[168:171], a[184:187], a[148:151], v[168:171]
  s_mov_b64 s[24:25], s[48:49]
  ds_read_b64_tr_b16 a[140:141], v21 offset:24576
  ds_read_b64_tr_b16 a[142:143], v21 offset:25600
  v_mfma_f32_16x16x32_bf16 v[172:175], a[188:191], a[148:151], 0
  s_waitcnt lgkmcnt(15)
  s_mov_b32 s26, 2621440
  s_mov_b32 s27, 0x20000
  v_mfma_f32_16x16x32_bf16 v[172:175], a[172:175], a[144:147], v[172:175]
  s_lshl_b32 s81, s77, 3
  ds_read_b128 a[212:215], v13 offset:10240
  s_and_b32 s82, s76, 2
  v_mfma_f32_16x16x32_bf16 v[188:191], a[172:175], a[152:155], 0
  s_lshl1_add_u32 s81, s82, s81
  s_and_b32 s81, s81, 127
  s_waitcnt lgkmcnt(13)
  v_mfma_f32_16x16x32_bf16 v[188:191], a[188:191], a[156:159], v[188:191]
  s_cmp_lt_u32 s77, 16
  s_cselect_b32 s82, s79, s80
  ds_read_b64_tr_b16 a[144:145], v22 offset:16384
  ds_read_b64_tr_b16 a[146:147], v22 offset:17408
  v_mfma_f32_16x16x32_bf16 v[184:187], a[184:187], a[156:159], 0
  s_lshl_b32 s82, s82, 7
  s_add_u32 s81, s81, s82
  v_mfma_f32_16x16x32_bf16 v[184:187], a[168:171], a[152:155], v[184:187]
  s_mul_i32 s82, s81, 1280
  ds_read_b128 a[216:219], v13 offset:12288
  s_lshr_b32 s88, s81, 4
  v_mfma_f32_16x16x32_bf16 v[180:183], a[164:167], a[152:155], 0
  s_mul_i32 s88, s88, 20480
  s_and_b32 s81, s81, 15
  s_lshl4_add_u32 s88, s81, s88
  v_mfma_f32_16x16x32_bf16 v[180:183], a[180:183], a[156:159], v[180:183]
  s_and_b32 s81, s76, 1
  ds_read_b64_tr_b16 a[148:149], v22 offset:24576
  ds_read_b64_tr_b16 a[150:151], v22 offset:25600
  v_mfma_f32_16x16x32_bf16 v[176:179], a[176:179], a[156:159], 0
  s_waitcnt lgkmcnt(15)
  s_lshl_b32 s83, s81, 13
  s_add_u32 s88, s88, s83
  v_mfma_f32_16x16x32_bf16 v[176:179], a[160:163], a[152:155], v[176:179]
  s_lshl_b32 s83, s81, 9
  ds_read_b128 a[220:223], v13 offset:14336
  s_add_u32 s83, s83, s82
  v_mfma_f32_16x16x32_bf16 v[192:195], a[160:163], a[128:131], 0
  s_xor_b32 s81, s81, 1
  s_mul_i32 s81, s81, 768
  s_add_u32 s82, s82, s81
  s_waitcnt lgkmcnt(13)
  v_mfma_f32_16x16x32_bf16 v[192:195], a[176:179], a[132:135], v[192:195]
  ds_read_b64_tr_b16 a[152:153], v23 offset:16384
  ds_read_b64_tr_b16 a[154:155], v23 offset:17408
  v_mfma_f32_16x16x32_bf16 v[196:199], a[180:183], a[132:135], 0
  v_lshrrev_b32 v56, 4, v14
  v_and_b32 v57, 15, v14
  v_mfma_f32_16x16x32_bf16 v[196:199], a[164:167], a[128:131], v[196:199]
  v_mul_u32_u24 v58, 1280, v56
  v_lshl_add_u32 v58, v57, 4, v58
  v_mfma_f32_16x16x32_bf16 v[200:203], a[168:171], a[128:131], 0
  buffer_load_dwordx4 v[84:87], v58, s[24:27], s83 offen offset:0
  v_mfma_f32_16x16x32_bf16 v[200:203], a[184:187], a[132:135], v[200:203]
  ds_read_b64_tr_b16 a[156:157], v23 offset:24576
  ds_read_b64_tr_b16 a[158:159], v23 offset:25600
  v_mfma_f32_16x16x32_bf16 v[204:207], a[188:191], a[132:135], 0
  s_waitcnt vmcnt(27) lgkmcnt(14)
  v_mfma_f32_16x16x32_bf16 v[204:207], a[172:175], a[128:131], v[204:207]
  s_barrier
  buffer_load_dwordx4 v[88:91], v58, s[24:27], s83 offen offset:256
  v_mfma_f32_16x16x32_bf16 v[220:223], a[172:175], a[136:139], 0
  s_waitcnt lgkmcnt(11)
  v_mfma_f32_16x16x32_bf16 v[220:223], a[188:191], a[140:143], v[220:223]
  ds_read_b64_tr_b16 a[128:129], v16 offset:32768
  ds_read_b64_tr_b16 a[130:131], v16 offset:33792
  v_mfma_f32_16x16x32_bf16 v[216:219], a[184:187], a[140:143], 0
  buffer_load_dwordx4 v[92:95], v58, s[24:27], s83 offen offset:512
  v_mfma_f32_16x16x32_bf16 v[216:219], a[168:171], a[136:139], v[216:219]
  v_mfma_f32_16x16x32_bf16 v[212:215], a[164:167], a[136:139], 0
  v_mfma_f32_16x16x32_bf16 v[212:215], a[180:183], a[140:143], v[212:215]
  ds_read_b64_tr_b16 a[132:133], v16 offset:40960
  ds_read_b64_tr_b16 a[134:135], v16 offset:41984
  v_mfma_f32_16x16x32_bf16 v[208:211], a[176:179], a[140:143], 0
  buffer_load_dwordx4 v2, s[8:11], s84 offen offset:0 lds
  v_mfma_f32_16x16x32_bf16 v[208:211], a[160:163], a[136:139], v[208:211]
  s_waitcnt lgkmcnt(12)
  v_mfma_f32_16x16x32_bf16 v[224:227], a[160:163], a[144:147], 0
  s_waitcnt lgkmcnt(9)
  v_mfma_f32_16x16x32_bf16 v[224:227], a[176:179], a[148:151], v[224:227]
  ds_read_b64_tr_b16 a[136:137], v17 offset:32768
  ds_read_b64_tr_b16 a[138:139], v17 offset:33792
  v_mfma_f32_16x16x32_bf16 v[228:231], a[180:183], a[148:151], 0
  buffer_load_dwordx4 v3, s[8:11], s84 offen offset:1024 lds
  v_mfma_f32_16x16x32_bf16 v[228:231], a[164:167], a[144:147], v[228:231]
  v_mfma_f32_16x16x32_bf16 v[232:235], a[168:171], a[144:147], 0
  v_mfma_f32_16x16x32_bf16 v[232:235], a[184:187], a[148:151], v[232:235]
  ds_read_b64_tr_b16 a[140:141], v17 offset:40960
  ds_read_b64_tr_b16 a[142:143], v17 offset:41984
  v_mfma_f32_16x16x32_bf16 v[236:239], a[188:191], a[148:151], 0
  buffer_load_dwordx4 v4, s[8:11], s84 offen offset:2048 lds
  v_mfma_f32_16x16x32_bf16 v[236:239], a[172:175], a[144:147], v[236:239]
  s_waitcnt lgkmcnt(10)
  v_mfma_f32_16x16x32_bf16 v[252:255], a[172:175], a[152:155], 0
  s_waitcnt lgkmcnt(8)
  v_mfma_f32_16x16x32_bf16 v[252:255], a[188:191], a[156:159], v[252:255]
  buffer_load_dwordx4 v5, s[8:11], s84 offen offset:3072 lds
  v_mfma_f32_16x16x32_bf16 v[248:251], a[184:187], a[156:159], 0
  s_add_u32 m0, s3, 8192
  ds_read_b64_tr_b16 a[144:145], v18 offset:32768
  ds_read_b64_tr_b16 a[146:147], v18 offset:33792
  v_mfma_f32_16x16x32_bf16 v[248:251], a[168:171], a[152:155], v[248:251]
  v_mfma_f32_16x16x32_bf16 v[244:247], a[164:167], a[152:155], 0
  buffer_load_dwordx4 v[96:99], v58, s[24:27], s82 offen offset:0
  v_mfma_f32_16x16x32_bf16 v[244:247], a[180:183], a[156:159], v[244:247]
  ds_read_b64_tr_b16 a[148:149], v18 offset:40960
  ds_read_b64_tr_b16 a[150:151], v18 offset:41984
  v_mfma_f32_16x16x32_bf16 v[240:243], a[176:179], a[156:159], 0
  v_mfma_f32_16x16x32_bf16 v[240:243], a[160:163], a[152:155], v[240:243]
  s_waitcnt lgkmcnt(8)
  buffer_load_dwordx4 v[100:103], v58, s[24:27], s82 offen offset:256
  v_mfma_f32_16x16x32_bf16 a[0:3], a[128:131], a[192:195], a[0:3]
  s_mov_b64 s[96:97], s[52:53]
  s_mov_b32 s98, 5242880
  s_mov_b32 s99, 0x20000
  v_mfma_f32_16x16x32_bf16 a[0:3], a[132:135], a[208:211], a[0:3]
  s_mov_b64 s[16:17], s[62:63]
  ds_read_b64_tr_b16 a[152:153], v19 offset:32768
  ds_read_b64_tr_b16 a[154:155], v19 offset:33792
  v_mfma_f32_16x16x32_bf16 a[32:35], a[132:135], a[212:215], a[32:35]
  buffer_load_dwordx4 v6, s[12:15], s60 offen offset:0 lds
  v_mfma_f32_16x16x32_bf16 a[32:35], a[128:131], a[196:199], a[32:35]
  s_mov_b32 s19, 0x20000
  s_cmp_lt_u32 s77, 27
  s_cselect_b32 s18, 2211840, 0
  v_mfma_f32_16x16x32_bf16 a[64:67], a[128:131], a[200:203], a[64:67]
  v_mov_b32 v59, 2146435072
  v_lshrrev_b32 v56, 1, v14
  v_mfma_f32_16x16x32_bf16 a[64:67], a[132:135], a[216:219], a[64:67]
  ds_read_b64_tr_b16 a[156:157], v19 offset:40960
  ds_read_b64_tr_b16 a[158:159], v19 offset:41984
  v_mfma_f32_16x16x32_bf16 a[96:99], a[132:135], a[220:223], a[96:99]
  buffer_load_dwordx4 v7, s[12:15], s60 offen offset:1024 lds
  v_mfma_f32_16x16x32_bf16 a[96:99], a[128:131], a[204:207], a[96:99]
  s_waitcnt lgkmcnt(10)
  v_and_b32 v57, 1, v14
  v_lshlrev_b32 v57, 7, v57
  v_mfma_f32_16x16x32_bf16 a[100:103], a[136:139], a[204:207], a[100:103]
  s_waitcnt lgkmcnt(8)
  v_cmp_gt_u32 vcc, 20, v14
  v_lshl_add_u32 v56, v56, 13, v57
  v_mfma_f32_16x16x32_bf16 a[100:103], a[140:143], a[220:223], a[100:103]
  ds_read_b64_tr_b16 a[128:129], v20 offset:32768
  ds_read_b64_tr_b16 a[130:131], v20 offset:33792
  v_mfma_f32_16x16x32_bf16 a[68:71], a[140:143], a[216:219], a[68:71]
  buffer_load_dwordx4 v8, s[12:15], s60 offen offset:2048 lds
  v_mfma_f32_16x16x32_bf16 a[68:71], a[136:139], a[200:203], a[68:71]
  v_mul_u32_u24 v57, 3456, v14
  s_lshl2_add_u32 s81, s78, s76
  v_mfma_f32_16x16x32_bf16 a[36:39], a[136:139], a[196:199], a[36:39]
  s_mul_i32 s82, s81, 640
  s_add_u32 s82, s82, s77
  s_lshl_b32 s82, s82, 8
  v_mfma_f32_16x16x32_bf16 a[36:39], a[140:143], a[212:215], a[36:39]
  ds_read_b64_tr_b16 a[132:133], v20 offset:40960
  ds_read_b64_tr_b16 a[134:135], v20 offset:41984
  v_mfma_f32_16x16x32_bf16 a[4:7], a[140:143], a[208:211], a[4:7]
  buffer_load_dwordx4 v9, s[12:15], s60 offen offset:3072 lds
  s_add_u32 m0, s3, 12288
  v_mfma_f32_16x16x32_bf16 a[4:7], a[136:139], a[192:195], a[4:7]
  s_waitcnt lgkmcnt(8)
  v_add_u32 v56, s82, v56
  s_mul_i32 s82, s81, 540
  v_mfma_f32_16x16x32_bf16 a[8:11], a[144:147], a[192:195], a[8:11]
  s_add_u32 s82, s82, s77
  s_lshl_b32 s82, s82, 7
  v_add_u32 v57, s82, v57
  v_mfma_f32_16x16x32_bf16 a[8:11], a[148:151], a[208:211], a[8:11]
  s_add_u32 s60, s60, 128
  ds_read_b64_tr_b16 a[136:137], v21 offset:32768
  ds_read_b64_tr_b16 a[138:139], v21 offset:33792
  v_mfma_f32_16x16x32_bf16 a[40:43], a[148:151], a[212:215], a[40:43]
  buffer_load_dwordx4 v6, s[12:15], s61 offen offset:0 lds
  v_mfma_f32_16x16x32_bf16 a[40:43], a[144:147], a[196:199], a[40:43]
  v_add_u32 v58, 81920, v56
  v_cndmask_b32 v117, v59, v56, vcc
  v_mfma_f32_16x16x32_bf16 a[72:75], a[144:147], a[200:203], a[72:75]
  v_cndmask_b32 v118, v59, v58, vcc
  v_cndmask_b32 v119, v59, v57, vcc
  v_mfma_f32_16x16x32_bf16 a[72:75], a[148:151], a[216:219], a[72:75]
  s_add_u32 s36, s74, 92274688
  s_addc_u32 s37, s75, 0
  ds_read_b64_tr_b16 a[140:141], v21 offset:40960
  ds_read_b64_tr_b16 a[142:143], v21 offset:41984
  v_mfma_f32_16x16x32_bf16 a[104:107], a[148:151], a[220:223], a[104:107]
  s_waitcnt lgkmcnt(10)
  buffer_load_dwordx4 v7, s[12:15], s61 offen offset:1024 lds
  v_mfma_f32_16x16x32_bf16 a[104:107], a[144:147], a[204:207], a[104:107]
  s_mov_b32 s38, 278528
  s_mov_b32 s39, 0x20000
  v_mfma_f32_16x16x32_bf16 a[108:111], a[152:155], a[204:207], a[108:111]
  s_add_u32 s44, s74, 35651584
  s_addc_u32 s45, s75, 0
  s_mov_b32 s46, 2621440
  s_waitcnt lgkmcnt(8)
  v_mfma_f32_16x16x32_bf16 a[108:111], a[156:159], a[220:223], a[108:111]
  s_mov_b32 s47, 0x20000
  ds_read_b64_tr_b16 a[144:145], v22 offset:32768
  ds_read_b64_tr_b16 a[146:147], v22 offset:33792
  v_mfma_f32_16x16x32_bf16 a[76:79], a[156:159], a[216:219], a[76:79]
  buffer_load_dwordx4 v8, s[12:15], s61 offen offset:2048 lds
  v_mfma_f32_16x16x32_bf16 a[76:79], a[152:155], a[200:203], a[76:79]
  v_and_b32 v56, 3, v14
  v_lshrrev_b32 v57, 2, v14
  v_mfma_f32_16x16x32_bf16 a[44:47], a[152:155], a[196:199], a[44:47]
  v_lshlrev_b32 v110, 8, v57
  v_lshl_add_u32 v110, v56, 4, v110
  v_mfma_f32_16x16x32_bf16 a[44:47], a[156:159], a[212:215], a[44:47]
  buffer_load_dwordx4 v9, s[12:15], s61 offen offset:3072 lds
  v_mfma_f32_16x16x32_bf16 a[12:15], a[156:159], a[208:211], a[12:15]
  s_add_u32 s61, s61, 128
  ds_read_b64_tr_b16 a[148:149], v22 offset:40960
  ds_read_b64_tr_b16 a[150:151], v22 offset:41984
  v_mfma_f32_16x16x32_bf16 a[12:15], a[152:155], a[192:195], a[12:15]
  s_waitcnt lgkmcnt(10)
  v_add_u32 v111, 4096, v110
  v_add_u32 v126, 8192, v110
  v_mfma_f32_16x16x32_bf16 a[16:19], a[128:131], a[192:195], a[16:19]
  s_waitcnt lgkmcnt(8)
  s_waitcnt vmcnt(17)
  v_add_u32 v116, 2654435769, v116
  s_lshl_b32 s81, s78, 11
  v_mfma_f32_16x16x32_bf16 a[16:19], a[132:135], a[208:211], a[16:19]
  s_add_u32 s81, s81, 262144
  ds_read_b64_tr_b16 a[152:153], v23 offset:32768
  ds_read_b64_tr_b16 a[154:155], v23 offset:33792
  v_mfma_f32_16x16x32_bf16 a[48:51], a[132:135], a[212:215], a[48:51]
  s_add_u32 m0, s85, 16384
  s_lshl_b32 s82, s77, 6
  s_add_u32 s82, s82, s81
  v_mfma_f32_16x16x32_bf16 a[48:51], a[128:131], a[196:199], a[48:51]
  v_readfirstlane_b32 s72, v116
  v_mfma_f32_16x16x32_bf16 a[80:83], a[128:131], a[200:203], a[80:83]
  s_cmp_eq_u32 s76, 0
  s_cselect_b32 s83, 16, 0
  v_cmp_gt_u32 vcc, s83, v14
  v_mfma_f32_16x16x32_bf16 a[80:83], a[132:135], a[216:219], a[80:83]
  ds_read_b64_tr_b16 a[156:157], v23 offset:40960
  ds_read_b64_tr_b16 a[158:159], v23 offset:41984
  v_mfma_f32_16x16x32_bf16 a[112:115], a[132:135], a[220:223], a[112:115]
  s_waitcnt lgkmcnt(10)
  v_lshl_add_u32 v56, v14, 2, s82
  v_mov_b32 v112, 2146435072
  v_mfma_f32_16x16x32_bf16 a[112:115], a[128:131], a[204:207], a[112:115]
  s_barrier
  v_cndmask_b32 v112, v112, v56, vcc
  v_mfma_f32_16x16x32_bf16 a[116:119], a[136:139], a[204:207], a[116:119]
  s_waitcnt lgkmcnt(8)
  buffer_load_dwordx4 v2, s[20:23], s84 offen offset:0 lds
  v_mfma_f32_16x16x32_bf16 a[116:119], a[140:143], a[220:223], a[116:119]
  s_cmp_eq_u32 s76, 0
  s_cselect_b32 s95, 32, 0
  ds_read_b64_tr_b16 a[128:129], v16 offset:49152
  ds_read_b64_tr_b16 a[130:131], v16 offset:50176
  v_mfma_f32_16x16x32_bf16 a[84:87], a[140:143], a[216:219], a[84:87]
  v_cmp_gt_u32 vcc, s95, v14
  v_lshl_add_u32 v56, v14, 6, s81
  v_mfma_f32_16x16x32_bf16 a[84:87], a[136:139], a[200:203], a[84:87]
  buffer_load_dwordx4 v3, s[20:23], s84 offen offset:1024 lds
  v_mfma_f32_16x16x32_bf16 a[52:55], a[136:139], a[196:199], a[52:55]
  v_mov_b32 v113, 2146435072
  v_mov_b32 v114, s72
  v_mfma_f32_16x16x32_bf16 a[52:55], a[140:143], a[212:215], a[52:55]
  ds_read_b64_tr_b16 a[132:133], v16 offset:57344
  ds_read_b64_tr_b16 a[134:135], v16 offset:58368
  v_mfma_f32_16x16x32_bf16 a[20:23], a[140:143], a[208:211], a[20:23]
  buffer_load_dwordx4 v4, s[20:23], s84 offen offset:2048 lds
  v_mfma_f32_16x16x32_bf16 a[20:23], a[136:139], a[192:195], a[20:23]
  s_waitcnt lgkmcnt(10)
  v_cndmask_b32 v113, v113, v56, vcc
  v_cndmask_b32 v114, 0, v114, vcc
  v_mfma_f32_16x16x32_bf16 a[24:27], a[144:147], a[192:195], a[24:27]
  s_waitcnt lgkmcnt(8)
  s_waitcnt vmcnt(19)
  v_lshlrev_b32 v64, 16, v84
  v_and_b32 v65, 0xffff0000, v84
  v_mfma_f32_16x16x32_bf16 a[24:27], a[148:151], a[208:211], a[24:27]
  ds_read_b64_tr_b16 a[136:137], v17 offset:49152
  ds_read_b64_tr_b16 a[138:139], v17 offset:50176
  v_mfma_f32_16x16x32_bf16 a[56:59], a[148:151], a[212:215], a[56:59]
  buffer_load_dwordx4 v5, s[20:23], s84 offen offset:3072 lds
  v_mfma_f32_16x16x32_bf16 a[56:59], a[144:147], a[196:199], a[56:59]
  s_add_u32 s84, s84, 524288
  v_lshlrev_b32 v66, 16, v85
  v_and_b32 v67, 0xffff0000, v85
  v_mfma_f32_16x16x32_bf16 a[88:91], a[144:147], a[200:203], a[88:91]
  s_add_u32 m0, s85, 32768
  v_lshlrev_b32 v68, 16, v86
  v_and_b32 v69, 0xffff0000, v86
  v_mfma_f32_16x16x32_bf16 a[88:91], a[148:151], a[216:219], a[88:91]
  ds_read_b64_tr_b16 a[140:141], v17 offset:57344
  ds_read_b64_tr_b16 a[142:143], v17 offset:58368
  v_mfma_f32_16x16x32_bf16 a[120:123], a[148:151], a[220:223], a[120:123]
  v_lshlrev_b32 v70, 16, v87
  v_and_b32 v71, 0xffff0000, v87
  v_mfma_f32_16x16x32_bf16 a[120:123], a[144:147], a[204:207], a[120:123]
  s_waitcnt lgkmcnt(10)
  s_waitcnt vmcnt(19)
  v_lshlrev_b32 v72, 16, v88
  v_and_b32 v73, 0xffff0000, v88
  v_mfma_f32_16x16x32_bf16 a[124:127], a[152:155], a[204:207], a[124:127]
  s_waitcnt lgkmcnt(8)
  v_lshlrev_b32 v74, 16, v89
  v_and_b32 v75, 0xffff0000, v89
  v_mfma_f32_16x16x32_bf16 a[124:127], a[156:159], a[220:223], a[124:127]
L_padA0:
  s_cbranch_execz L_padA4
  ds_read_b64_tr_b16 a[144:145], v18 offset:49152
  ds_read_b64_tr_b16 a[146:147], v18 offset:50176
  v_mfma_f32_16x16x32_bf16 a[92:95], a[156:159], a[216:219], a[92:95]
  v_lshlrev_b32 v76, 16, v90
  v_and_b32 v77, 0xffff0000, v90
  v_mfma_f32_16x16x32_bf16 a[92:95], a[152:155], a[200:203], a[92:95]
  v_lshlrev_b32 v78, 16, v91
  v_and_b32 v79, 0xffff0000, v91
  v_mfma_f32_16x16x32_bf16 a[60:63], a[152:155], a[196:199], a[60:63]
  s_waitcnt vmcnt(18)
  v_lshlrev_b32 v80, 16, v92
  v_and_b32 v81, 0xffff0000, v92
  v_mfma_f32_16x16x32_bf16 a[60:63], a[156:159], a[212:215], a[60:63]
  ds_read_b64_tr_b16 a[148:149], v18 offset:57344
  ds_read_b64_tr_b16 a[150:151], v18 offset:58368
  v_mfma_f32_16x16x32_bf16 a[28:31], a[156:159], a[208:211], a[28:31]
  v_lshlrev_b32 v82, 16, v93
  v_and_b32 v83, 0xffff0000, v93
  v_mfma_f32_16x16x32_bf16 a[28:31], a[152:155], a[192:195], a[28:31]
  s_waitcnt lgkmcnt(10)
  v_lshlrev_b32 v84, 16, v94
  v_and_b32 v85, 0xffff0000, v94
  v_mfma_f32_16x16x32_bf16 v[128:131], a[192:195], a[128:131], v[128:131]
  s_waitcnt lgkmcnt(8)
  v_lshlrev_b32 v86, 16, v95
  v_and_b32 v87, 0xffff0000, v95
  v_mfma_f32_16x16x32_bf16 v[128:131], a[208:211], a[132:135], v[128:131]
  ds_read_b64_tr_b16 a[152:153], v19 offset:49152
  ds_read_b64_tr_b16 a[154:155], v19 offset:50176
  v_mfma_f32_16x16x32_bf16 v[132:135], a[212:215], a[132:135], v[132:135]
  s_waitcnt vmcnt(13)
  v_lshlrev_b32 v88, 16, v96
  v_and_b32 v89, 0xffff0000, v96
  v_mfma_f32_16x16x32_bf16 v[132:135], a[196:199], a[128:131], v[132:135]
  ds_read_b128 a[224:227], v12 offset:0
  v_lshlrev_b32 v90, 16, v97
  v_mfma_f32_16x16x32_bf16 v[136:139], a[200:203], a[128:131], v[136:139]
  v_and_b32 v91, 0xffff0000, v97
  v_lshlrev_b32 v92, 16, v98
  v_mfma_f32_16x16x32_bf16 v[136:139], a[216:219], a[132:135], v[136:139]
  ds_read_b64_tr_b16 a[156:157], v19 offset:57344
  ds_read_b64_tr_b16 a[158:159], v19 offset:58368
  v_mfma_f32_16x16x32_bf16 v[140:143], a[220:223], a[132:135], v[140:143]
  v_and_b32 v93, 0xffff0000, v98
  v_lshlrev_b32 v94, 16, v99
  v_mfma_f32_16x16x32_bf16 v[140:143], a[204:207], a[128:131], v[140:143]
  s_waitcnt lgkmcnt(11)
  ds_read_b128 a[228:231], v12 offset:2048
  v_and_b32 v95, 0xffff0000, v99
  v_mfma_f32_16x16x32_bf16 v[156:159], a[204:207], a[136:139], v[156:159]
  s_waitcnt lgkmcnt(10)
  s_waitcnt vmcnt(12)
  v_lshlrev_b32 v96, 16, v100
  v_and_b32 v97, 0xffff0000, v100
  v_mfma_f32_16x16x32_bf16 v[156:159], a[220:223], a[140:143], v[156:159]
  ds_read_b64_tr_b16 a[128:129], v20 offset:49152
  ds_read_b64_tr_b16 a[130:131], v20 offset:50176
  v_mfma_f32_16x16x32_bf16 v[152:155], a[216:219], a[140:143], v[152:155]
  v_lshlrev_b32 v98, 16, v101
  v_and_b32 v99, 0xffff0000, v101
  v_mfma_f32_16x16x32_bf16 v[152:155], a[200:203], a[136:139], v[152:155]
  ds_read_b128 a[232:235], v12 offset:4096
  v_lshlrev_b32 v100, 16, v102
  v_mfma_f32_16x16x32_bf16 v[148:151], a[196:199], a[136:139], v[148:151]
  v_and_b32 v101, 0xffff0000, v102
  v_lshlrev_b32 v102, 16, v103
  v_mfma_f32_16x16x32_bf16 v[148:151], a[212:215], a[140:143], v[148:151]
  ds_read_b64_tr_b16 a[132:133], v20 offset:57344
  ds_read_b64_tr_b16 a[134:135], v20 offset:58368
  v_mfma_f32_16x16x32_bf16 v[144:147], a[208:211], a[140:143], v[144:147]
  v_and_b32 v103, 0xffff0000, v103
  v_add_f32 v104, v64, v65
  v_mfma_f32_16x16x32_bf16 v[144:147], a[192:195], a[136:139], v[144:147]
  s_waitcnt lgkmcnt(13)
  ds_read_b128 a[236:239], v12 offset:6144
  v_add_f32 v105, v66, v67
  v_mfma_f32_16x16x32_bf16 v[160:163], a[192:195], a[144:147], v[160:163]
  s_waitcnt lgkmcnt(12)
  v_add_f32 v104, v104, v68
  v_add_f32 v105, v105, v69
  v_mfma_f32_16x16x32_bf16 v[160:163], a[208:211], a[148:151], v[160:163]
  ds_read_b64_tr_b16 a[136:137], v21 offset:49152
  ds_read_b64_tr_b16 a[138:139], v21 offset:50176
  v_mfma_f32_16x16x32_bf16 v[164:167], a[212:215], a[148:151], v[164:167]
  v_add_f32 v104, v104, v70
  v_add_f32 v105, v105, v71
  v_mfma_f32_16x16x32_bf16 v[164:167], a[196:199], a[144:147], v[164:167]
  ds_read_b128 a[240:243], v13 offset:0
  v_add_f32 v104, v104, v72
  v_mfma_f32_16x16x32_bf16 v[168:171], a[200:203], a[144:147], v[168:171]
  v_add_f32 v105, v105, v73
  v_add_f32 v104, v104, v74
  v_mfma_f32_16x16x32_bf16 v[168:171], a[216:219], a[148:151], v[168:171]
  ds_read_b64_tr_b16 a[140:141], v21 offset:57344
  ds_read_b64_tr_b16 a[142:143], v21 offset:58368
  v_mfma_f32_16x16x32_bf16 v[172:175], a[220:223], a[148:151], v[172:175]
  v_add_f32 v105, v105, v75
  v_add_f32 v104, v104, v76
  v_mfma_f32_16x16x32_bf16 v[172:175], a[204:207], a[144:147], v[172:175]
  s_waitcnt lgkmcnt(15)
  ds_read_b128 a[244:247], v13 offset:2048
  v_add_f32 v105, v105, v77
  v_mfma_f32_16x16x32_bf16 v[188:191], a[204:207], a[152:155], v[188:191]
  s_waitcnt lgkmcnt(13)
  v_add_f32 v104, v104, v78
  v_add_f32 v105, v105, v79
  v_mfma_f32_16x16x32_bf16 v[188:191], a[220:223], a[156:159], v[188:191]
  ds_read_b64_tr_b16 a[144:145], v22 offset:49152
  ds_read_b64_tr_b16 a[146:147], v22 offset:50176
  v_mfma_f32_16x16x32_bf16 v[184:187], a[216:219], a[156:159], v[184:187]
  v_add_f32 v104, v104, v80
  v_add_f32 v105, v105, v81
  v_mfma_f32_16x16x32_bf16 v[184:187], a[200:203], a[152:155], v[184:187]
  ds_read_b128 a[248:251], v13 offset:4096
  v_add_f32 v104, v104, v82
  v_mfma_f32_16x16x32_bf16 v[180:183], a[196:199], a[152:155], v[180:183]
  v_add_f32 v105, v105, v83
  v_add_f32 v104, v104, v84
  v_mfma_f32_16x16x32_bf16 v[180:183], a[212:215], a[156:159], v[180:183]
  ds_read_b64_tr_b16 a[148:149], v22 offset:57344
  ds_read_b64_tr_b16 a[150:151], v22 offset:58368
  v_mfma_f32_16x16x32_bf16 v[176:179], a[208:211], a[156:159], v[176:179]
  v_add_f32 v105, v105, v85
  v_add_f32 v104, v104, v86
  v_mfma_f32_16x16x32_bf16 v[176:179], a[192:195], a[152:155], v[176:179]
  s_waitcnt lgkmcnt(15)
  ds_read_b128 a[252:255], v13 offset:6144
  v_add_f32 v105, v105, v87
  v_mfma_f32_16x16x32_bf16 v[192:195], a[192:195], a[128:131], v[192:195]
  s_waitcnt lgkmcnt(13)
  v_add_f32 v104, v104, v88
  v_add_f32 v105, v105, v89
  v_mfma_f32_16x16x32_bf16 v[192:195], a[208:211], a[132:135], v[192:195]
  ds_read_b64_tr_b16 a[152:153], v23 offset:49152
  ds_read_b64_tr_b16 a[154:155], v23 offset:50176
  v_mfma_f32_16x16x32_bf16 v[196:199], a[212:215], a[132:135], v[196:199]
  v_add_f32 v104, v104, v90
  v_add_f32 v105, v105, v91
  v_mfma_f32_16x16x32_bf16 v[196:199], a[196:199], a[128:131], v[196:199]
  v_add_f32 v104, v104, v92
  v_add_f32 v105, v105, v93
  v_mfma_f32_16x16x32_bf16 v[200:203], a[200:203], a[128:131], v[200:203]
  v_add_f32 v104, v104, v94
  v_add_f32 v105, v105, v95
  v_mfma_f32_16x16x32_bf16 v[200:203], a[216:219], a[132:135], v[200:203]
  ds_read_b64_tr_b16 a[156:157], v23 offset:57344
  ds_read_b64_tr_b16 a[158:159], v23 offset:58368
  v_mfma_f32_16x16x32_bf16 v[204:207], a[220:223], a[132:135], v[204:207]
  s_waitcnt lgkmcnt(14)
  v_add_f32 v104, v104, v96
  v_add_f32 v105, v105, v97
  v_mfma_f32_16x16x32_bf16 v[204:207], a[204:207], a[128:131], v[204:207]
  s_barrier
  v_add_f32 v104, v104, v98
  v_add_f32 v105, v105, v99
  v_mfma_f32_16x16x32_bf16 v[220:223], a[204:207], a[136:139], v[220:223]
  s_waitcnt lgkmcnt(11)
  buffer_load_dwordx4 v2, s[8:11], s84 offen offset:0 lds
  v_mfma_f32_16x16x32_bf16 v[220:223], a[220:223], a[140:143], v[220:223]
  ds_read_b64_tr_b16 a[128:129], v24 offset:0
  ds_read_b64_tr_b16 a[130:131], v24 offset:1024
  v_mfma_f32_16x16x32_bf16 v[216:219], a[216:219], a[140:143], v[216:219]
  v_add_f32 v104, v104, v100
  v_add_f32 v105, v105, v101
  v_mfma_f32_16x16x32_bf16 v[216:219], a[200:203], a[136:139], v[216:219]
  buffer_load_dwordx4 v3, s[8:11], s84 offen offset:1024 lds
  v_mfma_f32_16x16x32_bf16 v[212:215], a[196:199], a[136:139], v[212:215]
  v_add_f32 v104, v104, v102
  v_add_f32 v105, v105, v103
  v_mfma_f32_16x16x32_bf16 v[212:215], a[212:215], a[140:143], v[212:215]
  ds_read_b64_tr_b16 a[132:133], v24 offset:8192
  ds_read_b64_tr_b16 a[134:135], v24 offset:9216
  v_mfma_f32_16x16x32_bf16 v[208:211], a[208:211], a[140:143], v[208:211]
  buffer_load_dwordx4 v4, s[8:11], s84 offen offset:2048 lds
  v_mfma_f32_16x16x32_bf16 v[208:211], a[192:195], a[136:139], v[208:211]
  s_waitcnt lgkmcnt(12)
  v_add_f32 v104, v104, v105
  v_mfma_f32_16x16x32_bf16 v[224:227], a[192:195], a[144:147], v[224:227]
  s_waitcnt lgkmcnt(9)
  v_add_f32_dpp v104, v104, v104 row_ror:1 row_mask:0xf bank_mask:0xf
  v_mfma_f32_16x16x32_bf16 v[224:227], a[208:211], a[148:151], v[224:227]
  ds_read_b64_tr_b16 a[136:137], v25 offset:0
  ds_read_b64_tr_b16 a[138:139], v25 offset:1024
  v_mfma_f32_16x16x32_bf16 v[228:231], a[212:215], a[148:151], v[228:231]
  buffer_load_dwordx4 v5, s[8:11], s84 offen offset:3072 lds
  v_mfma_f32_16x16x32_bf16 v[228:231], a[196:199], a[144:147], v[228:231]
  s_add_u32 m0, s3, 0
  v_add_f32_dpp v104, v104, v104 row_ror:2 row_mask:0xf bank_mask:0xf
  v_mfma_f32_16x16x32_bf16 v[232:235], a[200:203], a[144:147], v[232:235]
  s_nop 0
  v_add_f32_dpp v104, v104, v104 row_ror:4 row_mask:0xf bank_mask:0xf
  v_mfma_f32_16x16x32_bf16 v[232:235], a[216:219], a[148:151], v[232:235]
  ds_read_b64_tr_b16 a[140:141], v25 offset:8192
  ds_read_b64_tr_b16 a[142:143], v25 offset:9216
  v_mfma_f32_16x16x32_bf16 v[236:239], a[220:223], a[148:151], v[236:239]
  v_add_f32_dpp v104, v104, v104 row_ror:8 row_mask:0xf bank_mask:0xf
  v_mul_f32 v104, 0x3acccccd, v104
  v_mfma_f32_16x16x32_bf16 v[236:239], a[204:207], a[144:147], v[236:239]
  s_waitcnt lgkmcnt(10)
  v_sub_f32 v108, v64, v104
  v_sub_f32 v109, v65, v104
  v_mfma_f32_16x16x32_bf16 v[252:255], a[204:207], a[152:155], v[252:255]
  s_waitcnt lgkmcnt(8)
  v_mul_f32 v106, v108, v108
  v_mul_f32 v107, v109, v109
  v_mfma_f32_16x16x32_bf16 v[252:255], a[220:223], a[156:159], v[252:255]
  ds_read_b64_tr_b16 a[144:145], v26 offset:0
  ds_read_b64_tr_b16 a[146:147], v26 offset:1024
  v_mfma_f32_16x16x32_bf16 v[248:251], a[216:219], a[156:159], v[248:251]
  v_sub_f32 v108, v66, v104
  v_sub_f32 v109, v67, v104
  v_mfma_f32_16x16x32_bf16 v[248:251], a[200:203], a[152:155], v[248:251]
  v_fmac_f32 v106, v108, v108
  v_fmac_f32 v107, v109, v109
  v_mfma_f32_16x16x32_bf16 v[244:247], a[196:199], a[152:155], v[244:247]
  v_sub_f32 v108, v68, v104
  v_sub_f32 v109, v69, v104
  v_mfma_f32_16x16x32_bf16 v[244:247], a[212:215], a[156:159], v[244:247]
  ds_read_b64_tr_b16 a[148:149], v26 offset:8192
  ds_read_b64_tr_b16 a[150:151], v26 offset:9216
  v_mfma_f32_16x16x32_bf16 v[240:243], a[208:211], a[156:159], v[240:243]
  v_fmac_f32 v106, v108, v108
  v_fmac_f32 v107, v109, v109
  v_mfma_f32_16x16x32_bf16 v[240:243], a[192:195], a[152:155], v[240:243]
  s_waitcnt lgkmcnt(10)
  v_sub_f32 v108, v70, v104
  v_sub_f32 v109, v71, v104
  v_mfma_f32_16x16x32_bf16 a[0:3], a[128:131], a[224:227], a[0:3]
  s_waitcnt lgkmcnt(8)
  v_fmac_f32 v106, v108, v108
  v_fmac_f32 v107, v109, v109
  v_mfma_f32_16x16x32_bf16 a[0:3], a[132:135], a[240:243], a[0:3]
  ds_read_b64_tr_b16 a[152:153], v27 offset:0
  ds_read_b64_tr_b16 a[154:155], v27 offset:1024
  v_mfma_f32_16x16x32_bf16 a[32:35], a[132:135], a[244:247], a[32:35]
  buffer_load_dwordx4 v6, s[12:15], s60 offen offset:0 lds
  v_mfma_f32_16x16x32_bf16 a[32:35], a[128:131], a[228:231], a[32:35]
  v_sub_f32 v108, v72, v104
  v_sub_f32 v109, v73, v104
  v_mfma_f32_16x16x32_bf16 a[64:67], a[128:131], a[232:235], a[64:67]
  v_fmac_f32 v106, v108, v108
  v_fmac_f32 v107, v109, v109
  v_mfma_f32_16x16x32_bf16 a[64:67], a[132:135], a[248:251], a[64:67]
  ds_read_b64_tr_b16 a[156:157], v27 offset:8192
  ds_read_b64_tr_b16 a[158:159], v27 offset:9216
  v_mfma_f32_16x16x32_bf16 a[96:99], a[132:135], a[252:255], a[96:99]
  buffer_load_dwordx4 v7, s[12:15], s60 offen offset:1024 lds
  v_mfma_f32_16x16x32_bf16 a[96:99], a[128:131], a[236:239], a[96:99]
  s_waitcnt lgkmcnt(10)
  v_sub_f32 v108, v74, v104
  v_sub_f32 v109, v75, v104
  v_mfma_f32_16x16x32_bf16 a[100:103], a[136:139], a[236:239], a[100:103]
  s_waitcnt lgkmcnt(8)
  v_fmac_f32 v106, v108, v108
  v_fmac_f32 v107, v109, v109
  v_mfma_f32_16x16x32_bf16 a[100:103], a[140:143], a[252:255], a[100:103]
  ds_read_b64_tr_b16 a[128:129], v28 offset:0
  ds_read_b64_tr_b16 a[130:131], v28 offset:1024
  v_mfma_f32_16x16x32_bf16 a[68:71], a[140:143], a[248:251], a[68:71]
  buffer_load_dwordx4 v8, s[12:15], s60 offen offset:2048 lds
  v_mfma_f32_16x16x32_bf16 a[68:71], a[136:139], a[232:235], a[68:71]
  v_sub_f32 v108, v76, v104
  v_sub_f32 v109, v77, v104
  v_mfma_f32_16x16x32_bf16 a[36:39], a[136:139], a[228:231], a[36:39]
  v_fmac_f32 v106, v108, v108
  v_fmac_f32 v107, v109, v109
  v_mfma_f32_16x16x32_bf16 a[36:39], a[140:143], a[244:247], a[36:39]
  ds_read_b64_tr_b16 a[132:133], v28 offset:8192
  ds_read_b64_tr_b16 a[134:135], v28 offset:9216
  v_mfma_f32_16x16x32_bf16 a[4:7], a[140:143], a[240:243], a[4:7]
  buffer_load_dwordx4 v9, s[12:15], s60 offen offset:3072 lds
  s_add_u32 m0, s3, 4096
  v_mfma_f32_16x16x32_bf16 a[4:7], a[136:139], a[224:227], a[4:7]
  s_waitcnt lgkmcnt(10)
  v_sub_f32 v108, v78, v104
  v_sub_f32 v109, v79, v104
  v_mfma_f32_16x16x32_bf16 a[8:11], a[144:147], a[224:227], a[8:11]
  s_waitcnt lgkmcnt(8)
  v_fmac_f32 v106, v108, v108
  v_fmac_f32 v107, v109, v109
  v_mfma_f32_16x16x32_bf16 a[8:11], a[148:151], a[240:243], a[8:11]
  s_add_u32 s60, s60, 128
  ds_read_b64_tr_b16 a[136:137], v29 offset:0
  ds_read_b64_tr_b16 a[138:139], v29 offset:1024
  v_mfma_f32_16x16x32_bf16 a[40:43], a[148:151], a[244:247], a[40:43]
  buffer_load_dwordx4 v6, s[12:15], s61 offen offset:0 lds
  v_mfma_f32_16x16x32_bf16 a[40:43], a[144:147], a[228:231], a[40:43]
  v_sub_f32 v108, v80, v104
  v_sub_f32 v109, v81, v104
  v_mfma_f32_16x16x32_bf16 a[72:75], a[144:147], a[232:235], a[72:75]
  v_fmac_f32 v106, v108, v108
  v_fmac_f32 v107, v109, v109
  v_mfma_f32_16x16x32_bf16 a[72:75], a[148:151], a[248:251], a[72:75]
  ds_read_b64_tr_b16 a[140:141], v29 offset:8192
  ds_read_b64_tr_b16 a[142:143], v29 offset:9216
  v_mfma_f32_16x16x32_bf16 a[104:107], a[148:151], a[252:255], a[104:107]
  buffer_load_dwordx4 v7, s[12:15], s61 offen offset:1024 lds
  v_mfma_f32_16x16x32_bf16 a[104:107], a[144:147], a[236:239], a[104:107]
  s_waitcnt lgkmcnt(10)
  v_sub_f32 v108, v82, v104
  v_sub_f32 v109, v83, v104
  v_mfma_f32_16x16x32_bf16 a[108:111], a[152:155], a[236:239], a[108:111]
  s_waitcnt lgkmcnt(8)
  v_fmac_f32 v106, v108, v108
  v_fmac_f32 v107, v109, v109
  v_mfma_f32_16x16x32_bf16 a[108:111], a[156:159], a[252:255], a[108:111]
  ds_read_b64_tr_b16 a[144:145], v30 offset:0
  ds_read_b64_tr_b16 a[146:147], v30 offset:1024
  v_mfma_f32_16x16x32_bf16 a[76:79], a[156:159], a[248:251], a[76:79]
  buffer_load_dwordx4 v8, s[12:15], s61 offen offset:2048 lds
  v_mfma_f32_16x16x32_bf16 a[76:79], a[152:155], a[232:235], a[76:79]
  v_sub_f32 v108, v84, v104
  v_sub_f32 v109, v85, v104
  v_mfma_f32_16x16x32_bf16 a[44:47], a[152:155], a[228:231], a[44:47]
  v_fmac_f32 v106, v108, v108
  v_fmac_f32 v107, v109, v109
  v_mfma_f32_16x16x32_bf16 a[44:47], a[156:159], a[244:247], a[44:47]
  buffer_load_dwordx4 v9, s[12:15], s61 offen offset:3072 lds
  v_mfma_f32_16x16x32_bf16 a[12:15], a[156:159], a[240:243], a[12:15]
  s_add_u32 s61, s61, 128
  ds_read_b64_tr_b16 a[148:149], v30 offset:8192
  ds_read_b64_tr_b16 a[150:151], v30 offset:9216
  v_mfma_f32_16x16x32_bf16 a[12:15], a[152:155], a[224:227], a[12:15]
  s_waitcnt lgkmcnt(10)
  v_sub_f32 v108, v86, v104
  v_sub_f32 v109, v87, v104
  v_mfma_f32_16x16x32_bf16 a[16:19], a[128:131], a[224:227], a[16:19]
  s_waitcnt lgkmcnt(8)
  v_fmac_f32 v106, v108, v108
  v_fmac_f32 v107, v109, v109
  v_mfma_f32_16x16x32_bf16 a[16:19], a[132:135], a[240:243], a[16:19]
  s_add_u32 m0, s85, 49152
  ds_read_b64_tr_b16 a[152:153], v31 offset:0
  ds_read_b64_tr_b16 a[154:155], v31 offset:1024
  v_mfma_f32_16x16x32_bf16 a[48:51], a[132:135], a[244:247], a[48:51]
  v_sub_f32 v108, v88, v104
  v_sub_f32 v109, v89, v104
  v_mfma_f32_16x16x32_bf16 a[48:51], a[128:131], a[228:231], a[48:51]
  v_fmac_f32 v106, v108, v108
  v_fmac_f32 v107, v109, v109
  v_mfma_f32_16x16x32_bf16 a[80:83], a[128:131], a[232:235], a[80:83]
  v_sub_f32 v108, v90, v104
  v_sub_f32 v109, v91, v104
  v_mfma_f32_16x16x32_bf16 a[80:83], a[132:135], a[248:251], a[80:83]
  ds_read_b64_tr_b16 a[156:157], v31 offset:8192
  ds_read_b64_tr_b16 a[158:159], v31 offset:9216
  v_mfma_f32_16x16x32_bf16 a[112:115], a[132:135], a[252:255], a[112:115]
  s_waitcnt lgkmcnt(10)
  v_fmac_f32 v106, v108, v108
  v_fmac_f32 v107, v109, v109
  v_mfma_f32_16x16x32_bf16 a[112:115], a[128:131], a[236:239], a[112:115]
  s_barrier
  v_sub_f32 v108, v92, v104
  v_sub_f32 v109, v93, v104
  v_mfma_f32_16x16x32_bf16 a[116:119], a[136:139], a[236:239], a[116:119]
  s_waitcnt lgkmcnt(8)
  buffer_load_dwordx4 v2, s[20:23], s84 offen offset:0 lds
  v_mfma_f32_16x16x32_bf16 a[116:119], a[140:143], a[252:255], a[116:119]
  ds_read_b64_tr_b16 a[128:129], v24 offset:16384
  ds_read_b64_tr_b16 a[130:131], v24 offset:17408
  v_mfma_f32_16x16x32_bf16 a[84:87], a[140:143], a[248:251], a[84:87]
  v_fmac_f32 v106, v108, v108
  v_fmac_f32 v107, v109, v109
  v_mfma_f32_16x16x32_bf16 a[84:87], a[136:139], a[232:235], a[84:87]
  buffer_load_dwordx4 v3, s[20:23], s84 offen offset:1024 lds
  v_mfma_f32_16x16x32_bf16 a[52:55], a[136:139], a[228:231], a[52:55]
  v_sub_f32 v108, v94, v104
  v_sub_f32 v109, v95, v104
  v_mfma_f32_16x16x32_bf16 a[52:55], a[140:143], a[244:247], a[52:55]
  ds_read_b64_tr_b16 a[132:133], v24 offset:24576
  ds_read_b64_tr_b16 a[134:135], v24 offset:25600
  v_mfma_f32_16x16x32_bf16 a[20:23], a[140:143], a[240:243], a[20:23]
  buffer_load_dwordx4 v4, s[20:23], s84 offen offset:2048 lds
  v_mfma_f32_16x16x32_bf16 a[20:23], a[136:139], a[224:227], a[20:23]
  s_waitcnt lgkmcnt(10)
  v_fmac_f32 v106, v108, v108
  v_fmac_f32 v107, v109, v109
  v_mfma_f32_16x16x32_bf16 a[24:27], a[144:147], a[224:227], a[24:27]
  s_waitcnt lgkmcnt(8)
  v_sub_f32 v108, v96, v104
  v_sub_f32 v109, v97, v104
  v_mfma_f32_16x16x32_bf16 a[24:27], a[148:151], a[240:243], a[24:27]
  ds_read_b64_tr_b16 a[136:137], v25 offset:16384
  ds_read_b64_tr_b16 a[138:139], v25 offset:17408
  v_mfma_f32_16x16x32_bf16 a[56:59], a[148:151], a[244:247], a[56:59]
  buffer_load_dwordx4 v5, s[20:23], s84 offen offset:3072 lds
  v_mfma_f32_16x16x32_bf16 a[56:59], a[144:147], a[228:231], a[56:59]
  s_add_u32 s84, s84, 524288
  v_fmac_f32 v106, v108, v108
  v_fmac_f32 v107, v109, v109
  v_mfma_f32_16x16x32_bf16 a[88:91], a[144:147], a[232:235], a[88:91]
  s_add_u32 m0, s85, 65536
  v_sub_f32 v108, v98, v104
  v_sub_f32 v109, v99, v104
  v_mfma_f32_16x16x32_bf16 a[88:91], a[148:151], a[248:251], a[88:91]
  ds_read_b64_tr_b16 a[140:141], v25 offset:24576
  ds_read_b64_tr_b16 a[142:143], v25 offset:25600
  v_mfma_f32_16x16x32_bf16 a[120:123], a[148:151], a[252:255], a[120:123]
  v_fmac_f32 v106, v108, v108
  v_fmac_f32 v107, v109, v109
  v_mfma_f32_16x16x32_bf16 a[120:123], a[144:147], a[236:239], a[120:123]
  s_waitcnt lgkmcnt(10)
  v_sub_f32 v108, v100, v104
  v_sub_f32 v109, v101, v104
  v_mfma_f32_16x16x32_bf16 a[124:127], a[152:155], a[236:239], a[124:127]
  s_waitcnt lgkmcnt(8)
  v_fmac_f32 v106, v108, v108
  v_fmac_f32 v107, v109, v109
  v_mfma_f32_16x16x32_bf16 a[124:127], a[156:159], a[252:255], a[124:127]
  ds_read_b64_tr_b16 a[144:145], v26 offset:16384
  ds_read_b64_tr_b16 a[146:147], v26 offset:17408
  v_mfma_f32_16x16x32_bf16 a[92:95], a[156:159], a[248:251], a[92:95]
  v_sub_f32 v108, v102, v104
  v_sub_f32 v109, v103, v104
  v_mfma_f32_16x16x32_bf16 a[92:95], a[152:155], a[232:235], a[92:95]
  v_fmac_f32 v106, v108, v108
  v_fmac_f32 v107, v109, v109
  v_mfma_f32_16x16x32_bf16 a[60:63], a[152:155], a[228:231], a[60:63]
  v_add_f32 v106, v106, v107
  v_mfma_f32_16x16x32_bf16 a[60:63], a[156:159], a[244:247], a[60:63]
  ds_read_b64_tr_b16 a[148:149], v26 offset:24576
  ds_read_b64_tr_b16 a[150:151], v26 offset:25600
  v_mfma_f32_16x16x32_bf16 a[28:31], a[156:159], a[240:243], a[28:31]
  v_add_f32_dpp v106, v106, v106 row_ror:1 row_mask:0xf bank_mask:0xf
  v_mfma_f32_16x16x32_bf16 a[28:31], a[152:155], a[224:227], a[28:31]
  s_waitcnt lgkmcnt(10)
  v_add_f32_dpp v106, v106, v106 row_ror:2 row_mask:0xf bank_mask:0xf
  v_mfma_f32_16x16x32_bf16 v[128:131], a[224:227], a[128:131], v[128:131]
  s_waitcnt lgkmcnt(8)
  v_add_f32_dpp v106, v106, v106 row_ror:4 row_mask:0xf bank_mask:0xf
  v_mfma_f32_16x16x32_bf16 v[128:131], a[240:243], a[132:135], v[128:131]
  ds_read_b64_tr_b16 a[152:153], v27 offset:16384
  ds_read_b64_tr_b16 a[154:155], v27 offset:17408
  v_mfma_f32_16x16x32_bf16 v[132:135], a[244:247], a[132:135], v[132:135]
  s_waitcnt vmcnt(20)
  v_add_f32_dpp v106, v106, v106 row_ror:8 row_mask:0xf bank_mask:0xf
  v_mul_f32 v106, 0x3acccccd, v106
  v_mfma_f32_16x16x32_bf16 v[132:135], a[228:231], a[128:131], v[132:135]
  ds_read_b128 a[160:163], v12 offset:8192
  v_cvt_pk_bf16_f32 v106, v106, v106
  v_mfma_f32_16x16x32_bf16 v[136:139], a[232:235], a[128:131], v[136:139]
  v_and_b32 v106, 0xffff0000, v106
  v_add_f32 v106, 0x3727c5ac, v106
  v_mfma_f32_16x16x32_bf16 v[136:139], a[248:251], a[132:135], v[136:139]
  ds_read_b64_tr_b16 a[156:157], v27 offset:24576
  ds_read_b64_tr_b16 a[158:159], v27 offset:25600
  v_mfma_f32_16x16x32_bf16 v[140:143], a[252:255], a[132:135], v[140:143]
  v_cvt_pk_bf16_f32 v106, v106, v106
  v_and_b32 v106, 0xffff0000, v106
  v_mfma_f32_16x16x32_bf16 v[140:143], a[236:239], a[128:131], v[140:143]
  s_waitcnt lgkmcnt(11)
  ds_read_b128 a[164:167], v12 offset:10240
  v_mfma_f32_16x16x32_bf16 v[156:159], a[236:239], a[136:139], v[156:159]
  s_waitcnt lgkmcnt(10)
  v_sqrt_f32 v106, v106
  v_mfma_f32_16x16x32_bf16 v[156:159], a[252:255], a[140:143], v[156:159]
  ds_read_b64_tr_b16 a[128:129], v28 offset:16384
  ds_read_b64_tr_b16 a[130:131], v28 offset:17408
  v_mfma_f32_16x16x32_bf16 v[152:155], a[248:251], a[140:143], v[152:155]
  v_cvt_pk_bf16_f32 v106, v106, v106
  v_and_b32 v106, 0xffff0000, v106
  v_mfma_f32_16x16x32_bf16 v[152:155], a[232:235], a[136:139], v[152:155]
  ds_read_b128 a[168:171], v12 offset:12288
  v_mfma_f32_16x16x32_bf16 v[148:151], a[228:231], a[136:139], v[148:151]
  v_rcp_f32 v106, v106
  v_mfma_f32_16x16x32_bf16 v[148:151], a[244:247], a[140:143], v[148:151]
  ds_read_b64_tr_b16 a[132:133], v28 offset:24576
  ds_read_b64_tr_b16 a[134:135], v28 offset:25600
  v_mfma_f32_16x16x32_bf16 v[144:147], a[240:243], a[140:143], v[144:147]
  v_cvt_pk_bf16_f32 v104, v104, v104
  v_and_b32 v104, 0xffff0000, v104
  v_mfma_f32_16x16x32_bf16 v[144:147], a[224:227], a[136:139], v[144:147]
  s_waitcnt lgkmcnt(13)
  ds_read_b128 a[172:175], v12 offset:14336
  v_mul_f32 v106, 0x3e0293ee, v106
  v_mfma_f32_16x16x32_bf16 v[160:163], a[224:227], a[144:147], v[160:163]
  s_waitcnt lgkmcnt(12)
  v_and_b32 v108, 3, v14
  v_lshrrev_b32 v109, 2, v14
  v_mfma_f32_16x16x32_bf16 v[160:163], a[240:243], a[148:151], v[160:163]
  ds_read_b64_tr_b16 a[136:137], v29 offset:16384
  ds_read_b64_tr_b16 a[138:139], v29 offset:17408
  v_mfma_f32_16x16x32_bf16 v[164:167], a[244:247], a[148:151], v[164:167]
  v_lshl_add_u32 v108, v108, 4, v109
  v_lshlrev_b32 v108, 2, v108
  v_mfma_f32_16x16x32_bf16 v[164:167], a[228:231], a[144:147], v[164:167]
  ds_read_b128 a[176:179], v13 offset:8192
  v_sub_f32 v64, v64, v104
  v_mfma_f32_16x16x32_bf16 v[168:171], a[232:235], a[144:147], v[168:171]
  v_sub_f32 v65, v65, v104
  v_mul_f32 v64, v64, v106
  v_mfma_f32_16x16x32_bf16 v[168:171], a[248:251], a[148:151], v[168:171]
  ds_read_b64_tr_b16 a[140:141], v29 offset:24576
  ds_read_b64_tr_b16 a[142:143], v29 offset:25600
  v_mfma_f32_16x16x32_bf16 v[172:175], a[252:255], a[148:151], v[172:175]
  v_mul_f32 v65, v65, v106
  v_cvt_pk_bf16_f32 v88, v64, v65
  v_mfma_f32_16x16x32_bf16 v[172:175], a[236:239], a[144:147], v[172:175]
  s_waitcnt lgkmcnt(15)
  ds_read_b128 a[180:183], v13 offset:10240
  v_sub_f32 v66, v66, v104
  v_mfma_f32_16x16x32_bf16 v[188:191], a[236:239], a[152:155], v[188:191]
  s_waitcnt lgkmcnt(13)
  v_sub_f32 v67, v67, v104
  v_mul_f32 v66, v66, v106
  v_mfma_f32_16x16x32_bf16 v[188:191], a[252:255], a[156:159], v[188:191]
  ds_read_b64_tr_b16 a[144:145], v30 offset:16384
  ds_read_b64_tr_b16 a[146:147], v30 offset:17408
  v_mfma_f32_16x16x32_bf16 v[184:187], a[248:251], a[156:159], v[184:187]
  v_mul_f32 v67, v67, v106
  v_cvt_pk_bf16_f32 v89, v66, v67
  v_mfma_f32_16x16x32_bf16 v[184:187], a[232:235], a[152:155], v[184:187]
  ds_read_b128 a[184:187], v13 offset:12288
  v_sub_f32 v68, v68, v104
  v_mfma_f32_16x16x32_bf16 v[180:183], a[228:231], a[152:155], v[180:183]
  v_sub_f32 v69, v69, v104
  v_mul_f32 v68, v68, v106
  v_mfma_f32_16x16x32_bf16 v[180:183], a[244:247], a[156:159], v[180:183]
  ds_read_b64_tr_b16 a[148:149], v30 offset:24576
  ds_read_b64_tr_b16 a[150:151], v30 offset:25600
  v_mfma_f32_16x16x32_bf16 v[176:179], a[240:243], a[156:159], v[176:179]
  v_mul_f32 v69, v69, v106
  v_cvt_pk_bf16_f32 v90, v68, v69
  v_mfma_f32_16x16x32_bf16 v[176:179], a[224:227], a[152:155], v[176:179]
  s_waitcnt lgkmcnt(15)
  ds_read_b128 a[188:191], v13 offset:14336
  v_sub_f32 v70, v70, v104
  v_mfma_f32_16x16x32_bf16 v[192:195], a[224:227], a[128:131], v[192:195]
  s_waitcnt lgkmcnt(13)
  v_sub_f32 v71, v71, v104
  v_mul_f32 v70, v70, v106
  v_mfma_f32_16x16x32_bf16 v[192:195], a[240:243], a[132:135], v[192:195]
  ds_read_b64_tr_b16 a[152:153], v31 offset:16384
  ds_read_b64_tr_b16 a[154:155], v31 offset:17408
  v_mfma_f32_16x16x32_bf16 v[196:199], a[244:247], a[132:135], v[196:199]
  v_mul_f32 v71, v71, v106
  v_cvt_pk_bf16_f32 v91, v70, v71
  v_mfma_f32_16x16x32_bf16 v[196:199], a[228:231], a[128:131], v[196:199]
  v_sub_f32 v72, v72, v104
  v_sub_f32 v73, v73, v104
  v_mfma_f32_16x16x32_bf16 v[200:203], a[232:235], a[128:131], v[200:203]
  v_mul_f32 v72, v72, v106
  v_mul_f32 v73, v73, v106
  v_mfma_f32_16x16x32_bf16 v[200:203], a[248:251], a[132:135], v[200:203]
  ds_read_b64_tr_b16 a[156:157], v31 offset:24576
  ds_read_b64_tr_b16 a[158:159], v31 offset:25600
  v_mfma_f32_16x16x32_bf16 v[204:207], a[252:255], a[132:135], v[204:207]
  s_waitcnt lgkmcnt(14)
  v_cvt_pk_bf16_f32 v92, v72, v73
  v_sub_f32 v74, v74, v104
  v_mfma_f32_16x16x32_bf16 v[204:207], a[236:239], a[128:131], v[204:207]
  s_barrier
  v_sub_f32 v75, v75, v104
  v_mul_f32 v74, v74, v106
  v_mfma_f32_16x16x32_bf16 v[220:223], a[236:239], a[136:139], v[220:223]
  s_waitcnt lgkmcnt(11)
  buffer_load_dwordx4 v2, s[8:11], s84 offen offset:0 lds
  v_mfma_f32_16x16x32_bf16 v[220:223], a[252:255], a[140:143], v[220:223]
  ds_read_b64_tr_b16 a[128:129], v16 offset:0
  ds_read_b64_tr_b16 a[130:131], v16 offset:1024
  v_mfma_f32_16x16x32_bf16 v[216:219], a[248:251], a[140:143], v[216:219]
  v_mul_f32 v75, v75, v106
  v_cvt_pk_bf16_f32 v93, v74, v75
  v_mfma_f32_16x16x32_bf16 v[216:219], a[232:235], a[136:139], v[216:219]
  buffer_load_dwordx4 v3, s[8:11], s84 offen offset:1024 lds
  v_mfma_f32_16x16x32_bf16 v[212:215], a[228:231], a[136:139], v[212:215]
  v_sub_f32 v76, v76, v104
  v_sub_f32 v77, v77, v104
  v_mfma_f32_16x16x32_bf16 v[212:215], a[244:247], a[140:143], v[212:215]
  ds_read_b64_tr_b16 a[132:133], v16 offset:8192
  ds_read_b64_tr_b16 a[134:135], v16 offset:9216
  v_mfma_f32_16x16x32_bf16 v[208:211], a[240:243], a[140:143], v[208:211]
  buffer_load_dwordx4 v4, s[8:11], s84 offen offset:2048 lds
  v_mfma_f32_16x16x32_bf16 v[208:211], a[224:227], a[136:139], v[208:211]
  s_waitcnt lgkmcnt(12)
  v_mul_f32 v76, v76, v106
  v_mul_f32 v77, v77, v106
  v_mfma_f32_16x16x32_bf16 v[224:227], a[224:227], a[144:147], v[224:227]
  s_waitcnt lgkmcnt(9)
  v_cvt_pk_bf16_f32 v94, v76, v77
  v_sub_f32 v78, v78, v104
  v_mfma_f32_16x16x32_bf16 v[224:227], a[240:243], a[148:151], v[224:227]
  ds_read_b64_tr_b16 a[136:137], v17 offset:0
  ds_read_b64_tr_b16 a[138:139], v17 offset:1024
  v_mfma_f32_16x16x32_bf16 v[228:231], a[244:247], a[148:151], v[228:231]
  buffer_load_dwordx4 v5, s[8:11], s84 offen offset:3072 lds
  v_mfma_f32_16x16x32_bf16 v[228:231], a[228:231], a[144:147], v[228:231]
  s_add_u32 m0, s3, 8192
  v_sub_f32 v79, v79, v104
  v_mul_f32 v78, v78, v106
  v_mfma_f32_16x16x32_bf16 v[232:235], a[232:235], a[144:147], v[232:235]
  v_mul_f32 v79, v79, v106
  v_cvt_pk_bf16_f32 v95, v78, v79
  v_mfma_f32_16x16x32_bf16 v[232:235], a[248:251], a[148:151], v[232:235]
  ds_read_b64_tr_b16 a[140:141], v17 offset:8192
  ds_read_b64_tr_b16 a[142:143], v17 offset:9216
  v_mfma_f32_16x16x32_bf16 v[236:239], a[252:255], a[148:151], v[236:239]
  v_sub_f32 v80, v80, v104
  v_sub_f32 v81, v81, v104
  v_mfma_f32_16x16x32_bf16 v[236:239], a[236:239], a[144:147], v[236:239]
  s_waitcnt lgkmcnt(10)
  v_mul_f32 v80, v80, v106
  v_mul_f32 v81, v81, v106
  v_mfma_f32_16x16x32_bf16 v[252:255], a[236:239], a[152:155], v[252:255]
  s_waitcnt lgkmcnt(8)
  v_cvt_pk_bf16_f32 v96, v80, v81
  v_sub_f32 v82, v82, v104
  v_mfma_f32_16x16x32_bf16 v[252:255], a[252:255], a[156:159], v[252:255]
  ds_read_b64_tr_b16 a[144:145], v18 offset:0
  ds_read_b64_tr_b16 a[146:147], v18 offset:1024
  v_mfma_f32_16x16x32_bf16 v[248:251], a[248:251], a[156:159], v[248:251]
  v_sub_f32 v83, v83, v104
  v_mul_f32 v82, v82, v106
  v_mfma_f32_16x16x32_bf16 v[248:251], a[232:235], a[152:155], v[248:251]
  v_mul_f32 v83, v83, v106
  v_cvt_pk_bf16_f32 v97, v82, v83
  v_mfma_f32_16x16x32_bf16 v[244:247], a[228:231], a[152:155], v[244:247]
  v_sub_f32 v84, v84, v104
  v_sub_f32 v85, v85, v104
  v_mfma_f32_16x16x32_bf16 v[244:247], a[244:247], a[156:159], v[244:247]
  ds_read_b64_tr_b16 a[148:149], v18 offset:8192
  ds_read_b64_tr_b16 a[150:151], v18 offset:9216
  v_mfma_f32_16x16x32_bf16 v[240:243], a[240:243], a[156:159], v[240:243]
  v_mul_f32 v84, v84, v106
  v_mul_f32 v85, v85, v106
  v_mfma_f32_16x16x32_bf16 v[240:243], a[224:227], a[152:155], v[240:243]
  s_waitcnt lgkmcnt(10)
  v_cvt_pk_bf16_f32 v98, v84, v85
  v_sub_f32 v86, v86, v104
  v_mfma_f32_16x16x32_bf16 a[0:3], a[128:131], a[160:163], a[0:3]
  s_waitcnt lgkmcnt(8)
  v_sub_f32 v87, v87, v104
  v_mul_f32 v86, v86, v106
  v_mfma_f32_16x16x32_bf16 a[0:3], a[132:135], a[176:179], a[0:3]
L_padA1:
  s_cbranch_execz L_padA5
  ds_read_b64_tr_b16 a[152:153], v19 offset:0
  ds_read_b64_tr_b16 a[154:155], v19 offset:1024
  v_mfma_f32_16x16x32_bf16 a[32:35], a[132:135], a[180:183], a[32:35]
  buffer_load_dwordx4 v6, s[12:15], s60 offen offset:0 lds
  v_mfma_f32_16x16x32_bf16 a[32:35], a[128:131], a[164:167], a[32:35]
  v_mul_f32 v87, v87, v106
  v_cvt_pk_bf16_f32 v99, v86, v87
  v_mfma_f32_16x16x32_bf16 a[64:67], a[128:131], a[168:171], a[64:67]
  s_lshl2_add_u32 s81, s78, s76
  ds_bpermute_b32 v88, v108, v88
  s_lshl_b32 s82, s77, 5
  v_mfma_f32_16x16x32_bf16 a[64:67], a[132:135], a[184:187], a[64:67]
  s_add_u32 s81, s81, s82
  ds_read_b64_tr_b16 a[156:157], v19 offset:8192
  ds_read_b64_tr_b16 a[158:159], v19 offset:9216
  v_mfma_f32_16x16x32_bf16 a[96:99], a[132:135], a[188:191], a[96:99]
  s_waitcnt lgkmcnt(11)
  buffer_load_dwordx4 v7, s[12:15], s60 offen offset:1024 lds
  v_mfma_f32_16x16x32_bf16 a[96:99], a[128:131], a[172:175], a[96:99]
  s_lshl_b32 s81, s81, 6
  ds_bpermute_b32 v89, v108, v89
  v_mov_b32 v0, s81
  v_mfma_f32_16x16x32_bf16 a[100:103], a[136:139], a[172:175], a[100:103]
  s_mul_i32 s82, s77, 37
  ds_bpermute_b32 v90, v108, v90
  s_lshr_b32 s82, s82, 8
  s_waitcnt lgkmcnt(11)
  v_mfma_f32_16x16x32_bf16 a[100:103], a[140:143], a[188:191], a[100:103]
  s_mul_i32 s83, s82, 7
  ds_read_b64_tr_b16 a[128:129], v20 offset:0
  ds_read_b64_tr_b16 a[130:131], v20 offset:1024
  v_mfma_f32_16x16x32_bf16 a[68:71], a[140:143], a[184:187], a[68:71]
  buffer_load_dwordx4 v8, s[12:15], s60 offen offset:2048 lds
  v_mfma_f32_16x16x32_bf16 a[68:71], a[136:139], a[168:171], a[68:71]
  s_sub_u32 s83, s77, s83
  ds_bpermute_b32 v91, v108, v91
  s_lshl2_add_u32 s81, s78, s82
  v_mfma_f32_16x16x32_bf16 a[36:39], a[136:139], a[164:167], a[36:39]
  s_lshl3_add_u32 s81, s81, s83
  ds_bpermute_b32 v92, v108, v92
  s_lshl2_add_u32 s81, s81, s76
  v_mfma_f32_16x16x32_bf16 a[36:39], a[140:143], a[180:183], a[36:39]
  s_lshl_b32 s81, s81, 6
  ds_read_b64_tr_b16 a[132:133], v20 offset:8192
  ds_read_b64_tr_b16 a[134:135], v20 offset:9216
  v_mfma_f32_16x16x32_bf16 a[4:7], a[140:143], a[176:179], a[4:7]
  s_waitcnt lgkmcnt(15)
  buffer_load_dwordx4 v9, s[12:15], s60 offen offset:3072 lds
  v_mfma_f32_16x16x32_bf16 a[4:7], a[136:139], a[160:163], a[4:7]
  s_add_u32 s81, s81, 65536
  ds_bpermute_b32 v93, v108, v93
  v_mfma_f32_16x16x32_bf16 a[8:11], a[144:147], a[160:163], a[8:11]
  s_cmp_lt_u32 s77, 27
  s_cselect_b32 s81, s81, 2146435072
  ds_bpermute_b32 v94, v108, v94
  s_waitcnt lgkmcnt(15)
  v_mfma_f32_16x16x32_bf16 a[8:11], a[148:151], a[176:179], a[8:11]
  s_waitcnt lgkmcnt(5)
  buffer_store_dwordx4 v[88:91], v110, s[44:47], s88 offen sc1
  v_mfma_f32_16x16x32_bf16 a[40:43], a[148:151], a[180:183], a[40:43]
  s_add_u32 s60, s60, 128
  ds_read_b64_tr_b16 a[136:137], v21 offset:0
  ds_read_b64_tr_b16 a[138:139], v21 offset:1024
  v_mfma_f32_16x16x32_bf16 a[40:43], a[144:147], a[164:167], a[40:43]
  s_add_u32 m0, s3, 12288
  ds_bpermute_b32 v95, v108, v95
  v_cmp_lt_u32 vcc, 15, v14
  v_mfma_f32_16x16x32_bf16 a[72:75], a[144:147], a[168:171], a[72:75]
  buffer_load_dwordx4 v6, s[12:15], s61 offen offset:0 lds
  v_mfma_f32_16x16x32_bf16 a[72:75], a[148:151], a[184:187], a[72:75]
  ds_read_b64_tr_b16 a[140:141], v21 offset:8192
  ds_read_b64_tr_b16 a[142:143], v21 offset:9216
  v_mfma_f32_16x16x32_bf16 a[104:107], a[148:151], a[188:191], a[104:107]
  ds_bpermute_b32 v96, v108, v96
  v_mov_b32 v56, s81
  v_mfma_f32_16x16x32_bf16 a[104:107], a[144:147], a[172:175], a[104:107]
  buffer_load_dwordx4 v7, s[12:15], s61 offen offset:1024 lds
  v_mfma_f32_16x16x32_bf16 a[108:111], a[152:155], a[172:175], a[108:111]
  s_lshl_b32 s81, s78, 5
  ds_bpermute_b32 v97, v108, v97
  s_add_u32 s81, s81, s77
  v_mfma_f32_16x16x32_bf16 a[108:111], a[156:159], a[188:191], a[108:111]
  ds_read_b64_tr_b16 a[144:145], v22 offset:0
  ds_read_b64_tr_b16 a[146:147], v22 offset:1024
  v_mfma_f32_16x16x32_bf16 a[76:79], a[156:159], a[184:187], a[76:79]
  s_waitcnt lgkmcnt(6)
  buffer_store_dwordx4 v[92:95], v111, s[44:47], s88 offen sc1
  v_mfma_f32_16x16x32_bf16 a[76:79], a[152:155], a[168:171], a[76:79]
  ds_bpermute_b32 v98, v108, v98
  v_cndmask_b32 v0, v0, v56, vcc
  v_mfma_f32_16x16x32_bf16 a[44:47], a[152:155], a[164:167], a[44:47]
  s_lshl2_add_u32 s81, s81, s76
  ds_bpermute_b32 v99, v108, v99
  s_lshl_b32 s81, s81, 6
  v_mfma_f32_16x16x32_bf16 a[44:47], a[156:159], a[180:183], a[44:47]
  buffer_load_dwordx4 v8, s[12:15], s61 offen offset:2048 lds
  v_mfma_f32_16x16x32_bf16 a[12:15], a[156:159], a[176:179], a[12:15]
  ds_read_b64_tr_b16 a[148:149], v22 offset:8192
  ds_read_b64_tr_b16 a[150:151], v22 offset:9216
  v_mfma_f32_16x16x32_bf16 a[12:15], a[152:155], a[160:163], a[12:15]
  s_add_u32 s81, s81, 131072
  v_cmp_lt_u32 vcc, 31, v14
  v_mov_b32 v56, s81
  v_mfma_f32_16x16x32_bf16 a[16:19], a[128:131], a[160:163], a[16:19]
  buffer_load_dwordx4 v9, s[12:15], s61 offen offset:3072 lds
  s_add_u32 m0, s85, 81920
  v_mfma_f32_16x16x32_bf16 a[16:19], a[132:135], a[176:179], a[16:19]
  s_and_b32 s81, s2, 15
  ds_read_b64_tr_b16 a[152:153], v23 offset:0
  ds_read_b64_tr_b16 a[154:155], v23 offset:1024
  v_mfma_f32_16x16x32_bf16 a[48:51], a[132:135], a[180:183], a[48:51]
  s_add_u32 s61, s61, 128
  s_lshr_b32 s82, s2, 4
  v_cndmask_b32 v0, v0, v56, vcc
  v_mfma_f32_16x16x32_bf16 a[48:51], a[128:131], a[164:167], a[48:51]
  s_waitcnt lgkmcnt(4)
  buffer_store_dwordx4 v[96:99], v126, s[44:47], s88 offen sc1
  v_mfma_f32_16x16x32_bf16 a[80:83], a[128:131], a[168:171], a[80:83]
  s_lshl4_add_u32 s81, s81, s82
  s_lshl2_add_u32 s81, s81, s76
  s_lshl_b32 s81, s81, 6
  v_mfma_f32_16x16x32_bf16 a[80:83], a[132:135], a[184:187], a[80:83]
  s_add_u32 s81, s81, 196608
  ds_read_b64_tr_b16 a[156:157], v23 offset:8192
  ds_read_b64_tr_b16 a[158:159], v23 offset:9216
  v_mfma_f32_16x16x32_bf16 a[112:115], a[132:135], a[188:191], a[112:115]
  s_waitcnt vmcnt(31)
  v_cmp_lt_u32 vcc, 47, v14
  v_mov_b32 v56, s81
  v_mfma_f32_16x16x32_bf16 a[112:115], a[128:131], a[172:175], a[112:115]
  s_barrier
  v_and_b32 v58, 15, v14
  v_cndmask_b32 v0, v0, v56, vcc
  v_mfma_f32_16x16x32_bf16 a[116:119], a[136:139], a[172:175], a[116:119]
  buffer_load_dwordx4 v2, s[20:23], s84 offen offset:0 lds
  v_mfma_f32_16x16x32_bf16 a[116:119], a[140:143], a[188:191], a[116:119]
  ds_read_b64_tr_b16 a[128:129], v16 offset:16384
  ds_read_b64_tr_b16 a[130:131], v16 offset:17408
  v_mfma_f32_16x16x32_bf16 a[84:87], a[140:143], a[184:187], a[84:87]
  v_lshl_add_u32 v0, v58, 2, v0
  s_mov_b64 s[28:29], s[64:65]
  v_mfma_f32_16x16x32_bf16 a[84:87], a[136:139], a[168:171], a[84:87]
  buffer_load_dwordx4 v3, s[20:23], s84 offen offset:1024 lds
  v_mfma_f32_16x16x32_bf16 a[52:55], a[136:139], a[164:167], a[52:55]
  s_mov_b32 s30, 3456
  s_mov_b32 s31, 0x20000
  v_lshrrev_b32 v56, 4, v14
  v_mfma_f32_16x16x32_bf16 a[52:55], a[140:143], a[180:183], a[52:55]
  ds_read_b64_tr_b16 a[132:133], v16 offset:24576
  ds_read_b64_tr_b16 a[134:135], v16 offset:25600
  v_mfma_f32_16x16x32_bf16 a[20:23], a[140:143], a[176:179], a[20:23]
  buffer_load_dwordx4 v4, s[20:23], s84 offen offset:2048 lds
  v_mfma_f32_16x16x32_bf16 a[20:23], a[136:139], a[160:163], a[20:23]
  v_lshlrev_b32 v56, 3, v56
  s_lshl_b32 s81, s77, 7
  v_mfma_f32_16x16x32_bf16 a[24:27], a[144:147], a[160:163], a[24:27]
  s_waitcnt lgkmcnt(8)
  v_mfma_f32_16x16x32_bf16 a[24:27], a[148:151], a[176:179], a[24:27]
  ds_read_b64_tr_b16 a[136:137], v17 offset:16384
  ds_read_b64_tr_b16 a[138:139], v17 offset:17408
  v_mfma_f32_16x16x32_bf16 a[56:59], a[148:151], a[180:183], a[56:59]
  buffer_load_dwordx4 v5, s[20:23], s84 offen offset:3072 lds
  v_mfma_f32_16x16x32_bf16 a[56:59], a[144:147], a[164:167], a[56:59]
  s_add_u32 s84, s84, 524288
  v_mfma_f32_16x16x32_bf16 a[88:91], a[144:147], a[168:171], a[88:91]
  s_add_u32 m0, s85, 0
  v_mfma_f32_16x16x32_bf16 a[88:91], a[148:151], a[184:187], a[88:91]
  ds_read_b64_tr_b16 a[140:141], v17 offset:24576
  ds_read_b64_tr_b16 a[142:143], v17 offset:25600
  v_mfma_f32_16x16x32_bf16 a[120:123], a[148:151], a[188:191], a[120:123]
  buffer_load_dwordx2 v[42:43], v56, s[28:31], s81 offen offset:0
  v_mfma_f32_16x16x32_bf16 a[120:123], a[144:147], a[172:175], a[120:123]
  s_waitcnt lgkmcnt(10)
  v_mfma_f32_16x16x32_bf16 a[124:127], a[152:155], a[172:175], a[124:127]
  s_waitcnt lgkmcnt(8)
  v_mfma_f32_16x16x32_bf16 a[124:127], a[156:159], a[188:191], a[124:127]
  ds_read_b64_tr_b16 a[144:145], v18 offset:16384
  ds_read_b64_tr_b16 a[146:147], v18 offset:17408
  v_mfma_f32_16x16x32_bf16 a[92:95], a[156:159], a[184:187], a[92:95]
  buffer_load_dwordx2 v[46:47], v56, s[28:31], s81 offen offset:32
  v_mfma_f32_16x16x32_bf16 a[92:95], a[152:155], a[168:171], a[92:95]
  v_mfma_f32_16x16x32_bf16 a[60:63], a[152:155], a[164:167], a[60:63]
  v_mfma_f32_16x16x32_bf16 a[60:63], a[156:159], a[180:183], a[60:63]
  ds_read_b64_tr_b16 a[148:149], v18 offset:24576
  ds_read_b64_tr_b16 a[150:151], v18 offset:25600
  v_mfma_f32_16x16x32_bf16 a[28:31], a[156:159], a[176:179], a[28:31]
  buffer_load_dwordx2 v[50:51], v56, s[28:31], s81 offen offset:64
  v_mfma_f32_16x16x32_bf16 a[28:31], a[152:155], a[160:163], a[28:31]
  s_waitcnt lgkmcnt(10)
  v_mfma_f32_16x16x32_bf16 v[128:131], a[160:163], a[128:131], v[128:131]
  s_waitcnt lgkmcnt(8)
  v_mfma_f32_16x16x32_bf16 v[128:131], a[176:179], a[132:135], v[128:131]
  ds_read_b64_tr_b16 a[152:153], v19 offset:16384
  ds_read_b64_tr_b16 a[154:155], v19 offset:17408
  v_mfma_f32_16x16x32_bf16 v[132:135], a[180:183], a[132:135], v[132:135]
  s_waitcnt vmcnt(26)
  buffer_load_dwordx2 v[54:55], v56, s[28:31], s81 offen offset:96
  v_mfma_f32_16x16x32_bf16 v[132:135], a[164:167], a[128:131], v[132:135]
  s_lshl3_add_u32 s81, s79, s76
  ds_read_b128 a[192:195], v12 offset:0
  s_mul_i32 s81, s81, 20480
  v_mfma_f32_16x16x32_bf16 v[136:139], a[168:171], a[128:131], v[136:139]
  v_add_u32 v10, s81, v1
  s_lshl3_add_u32 s81, s80, s76
  v_mfma_f32_16x16x32_bf16 v[136:139], a[184:187], a[132:135], v[136:139]
  s_mul_i32 s81, s81, 20480
  ds_read_b64_tr_b16 a[156:157], v19 offset:24576
  ds_read_b64_tr_b16 a[158:159], v19 offset:25600
  v_mfma_f32_16x16x32_bf16 v[140:143], a[188:191], a[132:135], v[140:143]
  s_waitcnt lgkmcnt(11)
  v_add_u32 v11, s81, v1
  s_lshl_b32 s73, s76, 1
  v_mfma_f32_16x16x32_bf16 v[140:143], a[172:175], a[128:131], v[140:143]
  s_sub_u32 s73, 7, s73
  ds_read_b128 a[196:199], v12 offset:2048
  s_mul_i32 s73, s73, 20480
  v_mfma_f32_16x16x32_bf16 v[156:159], a[172:175], a[136:139], v[156:159]
  s_mul_i32 s81, s77, 1081344
  s_add_u32 s4, s74, s81
  s_addc_u32 s5, s75, 0
  s_waitcnt lgkmcnt(10)
  v_mfma_f32_16x16x32_bf16 v[156:159], a[188:191], a[140:143], v[156:159]
  s_mov_b32 s6, 1081344
  ds_read_b64_tr_b16 a[128:129], v20 offset:16384
  ds_read_b64_tr_b16 a[130:131], v20 offset:17408
  v_mfma_f32_16x16x32_bf16 v[152:155], a[184:187], a[140:143], v[152:155]
  s_mov_b32 s7, 0x20000
  s_lshl2_add_u32 s81, s78, s76
  v_mfma_f32_16x16x32_bf16 v[152:155], a[168:171], a[136:139], v[152:155]
  s_lshl_b32 s81, s81, 15
  ds_read_b128 a[200:203], v12 offset:4096
  s_add_u32 s90, s81, 8192
  v_mfma_f32_16x16x32_bf16 v[148:151], a[164:167], a[136:139], v[148:151]
  s_add_u32 s91, s81, 24576
  s_add_u32 s92, s81, 32768
  s_add_u32 s93, s81, 49152
  v_mfma_f32_16x16x32_bf16 v[148:151], a[180:183], a[140:143], v[148:151]
  ds_read_b64_tr_b16 a[132:133], v20 offset:24576
  ds_read_b64_tr_b16 a[134:135], v20 offset:25600
  v_mfma_f32_16x16x32_bf16 v[144:147], a[176:179], a[140:143], v[144:147]
  v_and_b32 v56, 15, v14
  v_lshrrev_b32 v57, 4, v14
  v_mfma_f32_16x16x32_bf16 v[144:147], a[160:163], a[136:139], v[144:147]
  s_waitcnt lgkmcnt(13)
  ds_read_b128 a[204:207], v12 offset:6144
  v_lshrrev_b32 v58, 2, v56
  v_mfma_f32_16x16x32_bf16 v[160:163], a[160:163], a[144:147], v[160:163]
  s_waitcnt lgkmcnt(12)
  v_lshl_add_u32 v60, v57, 3, v58
  v_and_b32 v61, 3, v56
  v_mfma_f32_16x16x32_bf16 v[160:163], a[176:179], a[148:151], v[160:163]
  ds_read_b64_tr_b16 a[136:137], v21 offset:16384
  ds_read_b64_tr_b16 a[138:139], v21 offset:17408
  v_mfma_f32_16x16x32_bf16 v[164:167], a[180:183], a[148:151], v[164:167]
  v_lshlrev_b32 v61, 3, v61
  v_lshrrev_b32 v58, 3, v56
  v_mfma_f32_16x16x32_bf16 v[164:167], a[164:167], a[144:147], v[164:167]
  ds_read_b128 a[208:211], v13 offset:0
  v_and_b32 v59, 1, v57
  v_mfma_f32_16x16x32_bf16 v[168:171], a[168:171], a[144:147], v[168:171]
  v_lshl_or_b32 v59, v59, 1, v58
  v_lshl_add_u32 v60, v60, 7, v61
  v_mfma_f32_16x16x32_bf16 v[168:171], a[184:187], a[148:151], v[168:171]
  ds_read_b64_tr_b16 a[140:141], v21 offset:24576
  ds_read_b64_tr_b16 a[142:143], v21 offset:25600
  v_mfma_f32_16x16x32_bf16 v[172:175], a[188:191], a[148:151], v[172:175]
  v_add_u32 v60, 8192, v60
  v_lshl_add_u32 v32, v59, 5, v60
  v_mfma_f32_16x16x32_bf16 v[172:175], a[172:175], a[144:147], v[172:175]
  s_waitcnt lgkmcnt(15)
  ds_read_b128 a[212:215], v13 offset:2048
  v_xor_b32 v33, 32, v32
  v_mfma_f32_16x16x32_bf16 v[188:191], a[172:175], a[152:155], v[188:191]
  s_waitcnt lgkmcnt(13)
  v_xor_b32 v34, 64, v32
  v_xor_b32 v35, 96, v32
  v_mfma_f32_16x16x32_bf16 v[188:191], a[188:191], a[156:159], v[188:191]
  ds_read_b64_tr_b16 a[144:145], v22 offset:16384
  ds_read_b64_tr_b16 a[146:147], v22 offset:17408
  v_mfma_f32_16x16x32_bf16 v[184:187], a[184:187], a[156:159], v[184:187]
  v_add_u32 v36, 0x10000, v32
  v_add_u32 v37, 0x10000, v33
  v_mfma_f32_16x16x32_bf16 v[184:187], a[168:171], a[152:155], v[184:187]
  ds_read_b128 a[216:219], v13 offset:4096
  v_add_u32 v38, 0x10000, v34
  v_mfma_f32_16x16x32_bf16 v[180:183], a[164:167], a[152:155], v[180:183]
  v_add_u32 v39, 0x10000, v35
  s_and_b32 s81, s76, 1
  v_mfma_f32_16x16x32_bf16 v[180:183], a[180:183], a[156:159], v[180:183]
  s_lshl_b32 s81, s81, 7
  ds_read_b64_tr_b16 a[148:149], v22 offset:24576
  ds_read_b64_tr_b16 a[150:151], v22 offset:25600
  v_mfma_f32_16x16x32_bf16 v[176:179], a[176:179], a[156:159], v[176:179]
  v_xor_b32 v121, s81, v2
  v_add_u32 v122, 31744, v121
  v_mfma_f32_16x16x32_bf16 v[176:179], a[160:163], a[152:155], v[176:179]
  s_waitcnt lgkmcnt(15)
  ds_read_b128 a[220:223], v13 offset:6144
  v_lshrrev_b32 v56, 3, v14
  v_mfma_f32_16x16x32_bf16 v[192:195], a[160:163], a[128:131], v[192:195]
  s_waitcnt lgkmcnt(13)
  v_and_b32 v57, 7, v14
  v_bfe_u32 v58, v56, 1, 1
  v_mfma_f32_16x16x32_bf16 v[192:195], a[176:179], a[132:135], v[192:195]
  s_lshr_b32 s81, s81, 6
  ds_read_b64_tr_b16 a[152:153], v23 offset:16384
  ds_read_b64_tr_b16 a[154:155], v23 offset:17408
  v_mfma_f32_16x16x32_bf16 v[196:199], a[180:183], a[132:135], v[196:199]
  v_or_b32 v58, s81, v58
  v_lshrrev_b32 v59, 1, v57
  v_mfma_f32_16x16x32_bf16 v[196:199], a[164:167], a[128:131], v[196:199]
  v_xor_b32 v59, v59, v58
  v_and_b32 v57, 1, v57
  v_mfma_f32_16x16x32_bf16 v[200:203], a[168:171], a[128:131], v[200:203]
  v_lshlrev_b32 v57, 4, v57
  v_lshl_add_u32 v57, v59, 5, v57
  v_mfma_f32_16x16x32_bf16 v[200:203], a[184:187], a[132:135], v[200:203]
  ds_read_b64_tr_b16 a[156:157], v23 offset:24576
  ds_read_b64_tr_b16 a[158:159], v23 offset:25600
  v_mfma_f32_16x16x32_bf16 v[204:207], a[188:191], a[132:135], v[204:207]
  s_waitcnt vmcnt(8) lgkmcnt(14)
  v_mul_u32_u24 v56, 3456, v56
  v_add_u32 v123, v56, v57
  v_mfma_f32_16x16x32_bf16 v[204:207], a[172:175], a[128:131], v[204:207]
  s_barrier
  s_lshl_b32 s87, s76, 16
  s_lshl_b32 s81, s77, 8
  v_mfma_f32_16x16x32_bf16 v[220:223], a[172:175], a[136:139], v[220:223]
  s_waitcnt lgkmcnt(11)
  buffer_store_dword v116, v112, s[36:39], 0 offen sc1
  v_mfma_f32_16x16x32_bf16 v[220:223], a[188:191], a[140:143], v[220:223]
  s_add_u32 s87, s87, s81
  ds_read_b64_tr_b16 a[128:129], v16 offset:32768
  ds_read_b64_tr_b16 a[130:131], v16 offset:33792
  v_mfma_f32_16x16x32_bf16 v[216:219], a[184:187], a[140:143], v[216:219]
  s_lshl_b32 s0, s76, 11
  s_lshl_b32 s1, s76, 10
  v_mfma_f32_16x16x32_bf16 v[216:219], a[168:171], a[136:139], v[216:219]
  buffer_load_dwordx4 v2, s[8:11], s84 offen offset:0 lds
  v_mfma_f32_16x16x32_bf16 v[212:215], a[164:167], a[136:139], v[212:215]
  s_add_u32 s1, s1, 8192
  s_mul_i32 s89, s76, 27648
  s_lshl_b32 s81, s77, 7
  v_mfma_f32_16x16x32_bf16 v[212:215], a[180:183], a[140:143], v[212:215]
  s_add_u32 s89, s89, s81
  ds_read_b64_tr_b16 a[132:133], v16 offset:40960
  ds_read_b64_tr_b16 a[134:135], v16 offset:41984
  v_mfma_f32_16x16x32_bf16 v[208:211], a[176:179], a[140:143], v[208:211]
  buffer_load_dwordx4 v3, s[8:11], s84 offen offset:1024 lds
  v_mfma_f32_16x16x32_bf16 v[208:211], a[160:163], a[136:139], v[208:211]
  s_waitcnt lgkmcnt(12)
  v_lshrrev_b32 v124, 2, v14
  v_mul_u32_u24 v124, 1280, v124
  v_mfma_f32_16x16x32_bf16 v[224:227], a[160:163], a[144:147], v[224:227]
  s_waitcnt lgkmcnt(9)
  v_and_b32 v125, 3, v14
  v_lshl_add_u32 v124, v125, 4, v124
  v_mfma_f32_16x16x32_bf16 v[224:227], a[176:179], a[148:151], v[224:227]
  ds_read_b64_tr_b16 a[136:137], v17 offset:32768
  ds_read_b64_tr_b16 a[138:139], v17 offset:33792
  v_mfma_f32_16x16x32_bf16 v[228:231], a[180:183], a[148:151], v[228:231]
  buffer_load_dwordx4 v4, s[8:11], s84 offen offset:2048 lds
  v_mfma_f32_16x16x32_bf16 v[228:231], a[164:167], a[144:147], v[228:231]
  v_add_u32 v125, 19456, v124
  s_and_b32 s94, s2, 3
  v_mfma_f32_16x16x32_bf16 v[232:235], a[168:171], a[144:147], v[232:235]
  s_bfe_u32 s95, s2, 0x20002
  s_mov_b32 s65, 0
  s_lshr_b32 s81, s2, 4
  v_mfma_f32_16x16x32_bf16 v[232:235], a[184:187], a[148:151], v[232:235]
  s_lshl2_add_u32 s81, s81, s76
  ds_read_b64_tr_b16 a[140:141], v17 offset:40960
  ds_read_b64_tr_b16 a[142:143], v17 offset:41984
  v_mfma_f32_16x16x32_bf16 v[236:239], a[188:191], a[148:151], v[236:239]
  s_waitcnt lgkmcnt(10)
  buffer_load_dwordx4 v5, s[8:11], s84 offen offset:3072 lds
  v_mfma_f32_16x16x32_bf16 v[236:239], a[172:175], a[144:147], v[236:239]
  s_add_u32 s81, s81, 0
  s_mul_i32 s82, s81, 52429
  s_lshr_b32 s82, s82, 18
  v_mfma_f32_16x16x32_bf16 v[252:255], a[172:175], a[152:155], v[252:255]
  s_mul_i32 s83, s82, 5
  s_sub_u32 s83, s81, s83
  s_mul_i32 s54, s95, 5
  s_waitcnt lgkmcnt(8)
  v_mfma_f32_16x16x32_bf16 v[252:255], a[188:191], a[156:159], v[252:255]
  s_add_u32 s50, s54, s83
  ds_read_b64_tr_b16 a[144:145], v18 offset:32768
  ds_read_b64_tr_b16 a[146:147], v18 offset:33792
  v_mfma_f32_16x16x32_bf16 v[248:251], a[184:187], a[156:159], v[248:251]
  s_add_u32 m0, s3, 0
  s_lshl_b32 s50, s50, 6
  s_mul_i32 s54, s95, 1863680
  v_mfma_f32_16x16x32_bf16 v[248:251], a[168:171], a[152:155], v[248:251]
  s_lshl_b32 s83, s83, 11
  s_add_u32 s54, s54, s83
  v_mfma_f32_16x16x32_bf16 v[244:247], a[164:167], a[152:155], v[244:247]
  s_cmp_eq_u32 s94, 3
  s_cselect_b32 s83, 12, 14
  s_sub_i32 s81, s82, s83
  v_mfma_f32_16x16x32_bf16 v[244:247], a[180:183], a[156:159], v[244:247]
  s_mul_i32 s83, s94, 14
  ds_read_b64_tr_b16 a[148:149], v18 offset:40960
  ds_read_b64_tr_b16 a[150:151], v18 offset:41984
  v_mfma_f32_16x16x32_bf16 v[240:243], a[176:179], a[156:159], v[240:243]
  s_waitcnt lgkmcnt(10)
  s_add_u32 s82, s82, s83
  s_lshl_b32 s83, s94, 5
  v_mfma_f32_16x16x32_bf16 v[240:243], a[160:163], a[152:155], v[240:243]
  s_add_u32 s83, s83, s81
  v_mfma_f32_16x16x32_bf16 a[0:3], a[128:131], a[192:195], a[0:3]
  s_cmp_lt_i32 s81, 0
  s_cselect_b32 s82, s82, s83
  s_cselect_b32 s83, 0, 54
  s_cselect_b32 s81, 1, 0
  s_waitcnt lgkmcnt(8)
  v_mfma_f32_16x16x32_bf16 a[0:3], a[132:135], a[208:211], a[0:3]
  s_or_b32 s65, s65, s81
  ds_read_b64_tr_b16 a[152:153], v19 offset:32768
  ds_read_b64_tr_b16 a[154:155], v19 offset:33792
  v_mfma_f32_16x16x32_bf16 a[32:35], a[132:135], a[212:215], a[32:35]
  buffer_load_dwordx4 v6, s[12:15], s60 offen offset:0 lds
  v_mfma_f32_16x16x32_bf16 a[32:35], a[128:131], a[196:199], a[32:35]
  s_add_u32 s83, s83, s82
  s_mul_i32 s82, s82, 40960
  s_mul_i32 s83, s83, 10240
  v_mfma_f32_16x16x32_bf16 a[64:67], a[128:131], a[200:203], a[64:67]
  s_add_u32 s50, s50, s82
  s_add_u32 s54, s54, s83
  s_lshr_b32 s81, s2, 4
  v_mfma_f32_16x16x32_bf16 a[64:67], a[132:135], a[216:219], a[64:67]
  s_lshl2_add_u32 s81, s81, s76
  ds_read_b64_tr_b16 a[156:157], v19 offset:40960
  ds_read_b64_tr_b16 a[158:159], v19 offset:41984
  v_mfma_f32_16x16x32_bf16 a[96:99], a[132:135], a[220:223], a[96:99]
  s_waitcnt lgkmcnt(10)
  buffer_load_dwordx4 v7, s[12:15], s60 offen offset:1024 lds
  v_mfma_f32_16x16x32_bf16 a[96:99], a[128:131], a[204:207], a[96:99]
  s_add_u32 s81, s81, 64
  s_mul_i32 s82, s81, 52429
  s_lshr_b32 s82, s82, 18
  v_mfma_f32_16x16x32_bf16 a[100:103], a[136:139], a[204:207], a[100:103]
  s_mul_i32 s83, s82, 5
  s_sub_u32 s83, s81, s83
  s_mul_i32 s55, s95, 5
  s_waitcnt lgkmcnt(8)
  v_mfma_f32_16x16x32_bf16 a[100:103], a[140:143], a[220:223], a[100:103]
  s_add_u32 s51, s55, s83
  ds_read_b64_tr_b16 a[128:129], v20 offset:32768
  ds_read_b64_tr_b16 a[130:131], v20 offset:33792
  v_mfma_f32_16x16x32_bf16 a[68:71], a[140:143], a[216:219], a[68:71]
  buffer_load_dwordx4 v8, s[12:15], s60 offen offset:2048 lds
  v_mfma_f32_16x16x32_bf16 a[68:71], a[136:139], a[200:203], a[68:71]
  s_lshl_b32 s51, s51, 6
  s_mul_i32 s55, s95, 1863680
  s_lshl_b32 s83, s83, 11
  v_mfma_f32_16x16x32_bf16 a[36:39], a[136:139], a[196:199], a[36:39]
  s_add_u32 s55, s55, s83
  s_cmp_eq_u32 s94, 3
  s_cselect_b32 s83, 12, 14
  v_mfma_f32_16x16x32_bf16 a[36:39], a[140:143], a[212:215], a[36:39]
  s_sub_i32 s81, s82, s83
  ds_read_b64_tr_b16 a[132:133], v20 offset:40960
  ds_read_b64_tr_b16 a[134:135], v20 offset:41984
  v_mfma_f32_16x16x32_bf16 a[4:7], a[140:143], a[208:211], a[4:7]
  s_waitcnt lgkmcnt(10)
  buffer_load_dwordx4 v9, s[12:15], s60 offen offset:3072 lds
  s_add_u32 m0, s3, 4096
  v_mfma_f32_16x16x32_bf16 a[4:7], a[136:139], a[192:195], a[4:7]
  s_mul_i32 s83, s94, 14
  s_add_u32 s82, s82, s83
  s_lshl_b32 s83, s94, 5
  v_mfma_f32_16x16x32_bf16 a[8:11], a[144:147], a[192:195], a[8:11]
  s_add_u32 s83, s83, s81
  s_waitcnt lgkmcnt(8)
  v_mfma_f32_16x16x32_bf16 a[8:11], a[148:151], a[208:211], a[8:11]
  s_add_u32 s60, s60, 128
  ds_read_b64_tr_b16 a[136:137], v21 offset:32768
  ds_read_b64_tr_b16 a[138:139], v21 offset:33792
  v_mfma_f32_16x16x32_bf16 a[40:43], a[148:151], a[212:215], a[40:43]
  buffer_load_dwordx4 v6, s[12:15], s61 offen offset:0 lds
  v_mfma_f32_16x16x32_bf16 a[40:43], a[144:147], a[196:199], a[40:43]
  s_cmp_lt_i32 s81, 0
  s_cselect_b32 s82, s82, s83
  s_cselect_b32 s83, 0, 54
  s_cselect_b32 s81, 2, 0
  v_mfma_f32_16x16x32_bf16 a[72:75], a[144:147], a[200:203], a[72:75]
  s_or_b32 s65, s65, s81
  s_add_u32 s83, s83, s82
  s_mul_i32 s82, s82, 40960
  v_mfma_f32_16x16x32_bf16 a[72:75], a[148:151], a[216:219], a[72:75]
  s_mul_i32 s83, s83, 10240
  ds_read_b64_tr_b16 a[140:141], v21 offset:40960
  ds_read_b64_tr_b16 a[142:143], v21 offset:41984
  v_mfma_f32_16x16x32_bf16 a[104:107], a[148:151], a[220:223], a[104:107]
  s_waitcnt lgkmcnt(10)
  buffer_load_dwordx4 v7, s[12:15], s61 offen offset:1024 lds
  v_mfma_f32_16x16x32_bf16 a[104:107], a[144:147], a[204:207], a[104:107]
  s_add_u32 s51, s51, s82
  s_add_u32 s55, s55, s83
  s_lshr_b32 s81, s2, 4
  v_mfma_f32_16x16x32_bf16 a[108:111], a[152:155], a[204:207], a[108:111]
  s_lshl2_add_u32 s81, s81, s76
  s_add_u32 s81, s81, 128
  s_mul_i32 s82, s81, 52429
  s_waitcnt lgkmcnt(8)
  v_mfma_f32_16x16x32_bf16 a[108:111], a[156:159], a[220:223], a[108:111]
  s_lshr_b32 s82, s82, 18
  ds_read_b64_tr_b16 a[144:145], v22 offset:32768
  ds_read_b64_tr_b16 a[146:147], v22 offset:33792
  v_mfma_f32_16x16x32_bf16 a[76:79], a[156:159], a[216:219], a[76:79]
  buffer_load_dwordx4 v8, s[12:15], s61 offen offset:2048 lds
  v_mfma_f32_16x16x32_bf16 a[76:79], a[152:155], a[200:203], a[76:79]
  s_mul_i32 s83, s82, 5
  s_sub_u32 s83, s81, s83
  s_mul_i32 s56, s95, 5
  v_mfma_f32_16x16x32_bf16 a[44:47], a[152:155], a[196:199], a[44:47]
  s_add_u32 s52, s56, s83
  s_lshl_b32 s52, s52, 6
  s_mul_i32 s56, s95, 1863680
  v_mfma_f32_16x16x32_bf16 a[44:47], a[156:159], a[212:215], a[44:47]
  buffer_load_dwordx4 v9, s[12:15], s61 offen offset:3072 lds
  s_add_u32 m0, s85, 16384
  v_mfma_f32_16x16x32_bf16 a[12:15], a[156:159], a[208:211], a[12:15]
  s_waitcnt lgkmcnt(8)
  ds_read_b64_tr_b16 a[148:149], v22 offset:40960
  ds_read_b64_tr_b16 a[150:151], v22 offset:41984
  v_mfma_f32_16x16x32_bf16 a[12:15], a[152:155], a[192:195], a[12:15]
  s_lshl_b32 s83, s83, 11
  s_add_u32 s56, s56, s83
  v_mfma_f32_16x16x32_bf16 a[16:19], a[128:131], a[192:195], a[16:19]
  s_cmp_eq_u32 s94, 3
  s_cselect_b32 s83, 12, 14
  s_sub_i32 s81, s82, s83
  s_waitcnt lgkmcnt(8)
  v_mfma_f32_16x16x32_bf16 a[16:19], a[132:135], a[208:211], a[16:19]
  s_mul_i32 s83, s94, 14
  ds_read_b64_tr_b16 a[152:153], v23 offset:32768
  ds_read_b64_tr_b16 a[154:155], v23 offset:33792
  v_mfma_f32_16x16x32_bf16 a[48:51], a[132:135], a[212:215], a[48:51]
  s_add_u32 s61, s61, 128
  s_add_u32 s82, s82, s83
  s_lshl_b32 s83, s94, 5
  v_mfma_f32_16x16x32_bf16 a[48:51], a[128:131], a[196:199], a[48:51]
  s_add_u32 s83, s83, s81
  v_mfma_f32_16x16x32_bf16 a[80:83], a[128:131], a[200:203], a[80:83]
  s_cmp_lt_i32 s81, 0
  s_cselect_b32 s82, s82, s83
  s_cselect_b32 s83, 0, 54
  s_cselect_b32 s81, 4, 0
  v_mfma_f32_16x16x32_bf16 a[80:83], a[132:135], a[216:219], a[80:83]
  s_or_b32 s65, s65, s81
  ds_read_b64_tr_b16 a[156:157], v23 offset:40960
  ds_read_b64_tr_b16 a[158:159], v23 offset:41984
  v_mfma_f32_16x16x32_bf16 a[112:115], a[132:135], a[220:223], a[112:115]
  s_waitcnt lgkmcnt(10)
  s_add_u32 s83, s83, s82
  s_mul_i32 s82, s82, 40960
  v_mfma_f32_16x16x32_bf16 a[112:115], a[128:131], a[204:207], a[112:115]
  s_barrier
  s_mul_i32 s83, s83, 10240
  s_add_u32 s52, s52, s82
  v_mfma_f32_16x16x32_bf16 a[116:119], a[136:139], a[204:207], a[116:119]
  s_waitcnt lgkmcnt(8)
  buffer_load_dwordx4 v2, s[20:23], s84 offen offset:0 lds
  v_mfma_f32_16x16x32_bf16 a[116:119], a[140:143], a[220:223], a[116:119]
  s_add_u32 s56, s56, s83
  ds_read_b64_tr_b16 a[128:129], v16 offset:49152
  ds_read_b64_tr_b16 a[130:131], v16 offset:50176
  v_mfma_f32_16x16x32_bf16 a[84:87], a[140:143], a[216:219], a[84:87]
  s_lshr_b32 s81, s2, 4
  s_lshl2_add_u32 s81, s81, s76
  v_mfma_f32_16x16x32_bf16 a[84:87], a[136:139], a[200:203], a[84:87]
  buffer_load_dwordx4 v3, s[20:23], s84 offen offset:1024 lds
  v_mfma_f32_16x16x32_bf16 a[52:55], a[136:139], a[196:199], a[52:55]
  s_add_u32 s81, s81, 192
  s_mul_i32 s82, s81, 52429
  s_lshr_b32 s82, s82, 18
  v_mfma_f32_16x16x32_bf16 a[52:55], a[140:143], a[212:215], a[52:55]
  s_mul_i32 s83, s82, 5
  ds_read_b64_tr_b16 a[132:133], v16 offset:57344
  ds_read_b64_tr_b16 a[134:135], v16 offset:58368
  v_mfma_f32_16x16x32_bf16 a[20:23], a[140:143], a[208:211], a[20:23]
  s_waitcnt lgkmcnt(10)
  buffer_load_dwordx4 v4, s[20:23], s84 offen offset:2048 lds
  v_mfma_f32_16x16x32_bf16 a[20:23], a[136:139], a[192:195], a[20:23]
  s_sub_u32 s83, s81, s83
  s_mul_i32 s57, s95, 5
  s_add_u32 s53, s57, s83
  v_mfma_f32_16x16x32_bf16 a[24:27], a[144:147], a[192:195], a[24:27]
  s_lshl_b32 s53, s53, 6
  s_mul_i32 s57, s95, 1863680
  s_lshl_b32 s83, s83, 11
  s_waitcnt lgkmcnt(8)
  v_mfma_f32_16x16x32_bf16 a[24:27], a[148:151], a[208:211], a[24:27]
  s_add_u32 s57, s57, s83
  ds_read_b64_tr_b16 a[136:137], v17 offset:49152
  ds_read_b64_tr_b16 a[138:139], v17 offset:50176
  v_mfma_f32_16x16x32_bf16 a[56:59], a[148:151], a[212:215], a[56:59]
  buffer_load_dwordx4 v5, s[20:23], s84 offen offset:3072 lds
  v_mfma_f32_16x16x32_bf16 a[56:59], a[144:147], a[196:199], a[56:59]
  s_cmp_eq_u32 s94, 3
  s_cselect_b32 s83, 12, 14
  s_sub_i32 s81, s82, s83
  v_mfma_f32_16x16x32_bf16 a[88:91], a[144:147], a[200:203], a[88:91]
  s_mul_i32 s83, s94, 14
  s_add_u32 s82, s82, s83
  s_lshl_b32 s83, s94, 5
  v_mfma_f32_16x16x32_bf16 a[88:91], a[148:151], a[216:219], a[88:91]
  s_add_u32 s83, s83, s81
  ds_read_b64_tr_b16 a[140:141], v17 offset:57344
  ds_read_b64_tr_b16 a[142:143], v17 offset:58368
  v_mfma_f32_16x16x32_bf16 a[120:123], a[148:151], a[220:223], a[120:123]
  s_waitcnt lgkmcnt(10)
  v_mfma_f32_16x16x32_bf16 a[120:123], a[144:147], a[204:207], a[120:123]
  s_cmp_lt_i32 s81, 32
  s_cselect_b32 s57, s57, 2146435072
  s_cselect_b32 s53, s53, 2146435072
  v_mfma_f32_16x16x32_bf16 a[124:127], a[152:155], a[204:207], a[124:127]
  s_cmp_lt_i32 s81, 0
  s_cselect_b32 s82, s82, s83
  s_cselect_b32 s83, 0, 54
  s_cselect_b32 s81, 8, 0
  s_waitcnt lgkmcnt(8)
  v_mfma_f32_16x16x32_bf16 a[124:127], a[156:159], a[220:223], a[124:127]
  s_or_b32 s65, s65, s81
  ds_read_b64_tr_b16 a[144:145], v18 offset:49152
  ds_read_b64_tr_b16 a[146:147], v18 offset:50176
  v_mfma_f32_16x16x32_bf16 a[92:95], a[156:159], a[216:219], a[92:95]
  s_add_u32 s84, s84, 524288
  s_add_u32 s83, s83, s82
L_padA2:
  s_cbranch_execz L_padA6
  s_mul_i32 s82, s82, 40960
  v_mfma_f32_16x16x32_bf16 a[92:95], a[152:155], a[200:203], a[92:95]
  s_mul_i32 s83, s83, 10240
  s_add_u32 s53, s53, s82
  s_add_u32 s57, s57, s83
  v_mfma_f32_16x16x32_bf16 a[60:63], a[152:155], a[196:199], a[60:63]
  s_add_u32 m0, s85, 32768
  v_cmp_gt_u32 vcc, 16, v14
  v_mov_b32 v120, 2146435072
  v_mfma_f32_16x16x32_bf16 a[60:63], a[156:159], a[212:215], a[60:63]
  ds_read_b64_tr_b16 a[148:149], v18 offset:57344
  ds_read_b64_tr_b16 a[150:151], v18 offset:58368
  v_mfma_f32_16x16x32_bf16 a[28:31], a[156:159], a[208:211], a[28:31]
  s_waitcnt lgkmcnt(10)
  v_cndmask_b32 v120, v120, v0, vcc
  s_lshl2_add_u32 s81, s77, s76
  v_mfma_f32_16x16x32_bf16 a[28:31], a[152:155], a[192:195], a[28:31]
  s_cmp_lt_u32 s81, 64
  s_cselect_b32 s82, s79, s80
  s_and_b32 s81, s81, 63
  v_mfma_f32_16x16x32_bf16 v[128:131], a[192:195], a[128:131], v[128:131]
  s_mul_i32 s82, s82, 163840
  s_mul_i32 s81, s81, 2560
  s_add_u32 s81, s81, s82
  s_waitcnt lgkmcnt(8)
  v_mfma_f32_16x16x32_bf16 v[128:131], a[208:211], a[132:135], v[128:131]
  s_bitcmp1_b32 s65, 0
  s_cselect_b64 s[28:29], s[66:67], s[58:59]
  s_mov_b32 s30, 5242880
  s_cselect_b32 s30, 2211840, s30
  ds_read_b64_tr_b16 a[152:153], v19 offset:49152
  ds_read_b64_tr_b16 a[154:155], v19 offset:50176
  v_mfma_f32_16x16x32_bf16 v[132:135], a[212:215], a[132:135], v[132:135]
  v_cmp_gt_u32 vcc, 20, v14
  v_lshl_add_u32 v56, v14, 7, s81
  v_mfma_f32_16x16x32_bf16 v[132:135], a[196:199], a[128:131], v[132:135]
  ds_read_b128 a[224:227], v12 offset:8192
  v_mov_b32 v112, 2146435072
  v_mfma_f32_16x16x32_bf16 v[136:139], a[200:203], a[128:131], v[136:139]
  v_cndmask_b32 v112, v112, v56, vcc
  v_mfma_f32_16x16x32_bf16 v[136:139], a[216:219], a[132:135], v[136:139]
  ds_read_b64_tr_b16 a[156:157], v19 offset:57344
  ds_read_b64_tr_b16 a[158:159], v19 offset:58368
  v_mfma_f32_16x16x32_bf16 v[140:143], a[220:223], a[132:135], v[140:143]
  v_mfma_f32_16x16x32_bf16 v[140:143], a[204:207], a[128:131], v[140:143]
  s_waitcnt lgkmcnt(11)
  ds_read_b128 a[228:231], v12 offset:10240
  v_mfma_f32_16x16x32_bf16 v[156:159], a[204:207], a[136:139], v[156:159]
  s_waitcnt lgkmcnt(10)
  v_mfma_f32_16x16x32_bf16 v[156:159], a[220:223], a[140:143], v[156:159]
  ds_read_b64_tr_b16 a[128:129], v20 offset:49152
  ds_read_b64_tr_b16 a[130:131], v20 offset:50176
  v_mfma_f32_16x16x32_bf16 v[152:155], a[216:219], a[140:143], v[152:155]
  v_mfma_f32_16x16x32_bf16 v[152:155], a[200:203], a[136:139], v[152:155]
  ds_read_b128 a[232:235], v12 offset:12288
  v_mfma_f32_16x16x32_bf16 v[148:151], a[196:199], a[136:139], v[148:151]
  v_mfma_f32_16x16x32_bf16 v[148:151], a[212:215], a[140:143], v[148:151]
  ds_read_b64_tr_b16 a[132:133], v20 offset:57344
  ds_read_b64_tr_b16 a[134:135], v20 offset:58368
  v_mfma_f32_16x16x32_bf16 v[144:147], a[208:211], a[140:143], v[144:147]
  v_mfma_f32_16x16x32_bf16 v[144:147], a[192:195], a[136:139], v[144:147]
  s_waitcnt lgkmcnt(13)
  ds_read_b128 a[236:239], v12 offset:14336
  v_mfma_f32_16x16x32_bf16 v[160:163], a[192:195], a[144:147], v[160:163]
  s_waitcnt lgkmcnt(12)
  v_mfma_f32_16x16x32_bf16 v[160:163], a[208:211], a[148:151], v[160:163]
  ds_read_b64_tr_b16 a[136:137], v21 offset:49152
  ds_read_b64_tr_b16 a[138:139], v21 offset:50176
  v_mfma_f32_16x16x32_bf16 v[164:167], a[212:215], a[148:151], v[164:167]
  v_mfma_f32_16x16x32_bf16 v[164:167], a[196:199], a[144:147], v[164:167]
  ds_read_b128 a[240:243], v13 offset:8192
  v_mfma_f32_16x16x32_bf16 v[168:171], a[200:203], a[144:147], v[168:171]
  v_mfma_f32_16x16x32_bf16 v[168:171], a[216:219], a[148:151], v[168:171]
  ds_read_b64_tr_b16 a[140:141], v21 offset:57344
  ds_read_b64_tr_b16 a[142:143], v21 offset:58368
  v_mfma_f32_16x16x32_bf16 v[172:175], a[220:223], a[148:151], v[172:175]
  v_mfma_f32_16x16x32_bf16 v[172:175], a[204:207], a[144:147], v[172:175]
  s_waitcnt lgkmcnt(15)
  ds_read_b128 a[244:247], v13 offset:10240
  v_mfma_f32_16x16x32_bf16 v[188:191], a[204:207], a[152:155], v[188:191]
  s_waitcnt lgkmcnt(13)
  buffer_load_dword v127, v117, s[96:99], 0 offen offset:0
  v_mfma_f32_16x16x32_bf16 v[188:191], a[220:223], a[156:159], v[188:191]
  ds_read_b64_tr_b16 a[144:145], v22 offset:49152
  ds_read_b64_tr_b16 a[146:147], v22 offset:50176
  v_mfma_f32_16x16x32_bf16 v[184:187], a[216:219], a[156:159], v[184:187]
  v_mfma_f32_16x16x32_bf16 v[184:187], a[200:203], a[152:155], v[184:187]
  ds_read_b128 a[248:251], v13 offset:12288
  v_mfma_f32_16x16x32_bf16 v[180:183], a[196:199], a[152:155], v[180:183]
  v_mfma_f32_16x16x32_bf16 v[180:183], a[212:215], a[156:159], v[180:183]
  ds_read_b64_tr_b16 a[148:149], v22 offset:57344
  ds_read_b64_tr_b16 a[150:151], v22 offset:58368
  v_mfma_f32_16x16x32_bf16 v[176:179], a[208:211], a[156:159], v[176:179]
  v_mfma_f32_16x16x32_bf16 v[176:179], a[192:195], a[152:155], v[176:179]
  s_waitcnt lgkmcnt(15)
  ds_read_b128 a[252:255], v13 offset:14336
  v_mfma_f32_16x16x32_bf16 v[192:195], a[192:195], a[128:131], v[192:195]
  s_waitcnt lgkmcnt(13)
  v_mfma_f32_16x16x32_bf16 v[192:195], a[208:211], a[132:135], v[192:195]
  ds_read_b64_tr_b16 a[152:153], v23 offset:49152
  ds_read_b64_tr_b16 a[154:155], v23 offset:50176
  v_mfma_f32_16x16x32_bf16 v[196:199], a[212:215], a[132:135], v[196:199]
  v_mfma_f32_16x16x32_bf16 v[196:199], a[196:199], a[128:131], v[196:199]
  v_mfma_f32_16x16x32_bf16 v[200:203], a[200:203], a[128:131], v[200:203]
  v_mfma_f32_16x16x32_bf16 v[200:203], a[216:219], a[132:135], v[200:203]
  ds_read_b64_tr_b16 a[156:157], v23 offset:57344
  ds_read_b64_tr_b16 a[158:159], v23 offset:58368
  v_mfma_f32_16x16x32_bf16 v[204:207], a[220:223], a[132:135], v[204:207]
  s_waitcnt lgkmcnt(14)
  v_mfma_f32_16x16x32_bf16 v[204:207], a[204:207], a[128:131], v[204:207]
  s_barrier
  v_mfma_f32_16x16x32_bf16 v[220:223], a[204:207], a[136:139], v[220:223]
  s_waitcnt lgkmcnt(11)
  buffer_load_dwordx4 v2, s[8:11], s84 offen offset:0 lds
  v_mfma_f32_16x16x32_bf16 v[220:223], a[220:223], a[140:143], v[220:223]
  ds_read_b64_tr_b16 a[128:129], v24 offset:0
  ds_read_b64_tr_b16 a[130:131], v24 offset:1024
  v_mfma_f32_16x16x32_bf16 v[216:219], a[216:219], a[140:143], v[216:219]
  v_mfma_f32_16x16x32_bf16 v[216:219], a[200:203], a[136:139], v[216:219]
  buffer_load_dwordx4 v3, s[8:11], s84 offen offset:1024 lds
  v_mfma_f32_16x16x32_bf16 v[212:215], a[196:199], a[136:139], v[212:215]
  v_mfma_f32_16x16x32_bf16 v[212:215], a[212:215], a[140:143], v[212:215]
  ds_read_b64_tr_b16 a[132:133], v24 offset:8192
  ds_read_b64_tr_b16 a[134:135], v24 offset:9216
  v_mfma_f32_16x16x32_bf16 v[208:211], a[208:211], a[140:143], v[208:211]
  buffer_load_dwordx4 v4, s[8:11], s84 offen offset:2048 lds
  v_mfma_f32_16x16x32_bf16 v[208:211], a[192:195], a[136:139], v[208:211]
  s_waitcnt lgkmcnt(12)
  v_mfma_f32_16x16x32_bf16 v[224:227], a[192:195], a[144:147], v[224:227]
  s_waitcnt lgkmcnt(9)
  v_mfma_f32_16x16x32_bf16 v[224:227], a[208:211], a[148:151], v[224:227]
  ds_read_b64_tr_b16 a[136:137], v25 offset:0
  ds_read_b64_tr_b16 a[138:139], v25 offset:1024
  v_mfma_f32_16x16x32_bf16 v[228:231], a[212:215], a[148:151], v[228:231]
  buffer_load_dwordx4 v5, s[8:11], s84 offen offset:3072 lds
  v_mfma_f32_16x16x32_bf16 v[228:231], a[196:199], a[144:147], v[228:231]
  s_add_u32 m0, s3, 8192
  v_mfma_f32_16x16x32_bf16 v[232:235], a[200:203], a[144:147], v[232:235]
  v_mfma_f32_16x16x32_bf16 v[232:235], a[216:219], a[148:151], v[232:235]
  ds_read_b64_tr_b16 a[140:141], v25 offset:8192
  ds_read_b64_tr_b16 a[142:143], v25 offset:9216
  v_mfma_f32_16x16x32_bf16 v[236:239], a[220:223], a[148:151], v[236:239]
  v_mfma_f32_16x16x32_bf16 v[236:239], a[204:207], a[144:147], v[236:239]
  s_waitcnt lgkmcnt(10)
  v_mfma_f32_16x16x32_bf16 v[252:255], a[204:207], a[152:155], v[252:255]
  s_waitcnt lgkmcnt(8)
  v_mfma_f32_16x16x32_bf16 v[252:255], a[220:223], a[156:159], v[252:255]
  ds_read_b64_tr_b16 a[144:145], v26 offset:0
  ds_read_b64_tr_b16 a[146:147], v26 offset:1024
  v_mfma_f32_16x16x32_bf16 v[248:251], a[216:219], a[156:159], v[248:251]
  v_mfma_f32_16x16x32_bf16 v[248:251], a[200:203], a[152:155], v[248:251]
  v_mfma_f32_16x16x32_bf16 v[244:247], a[196:199], a[152:155], v[244:247]
  v_mfma_f32_16x16x32_bf16 v[244:247], a[212:215], a[156:159], v[244:247]
  ds_read_b64_tr_b16 a[148:149], v26 offset:8192
  ds_read_b64_tr_b16 a[150:151], v26 offset:9216
  v_mfma_f32_16x16x32_bf16 v[240:243], a[208:211], a[156:159], v[240:243]
  v_mfma_f32_16x16x32_bf16 v[240:243], a[192:195], a[152:155], v[240:243]
  s_waitcnt lgkmcnt(10)
  v_mfma_f32_16x16x32_bf16 a[0:3], a[128:131], a[224:227], a[0:3]
  s_waitcnt lgkmcnt(8)
  buffer_load_dword v127, v118, s[96:99], 0 offen offset:0
  v_mfma_f32_16x16x32_bf16 a[0:3], a[132:135], a[240:243], a[0:3]
  ds_read_b64_tr_b16 a[152:153], v27 offset:0
  ds_read_b64_tr_b16 a[154:155], v27 offset:1024
  v_mfma_f32_16x16x32_bf16 a[32:35], a[132:135], a[244:247], a[32:35]
  v_mfma_f32_16x16x32_bf16 a[32:35], a[128:131], a[228:231], a[32:35]
  buffer_load_dwordx4 v6, s[12:15], s60 offen offset:0 lds
  v_mfma_f32_16x16x32_bf16 a[64:67], a[128:131], a[232:235], a[64:67]
  v_mfma_f32_16x16x32_bf16 a[64:67], a[132:135], a[248:251], a[64:67]
  ds_read_b64_tr_b16 a[156:157], v27 offset:8192
  ds_read_b64_tr_b16 a[158:159], v27 offset:9216
  v_mfma_f32_16x16x32_bf16 a[96:99], a[132:135], a[252:255], a[96:99]
  buffer_load_dwordx4 v7, s[12:15], s60 offen offset:1024 lds
  v_mfma_f32_16x16x32_bf16 a[96:99], a[128:131], a[236:239], a[96:99]
  s_waitcnt lgkmcnt(10)
  v_mfma_f32_16x16x32_bf16 a[100:103], a[136:139], a[236:239], a[100:103]
  s_waitcnt lgkmcnt(8)
  v_mfma_f32_16x16x32_bf16 a[100:103], a[140:143], a[252:255], a[100:103]
  ds_read_b64_tr_b16 a[128:129], v28 offset:0
  ds_read_b64_tr_b16 a[130:131], v28 offset:1024
  v_mfma_f32_16x16x32_bf16 a[68:71], a[140:143], a[248:251], a[68:71]
  buffer_load_dwordx4 v8, s[12:15], s60 offen offset:2048 lds
  v_mfma_f32_16x16x32_bf16 a[68:71], a[136:139], a[232:235], a[68:71]
  v_mfma_f32_16x16x32_bf16 a[36:39], a[136:139], a[228:231], a[36:39]
  v_mfma_f32_16x16x32_bf16 a[36:39], a[140:143], a[244:247], a[36:39]
  ds_read_b64_tr_b16 a[132:133], v28 offset:8192
  ds_read_b64_tr_b16 a[134:135], v28 offset:9216
  v_mfma_f32_16x16x32_bf16 a[4:7], a[140:143], a[240:243], a[4:7]
  buffer_load_dwordx4 v9, s[12:15], s60 offen offset:3072 lds
  v_mfma_f32_16x16x32_bf16 a[4:7], a[136:139], a[224:227], a[4:7]
  s_waitcnt lgkmcnt(10)
  v_mfma_f32_16x16x32_bf16 a[8:11], a[144:147], a[224:227], a[8:11]
  s_waitcnt lgkmcnt(8)
  v_mfma_f32_16x16x32_bf16 a[8:11], a[148:151], a[240:243], a[8:11]
  s_add_u32 m0, s3, 12288
  ds_read_b64_tr_b16 a[136:137], v29 offset:0
  ds_read_b64_tr_b16 a[138:139], v29 offset:1024
  v_mfma_f32_16x16x32_bf16 a[40:43], a[148:151], a[244:247], a[40:43]
  buffer_load_dwordx4 v6, s[12:15], s61 offen offset:0 lds
  v_mfma_f32_16x16x32_bf16 a[40:43], a[144:147], a[228:231], a[40:43]
  v_mfma_f32_16x16x32_bf16 a[72:75], a[144:147], a[232:235], a[72:75]
  v_mfma_f32_16x16x32_bf16 a[72:75], a[148:151], a[248:251], a[72:75]
  ds_read_b64_tr_b16 a[140:141], v29 offset:8192
  ds_read_b64_tr_b16 a[142:143], v29 offset:9216
  v_mfma_f32_16x16x32_bf16 a[104:107], a[148:151], a[252:255], a[104:107]
  buffer_load_dwordx4 v7, s[12:15], s61 offen offset:1024 lds
  v_mfma_f32_16x16x32_bf16 a[104:107], a[144:147], a[236:239], a[104:107]
  s_waitcnt lgkmcnt(10)
  v_mfma_f32_16x16x32_bf16 a[108:111], a[152:155], a[236:239], a[108:111]
  s_waitcnt lgkmcnt(8)
  v_mfma_f32_16x16x32_bf16 a[108:111], a[156:159], a[252:255], a[108:111]
  ds_read_b64_tr_b16 a[144:145], v30 offset:0
  ds_read_b64_tr_b16 a[146:147], v30 offset:1024
  v_mfma_f32_16x16x32_bf16 a[76:79], a[156:159], a[248:251], a[76:79]
  buffer_load_dwordx4 v8, s[12:15], s61 offen offset:2048 lds
  v_mfma_f32_16x16x32_bf16 a[76:79], a[152:155], a[232:235], a[76:79]
  v_mfma_f32_16x16x32_bf16 a[44:47], a[152:155], a[228:231], a[44:47]
  v_mfma_f32_16x16x32_bf16 a[44:47], a[156:159], a[244:247], a[44:47]
  buffer_load_dwordx4 v9, s[12:15], s61 offen offset:3072 lds
  v_mfma_f32_16x16x32_bf16 a[12:15], a[156:159], a[240:243], a[12:15]
  s_add_u32 m0, s85, 49152
  ds_read_b64_tr_b16 a[148:149], v30 offset:8192
  ds_read_b64_tr_b16 a[150:151], v30 offset:9216
  v_mfma_f32_16x16x32_bf16 a[12:15], a[152:155], a[224:227], a[12:15]
  s_waitcnt lgkmcnt(10)
  v_mov_b32 v6, v1
  v_add_u32 v7, 4096, v1
  v_mfma_f32_16x16x32_bf16 a[16:19], a[128:131], a[224:227], a[16:19]
  s_waitcnt lgkmcnt(8)
  v_mfma_f32_16x16x32_bf16 a[16:19], a[132:135], a[240:243], a[16:19]
  s_mov_b32 s60, 0
  ds_read_b64_tr_b16 a[152:153], v31 offset:0
  ds_read_b64_tr_b16 a[154:155], v31 offset:1024
  v_mfma_f32_16x16x32_bf16 a[48:51], a[132:135], a[244:247], a[48:51]
  s_add_u32 s61, s73, 0
  v_mfma_f32_16x16x32_bf16 a[48:51], a[128:131], a[228:231], a[48:51]
  v_mfma_f32_16x16x32_bf16 a[80:83], a[128:131], a[232:235], a[80:83]
  v_mfma_f32_16x16x32_bf16 a[80:83], a[132:135], a[248:251], a[80:83]
  ds_read_b64_tr_b16 a[156:157], v31 offset:8192
  ds_read_b64_tr_b16 a[158:159], v31 offset:9216
  v_mfma_f32_16x16x32_bf16 a[112:115], a[132:135], a[252:255], a[112:115]
  s_waitcnt vmcnt(35) lgkmcnt(10)
  v_mfma_f32_16x16x32_bf16 a[112:115], a[128:131], a[236:239], a[112:115]
  s_barrier
  v_mfma_f32_16x16x32_bf16 a[116:119], a[136:139], a[236:239], a[116:119]
  s_waitcnt lgkmcnt(8)
  buffer_load_dwordx4 v2, s[20:23], s84 offen offset:0 lds
  v_mfma_f32_16x16x32_bf16 a[116:119], a[140:143], a[252:255], a[116:119]
  ds_read_b64_tr_b16 a[128:129], v24 offset:16384
  ds_read_b64_tr_b16 a[130:131], v24 offset:17408
  v_mfma_f32_16x16x32_bf16 a[84:87], a[140:143], a[248:251], a[84:87]
  v_mfma_f32_16x16x32_bf16 a[84:87], a[136:139], a[232:235], a[84:87]
  buffer_load_dwordx4 v3, s[20:23], s84 offen offset:1024 lds
  v_mfma_f32_16x16x32_bf16 a[52:55], a[136:139], a[228:231], a[52:55]
  v_mfma_f32_16x16x32_bf16 a[52:55], a[140:143], a[244:247], a[52:55]
  ds_read_b64_tr_b16 a[132:133], v24 offset:24576
  ds_read_b64_tr_b16 a[134:135], v24 offset:25600
  v_mfma_f32_16x16x32_bf16 a[20:23], a[140:143], a[240:243], a[20:23]
  buffer_load_dwordx4 v4, s[20:23], s84 offen offset:2048 lds
  v_mfma_f32_16x16x32_bf16 a[20:23], a[136:139], a[224:227], a[20:23]
  s_waitcnt lgkmcnt(10)
  v_mfma_f32_16x16x32_bf16 a[24:27], a[144:147], a[224:227], a[24:27]
  s_waitcnt lgkmcnt(8)
  v_mfma_f32_16x16x32_bf16 a[24:27], a[148:151], a[240:243], a[24:27]
  ds_read_b64_tr_b16 a[136:137], v25 offset:16384
  ds_read_b64_tr_b16 a[138:139], v25 offset:17408
  v_mfma_f32_16x16x32_bf16 a[56:59], a[148:151], a[244:247], a[56:59]
  buffer_load_dwordx4 v5, s[20:23], s84 offen offset:3072 lds
  v_mfma_f32_16x16x32_bf16 a[56:59], a[144:147], a[228:231], a[56:59]
  s_add_u32 s84, s84, 524288
  v_mfma_f32_16x16x32_bf16 a[88:91], a[144:147], a[232:235], a[88:91]
  s_add_u32 m0, s0, 65536
  v_mfma_f32_16x16x32_bf16 a[88:91], a[148:151], a[248:251], a[88:91]
  ds_read_b64_tr_b16 a[140:141], v25 offset:24576
  ds_read_b64_tr_b16 a[142:143], v25 offset:25600
  v_mfma_f32_16x16x32_bf16 a[120:123], a[148:151], a[252:255], a[120:123]
  buffer_load_dword v127, v119, s[16:19], 0 offen offset:0
  v_mfma_f32_16x16x32_bf16 a[120:123], a[144:147], a[236:239], a[120:123]
  s_waitcnt lgkmcnt(10)
  v_mfma_f32_16x16x32_bf16 a[124:127], a[152:155], a[236:239], a[124:127]
  s_waitcnt lgkmcnt(8)
  v_mfma_f32_16x16x32_bf16 a[124:127], a[156:159], a[252:255], a[124:127]
  ds_read_b64_tr_b16 a[144:145], v26 offset:16384
  ds_read_b64_tr_b16 a[146:147], v26 offset:17408
  v_mfma_f32_16x16x32_bf16 a[92:95], a[156:159], a[248:251], a[92:95]
  v_mfma_f32_16x16x32_bf16 a[92:95], a[152:155], a[232:235], a[92:95]
  v_mfma_f32_16x16x32_bf16 a[60:63], a[152:155], a[228:231], a[60:63]
  v_mfma_f32_16x16x32_bf16 a[60:63], a[156:159], a[244:247], a[60:63]
  ds_read_b64_tr_b16 a[148:149], v26 offset:24576
  ds_read_b64_tr_b16 a[150:151], v26 offset:25600
  v_mfma_f32_16x16x32_bf16 a[28:31], a[156:159], a[240:243], a[28:31]
  v_mfma_f32_16x16x32_bf16 a[28:31], a[152:155], a[224:227], a[28:31]
  s_waitcnt lgkmcnt(10)
  v_mfma_f32_16x16x32_bf16 v[128:131], a[224:227], a[128:131], v[128:131]
  s_waitcnt lgkmcnt(8)
  v_mfma_f32_16x16x32_bf16 v[128:131], a[240:243], a[132:135], v[128:131]
  ds_read_b64_tr_b16 a[152:153], v27 offset:16384
  ds_read_b64_tr_b16 a[154:155], v27 offset:17408
  v_mfma_f32_16x16x32_bf16 v[132:135], a[244:247], a[132:135], v[132:135]
  s_waitcnt vmcnt(23)
  v_mfma_f32_16x16x32_bf16 v[132:135], a[228:231], a[128:131], v[132:135]
  ds_read_b128 a[160:163], v12 offset:0
  v_mfma_f32_16x16x32_bf16 v[136:139], a[232:235], a[128:131], v[136:139]
  v_mfma_f32_16x16x32_bf16 v[136:139], a[248:251], a[132:135], v[136:139]
  ds_read_b64_tr_b16 a[156:157], v27 offset:24576
  ds_read_b64_tr_b16 a[158:159], v27 offset:25600
  v_mfma_f32_16x16x32_bf16 v[140:143], a[252:255], a[132:135], v[140:143]
  v_mfma_f32_16x16x32_bf16 v[140:143], a[236:239], a[128:131], v[140:143]
  s_waitcnt lgkmcnt(11)
  ds_read_b128 a[164:167], v12 offset:2048
  v_mfma_f32_16x16x32_bf16 v[156:159], a[236:239], a[136:139], v[156:159]
  s_waitcnt lgkmcnt(10)
  v_mfma_f32_16x16x32_bf16 v[156:159], a[252:255], a[140:143], v[156:159]
  ds_read_b64_tr_b16 a[128:129], v28 offset:16384
  ds_read_b64_tr_b16 a[130:131], v28 offset:17408
  v_mfma_f32_16x16x32_bf16 v[152:155], a[248:251], a[140:143], v[152:155]
  v_mfma_f32_16x16x32_bf16 v[152:155], a[232:235], a[136:139], v[152:155]
  ds_read_b128 a[168:171], v12 offset:4096
  v_mfma_f32_16x16x32_bf16 v[148:151], a[228:231], a[136:139], v[148:151]
  v_mfma_f32_16x16x32_bf16 v[148:151], a[244:247], a[140:143], v[148:151]
  ds_read_b64_tr_b16 a[132:133], v28 offset:24576
  ds_read_b64_tr_b16 a[134:135], v28 offset:25600
  v_mfma_f32_16x16x32_bf16 v[144:147], a[240:243], a[140:143], v[144:147]
  v_mfma_f32_16x16x32_bf16 v[144:147], a[224:227], a[136:139], v[144:147]
  s_waitcnt lgkmcnt(13)
  ds_read_b128 a[172:175], v12 offset:6144
  v_mfma_f32_16x16x32_bf16 v[160:163], a[224:227], a[144:147], v[160:163]
  s_waitcnt lgkmcnt(12)
  v_mfma_f32_16x16x32_bf16 v[160:163], a[240:243], a[148:151], v[160:163]
  ds_read_b64_tr_b16 a[136:137], v29 offset:16384
  ds_read_b64_tr_b16 a[138:139], v29 offset:17408
  v_mfma_f32_16x16x32_bf16 v[164:167], a[244:247], a[148:151], v[164:167]
  v_mfma_f32_16x16x32_bf16 v[164:167], a[228:231], a[144:147], v[164:167]
  ds_read_b128 a[176:179], v13 offset:0
  v_mfma_f32_16x16x32_bf16 v[168:171], a[232:235], a[144:147], v[168:171]
  v_mfma_f32_16x16x32_bf16 v[168:171], a[248:251], a[148:151], v[168:171]
  ds_read_b64_tr_b16 a[140:141], v29 offset:24576
  ds_read_b64_tr_b16 a[142:143], v29 offset:25600
  v_mfma_f32_16x16x32_bf16 v[172:175], a[252:255], a[148:151], v[172:175]
  v_mfma_f32_16x16x32_bf16 v[172:175], a[236:239], a[144:147], v[172:175]
  s_waitcnt lgkmcnt(15)
  ds_read_b128 a[180:183], v13 offset:2048
  v_mfma_f32_16x16x32_bf16 v[188:191], a[236:239], a[152:155], v[188:191]
  s_waitcnt lgkmcnt(13)
  v_mfma_f32_16x16x32_bf16 v[188:191], a[252:255], a[156:159], v[188:191]
  ds_read_b64_tr_b16 a[144:145], v30 offset:16384
  ds_read_b64_tr_b16 a[146:147], v30 offset:17408
  v_mfma_f32_16x16x32_bf16 v[184:187], a[248:251], a[156:159], v[184:187]
  v_mfma_f32_16x16x32_bf16 v[184:187], a[232:235], a[152:155], v[184:187]
  ds_read_b128 a[184:187], v13 offset:4096
  v_mfma_f32_16x16x32_bf16 v[180:183], a[228:231], a[152:155], v[180:183]
  v_mfma_f32_16x16x32_bf16 v[180:183], a[244:247], a[156:159], v[180:183]
  ds_read_b64_tr_b16 a[148:149], v30 offset:24576
  ds_read_b64_tr_b16 a[150:151], v30 offset:25600
  v_mfma_f32_16x16x32_bf16 v[176:179], a[240:243], a[156:159], v[176:179]
  v_mfma_f32_16x16x32_bf16 v[176:179], a[224:227], a[152:155], v[176:179]
  s_waitcnt lgkmcnt(15)
  ds_read_b128 a[188:191], v13 offset:6144
  v_mfma_f32_16x16x32_bf16 v[192:195], a[224:227], a[128:131], v[192:195]
  s_waitcnt lgkmcnt(13)
  v_mov_b32 v2, v121
  v_mov_b32 v3, v122
  v_mfma_f32_16x16x32_bf16 v[192:195], a[240:243], a[132:135], v[192:195]
  ds_read_b64_tr_b16 a[152:153], v31 offset:16384
  ds_read_b64_tr_b16 a[154:155], v31 offset:17408
  v_mfma_f32_16x16x32_bf16 v[196:199], a[244:247], a[132:135], v[196:199]
  v_mov_b32 v4, v123
  v_mfma_f32_16x16x32_bf16 v[196:199], a[228:231], a[128:131], v[196:199]
  v_mfma_f32_16x16x32_bf16 v[200:203], a[232:235], a[128:131], v[200:203]
  v_mfma_f32_16x16x32_bf16 v[200:203], a[248:251], a[132:135], v[200:203]
  ds_read_b64_tr_b16 a[156:157], v31 offset:24576
  ds_read_b64_tr_b16 a[158:159], v31 offset:25600
  v_mfma_f32_16x16x32_bf16 v[204:207], a[252:255], a[132:135], v[204:207]
  s_waitcnt lgkmcnt(14)
  v_mfma_f32_16x16x32_bf16 v[204:207], a[236:239], a[128:131], v[204:207]
  s_barrier
  v_mfma_f32_16x16x32_bf16 v[220:223], a[236:239], a[136:139], v[220:223]
  s_waitcnt lgkmcnt(11)
  buffer_load_dwordx4 v2, s[96:99], s87 offen offset:0 lds
  v_mfma_f32_16x16x32_bf16 v[220:223], a[252:255], a[140:143], v[220:223]
  ds_read_b64_tr_b16 a[128:129], v16 offset:0
  ds_read_b64_tr_b16 a[130:131], v16 offset:1024
  v_mfma_f32_16x16x32_bf16 v[216:219], a[248:251], a[140:143], v[216:219]
  v_mfma_f32_16x16x32_bf16 v[216:219], a[232:235], a[136:139], v[216:219]
  buffer_load_dwordx4 v3, s[96:99], s87 offen offset:1024 lds
  v_mfma_f32_16x16x32_bf16 v[212:215], a[228:231], a[136:139], v[212:215]
  s_add_u32 s87, s87, 262144
  v_mfma_f32_16x16x32_bf16 v[212:215], a[244:247], a[140:143], v[212:215]
  s_add_u32 m0, s1, 65536
  ds_read_b64_tr_b16 a[132:133], v16 offset:8192
  ds_read_b64_tr_b16 a[134:135], v16 offset:9216
  v_mfma_f32_16x16x32_bf16 v[208:211], a[240:243], a[140:143], v[208:211]
  buffer_load_dwordx4 v4, s[16:19], s89 offen lds
  v_mfma_f32_16x16x32_bf16 v[208:211], a[224:227], a[136:139], v[208:211]
  s_waitcnt lgkmcnt(12)
  v_mfma_f32_16x16x32_bf16 v[224:227], a[224:227], a[144:147], v[224:227]
  s_waitcnt lgkmcnt(9)
  v_mfma_f32_16x16x32_bf16 v[224:227], a[240:243], a[148:151], v[224:227]
  s_add_u32 s89, s89, 110592
  ds_read_b64_tr_b16 a[136:137], v17 offset:0
  ds_read_b64_tr_b16 a[138:139], v17 offset:1024
  v_mfma_f32_16x16x32_bf16 v[228:231], a[244:247], a[148:151], v[228:231]
  s_add_u32 m0, s3, 0
  v_mfma_f32_16x16x32_bf16 v[228:231], a[228:231], a[144:147], v[228:231]
  v_mfma_f32_16x16x32_bf16 v[232:235], a[232:235], a[144:147], v[232:235]
  v_mfma_f32_16x16x32_bf16 v[232:235], a[248:251], a[148:151], v[232:235]
  ds_read_b64_tr_b16 a[140:141], v17 offset:8192
  ds_read_b64_tr_b16 a[142:143], v17 offset:9216
  v_mfma_f32_16x16x32_bf16 v[236:239], a[252:255], a[148:151], v[236:239]
  v_mfma_f32_16x16x32_bf16 v[236:239], a[236:239], a[144:147], v[236:239]
  s_waitcnt lgkmcnt(10)
  v_mfma_f32_16x16x32_bf16 v[252:255], a[236:239], a[152:155], v[252:255]
  s_waitcnt lgkmcnt(8)
  v_mfma_f32_16x16x32_bf16 v[252:255], a[252:255], a[156:159], v[252:255]
  ds_read_b64_tr_b16 a[144:145], v18 offset:0
  ds_read_b64_tr_b16 a[146:147], v18 offset:1024
  v_mfma_f32_16x16x32_bf16 v[248:251], a[248:251], a[156:159], v[248:251]
  v_mfma_f32_16x16x32_bf16 v[248:251], a[232:235], a[152:155], v[248:251]
  v_mfma_f32_16x16x32_bf16 v[244:247], a[228:231], a[152:155], v[244:247]
  v_mfma_f32_16x16x32_bf16 v[244:247], a[244:247], a[156:159], v[244:247]
  ds_read_b64_tr_b16 a[148:149], v18 offset:8192
  ds_read_b64_tr_b16 a[150:151], v18 offset:9216
  v_mfma_f32_16x16x32_bf16 v[240:243], a[240:243], a[156:159], v[240:243]
  v_mfma_f32_16x16x32_bf16 v[240:243], a[224:227], a[152:155], v[240:243]
  s_waitcnt lgkmcnt(10)
  v_mfma_f32_16x16x32_bf16 a[0:3], a[128:131], a[160:163], a[0:3]
  s_waitcnt lgkmcnt(8)
  v_mfma_f32_16x16x32_bf16 a[0:3], a[132:135], a[176:179], a[0:3]
  ds_read_b64_tr_b16 a[152:153], v19 offset:0
  ds_read_b64_tr_b16 a[154:155], v19 offset:1024
  v_mfma_f32_16x16x32_bf16 a[32:35], a[132:135], a[180:183], a[32:35]
  v_mfma_f32_16x16x32_bf16 a[32:35], a[128:131], a[164:167], a[32:35]
  v_mfma_f32_16x16x32_bf16 a[64:67], a[128:131], a[168:171], a[64:67]
  buffer_load_dwordx4 v124, s[28:31], s50 offen offset:0 lds
  v_mfma_f32_16x16x32_bf16 a[64:67], a[132:135], a[184:187], a[64:67]
  ds_read_b64_tr_b16 a[156:157], v19 offset:8192
  ds_read_b64_tr_b16 a[158:159], v19 offset:9216
  v_mfma_f32_16x16x32_bf16 a[96:99], a[132:135], a[188:191], a[96:99]
  v_mfma_f32_16x16x32_bf16 a[96:99], a[128:131], a[172:175], a[96:99]
  s_waitcnt lgkmcnt(10)
  buffer_load_dwordx4 v125, s[28:31], s50 offen offset:1024 lds
  v_mfma_f32_16x16x32_bf16 a[100:103], a[136:139], a[172:175], a[100:103]
  s_waitcnt lgkmcnt(8)
  v_mfma_f32_16x16x32_bf16 a[100:103], a[140:143], a[188:191], a[100:103]
  s_add_u32 m0, s3, 2048
  ds_read_b64_tr_b16 a[128:129], v20 offset:0
  ds_read_b64_tr_b16 a[130:131], v20 offset:1024
  v_mfma_f32_16x16x32_bf16 a[68:71], a[140:143], a[184:187], a[68:71]
  s_bitcmp1_b32 s65, 1
  s_cselect_b64 s[28:29], s[66:67], s[58:59]
  s_mov_b32 s30, 5242880
  s_cselect_b32 s30, 2211840, s30
  v_mfma_f32_16x16x32_bf16 a[68:71], a[136:139], a[168:171], a[68:71]
  v_mfma_f32_16x16x32_bf16 a[36:39], a[136:139], a[164:167], a[36:39]
  v_mfma_f32_16x16x32_bf16 a[36:39], a[140:143], a[180:183], a[36:39]
  ds_read_b64_tr_b16 a[132:133], v20 offset:8192
  ds_read_b64_tr_b16 a[134:135], v20 offset:9216
  v_mfma_f32_16x16x32_bf16 a[4:7], a[140:143], a[176:179], a[4:7]
  v_mfma_f32_16x16x32_bf16 a[4:7], a[136:139], a[160:163], a[4:7]
  s_waitcnt lgkmcnt(10)
  v_mfma_f32_16x16x32_bf16 a[8:11], a[144:147], a[160:163], a[8:11]
  s_waitcnt lgkmcnt(8)
  v_mfma_f32_16x16x32_bf16 a[8:11], a[148:151], a[176:179], a[8:11]
  ds_read_b64_tr_b16 a[136:137], v21 offset:0
  ds_read_b64_tr_b16 a[138:139], v21 offset:1024
  v_mfma_f32_16x16x32_bf16 a[40:43], a[148:151], a[180:183], a[40:43]
  v_mfma_f32_16x16x32_bf16 a[40:43], a[144:147], a[164:167], a[40:43]
  v_mfma_f32_16x16x32_bf16 a[72:75], a[144:147], a[168:171], a[72:75]
  v_mfma_f32_16x16x32_bf16 a[72:75], a[148:151], a[184:187], a[72:75]
  ds_read_b64_tr_b16 a[140:141], v21 offset:8192
  ds_read_b64_tr_b16 a[142:143], v21 offset:9216
  v_mfma_f32_16x16x32_bf16 a[104:107], a[148:151], a[188:191], a[104:107]
  v_mfma_f32_16x16x32_bf16 a[104:107], a[144:147], a[172:175], a[104:107]
  s_waitcnt lgkmcnt(10)
  v_mfma_f32_16x16x32_bf16 a[108:111], a[152:155], a[172:175], a[108:111]
  s_waitcnt lgkmcnt(8)
  v_mfma_f32_16x16x32_bf16 a[108:111], a[156:159], a[188:191], a[108:111]
  ds_read_b64_tr_b16 a[144:145], v22 offset:0
  ds_read_b64_tr_b16 a[146:147], v22 offset:1024
  v_mfma_f32_16x16x32_bf16 a[76:79], a[156:159], a[184:187], a[76:79]
  v_mfma_f32_16x16x32_bf16 a[76:79], a[152:155], a[168:171], a[76:79]
  v_mfma_f32_16x16x32_bf16 a[44:47], a[152:155], a[164:167], a[44:47]
  buffer_load_dwordx4 v124, s[28:31], s51 offen offset:0 lds
  v_mfma_f32_16x16x32_bf16 a[44:47], a[156:159], a[180:183], a[44:47]
  ds_read_b64_tr_b16 a[148:149], v22 offset:8192
  ds_read_b64_tr_b16 a[150:151], v22 offset:9216
  v_mfma_f32_16x16x32_bf16 a[12:15], a[156:159], a[176:179], a[12:15]
  v_mfma_f32_16x16x32_bf16 a[12:15], a[152:155], a[160:163], a[12:15]
  s_waitcnt lgkmcnt(10)
  buffer_load_dwordx4 v125, s[28:31], s51 offen offset:1024 lds
  v_mfma_f32_16x16x32_bf16 a[16:19], a[128:131], a[160:163], a[16:19]
  s_waitcnt lgkmcnt(8)
  v_mfma_f32_16x16x32_bf16 a[16:19], a[132:135], a[176:179], a[16:19]
  s_add_u32 m0, s0, 81920
  ds_read_b64_tr_b16 a[152:153], v23 offset:0
  ds_read_b64_tr_b16 a[154:155], v23 offset:1024
  v_mfma_f32_16x16x32_bf16 a[48:51], a[132:135], a[180:183], a[48:51]
  buffer_load_dword v115, v113, s[36:39], 0 offen sc1
  v_mfma_f32_16x16x32_bf16 a[48:51], a[128:131], a[164:167], a[48:51]
  s_bitcmp1_b32 s65, 2
  s_cselect_b64 s[28:29], s[66:67], s[58:59]
  s_mov_b32 s30, 5242880
  s_cselect_b32 s30, 2211840, s30
  v_mfma_f32_16x16x32_bf16 a[80:83], a[128:131], a[168:171], a[80:83]
  v_mfma_f32_16x16x32_bf16 a[80:83], a[132:135], a[184:187], a[80:83]
  ds_read_b64_tr_b16 a[156:157], v23 offset:8192
  ds_read_b64_tr_b16 a[158:159], v23 offset:9216
  v_mfma_f32_16x16x32_bf16 a[112:115], a[132:135], a[188:191], a[112:115]
  s_waitcnt vmcnt(27) lgkmcnt(10)
  v_mfma_f32_16x16x32_bf16 a[112:115], a[128:131], a[172:175], a[112:115]
  s_barrier
  v_mfma_f32_16x16x32_bf16 a[116:119], a[136:139], a[172:175], a[116:119]
  s_waitcnt lgkmcnt(8)
  buffer_load_dwordx4 v2, s[96:99], s87 offen offset:0 lds
  v_mfma_f32_16x16x32_bf16 a[116:119], a[140:143], a[188:191], a[116:119]
  ds_read_b64_tr_b16 a[128:129], v16 offset:16384
  ds_read_b64_tr_b16 a[130:131], v16 offset:17408
  v_mfma_f32_16x16x32_bf16 a[84:87], a[140:143], a[184:187], a[84:87]
  v_mfma_f32_16x16x32_bf16 a[84:87], a[136:139], a[168:171], a[84:87]
  buffer_load_dwordx4 v3, s[96:99], s87 offen offset:1024 lds
  v_mfma_f32_16x16x32_bf16 a[52:55], a[136:139], a[164:167], a[52:55]
  s_add_u32 s87, s87, 262144
  v_mfma_f32_16x16x32_bf16 a[52:55], a[140:143], a[180:183], a[52:55]
  s_add_u32 m0, s1, 81920
  ds_read_b64_tr_b16 a[132:133], v16 offset:24576
  ds_read_b64_tr_b16 a[134:135], v16 offset:25600
  v_mfma_f32_16x16x32_bf16 a[20:23], a[140:143], a[176:179], a[20:23]
  buffer_load_dwordx4 v4, s[16:19], s89 offen lds
  v_mfma_f32_16x16x32_bf16 a[20:23], a[136:139], a[160:163], a[20:23]
  s_waitcnt lgkmcnt(10)
  v_mfma_f32_16x16x32_bf16 a[24:27], a[144:147], a[160:163], a[24:27]
  s_waitcnt lgkmcnt(8)
  v_mfma_f32_16x16x32_bf16 a[24:27], a[148:151], a[176:179], a[24:27]
  s_add_u32 s89, s89, 110592
  ds_read_b64_tr_b16 a[136:137], v17 offset:16384
  ds_read_b64_tr_b16 a[138:139], v17 offset:17408
  v_mfma_f32_16x16x32_bf16 a[56:59], a[148:151], a[180:183], a[56:59]
  s_add_u32 m0, s3, 4096
  v_mfma_f32_16x16x32_bf16 a[56:59], a[144:147], a[164:167], a[56:59]
  v_mfma_f32_16x16x32_bf16 a[88:91], a[144:147], a[168:171], a[88:91]
  buffer_load_dwordx4 v124, s[28:31], s52 offen offset:0 lds
  v_mfma_f32_16x16x32_bf16 a[88:91], a[148:151], a[184:187], a[88:91]
  ds_read_b64_tr_b16 a[140:141], v17 offset:24576
  ds_read_b64_tr_b16 a[142:143], v17 offset:25600
  v_mfma_f32_16x16x32_bf16 a[120:123], a[148:151], a[188:191], a[120:123]
  v_mfma_f32_16x16x32_bf16 a[120:123], a[144:147], a[172:175], a[120:123]
  s_waitcnt lgkmcnt(10)
  buffer_load_dwordx4 v125, s[28:31], s52 offen offset:1024 lds
  v_mfma_f32_16x16x32_bf16 a[124:127], a[152:155], a[172:175], a[124:127]
  s_waitcnt lgkmcnt(8)
  v_mfma_f32_16x16x32_bf16 a[124:127], a[156:159], a[188:191], a[124:127]
  s_add_u32 m0, s3, 6144
  ds_read_b64_tr_b16 a[144:145], v18 offset:16384
  ds_read_b64_tr_b16 a[146:147], v18 offset:17408
  v_mfma_f32_16x16x32_bf16 a[92:95], a[156:159], a[184:187], a[92:95]
  s_bitcmp1_b32 s65, 3
  s_cselect_b64 s[28:29], s[66:67], s[58:59]
  s_mov_b32 s30, 5242880
  s_cselect_b32 s30, 2211840, s30
L_padA3:
  s_cbranch_execz L_padA7
  v_mfma_f32_16x16x32_bf16 a[92:95], a[152:155], a[168:171], a[92:95]
  v_mfma_f32_16x16x32_bf16 a[60:63], a[152:155], a[164:167], a[60:63]
  v_mfma_f32_16x16x32_bf16 a[60:63], a[156:159], a[180:183], a[60:63]
  ds_read_b64_tr_b16 a[148:149], v18 offset:24576
  ds_read_b64_tr_b16 a[150:151], v18 offset:25600
  v_mfma_f32_16x16x32_bf16 a[28:31], a[156:159], a[176:179], a[28:31]
  v_mfma_f32_16x16x32_bf16 a[28:31], a[152:155], a[160:163], a[28:31]
  s_waitcnt lgkmcnt(10)
  v_mfma_f32_16x16x32_bf16 v[128:131], a[160:163], a[128:131], v[128:131]
  s_waitcnt lgkmcnt(8)
  v_lshlrev_b32 v40, 16, v42
  v_and_b32 v41, 0xffff0000, v42
  v_mfma_f32_16x16x32_bf16 v[128:131], a[176:179], a[132:135], v[128:131]
  ds_read_b64_tr_b16 a[152:153], v19 offset:16384
  ds_read_b64_tr_b16 a[154:155], v19 offset:17408
  v_mfma_f32_16x16x32_bf16 v[132:135], a[180:183], a[132:135], v[132:135]
  s_waitcnt vmcnt(18)
  v_lshlrev_b32 v42, 16, v43
  v_and_b32 v43, 0xffff0000, v43
  v_mfma_f32_16x16x32_bf16 v[132:135], a[164:167], a[128:131], v[132:135]
  ds_read_b128 a[192:195], v12 offset:8192
  v_mul_f32 v40, 0x3e0293ee, v40
  v_mfma_f32_16x16x32_bf16 v[136:139], a[168:171], a[128:131], v[136:139]
  v_mul_f32 v41, 0x3e0293ee, v41
  v_mul_f32 v42, 0x3e0293ee, v42
  v_mfma_f32_16x16x32_bf16 v[136:139], a[184:187], a[132:135], v[136:139]
  ds_read_b64_tr_b16 a[156:157], v19 offset:24576
  ds_read_b64_tr_b16 a[158:159], v19 offset:25600
  v_mfma_f32_16x16x32_bf16 v[140:143], a[188:191], a[132:135], v[140:143]
  v_mul_f32 v43, 0x3e0293ee, v43
  v_lshlrev_b32 v44, 16, v46
  v_mfma_f32_16x16x32_bf16 v[140:143], a[172:175], a[128:131], v[140:143]
  s_waitcnt lgkmcnt(11)
  ds_read_b128 a[196:199], v12 offset:10240
  v_and_b32 v45, 0xffff0000, v46
  v_mfma_f32_16x16x32_bf16 v[156:159], a[172:175], a[136:139], v[156:159]
  s_waitcnt lgkmcnt(10)
  v_lshlrev_b32 v46, 16, v47
  v_and_b32 v47, 0xffff0000, v47
  v_mfma_f32_16x16x32_bf16 v[156:159], a[188:191], a[140:143], v[156:159]
  ds_read_b64_tr_b16 a[128:129], v20 offset:16384
  ds_read_b64_tr_b16 a[130:131], v20 offset:17408
  v_mfma_f32_16x16x32_bf16 v[152:155], a[184:187], a[140:143], v[152:155]
  v_mul_f32 v44, 0x3e0293ee, v44
  v_mul_f32 v45, 0x3e0293ee, v45
  v_mfma_f32_16x16x32_bf16 v[152:155], a[168:171], a[136:139], v[152:155]
  ds_read_b128 a[200:203], v12 offset:12288
  v_mul_f32 v46, 0x3e0293ee, v46
  v_mfma_f32_16x16x32_bf16 v[148:151], a[164:167], a[136:139], v[148:151]
  buffer_load_dwordx4 v124, s[28:31], s53 offen offset:0 lds
  v_mfma_f32_16x16x32_bf16 v[148:151], a[180:183], a[140:143], v[148:151]
  ds_read_b64_tr_b16 a[132:133], v20 offset:24576
  ds_read_b64_tr_b16 a[134:135], v20 offset:25600
  v_mfma_f32_16x16x32_bf16 v[144:147], a[176:179], a[140:143], v[144:147]
  v_mul_f32 v47, 0x3e0293ee, v47
  v_lshlrev_b32 v48, 16, v50
  v_mfma_f32_16x16x32_bf16 v[144:147], a[160:163], a[136:139], v[144:147]
  s_waitcnt lgkmcnt(13)
  ds_read_b128 a[204:207], v12 offset:14336
  v_and_b32 v49, 0xffff0000, v50
  v_mfma_f32_16x16x32_bf16 v[160:163], a[160:163], a[144:147], v[160:163]
  s_waitcnt lgkmcnt(12)
  buffer_load_dwordx4 v125, s[28:31], s53 offen offset:1024 lds
  v_mfma_f32_16x16x32_bf16 v[160:163], a[176:179], a[148:151], v[160:163]
  s_add_u32 m0, s0, 0
  ds_read_b64_tr_b16 a[136:137], v21 offset:16384
  ds_read_b64_tr_b16 a[138:139], v21 offset:17408
  v_mfma_f32_16x16x32_bf16 v[164:167], a[180:183], a[148:151], v[164:167]
  v_lshlrev_b32 v50, 16, v51
  v_and_b32 v51, 0xffff0000, v51
  v_mfma_f32_16x16x32_bf16 v[164:167], a[164:167], a[144:147], v[164:167]
  ds_read_b128 a[208:211], v13 offset:8192
  v_mul_f32 v48, 0x3e0293ee, v48
  v_mfma_f32_16x16x32_bf16 v[168:171], a[168:171], a[144:147], v[168:171]
  v_mul_f32 v49, 0x3e0293ee, v49
  v_mul_f32 v50, 0x3e0293ee, v50
  v_mfma_f32_16x16x32_bf16 v[168:171], a[184:187], a[148:151], v[168:171]
  ds_read_b64_tr_b16 a[140:141], v21 offset:24576
  ds_read_b64_tr_b16 a[142:143], v21 offset:25600
  v_mfma_f32_16x16x32_bf16 v[172:175], a[188:191], a[148:151], v[172:175]
  v_mul_f32 v51, 0x3e0293ee, v51
  v_lshlrev_b32 v52, 16, v54
  v_mfma_f32_16x16x32_bf16 v[172:175], a[172:175], a[144:147], v[172:175]
  s_waitcnt lgkmcnt(15)
  ds_read_b128 a[212:215], v13 offset:10240
  v_and_b32 v53, 0xffff0000, v54
  v_mfma_f32_16x16x32_bf16 v[188:191], a[172:175], a[152:155], v[188:191]
  s_waitcnt lgkmcnt(13)
  v_lshlrev_b32 v54, 16, v55
  v_and_b32 v55, 0xffff0000, v55
  v_mfma_f32_16x16x32_bf16 v[188:191], a[188:191], a[156:159], v[188:191]
  ds_read_b64_tr_b16 a[144:145], v22 offset:16384
  ds_read_b64_tr_b16 a[146:147], v22 offset:17408
  v_mfma_f32_16x16x32_bf16 v[184:187], a[184:187], a[156:159], v[184:187]
  v_mul_f32 v52, 0x3e0293ee, v52
  v_mul_f32 v53, 0x3e0293ee, v53
  v_mfma_f32_16x16x32_bf16 v[184:187], a[168:171], a[152:155], v[184:187]
  ds_read_b128 a[216:219], v13 offset:12288
  v_mul_f32 v54, 0x3e0293ee, v54
  v_mfma_f32_16x16x32_bf16 v[180:183], a[164:167], a[152:155], v[180:183]
  v_mul_f32 v55, 0x3e0293ee, v55
  v_mfma_f32_16x16x32_bf16 v[180:183], a[180:183], a[156:159], v[180:183]
  ds_read_b64_tr_b16 a[148:149], v22 offset:24576
  ds_read_b64_tr_b16 a[150:151], v22 offset:25600
  v_mfma_f32_16x16x32_bf16 v[176:179], a[176:179], a[156:159], v[176:179]
  v_mfma_f32_16x16x32_bf16 v[176:179], a[160:163], a[152:155], v[176:179]
  s_waitcnt lgkmcnt(12)
  ds_read_b128 a[220:223], v13 offset:14336
  s_waitcnt vmcnt(7)
  v_cmp_ne_u32 vcc, v115, v114
  v_mfma_f32_16x16x32_bf16 v[192:195], a[160:163], a[128:131], v[192:195]
  s_cbranch_vccnz L_xn_spin
L_xn_ok:
  v_mfma_f32_16x16x32_bf16 v[192:195], a[176:179], a[132:135], v[192:195]
  ds_read_b64_tr_b16 a[152:153], v23 offset:16384
  ds_read_b64_tr_b16 a[154:155], v23 offset:17408
  v_mfma_f32_16x16x32_bf16 v[196:199], a[180:183], a[132:135], v[196:199]
  v_mfma_f32_16x16x32_bf16 v[196:199], a[164:167], a[128:131], v[196:199]
  v_mfma_f32_16x16x32_bf16 v[200:203], a[168:171], a[128:131], v[200:203]
  v_mfma_f32_16x16x32_bf16 v[200:203], a[184:187], a[132:135], v[200:203]
  ds_read_b64_tr_b16 a[156:157], v23 offset:24576
  ds_read_b64_tr_b16 a[158:159], v23 offset:25600
  v_mfma_f32_16x16x32_bf16 v[204:207], a[188:191], a[132:135], v[204:207]
  s_waitcnt lgkmcnt(14)
  v_mfma_f32_16x16x32_bf16 v[204:207], a[172:175], a[128:131], v[204:207]
  s_barrier
  v_mfma_f32_16x16x32_bf16 v[220:223], a[172:175], a[136:139], v[220:223]
  s_waitcnt lgkmcnt(11)
  buffer_load_dwordx4 v2, s[96:99], s87 offen offset:0 lds
  v_mfma_f32_16x16x32_bf16 v[220:223], a[188:191], a[140:143], v[220:223]
  ds_read_b64_tr_b16 a[128:129], v16 offset:32768
  ds_read_b64_tr_b16 a[130:131], v16 offset:33792
  v_mfma_f32_16x16x32_bf16 v[216:219], a[184:187], a[140:143], v[216:219]
  v_mov_b32 v12, v120
  v_mfma_f32_16x16x32_bf16 v[216:219], a[168:171], a[136:139], v[216:219]
  buffer_load_dwordx4 v3, s[96:99], s87 offen offset:1024 lds
  v_mfma_f32_16x16x32_bf16 v[212:215], a[164:167], a[136:139], v[212:215]
  s_add_u32 s87, s87, 262144
  v_mfma_f32_16x16x32_bf16 v[212:215], a[180:183], a[140:143], v[212:215]
  s_add_u32 m0, s1, 0
  ds_read_b64_tr_b16 a[132:133], v16 offset:40960
  ds_read_b64_tr_b16 a[134:135], v16 offset:41984
  v_mfma_f32_16x16x32_bf16 v[208:211], a[176:179], a[140:143], v[208:211]
  buffer_load_dwordx4 v4, s[16:19], s89 offen lds
  v_mfma_f32_16x16x32_bf16 v[208:211], a[160:163], a[136:139], v[208:211]
  s_waitcnt lgkmcnt(12)
  v_mfma_f32_16x16x32_bf16 v[224:227], a[160:163], a[144:147], v[224:227]
  s_waitcnt lgkmcnt(9)
  v_mfma_f32_16x16x32_bf16 v[224:227], a[176:179], a[148:151], v[224:227]
  s_add_u32 s89, s89, 110592
  ds_read_b64_tr_b16 a[136:137], v17 offset:32768
  ds_read_b64_tr_b16 a[138:139], v17 offset:33792
  v_mfma_f32_16x16x32_bf16 v[228:231], a[180:183], a[148:151], v[228:231]
  buffer_load_dword v127, v112, s[44:47], 0 offen sc1
  v_mfma_f32_16x16x32_bf16 v[228:231], a[164:167], a[144:147], v[228:231]
  s_add_u32 m0, s0, 16384
  v_mfma_f32_16x16x32_bf16 v[232:235], a[168:171], a[144:147], v[232:235]
  v_mfma_f32_16x16x32_bf16 v[232:235], a[184:187], a[148:151], v[232:235]
  ds_read_b64_tr_b16 a[140:141], v17 offset:40960
  ds_read_b64_tr_b16 a[142:143], v17 offset:41984
  v_mfma_f32_16x16x32_bf16 v[236:239], a[188:191], a[148:151], v[236:239]
  buffer_load_dwordx4 a[224:227], v10, s[44:47], s60 offen offset:0 sc1
  v_mfma_f32_16x16x32_bf16 v[236:239], a[172:175], a[144:147], v[236:239]
  s_waitcnt lgkmcnt(10)
  v_mfma_f32_16x16x32_bf16 v[252:255], a[172:175], a[152:155], v[252:255]
  s_waitcnt lgkmcnt(8)
  v_mfma_f32_16x16x32_bf16 v[252:255], a[188:191], a[156:159], v[252:255]
  ds_read_b64_tr_b16 a[144:145], v18 offset:32768
  ds_read_b64_tr_b16 a[146:147], v18 offset:33792
  v_mfma_f32_16x16x32_bf16 v[248:251], a[184:187], a[156:159], v[248:251]
  buffer_load_dwordx4 a[228:231], v10, s[44:47], s61 offen offset:0 sc1
  v_mfma_f32_16x16x32_bf16 v[248:251], a[168:171], a[152:155], v[248:251]
  v_mfma_f32_16x16x32_bf16 v[244:247], a[164:167], a[152:155], v[244:247]
  v_mfma_f32_16x16x32_bf16 v[244:247], a[180:183], a[156:159], v[244:247]
  ds_read_b64_tr_b16 a[148:149], v18 offset:40960
  ds_read_b64_tr_b16 a[150:151], v18 offset:41984
  v_mfma_f32_16x16x32_bf16 v[240:243], a[176:179], a[156:159], v[240:243]
  buffer_load_dwordx4 a[232:235], v11, s[44:47], s60 offen offset:0 sc1
  v_mfma_f32_16x16x32_bf16 v[240:243], a[160:163], a[152:155], v[240:243]
  s_waitcnt lgkmcnt(10)
  v_mfma_f32_16x16x32_bf16 a[0:3], a[128:131], a[192:195], a[0:3]
  s_waitcnt lgkmcnt(8)
  v_mfma_f32_16x16x32_bf16 a[0:3], a[132:135], a[208:211], a[0:3]
  ds_read_b64_tr_b16 a[152:153], v19 offset:32768
  ds_read_b64_tr_b16 a[154:155], v19 offset:33792
  v_mfma_f32_16x16x32_bf16 a[32:35], a[132:135], a[212:215], a[32:35]
  buffer_load_dwordx4 a[236:239], v11, s[44:47], s61 offen offset:0 sc1
  v_mfma_f32_16x16x32_bf16 a[32:35], a[128:131], a[196:199], a[32:35]
  v_mfma_f32_16x16x32_bf16 a[64:67], a[128:131], a[200:203], a[64:67]
  v_mfma_f32_16x16x32_bf16 a[64:67], a[132:135], a[216:219], a[64:67]
  ds_read_b64_tr_b16 a[156:157], v19 offset:40960
  ds_read_b64_tr_b16 a[158:159], v19 offset:41984
  v_mfma_f32_16x16x32_bf16 a[96:99], a[132:135], a[220:223], a[96:99]
  buffer_load_dwordx4 a[240:243], v10, s[44:47], s60 offen offset:1024 sc1
  v_mfma_f32_16x16x32_bf16 a[96:99], a[128:131], a[204:207], a[96:99]
  s_waitcnt lgkmcnt(10)
  v_mfma_f32_16x16x32_bf16 a[100:103], a[136:139], a[204:207], a[100:103]
  s_waitcnt lgkmcnt(8)
  v_mfma_f32_16x16x32_bf16 a[100:103], a[140:143], a[220:223], a[100:103]
  ds_read_b64_tr_b16 a[128:129], v20 offset:32768
  ds_read_b64_tr_b16 a[130:131], v20 offset:33792
  v_mfma_f32_16x16x32_bf16 a[68:71], a[140:143], a[216:219], a[68:71]
  buffer_load_dwordx4 a[244:247], v10, s[44:47], s61 offen offset:1024 sc1
  v_mfma_f32_16x16x32_bf16 a[68:71], a[136:139], a[200:203], a[68:71]
  v_mfma_f32_16x16x32_bf16 a[36:39], a[136:139], a[196:199], a[36:39]
  v_mfma_f32_16x16x32_bf16 a[36:39], a[140:143], a[212:215], a[36:39]
  ds_read_b64_tr_b16 a[132:133], v20 offset:40960
  ds_read_b64_tr_b16 a[134:135], v20 offset:41984
  v_mfma_f32_16x16x32_bf16 a[4:7], a[140:143], a[208:211], a[4:7]
  buffer_load_dwordx4 a[248:251], v11, s[44:47], s60 offen offset:1024 sc1
  v_mfma_f32_16x16x32_bf16 a[4:7], a[136:139], a[192:195], a[4:7]
  s_waitcnt lgkmcnt(10)
  v_accvgpr_read_b32 v56, a0
  v_accvgpr_read_b32 v57, a1
  v_mfma_f32_16x16x32_bf16 a[8:11], a[144:147], a[192:195], a[8:11]
  s_waitcnt lgkmcnt(8)
  v_cvt_pk_bf16_f32 v64, v56, v57
  v_accvgpr_read_b32 v58, a2
  v_mfma_f32_16x16x32_bf16 a[8:11], a[148:151], a[208:211], a[8:11]
  ds_read_b64_tr_b16 a[136:137], v21 offset:32768
  ds_read_b64_tr_b16 a[138:139], v21 offset:33792
  v_mfma_f32_16x16x32_bf16 a[40:43], a[148:151], a[212:215], a[40:43]
  buffer_load_dwordx4 a[252:255], v11, s[44:47], s61 offen offset:1024 sc1
  v_mfma_f32_16x16x32_bf16 a[40:43], a[144:147], a[196:199], a[40:43]
  v_accvgpr_read_b32 v59, a3
  v_cvt_pk_bf16_f32 v65, v58, v59
  v_mfma_f32_16x16x32_bf16 a[72:75], a[144:147], a[200:203], a[72:75]
  v_accvgpr_read_b32 v56, a32
  v_accvgpr_read_b32 v57, a33
  v_mfma_f32_16x16x32_bf16 a[72:75], a[148:151], a[216:219], a[72:75]
  ds_read_b64_tr_b16 a[140:141], v21 offset:40960
  ds_read_b64_tr_b16 a[142:143], v21 offset:41984
  v_mfma_f32_16x16x32_bf16 a[104:107], a[148:151], a[220:223], a[104:107]
  buffer_load_dwordx4 a[160:163], v10, s[44:47], s60 offen offset:2048 sc1
  v_mfma_f32_16x16x32_bf16 a[104:107], a[144:147], a[204:207], a[104:107]
  s_waitcnt lgkmcnt(10)
  v_cvt_pk_bf16_f32 v80, v56, v57
  v_accvgpr_read_b32 v58, a34
  v_mfma_f32_16x16x32_bf16 a[108:111], a[152:155], a[204:207], a[108:111]
  s_waitcnt lgkmcnt(8)
  v_accvgpr_read_b32 v59, a35
  v_cvt_pk_bf16_f32 v81, v58, v59
  v_mfma_f32_16x16x32_bf16 a[108:111], a[156:159], a[220:223], a[108:111]
  ds_read_b64_tr_b16 a[144:145], v22 offset:32768
  ds_read_b64_tr_b16 a[146:147], v22 offset:33792
  v_mfma_f32_16x16x32_bf16 a[76:79], a[156:159], a[216:219], a[76:79]
  buffer_load_dwordx4 a[164:167], v10, s[44:47], s61 offen offset:2048 sc1
  v_mfma_f32_16x16x32_bf16 a[76:79], a[152:155], a[200:203], a[76:79]
  v_accvgpr_read_b32 v56, a64
  v_accvgpr_read_b32 v57, a65
  v_mfma_f32_16x16x32_bf16 a[44:47], a[152:155], a[196:199], a[44:47]
  v_cvt_pk_bf16_f32 v96, v56, v57
  v_accvgpr_read_b32 v58, a66
  v_mfma_f32_16x16x32_bf16 a[44:47], a[156:159], a[212:215], a[44:47]
  ds_read_b64_tr_b16 a[148:149], v22 offset:40960
  ds_read_b64_tr_b16 a[150:151], v22 offset:41984
  v_mfma_f32_16x16x32_bf16 a[12:15], a[156:159], a[208:211], a[12:15]
  buffer_load_dwordx4 a[168:171], v11, s[44:47], s60 offen offset:2048 sc1
  v_mfma_f32_16x16x32_bf16 a[12:15], a[152:155], a[192:195], a[12:15]
  s_waitcnt lgkmcnt(10)
  v_accvgpr_read_b32 v59, a67
  v_cvt_pk_bf16_f32 v97, v58, v59
  v_mfma_f32_16x16x32_bf16 a[16:19], a[128:131], a[192:195], a[16:19]
  s_waitcnt lgkmcnt(8)
  v_accvgpr_read_b32 v56, a96
  v_accvgpr_read_b32 v57, a97
  v_mfma_f32_16x16x32_bf16 a[16:19], a[132:135], a[208:211], a[16:19]
  ds_read_b64_tr_b16 a[152:153], v23 offset:32768
  ds_read_b64_tr_b16 a[154:155], v23 offset:33792
  v_mfma_f32_16x16x32_bf16 a[48:51], a[132:135], a[212:215], a[48:51]
  buffer_load_dwordx4 a[172:175], v11, s[44:47], s61 offen offset:2048 sc1
  v_mfma_f32_16x16x32_bf16 a[48:51], a[128:131], a[196:199], a[48:51]
  v_accvgpr_read_b32 v58, a98
  v_accvgpr_read_b32 v59, a99
  v_mfma_f32_16x16x32_bf16 a[80:83], a[128:131], a[200:203], a[80:83]
  v_cvt_pk_bf16_f32 v112, v56, v57
  v_cvt_pk_bf16_f32 v113, v58, v59
  v_mfma_f32_16x16x32_bf16 a[80:83], a[132:135], a[216:219], a[80:83]
  ds_read_b64_tr_b16 a[156:157], v23 offset:40960
  ds_read_b64_tr_b16 a[158:159], v23 offset:41984
  v_mfma_f32_16x16x32_bf16 a[112:115], a[132:135], a[220:223], a[112:115]
  s_waitcnt lgkmcnt(10)
  buffer_load_dwordx4 a[176:179], v10, s[44:47], s60 offen offset:3072 sc1
  v_mfma_f32_16x16x32_bf16 a[112:115], a[128:131], a[204:207], a[112:115]
  s_barrier
  v_accvgpr_read_b32 v60, a4
  v_accvgpr_read_b32 v61, a5
  v_mfma_f32_16x16x32_bf16 a[116:119], a[136:139], a[204:207], a[116:119]
  s_waitcnt lgkmcnt(8)
  v_cvt_pk_bf16_f32 v66, v60, v61
  v_accvgpr_read_b32 v62, a6
  v_mfma_f32_16x16x32_bf16 a[116:119], a[140:143], a[220:223], a[116:119]
  ds_read_b64_tr_b16 a[128:129], v16 offset:49152
  ds_read_b64_tr_b16 a[130:131], v16 offset:50176
  v_mfma_f32_16x16x32_bf16 a[84:87], a[140:143], a[216:219], a[84:87]
  buffer_load_dwordx4 a[180:183], v10, s[44:47], s61 offen offset:3072 sc1
  v_mfma_f32_16x16x32_bf16 a[84:87], a[136:139], a[200:203], a[84:87]
  v_accvgpr_read_b32 v63, a7
  v_cvt_pk_bf16_f32 v67, v62, v63
  v_mfma_f32_16x16x32_bf16 a[52:55], a[136:139], a[196:199], a[52:55]
  v_accvgpr_read_b32 v60, a36
  v_accvgpr_read_b32 v61, a37
  v_mfma_f32_16x16x32_bf16 a[52:55], a[140:143], a[212:215], a[52:55]
  ds_read_b64_tr_b16 a[132:133], v16 offset:57344
  ds_read_b64_tr_b16 a[134:135], v16 offset:58368
  v_mfma_f32_16x16x32_bf16 a[20:23], a[140:143], a[208:211], a[20:23]
  buffer_load_dwordx4 a[184:187], v11, s[44:47], s60 offen offset:3072 sc1
  v_mfma_f32_16x16x32_bf16 a[20:23], a[136:139], a[192:195], a[20:23]
  s_waitcnt lgkmcnt(10)
  v_cvt_pk_bf16_f32 v82, v60, v61
  v_accvgpr_read_b32 v62, a38
  v_mfma_f32_16x16x32_bf16 a[24:27], a[144:147], a[192:195], a[24:27]
  s_waitcnt lgkmcnt(8)
  v_accvgpr_read_b32 v63, a39
  v_cvt_pk_bf16_f32 v83, v62, v63
  v_mfma_f32_16x16x32_bf16 a[24:27], a[148:151], a[208:211], a[24:27]
  ds_read_b64_tr_b16 a[136:137], v17 offset:49152
  ds_read_b64_tr_b16 a[138:139], v17 offset:50176
  v_mfma_f32_16x16x32_bf16 a[56:59], a[148:151], a[212:215], a[56:59]
  buffer_load_dwordx4 a[188:191], v11, s[44:47], s61 offen offset:3072 sc1
  v_mfma_f32_16x16x32_bf16 a[56:59], a[144:147], a[196:199], a[56:59]
  s_mov_b32 s60, 4096
  v_accvgpr_read_b32 v60, a68
  v_accvgpr_read_b32 v61, a69
  v_mfma_f32_16x16x32_bf16 a[88:91], a[144:147], a[200:203], a[88:91]
  s_add_u32 s61, s73, 4096
  v_cvt_pk_bf16_f32 v98, v60, v61
  v_accvgpr_read_b32 v62, a70
  v_mfma_f32_16x16x32_bf16 a[88:91], a[148:151], a[216:219], a[88:91]
  ds_read_b64_tr_b16 a[140:141], v17 offset:57344
  ds_read_b64_tr_b16 a[142:143], v17 offset:58368
  v_mfma_f32_16x16x32_bf16 a[120:123], a[148:151], a[220:223], a[120:123]
  buffer_load_dwordx4 v2, s[96:99], s87 offen offset:0 lds
  v_mfma_f32_16x16x32_bf16 a[120:123], a[144:147], a[204:207], a[120:123]
  s_waitcnt lgkmcnt(10)
  v_accvgpr_read_b32 v63, a71
  v_cvt_pk_bf16_f32 v99, v62, v63
  v_mfma_f32_16x16x32_bf16 a[124:127], a[152:155], a[204:207], a[124:127]
  s_waitcnt lgkmcnt(8)
  v_accvgpr_read_b32 v60, a100
  v_accvgpr_read_b32 v61, a101
  v_mfma_f32_16x16x32_bf16 a[124:127], a[156:159], a[220:223], a[124:127]
  buffer_load_dwordx4 v3, s[96:99], s87 offen offset:1024 lds
  v_mfma_f32_16x16x32_bf16 a[92:95], a[156:159], a[216:219], a[92:95]
  s_add_u32 s87, s87, 262144
  ds_read_b64_tr_b16 a[144:145], v18 offset:49152
  ds_read_b64_tr_b16 a[146:147], v18 offset:50176
  v_mfma_f32_16x16x32_bf16 a[92:95], a[152:155], a[200:203], a[92:95]
  s_add_u32 m0, s1, 16384
  v_accvgpr_read_b32 v62, a102
  v_accvgpr_read_b32 v63, a103
  v_mfma_f32_16x16x32_bf16 a[60:63], a[152:155], a[196:199], a[60:63]
  buffer_load_dwordx4 v4, s[16:19], s89 offen lds
  v_mfma_f32_16x16x32_bf16 a[60:63], a[156:159], a[212:215], a[60:63]
  s_add_u32 s89, s89, 110592
  ds_read_b64_tr_b16 a[148:149], v18 offset:57344
  ds_read_b64_tr_b16 a[150:151], v18 offset:58368
  v_mfma_f32_16x16x32_bf16 a[28:31], a[156:159], a[208:211], a[28:31]
  s_add_u32 m0, s0, 32768
  v_cvt_pk_bf16_f32 v114, v60, v61
  v_cvt_pk_bf16_f32 v115, v62, v63
  v_mfma_f32_16x16x32_bf16 a[28:31], a[152:155], a[192:195], a[28:31]
  s_waitcnt lgkmcnt(10)
  v_accvgpr_read_b32 v56, a8
  v_accvgpr_read_b32 v57, a9
  v_mfma_f32_16x16x32_bf16 v[128:131], a[192:195], a[128:131], v[128:131]
  s_waitcnt lgkmcnt(8)
  v_cvt_pk_bf16_f32 v68, v56, v57
  v_accvgpr_read_b32 v58, a10
  v_mfma_f32_16x16x32_bf16 v[128:131], a[208:211], a[132:135], v[128:131]
  ds_read_b64_tr_b16 a[152:153], v19 offset:49152
  ds_read_b64_tr_b16 a[154:155], v19 offset:50176
  v_mfma_f32_16x16x32_bf16 v[132:135], a[212:215], a[132:135], v[132:135]
  v_accvgpr_read_b32 v59, a11
  v_cvt_pk_bf16_f32 v69, v58, v59
  v_mfma_f32_16x16x32_bf16 v[132:135], a[196:199], a[128:131], v[132:135]
  v_accvgpr_read_b32 v56, a40
  v_accvgpr_read_b32 v57, a41
  v_mfma_f32_16x16x32_bf16 v[136:139], a[200:203], a[128:131], v[136:139]
  v_cvt_pk_bf16_f32 v84, v56, v57
  v_accvgpr_read_b32 v58, a42
  v_mfma_f32_16x16x32_bf16 v[136:139], a[216:219], a[132:135], v[136:139]
  ds_read_b64_tr_b16 a[156:157], v19 offset:57344
  ds_read_b64_tr_b16 a[158:159], v19 offset:58368
  v_mfma_f32_16x16x32_bf16 v[140:143], a[220:223], a[132:135], v[140:143]
  v_accvgpr_read_b32 v59, a43
  v_cvt_pk_bf16_f32 v85, v58, v59
  v_mfma_f32_16x16x32_bf16 v[140:143], a[204:207], a[128:131], v[140:143]
  s_waitcnt lgkmcnt(10)
  v_accvgpr_read_b32 v56, a72
  v_accvgpr_read_b32 v57, a73
  v_mfma_f32_16x16x32_bf16 v[156:159], a[204:207], a[136:139], v[156:159]
  s_waitcnt lgkmcnt(8)
  v_cvt_pk_bf16_f32 v100, v56, v57
  v_accvgpr_read_b32 v58, a74
  v_mfma_f32_16x16x32_bf16 v[156:159], a[220:223], a[140:143], v[156:159]
  ds_read_b64_tr_b16 a[128:129], v20 offset:49152
  ds_read_b64_tr_b16 a[130:131], v20 offset:50176
  v_mfma_f32_16x16x32_bf16 v[152:155], a[216:219], a[140:143], v[152:155]
  v_accvgpr_read_b32 v59, a75
  v_cvt_pk_bf16_f32 v101, v58, v59
  v_mfma_f32_16x16x32_bf16 v[152:155], a[200:203], a[136:139], v[152:155]
  v_accvgpr_read_b32 v56, a104
  v_accvgpr_read_b32 v57, a105
  v_mfma_f32_16x16x32_bf16 v[148:151], a[196:199], a[136:139], v[148:151]
  v_accvgpr_read_b32 v58, a106
  v_accvgpr_read_b32 v59, a107
  v_mfma_f32_16x16x32_bf16 v[148:151], a[212:215], a[140:143], v[148:151]
  ds_read_b64_tr_b16 a[132:133], v20 offset:57344
  ds_read_b64_tr_b16 a[134:135], v20 offset:58368
  v_mfma_f32_16x16x32_bf16 v[144:147], a[208:211], a[140:143], v[144:147]
  v_cvt_pk_bf16_f32 v116, v56, v57
  v_cvt_pk_bf16_f32 v117, v58, v59
  v_mfma_f32_16x16x32_bf16 v[144:147], a[192:195], a[136:139], v[144:147]
  s_waitcnt lgkmcnt(10)
  v_accvgpr_read_b32 v60, a12
  v_accvgpr_read_b32 v61, a13
  v_mfma_f32_16x16x32_bf16 v[160:163], a[192:195], a[144:147], v[160:163]
  s_waitcnt lgkmcnt(8)
  v_cvt_pk_bf16_f32 v70, v60, v61
  v_accvgpr_read_b32 v62, a14
  v_mfma_f32_16x16x32_bf16 v[160:163], a[208:211], a[148:151], v[160:163]
  ds_read_b64_tr_b16 a[136:137], v21 offset:49152
  ds_read_b64_tr_b16 a[138:139], v21 offset:50176
  v_mfma_f32_16x16x32_bf16 v[164:167], a[212:215], a[148:151], v[164:167]
  v_accvgpr_read_b32 v63, a15
  v_cvt_pk_bf16_f32 v71, v62, v63
  v_mfma_f32_16x16x32_bf16 v[164:167], a[196:199], a[144:147], v[164:167]
  v_accvgpr_read_b32 v60, a44
  v_accvgpr_read_b32 v61, a45
  v_mfma_f32_16x16x32_bf16 v[168:171], a[200:203], a[144:147], v[168:171]
  v_cvt_pk_bf16_f32 v86, v60, v61
  v_accvgpr_read_b32 v62, a46
  v_mfma_f32_16x16x32_bf16 v[168:171], a[216:219], a[148:151], v[168:171]
  ds_read_b64_tr_b16 a[140:141], v21 offset:57344
  ds_read_b64_tr_b16 a[142:143], v21 offset:58368
  v_mfma_f32_16x16x32_bf16 v[172:175], a[220:223], a[148:151], v[172:175]
  v_accvgpr_read_b32 v63, a47
  v_cvt_pk_bf16_f32 v87, v62, v63
  v_mfma_f32_16x16x32_bf16 v[172:175], a[204:207], a[144:147], v[172:175]
  s_waitcnt lgkmcnt(10)
  v_accvgpr_read_b32 v60, a76
  v_accvgpr_read_b32 v61, a77
  v_mfma_f32_16x16x32_bf16 v[188:191], a[204:207], a[152:155], v[188:191]
  s_waitcnt lgkmcnt(8)
  v_cvt_pk_bf16_f32 v102, v60, v61
  v_accvgpr_read_b32 v62, a78
  v_mfma_f32_16x16x32_bf16 v[188:191], a[220:223], a[156:159], v[188:191]
  ds_read_b64_tr_b16 a[144:145], v22 offset:49152
  ds_read_b64_tr_b16 a[146:147], v22 offset:50176
  v_mfma_f32_16x16x32_bf16 v[184:187], a[216:219], a[156:159], v[184:187]
  v_accvgpr_read_b32 v63, a79
  v_cvt_pk_bf16_f32 v103, v62, v63
  v_mfma_f32_16x16x32_bf16 v[184:187], a[200:203], a[152:155], v[184:187]
  v_accvgpr_read_b32 v60, a108
  v_accvgpr_read_b32 v61, a109
  v_mfma_f32_16x16x32_bf16 v[180:183], a[196:199], a[152:155], v[180:183]
  v_accvgpr_read_b32 v62, a110
  v_accvgpr_read_b32 v63, a111
  v_mfma_f32_16x16x32_bf16 v[180:183], a[212:215], a[156:159], v[180:183]
  ds_read_b64_tr_b16 a[148:149], v22 offset:57344
  ds_read_b64_tr_b16 a[150:151], v22 offset:58368
  v_mfma_f32_16x16x32_bf16 v[176:179], a[208:211], a[156:159], v[176:179]
  v_cvt_pk_bf16_f32 v118, v60, v61
  v_cvt_pk_bf16_f32 v119, v62, v63
  v_mfma_f32_16x16x32_bf16 v[176:179], a[192:195], a[152:155], v[176:179]
  s_waitcnt lgkmcnt(10)
  v_accvgpr_read_b32 v56, a16
  v_accvgpr_read_b32 v57, a17
  v_mfma_f32_16x16x32_bf16 v[192:195], a[192:195], a[128:131], v[192:195]
  s_waitcnt lgkmcnt(8)
  v_cvt_pk_bf16_f32 v72, v56, v57
  v_accvgpr_read_b32 v58, a18
  v_mfma_f32_16x16x32_bf16 v[192:195], a[208:211], a[132:135], v[192:195]
  ds_read_b64_tr_b16 a[152:153], v23 offset:49152
  ds_read_b64_tr_b16 a[154:155], v23 offset:50176
  v_mfma_f32_16x16x32_bf16 v[196:199], a[212:215], a[132:135], v[196:199]
  v_accvgpr_read_b32 v59, a19
  v_cvt_pk_bf16_f32 v73, v58, v59
  v_mfma_f32_16x16x32_bf16 v[196:199], a[196:199], a[128:131], v[196:199]
  v_accvgpr_read_b32 v56, a48
  v_accvgpr_read_b32 v57, a49
  v_mfma_f32_16x16x32_bf16 v[200:203], a[200:203], a[128:131], v[200:203]
  v_cvt_pk_bf16_f32 v88, v56, v57
  v_accvgpr_read_b32 v58, a50
  v_mfma_f32_16x16x32_bf16 v[200:203], a[216:219], a[132:135], v[200:203]
  ds_read_b64_tr_b16 a[156:157], v23 offset:57344
  ds_read_b64_tr_b16 a[158:159], v23 offset:58368
  v_mfma_f32_16x16x32_bf16 v[204:207], a[220:223], a[132:135], v[204:207]
  s_waitcnt vmcnt(27) lgkmcnt(10)
  v_accvgpr_read_b32 v59, a51
  v_cvt_pk_bf16_f32 v89, v58, v59
  v_mfma_f32_16x16x32_bf16 v[204:207], a[204:207], a[128:131], v[204:207]
  s_barrier
  v_accvgpr_read_b32 v56, a80
  v_accvgpr_read_b32 v57, a81
  v_mfma_f32_16x16x32_bf16 v[220:223], a[204:207], a[136:139], v[220:223]
  s_waitcnt lgkmcnt(8)
  buffer_load_dwordx4 v2, s[96:99], s87 offen offset:0 lds
  v_mfma_f32_16x16x32_bf16 v[220:223], a[220:223], a[140:143], v[220:223]
  ds_read_b64_tr_b16 a[128:129], v24 offset:0
  ds_read_b64_tr_b16 a[130:131], v24 offset:1024
  v_mfma_f32_16x16x32_bf16 v[216:219], a[216:219], a[140:143], v[216:219]
  v_cvt_pk_bf16_f32 v104, v56, v57
  v_accvgpr_read_b32 v58, a82
  v_mfma_f32_16x16x32_bf16 v[216:219], a[200:203], a[136:139], v[216:219]
  buffer_load_dwordx4 v3, s[96:99], s87 offen offset:1024 lds
  v_mfma_f32_16x16x32_bf16 v[212:215], a[196:199], a[136:139], v[212:215]
  s_add_u32 s87, s87, 262144
  v_accvgpr_read_b32 v59, a83
  v_cvt_pk_bf16_f32 v105, v58, v59
  v_mfma_f32_16x16x32_bf16 v[212:215], a[212:215], a[140:143], v[212:215]
  s_add_u32 m0, s1, 32768
  ds_read_b64_tr_b16 a[132:133], v24 offset:16384
  ds_read_b64_tr_b16 a[134:135], v24 offset:17408
  v_mfma_f32_16x16x32_bf16 v[208:211], a[208:211], a[140:143], v[208:211]
  buffer_load_dwordx4 v4, s[16:19], s89 offen lds
  v_mfma_f32_16x16x32_bf16 v[208:211], a[192:195], a[136:139], v[208:211]
  s_waitcnt lgkmcnt(10)
  v_accvgpr_read_b32 v56, a112
  v_accvgpr_read_b32 v57, a113
  v_mfma_f32_16x16x32_bf16 v[224:227], a[192:195], a[144:147], v[224:227]
  s_waitcnt lgkmcnt(8)
  v_accvgpr_read_b32 v58, a114
  v_accvgpr_read_b32 v59, a115
  v_mfma_f32_16x16x32_bf16 v[224:227], a[208:211], a[148:151], v[224:227]
  s_add_u32 s89, s89, 110592
  ds_read_b64_tr_b16 a[136:137], v25 offset:0
  ds_read_b64_tr_b16 a[138:139], v25 offset:1024
  v_mfma_f32_16x16x32_bf16 v[228:231], a[212:215], a[148:151], v[228:231]
  s_add_u32 m0, s0, 49152
  v_cvt_pk_bf16_f32 v120, v56, v57
  v_cvt_pk_bf16_f32 v121, v58, v59
  v_mfma_f32_16x16x32_bf16 v[228:231], a[196:199], a[144:147], v[228:231]
  v_accvgpr_read_b32 v60, a20
  v_accvgpr_read_b32 v61, a21
  v_mfma_f32_16x16x32_bf16 v[232:235], a[200:203], a[144:147], v[232:235]
  v_cvt_pk_bf16_f32 v74, v60, v61
  v_accvgpr_read_b32 v62, a22
  v_mfma_f32_16x16x32_bf16 v[232:235], a[216:219], a[148:151], v[232:235]
L_padA4:
  s_cbranch_execz L_padA8
  ds_read_b64_tr_b16 a[140:141], v25 offset:16384
  ds_read_b64_tr_b16 a[142:143], v25 offset:17408
  v_mfma_f32_16x16x32_bf16 v[236:239], a[220:223], a[148:151], v[236:239]
  v_accvgpr_read_b32 v63, a23
  v_cvt_pk_bf16_f32 v75, v62, v63
  v_mfma_f32_16x16x32_bf16 v[236:239], a[204:207], a[144:147], v[236:239]
  s_waitcnt lgkmcnt(10)
  v_accvgpr_read_b32 v60, a52
  v_accvgpr_read_b32 v61, a53
  v_mfma_f32_16x16x32_bf16 v[252:255], a[204:207], a[152:155], v[252:255]
  s_waitcnt lgkmcnt(8)
  v_cvt_pk_bf16_f32 v90, v60, v61
  v_accvgpr_read_b32 v62, a54
  v_mfma_f32_16x16x32_bf16 v[252:255], a[220:223], a[156:159], v[252:255]
  ds_read_b64_tr_b16 a[144:145], v26 offset:0
  ds_read_b64_tr_b16 a[146:147], v26 offset:1024
  v_mfma_f32_16x16x32_bf16 v[248:251], a[216:219], a[156:159], v[248:251]
  v_accvgpr_read_b32 v63, a55
  v_cvt_pk_bf16_f32 v91, v62, v63
  v_mfma_f32_16x16x32_bf16 v[248:251], a[200:203], a[152:155], v[248:251]
  v_accvgpr_read_b32 v60, a84
  v_accvgpr_read_b32 v61, a85
  v_mfma_f32_16x16x32_bf16 v[244:247], a[196:199], a[152:155], v[244:247]
  v_cvt_pk_bf16_f32 v106, v60, v61
  v_accvgpr_read_b32 v62, a86
  v_mfma_f32_16x16x32_bf16 v[244:247], a[212:215], a[156:159], v[244:247]
  ds_read_b64_tr_b16 a[148:149], v26 offset:16384
  ds_read_b64_tr_b16 a[150:151], v26 offset:17408
  v_mfma_f32_16x16x32_bf16 v[240:243], a[208:211], a[156:159], v[240:243]
  v_accvgpr_read_b32 v63, a87
  v_cvt_pk_bf16_f32 v107, v62, v63
  v_mfma_f32_16x16x32_bf16 v[240:243], a[192:195], a[152:155], v[240:243]
  s_waitcnt vmcnt(17) lgkmcnt(8)
  v_accvgpr_read_b32 v60, a116
  v_accvgpr_read_b32 v61, a117
  v_mfma_f32_16x16x32_bf16 a[0:3], a[128:131], a[224:227], 0
  s_barrier
  v_accvgpr_read_b32 v62, a118
  v_accvgpr_read_b32 v63, a119
  v_mfma_f32_16x16x32_bf16 a[0:3], a[132:135], a[240:243], a[0:3]
  s_waitcnt vmcnt(16)
  ds_read_b64_tr_b16 a[152:153], v27 offset:0
  ds_read_b64_tr_b16 a[154:155], v27 offset:1024
  v_mfma_f32_16x16x32_bf16 a[32:35], a[132:135], a[244:247], 0
  buffer_load_dwordx4 v2, s[96:99], s87 offen offset:0 lds
  v_mfma_f32_16x16x32_bf16 a[32:35], a[128:131], a[228:231], a[32:35]
  v_cvt_pk_bf16_f32 v122, v60, v61
  v_cvt_pk_bf16_f32 v123, v62, v63
  v_mfma_f32_16x16x32_bf16 a[64:67], a[128:131], a[232:235], 0
  s_waitcnt vmcnt(16)
  v_accvgpr_read_b32 v56, a24
  v_accvgpr_read_b32 v57, a25
  v_mfma_f32_16x16x32_bf16 a[64:67], a[132:135], a[248:251], a[64:67]
  s_waitcnt vmcnt(15)
  ds_read_b64_tr_b16 a[156:157], v27 offset:16384
  ds_read_b64_tr_b16 a[158:159], v27 offset:17408
  v_mfma_f32_16x16x32_bf16 a[96:99], a[132:135], a[252:255], 0
  buffer_load_dwordx4 v3, s[96:99], s87 offen offset:1024 lds
  s_add_u32 m0, s1, 49152
  v_mfma_f32_16x16x32_bf16 a[96:99], a[128:131], a[236:239], a[96:99]
  s_waitcnt lgkmcnt(10)
  v_cvt_pk_bf16_f32 v76, v56, v57
  v_accvgpr_read_b32 v58, a26
  v_mfma_f32_16x16x32_bf16 a[100:103], a[136:139], a[236:239], 0
  s_waitcnt lgkmcnt(8)
  v_accvgpr_read_b32 v59, a27
  v_cvt_pk_bf16_f32 v77, v58, v59
  v_mfma_f32_16x16x32_bf16 a[100:103], a[140:143], a[252:255], a[100:103]
  s_add_u32 s87, s87, 262144
  ds_read_b64_tr_b16 a[128:129], v28 offset:0
  ds_read_b64_tr_b16 a[130:131], v28 offset:1024
  v_mfma_f32_16x16x32_bf16 a[68:71], a[140:143], a[248:251], 0
  buffer_load_dwordx4 v4, s[16:19], s89 offen lds
  v_mfma_f32_16x16x32_bf16 a[68:71], a[136:139], a[232:235], a[68:71]
  s_add_u32 s89, s89, 110592
  v_accvgpr_read_b32 v56, a56
  v_accvgpr_read_b32 v57, a57
  v_mfma_f32_16x16x32_bf16 a[36:39], a[136:139], a[228:231], 0
  s_add_u32 m0, s0, 65536
  v_cvt_pk_bf16_f32 v92, v56, v57
  v_accvgpr_read_b32 v58, a58
  v_mfma_f32_16x16x32_bf16 a[36:39], a[140:143], a[244:247], a[36:39]
  ds_read_b64_tr_b16 a[132:133], v28 offset:16384
  ds_read_b64_tr_b16 a[134:135], v28 offset:17408
  v_mfma_f32_16x16x32_bf16 a[4:7], a[140:143], a[240:243], 0
  buffer_load_dwordx4 a[192:195], v10, s[44:47], s60 offen offset:0 sc1
  v_mfma_f32_16x16x32_bf16 a[4:7], a[136:139], a[224:227], a[4:7]
  s_waitcnt lgkmcnt(10)
  v_accvgpr_read_b32 v59, a59
  v_cvt_pk_bf16_f32 v93, v58, v59
  v_mfma_f32_16x16x32_bf16 a[8:11], a[144:147], a[224:227], 0
  s_waitcnt lgkmcnt(8)
  v_accvgpr_read_b32 v56, a88
  v_accvgpr_read_b32 v57, a89
  v_mfma_f32_16x16x32_bf16 a[8:11], a[148:151], a[240:243], a[8:11]
  ds_read_b64_tr_b16 a[136:137], v29 offset:0
  ds_read_b64_tr_b16 a[138:139], v29 offset:1024
  v_mfma_f32_16x16x32_bf16 a[40:43], a[148:151], a[244:247], 0
  buffer_load_dwordx4 a[196:199], v10, s[44:47], s61 offen offset:0 sc1
  v_mfma_f32_16x16x32_bf16 a[40:43], a[144:147], a[228:231], a[40:43]
  v_cvt_pk_bf16_f32 v108, v56, v57
  v_accvgpr_read_b32 v58, a90
  v_mfma_f32_16x16x32_bf16 a[72:75], a[144:147], a[232:235], 0
  v_accvgpr_read_b32 v59, a91
  v_cvt_pk_bf16_f32 v109, v58, v59
  v_mfma_f32_16x16x32_bf16 a[72:75], a[148:151], a[248:251], a[72:75]
  ds_read_b64_tr_b16 a[140:141], v29 offset:16384
  ds_read_b64_tr_b16 a[142:143], v29 offset:17408
  v_mfma_f32_16x16x32_bf16 a[104:107], a[148:151], a[252:255], 0
  buffer_load_dwordx4 a[200:203], v11, s[44:47], s60 offen offset:0 sc1
  v_mfma_f32_16x16x32_bf16 a[104:107], a[144:147], a[236:239], a[104:107]
  s_waitcnt lgkmcnt(10)
  v_accvgpr_read_b32 v56, a120
  v_accvgpr_read_b32 v57, a121
  v_mfma_f32_16x16x32_bf16 a[108:111], a[152:155], a[236:239], 0
  s_waitcnt lgkmcnt(8)
  v_accvgpr_read_b32 v58, a122
  v_accvgpr_read_b32 v59, a123
  v_mfma_f32_16x16x32_bf16 a[108:111], a[156:159], a[252:255], a[108:111]
  ds_read_b64_tr_b16 a[144:145], v30 offset:0
  ds_read_b64_tr_b16 a[146:147], v30 offset:1024
  v_mfma_f32_16x16x32_bf16 a[76:79], a[156:159], a[248:251], 0
  buffer_load_dwordx4 a[204:207], v11, s[44:47], s61 offen offset:0 sc1
  v_mfma_f32_16x16x32_bf16 a[76:79], a[152:155], a[232:235], a[76:79]
  v_cvt_pk_bf16_f32 v124, v56, v57
  v_cvt_pk_bf16_f32 v125, v58, v59
  v_mfma_f32_16x16x32_bf16 a[44:47], a[152:155], a[228:231], 0
  v_accvgpr_read_b32 v60, a28
  v_accvgpr_read_b32 v61, a29
  v_mfma_f32_16x16x32_bf16 a[44:47], a[156:159], a[244:247], a[44:47]
  buffer_store_dwordx4 v[64:67], v6, s[4:7], s90 offen offset:0 sc1
  v_mfma_f32_16x16x32_bf16 a[12:15], a[156:159], a[240:243], 0
  ds_read_b64_tr_b16 a[148:149], v30 offset:16384
  ds_read_b64_tr_b16 a[150:151], v30 offset:17408
  v_mfma_f32_16x16x32_bf16 a[12:15], a[152:155], a[224:227], a[12:15]
  s_waitcnt lgkmcnt(10)
  v_cvt_pk_bf16_f32 v78, v60, v61
  v_accvgpr_read_b32 v62, a30
  v_mfma_f32_16x16x32_bf16 a[16:19], a[128:131], a[224:227], 0
  s_waitcnt lgkmcnt(8)
  buffer_load_dwordx4 a[208:211], v10, s[44:47], s60 offen offset:1024 sc1
  v_mfma_f32_16x16x32_bf16 a[16:19], a[132:135], a[240:243], a[16:19]
  ds_read_b64_tr_b16 a[152:153], v31 offset:0
  ds_read_b64_tr_b16 a[154:155], v31 offset:1024
  v_mfma_f32_16x16x32_bf16 a[48:51], a[132:135], a[244:247], 0
  v_accvgpr_read_b32 v63, a31
  v_cvt_pk_bf16_f32 v79, v62, v63
  v_mfma_f32_16x16x32_bf16 a[48:51], a[128:131], a[228:231], a[48:51]
  buffer_load_dwordx4 a[212:215], v10, s[44:47], s61 offen offset:1024 sc1
  v_mfma_f32_16x16x32_bf16 a[80:83], a[128:131], a[232:235], 0
  v_accvgpr_read_b32 v60, a60
  v_accvgpr_read_b32 v61, a61
  v_mfma_f32_16x16x32_bf16 a[80:83], a[132:135], a[248:251], a[80:83]
  ds_read_b64_tr_b16 a[156:157], v31 offset:16384
  ds_read_b64_tr_b16 a[158:159], v31 offset:17408
  v_mfma_f32_16x16x32_bf16 a[112:115], a[132:135], a[252:255], 0
  buffer_load_dwordx4 a[216:219], v11, s[44:47], s60 offen offset:1024 sc1
  v_mfma_f32_16x16x32_bf16 a[112:115], a[128:131], a[236:239], a[112:115]
  s_waitcnt lgkmcnt(10)
  v_cvt_pk_bf16_f32 v94, v60, v61
  v_accvgpr_read_b32 v62, a62
  v_mfma_f32_16x16x32_bf16 a[116:119], a[136:139], a[236:239], 0
  s_waitcnt lgkmcnt(8)
  v_accvgpr_read_b32 v63, a63
  v_cvt_pk_bf16_f32 v95, v62, v63
  v_mfma_f32_16x16x32_bf16 a[116:119], a[140:143], a[252:255], a[116:119]
  ds_read_b64_tr_b16 a[128:129], v36 offset:0
  ds_read_b64_tr_b16 a[130:131], v36 offset:512
  v_mfma_f32_16x16x32_bf16 a[84:87], a[140:143], a[248:251], 0
  buffer_load_dwordx4 a[220:223], v11, s[44:47], s61 offen offset:1024 sc1
  v_mfma_f32_16x16x32_bf16 a[84:87], a[136:139], a[232:235], a[84:87]
  v_accvgpr_read_b32 v60, a92
  v_accvgpr_read_b32 v61, a93
  v_mfma_f32_16x16x32_bf16 a[52:55], a[136:139], a[228:231], 0
  v_cvt_pk_bf16_f32 v110, v60, v61
  v_accvgpr_read_b32 v62, a94
  v_mfma_f32_16x16x32_bf16 a[52:55], a[140:143], a[244:247], a[52:55]
  buffer_store_dwordx4 v[68:71], v6, s[4:7], s90 offen offset:1024 sc1
  v_mfma_f32_16x16x32_bf16 a[20:23], a[140:143], a[240:243], 0
  ds_read_b64_tr_b16 a[132:133], v36 offset:16384
  ds_read_b64_tr_b16 a[134:135], v36 offset:16896
  v_mfma_f32_16x16x32_bf16 a[20:23], a[136:139], a[224:227], a[20:23]
  s_waitcnt lgkmcnt(10)
  v_accvgpr_read_b32 v63, a95
  v_cvt_pk_bf16_f32 v111, v62, v63
  v_mfma_f32_16x16x32_bf16 a[24:27], a[144:147], a[224:227], 0
  s_waitcnt lgkmcnt(8)
  v_accvgpr_read_b32 v60, a124
  v_accvgpr_read_b32 v61, a125
  v_mfma_f32_16x16x32_bf16 a[24:27], a[148:151], a[240:243], a[24:27]
  ds_read_b64_tr_b16 a[136:137], v37 offset:0
  ds_read_b64_tr_b16 a[138:139], v37 offset:512
  v_mfma_f32_16x16x32_bf16 a[56:59], a[148:151], a[244:247], 0
  v_accvgpr_read_b32 v62, a126
  v_accvgpr_read_b32 v63, a127
  v_mfma_f32_16x16x32_bf16 a[56:59], a[144:147], a[228:231], a[56:59]
  v_cvt_pk_bf16_f32 v126, v60, v61
  v_cvt_pk_bf16_f32 v127, v62, v63
  v_mfma_f32_16x16x32_bf16 a[88:91], a[144:147], a[232:235], 0
  v_cvt_pk_bf16_f32 v128, v128, v129
  v_cvt_pk_bf16_f32 v129, v130, v131
  v_mfma_f32_16x16x32_bf16 a[88:91], a[148:151], a[248:251], a[88:91]
  ds_read_b64_tr_b16 a[140:141], v37 offset:16384
  ds_read_b64_tr_b16 a[142:143], v37 offset:16896
  v_mfma_f32_16x16x32_bf16 a[120:123], a[148:151], a[252:255], 0
  v_cvt_pk_bf16_f32 v130, v132, v133
  v_cvt_pk_bf16_f32 v131, v134, v135
  v_mfma_f32_16x16x32_bf16 a[120:123], a[144:147], a[236:239], a[120:123]
  s_waitcnt lgkmcnt(10)
  v_cvt_pk_bf16_f32 v132, v136, v137
  v_cvt_pk_bf16_f32 v133, v138, v139
  v_mfma_f32_16x16x32_bf16 a[124:127], a[152:155], a[236:239], 0
  s_waitcnt lgkmcnt(8)
  buffer_store_dwordx4 v[72:75], v6, s[4:7], s90 offen offset:2048 sc1
  v_mfma_f32_16x16x32_bf16 a[124:127], a[156:159], a[252:255], a[124:127]
  ds_read_b64_tr_b16 a[144:145], v38 offset:0
  ds_read_b64_tr_b16 a[146:147], v38 offset:512
  v_mfma_f32_16x16x32_bf16 a[92:95], a[156:159], a[248:251], 0
  v_cvt_pk_bf16_f32 v134, v140, v141
  v_cvt_pk_bf16_f32 v135, v142, v143
  v_mfma_f32_16x16x32_bf16 a[92:95], a[152:155], a[232:235], a[92:95]
  v_cvt_pk_bf16_f32 v136, v144, v145
  v_cvt_pk_bf16_f32 v137, v146, v147
  v_mfma_f32_16x16x32_bf16 a[60:63], a[152:155], a[228:231], 0
  v_cvt_pk_bf16_f32 v138, v148, v149
  v_cvt_pk_bf16_f32 v139, v150, v151
  v_mfma_f32_16x16x32_bf16 a[60:63], a[156:159], a[244:247], a[60:63]
  v_cvt_pk_bf16_f32 v140, v152, v153
  v_cvt_pk_bf16_f32 v141, v154, v155
  v_mfma_f32_16x16x32_bf16 a[28:31], a[156:159], a[240:243], 0
  v_cvt_pk_bf16_f32 v142, v156, v157
  v_cvt_pk_bf16_f32 v143, v158, v159
  v_cvt_pk_bf16_f32 v144, v160, v161
  v_cvt_pk_bf16_f32 v145, v162, v163
  v_cvt_pk_bf16_f32 v146, v164, v165
  v_cvt_pk_bf16_f32 v147, v166, v167
  v_cvt_pk_bf16_f32 v148, v168, v169
  v_cvt_pk_bf16_f32 v149, v170, v171
  v_cvt_pk_bf16_f32 v150, v172, v173
  v_cvt_pk_bf16_f32 v151, v174, v175
  v_cvt_pk_bf16_f32 v152, v176, v177
  v_cvt_pk_bf16_f32 v153, v178, v179
  v_cvt_pk_bf16_f32 v154, v180, v181
  v_cvt_pk_bf16_f32 v155, v182, v183
  v_cvt_pk_bf16_f32 v156, v184, v185
  v_cvt_pk_bf16_f32 v157, v186, v187
  v_cvt_pk_bf16_f32 v158, v188, v189
  v_cvt_pk_bf16_f32 v159, v190, v191
  v_cvt_pk_bf16_f32 v160, v192, v193
  v_cvt_pk_bf16_f32 v161, v194, v195
  v_cvt_pk_bf16_f32 v162, v196, v197
  v_cvt_pk_bf16_f32 v163, v198, v199
  v_cvt_pk_bf16_f32 v164, v200, v201
  v_cvt_pk_bf16_f32 v165, v202, v203
  v_cvt_pk_bf16_f32 v166, v204, v205
  v_cvt_pk_bf16_f32 v167, v206, v207
  v_cvt_pk_bf16_f32 v168, v208, v209
  v_cvt_pk_bf16_f32 v169, v210, v211
  v_cvt_pk_bf16_f32 v170, v212, v213
  v_cvt_pk_bf16_f32 v171, v214, v215
  v_cvt_pk_bf16_f32 v172, v216, v217
  v_cvt_pk_bf16_f32 v173, v218, v219
  v_cvt_pk_bf16_f32 v174, v220, v221
  v_cvt_pk_bf16_f32 v175, v222, v223
  v_cvt_pk_bf16_f32 v176, v224, v225
  v_cvt_pk_bf16_f32 v177, v226, v227
  v_cvt_pk_bf16_f32 v178, v228, v229
  v_cvt_pk_bf16_f32 v179, v230, v231
  v_cvt_pk_bf16_f32 v180, v232, v233
  v_cvt_pk_bf16_f32 v181, v234, v235
  v_cvt_pk_bf16_f32 v182, v236, v237
  v_cvt_pk_bf16_f32 v183, v238, v239
  v_cvt_pk_bf16_f32 v184, v240, v241
  v_cvt_pk_bf16_f32 v185, v242, v243
  v_cvt_pk_bf16_f32 v186, v244, v245
  v_cvt_pk_bf16_f32 v187, v246, v247
  v_cvt_pk_bf16_f32 v188, v248, v249
  v_cvt_pk_bf16_f32 v189, v250, v251
  v_cvt_pk_bf16_f32 v190, v252, v253
  v_cvt_pk_bf16_f32 v191, v254, v255
  v_mfma_f32_16x16x32_bf16 a[28:31], a[152:155], a[224:227], a[28:31]
  s_waitcnt lgkmcnt(8)
  ds_read_b64_tr_b16 a[148:149], v38 offset:16384
  ds_read_b64_tr_b16 a[150:151], v38 offset:16896
  v_mfma_f32_16x16x32_bf16 v[192:195], a[128:131], a[224:227], v[40:43]
  s_waitcnt lgkmcnt(8)
  v_mfma_f32_16x16x32_bf16 v[192:195], a[132:135], a[240:243], v[192:195]
  ds_read_b64_tr_b16 a[152:153], v39 offset:0
  ds_read_b64_tr_b16 a[154:155], v39 offset:512
  v_mfma_f32_16x16x32_bf16 v[208:211], a[132:135], a[244:247], v[40:43]
  v_mfma_f32_16x16x32_bf16 v[208:211], a[128:131], a[228:231], v[208:211]
  v_mfma_f32_16x16x32_bf16 v[224:227], a[128:131], a[232:235], v[40:43]
  v_mfma_f32_16x16x32_bf16 v[224:227], a[132:135], a[248:251], v[224:227]
  ds_read_b64_tr_b16 a[156:157], v39 offset:16384
  ds_read_b64_tr_b16 a[158:159], v39 offset:16896
  v_mfma_f32_16x16x32_bf16 v[240:243], a[132:135], a[252:255], v[40:43]
  s_waitcnt vmcnt(17) lgkmcnt(10)
  v_mfma_f32_16x16x32_bf16 v[240:243], a[128:131], a[236:239], v[240:243]
  s_barrier
  v_mfma_f32_16x16x32_bf16 v[244:247], a[136:139], a[236:239], v[44:47]
  s_waitcnt lgkmcnt(8)
  v_mfma_f32_16x16x32_bf16 v[244:247], a[140:143], a[252:255], v[244:247]
  ds_read_b64_tr_b16 a[128:129], v16 offset:0
  ds_read_b64_tr_b16 a[130:131], v16 offset:1024
  v_mfma_f32_16x16x32_bf16 v[228:231], a[140:143], a[248:251], v[44:47]
  v_mfma_f32_16x16x32_bf16 v[228:231], a[136:139], a[232:235], v[228:231]
  v_mfma_f32_16x16x32_bf16 v[212:215], a[136:139], a[228:231], v[44:47]
  v_mfma_f32_16x16x32_bf16 v[212:215], a[140:143], a[244:247], v[212:215]
  ds_read_b64_tr_b16 a[132:133], v16 offset:16384
  ds_read_b64_tr_b16 a[134:135], v16 offset:17408
  v_mfma_f32_16x16x32_bf16 v[196:199], a[140:143], a[240:243], v[44:47]
  v_mfma_f32_16x16x32_bf16 v[196:199], a[136:139], a[224:227], v[196:199]
  s_waitcnt lgkmcnt(10)
  v_mfma_f32_16x16x32_bf16 v[200:203], a[144:147], a[224:227], v[48:51]
  s_waitcnt lgkmcnt(8)
  buffer_store_dwordx4 v[76:79], v6, s[4:7], s90 offen offset:3072 sc1
  v_mfma_f32_16x16x32_bf16 v[200:203], a[148:151], a[240:243], v[200:203]
  ds_read_b64_tr_b16 a[136:137], v17 offset:0
  ds_read_b64_tr_b16 a[138:139], v17 offset:1024
  v_mfma_f32_16x16x32_bf16 v[216:219], a[148:151], a[244:247], v[48:51]
  v_mfma_f32_16x16x32_bf16 v[216:219], a[144:147], a[228:231], v[216:219]
  v_mfma_f32_16x16x32_bf16 v[232:235], a[144:147], a[232:235], v[48:51]
  v_mfma_f32_16x16x32_bf16 v[232:235], a[148:151], a[248:251], v[232:235]
  ds_read_b64_tr_b16 a[140:141], v17 offset:16384
  ds_read_b64_tr_b16 a[142:143], v17 offset:17408
  v_mfma_f32_16x16x32_bf16 v[248:251], a[148:151], a[252:255], v[48:51]
  v_mfma_f32_16x16x32_bf16 v[248:251], a[144:147], a[236:239], v[248:251]
  s_waitcnt lgkmcnt(10)
  v_mfma_f32_16x16x32_bf16 v[252:255], a[152:155], a[236:239], v[52:55]
  s_waitcnt lgkmcnt(8)
  v_mfma_f32_16x16x32_bf16 v[252:255], a[156:159], a[252:255], v[252:255]
  ds_read_b64_tr_b16 a[144:145], v18 offset:0
  ds_read_b64_tr_b16 a[146:147], v18 offset:1024
  v_mfma_f32_16x16x32_bf16 v[236:239], a[156:159], a[248:251], v[52:55]
  v_mfma_f32_16x16x32_bf16 v[236:239], a[152:155], a[232:235], v[236:239]
  v_mfma_f32_16x16x32_bf16 v[220:223], a[152:155], a[228:231], v[52:55]
  v_mfma_f32_16x16x32_bf16 v[220:223], a[156:159], a[244:247], v[220:223]
  ds_read_b64_tr_b16 a[148:149], v18 offset:16384
  ds_read_b64_tr_b16 a[150:151], v18 offset:17408
  v_mfma_f32_16x16x32_bf16 v[204:207], a[156:159], a[240:243], v[52:55]
  v_mfma_f32_16x16x32_bf16 v[204:207], a[152:155], a[224:227], v[204:207]
  s_waitcnt lgkmcnt(8)
  v_mfma_f32_16x16x32_bf16 a[0:3], a[128:131], a[160:163], a[0:3]
  s_barrier
  v_mfma_f32_16x16x32_bf16 a[0:3], a[132:135], a[176:179], a[0:3]
  ds_read_b64_tr_b16 a[152:153], v19 offset:0
  ds_read_b64_tr_b16 a[154:155], v19 offset:1024
  v_mfma_f32_16x16x32_bf16 a[32:35], a[132:135], a[180:183], a[32:35]
  buffer_load_dwordx4 v2, s[96:99], s87 offen offset:0 lds
  v_mfma_f32_16x16x32_bf16 a[32:35], a[128:131], a[164:167], a[32:35]
  v_mfma_f32_16x16x32_bf16 a[64:67], a[128:131], a[168:171], a[64:67]
  v_mfma_f32_16x16x32_bf16 a[64:67], a[132:135], a[184:187], a[64:67]
  ds_read_b64_tr_b16 a[156:157], v19 offset:16384
  ds_read_b64_tr_b16 a[158:159], v19 offset:17408
  v_mfma_f32_16x16x32_bf16 a[96:99], a[132:135], a[188:191], a[96:99]
  buffer_load_dwordx4 v3, s[96:99], s87 offen offset:1024 lds
  s_add_u32 m0, s1, 65536
  v_mfma_f32_16x16x32_bf16 a[96:99], a[128:131], a[172:175], a[96:99]
  s_waitcnt lgkmcnt(10)
  v_mfma_f32_16x16x32_bf16 a[100:103], a[136:139], a[172:175], a[100:103]
  s_waitcnt lgkmcnt(8)
  v_mfma_f32_16x16x32_bf16 a[100:103], a[140:143], a[188:191], a[100:103]
  s_add_u32 s87, s87, 262144
  ds_read_b64_tr_b16 a[128:129], v20 offset:0
  ds_read_b64_tr_b16 a[130:131], v20 offset:1024
  v_mfma_f32_16x16x32_bf16 a[68:71], a[140:143], a[184:187], a[68:71]
  buffer_load_dwordx4 v4, s[16:19], s89 offen lds
  v_mfma_f32_16x16x32_bf16 a[68:71], a[136:139], a[168:171], a[68:71]
  s_add_u32 s89, s89, 110592
  v_mfma_f32_16x16x32_bf16 a[36:39], a[136:139], a[164:167], a[36:39]
  s_add_u32 m0, s0, 81920
  v_mfma_f32_16x16x32_bf16 a[36:39], a[140:143], a[180:183], a[36:39]
  ds_read_b64_tr_b16 a[132:133], v20 offset:16384
  ds_read_b64_tr_b16 a[134:135], v20 offset:17408
  v_mfma_f32_16x16x32_bf16 a[4:7], a[140:143], a[176:179], a[4:7]
  buffer_store_dwordx4 v[80:83], v7, s[4:7], s90 offen offset:0 sc1
  v_mfma_f32_16x16x32_bf16 a[4:7], a[136:139], a[160:163], a[4:7]
  s_waitcnt lgkmcnt(10)
  v_mfma_f32_16x16x32_bf16 a[8:11], a[144:147], a[160:163], a[8:11]
  s_waitcnt lgkmcnt(8)
  v_mfma_f32_16x16x32_bf16 a[8:11], a[148:151], a[176:179], a[8:11]
  ds_read_b64_tr_b16 a[136:137], v21 offset:0
  ds_read_b64_tr_b16 a[138:139], v21 offset:1024
  v_mfma_f32_16x16x32_bf16 a[40:43], a[148:151], a[180:183], a[40:43]
  buffer_load_dwordx4 a[224:227], v10, s[44:47], s60 offen offset:2048 sc1
  v_mfma_f32_16x16x32_bf16 a[40:43], a[144:147], a[164:167], a[40:43]
  v_mfma_f32_16x16x32_bf16 a[72:75], a[144:147], a[168:171], a[72:75]
  v_mfma_f32_16x16x32_bf16 a[72:75], a[148:151], a[184:187], a[72:75]
  ds_read_b64_tr_b16 a[140:141], v21 offset:16384
  ds_read_b64_tr_b16 a[142:143], v21 offset:17408
  v_mfma_f32_16x16x32_bf16 a[104:107], a[148:151], a[188:191], a[104:107]
  buffer_load_dwordx4 a[228:231], v10, s[44:47], s61 offen offset:2048 sc1
  v_mfma_f32_16x16x32_bf16 a[104:107], a[144:147], a[172:175], a[104:107]
  s_waitcnt lgkmcnt(10)
  v_mfma_f32_16x16x32_bf16 a[108:111], a[152:155], a[172:175], a[108:111]
  s_waitcnt lgkmcnt(8)
  v_mfma_f32_16x16x32_bf16 a[108:111], a[156:159], a[188:191], a[108:111]
  ds_read_b64_tr_b16 a[144:145], v22 offset:0
  ds_read_b64_tr_b16 a[146:147], v22 offset:1024
  v_mfma_f32_16x16x32_bf16 a[76:79], a[156:159], a[184:187], a[76:79]
  buffer_load_dwordx4 a[232:235], v11, s[44:47], s60 offen offset:2048 sc1
  v_mfma_f32_16x16x32_bf16 a[76:79], a[152:155], a[168:171], a[76:79]
  v_mfma_f32_16x16x32_bf16 a[44:47], a[152:155], a[164:167], a[44:47]
  v_mfma_f32_16x16x32_bf16 a[44:47], a[156:159], a[180:183], a[44:47]
  ds_read_b64_tr_b16 a[148:149], v22 offset:16384
  ds_read_b64_tr_b16 a[150:151], v22 offset:17408
  v_mfma_f32_16x16x32_bf16 a[12:15], a[156:159], a[176:179], a[12:15]
  buffer_load_dwordx4 a[236:239], v11, s[44:47], s61 offen offset:2048 sc1
  v_mfma_f32_16x16x32_bf16 a[12:15], a[152:155], a[160:163], a[12:15]
  s_waitcnt lgkmcnt(10)
  v_mfma_f32_16x16x32_bf16 a[16:19], a[128:131], a[160:163], a[16:19]
  s_waitcnt lgkmcnt(8)
  v_mfma_f32_16x16x32_bf16 a[16:19], a[132:135], a[176:179], a[16:19]
  ds_read_b64_tr_b16 a[152:153], v23 offset:0
  ds_read_b64_tr_b16 a[154:155], v23 offset:1024
  v_mfma_f32_16x16x32_bf16 a[48:51], a[132:135], a[180:183], a[48:51]
  buffer_store_dwordx4 v[84:87], v7, s[4:7], s90 offen offset:1024 sc1
  v_mfma_f32_16x16x32_bf16 a[48:51], a[128:131], a[164:167], a[48:51]
  v_mfma_f32_16x16x32_bf16 a[80:83], a[128:131], a[168:171], a[80:83]
  v_mfma_f32_16x16x32_bf16 a[80:83], a[132:135], a[184:187], a[80:83]
  ds_read_b64_tr_b16 a[156:157], v23 offset:16384
  ds_read_b64_tr_b16 a[158:159], v23 offset:17408
  v_mfma_f32_16x16x32_bf16 a[112:115], a[132:135], a[188:191], a[112:115]
  buffer_load_dwordx4 v2, s[96:99], s87 offen offset:0 lds
  v_mfma_f32_16x16x32_bf16 a[112:115], a[128:131], a[172:175], a[112:115]
  s_waitcnt lgkmcnt(10)
  v_mfma_f32_16x16x32_bf16 a[116:119], a[136:139], a[172:175], a[116:119]
  s_waitcnt lgkmcnt(8)
  v_mfma_f32_16x16x32_bf16 a[116:119], a[140:143], a[188:191], a[116:119]
  ds_read_b64_tr_b16 a[128:129], v32 offset:0
  ds_read_b64_tr_b16 a[130:131], v32 offset:512
  v_mfma_f32_16x16x32_bf16 a[84:87], a[140:143], a[184:187], a[84:87]
  buffer_load_dwordx4 v3, s[96:99], s87 offen offset:1024 lds
  v_mfma_f32_16x16x32_bf16 a[84:87], a[136:139], a[168:171], a[84:87]
  s_add_u32 s87, s87, 262144
  v_mfma_f32_16x16x32_bf16 a[52:55], a[136:139], a[164:167], a[52:55]
  s_add_u32 m0, s1, 81920
  v_mfma_f32_16x16x32_bf16 a[52:55], a[140:143], a[180:183], a[52:55]
  ds_read_b64_tr_b16 a[132:133], v32 offset:16384
  ds_read_b64_tr_b16 a[134:135], v32 offset:16896
  v_mfma_f32_16x16x32_bf16 a[20:23], a[140:143], a[176:179], a[20:23]
  buffer_load_dwordx4 v4, s[16:19], s89 offen lds
  v_mfma_f32_16x16x32_bf16 a[20:23], a[136:139], a[160:163], a[20:23]
  s_waitcnt lgkmcnt(10)
  v_mfma_f32_16x16x32_bf16 a[24:27], a[144:147], a[160:163], a[24:27]
  s_waitcnt lgkmcnt(8)
  v_mov_b32 v56, s72
  s_lshl_b32 s81, s77, 11
  v_mfma_f32_16x16x32_bf16 a[24:27], a[148:151], a[176:179], a[24:27]
  s_cmp_eq_u32 s76, 0
  s_cselect_b32 s95, 32, 0
  ds_read_b64_tr_b16 a[136:137], v33 offset:0
  ds_read_b64_tr_b16 a[138:139], v33 offset:512
  v_mfma_f32_16x16x32_bf16 a[56:59], a[148:151], a[180:183], a[56:59]
  s_add_u32 s89, s89, 110592
  v_cmp_gt_u32 vcc, s95, v14
  v_lshl_add_u32 v57, v14, 6, s81
  v_mfma_f32_16x16x32_bf16 a[56:59], a[144:147], a[164:167], a[56:59]
  s_add_u32 m0, s0, 0
  v_mov_b32 v8, 2146435072
  v_mov_b32 v9, s72
  v_mfma_f32_16x16x32_bf16 a[88:91], a[144:147], a[168:171], a[88:91]
  v_cndmask_b32 v8, v8, v57, vcc
  v_cndmask_b32 v9, 0, v9, vcc
  v_mfma_f32_16x16x32_bf16 a[88:91], a[148:151], a[184:187], a[88:91]
  s_add_u32 s40, s74, 65011712
  s_addc_u32 s41, s75, 0
  ds_read_b64_tr_b16 a[140:141], v33 offset:16384
  ds_read_b64_tr_b16 a[142:143], v33 offset:16896
  v_mfma_f32_16x16x32_bf16 a[120:123], a[148:151], a[188:191], a[120:123]
  s_waitcnt lgkmcnt(10)
  s_mov_b32 s42, 7454720
  s_mov_b32 s43, 0x20000
  v_mfma_f32_16x16x32_bf16 a[120:123], a[144:147], a[172:175], a[120:123]
  s_add_u32 s20, s74, 39845888
  s_addc_u32 s21, s75, 0
  s_mov_b32 s22, 23855104
  v_mfma_f32_16x16x32_bf16 a[124:127], a[152:155], a[172:175], a[124:127]
  s_waitcnt lgkmcnt(8)
  buffer_store_dwordx4 v[88:91], v7, s[4:7], s90 offen offset:2048 sc1
  v_mfma_f32_16x16x32_bf16 a[124:127], a[156:159], a[188:191], a[124:127]
  s_mov_b32 s23, 0x20000
  ds_read_b64_tr_b16 a[144:145], v34 offset:0
  ds_read_b64_tr_b16 a[146:147], v34 offset:512
  v_mfma_f32_16x16x32_bf16 a[92:95], a[156:159], a[184:187], a[92:95]
  v_lshrrev_b32 v58, 2, v14
  v_and_b32 v60, 3, v14
  v_mfma_f32_16x16x32_bf16 a[92:95], a[152:155], a[168:171], a[92:95]
  v_lshlrev_b32 v58, 6, v58
  v_lshl_add_u32 v58, v60, 3, v58
  v_mfma_f32_16x16x32_bf16 a[60:63], a[152:155], a[164:167], a[60:63]
  v_add_u32 v58, s3, v58
  v_mfma_f32_16x16x32_bf16 a[60:63], a[156:159], a[180:183], a[60:63]
  ds_read_b64_tr_b16 a[148:149], v34 offset:16384
  ds_read_b64_tr_b16 a[150:151], v34 offset:16896
  v_mfma_f32_16x16x32_bf16 a[28:31], a[156:159], a[176:179], a[28:31]
  buffer_load_dwordx4 a[240:243], v10, s[44:47], s60 offen offset:3072 sc1
  v_mfma_f32_16x16x32_bf16 a[28:31], a[152:155], a[160:163], a[28:31]
  s_waitcnt lgkmcnt(10)
  v_mfma_f32_16x16x32_bf16 v[192:195], a[128:131], a[160:163], v[192:195]
  s_waitcnt lgkmcnt(8)
  v_mfma_f32_16x16x32_bf16 v[192:195], a[132:135], a[176:179], v[192:195]
  ds_read_b64_tr_b16 a[152:153], v35 offset:0
  ds_read_b64_tr_b16 a[154:155], v35 offset:512
  v_mfma_f32_16x16x32_bf16 v[208:211], a[132:135], a[180:183], v[208:211]
  buffer_load_dwordx4 a[244:247], v10, s[44:47], s61 offen offset:3072 sc1
  v_mfma_f32_16x16x32_bf16 v[208:211], a[128:131], a[164:167], v[208:211]
  v_mfma_f32_16x16x32_bf16 v[224:227], a[128:131], a[168:171], v[224:227]
  v_mfma_f32_16x16x32_bf16 v[224:227], a[132:135], a[184:187], v[224:227]
  ds_read_b64_tr_b16 a[156:157], v35 offset:16384
  ds_read_b64_tr_b16 a[158:159], v35 offset:16896
  v_mfma_f32_16x16x32_bf16 v[240:243], a[132:135], a[188:191], v[240:243]
  s_waitcnt vmcnt(27) lgkmcnt(10)
  buffer_load_dwordx4 a[248:251], v11, s[44:47], s60 offen offset:3072 sc1
  v_mfma_f32_16x16x32_bf16 v[240:243], a[128:131], a[172:175], v[240:243]
  s_barrier
  v_mfma_f32_16x16x32_bf16 v[244:247], a[136:139], a[172:175], v[244:247]
  s_waitcnt lgkmcnt(8)
  v_mfma_f32_16x16x32_bf16 v[244:247], a[140:143], a[188:191], v[244:247]
  ds_read_b64_tr_b16 a[128:129], v16 offset:32768
  ds_read_b64_tr_b16 a[130:131], v16 offset:33792
  v_mfma_f32_16x16x32_bf16 v[228:231], a[140:143], a[184:187], v[228:231]
  buffer_load_dwordx4 a[252:255], v11, s[44:47], s61 offen offset:3072 sc1
  v_mfma_f32_16x16x32_bf16 v[228:231], a[136:139], a[168:171], v[228:231]
  s_mov_b32 s60, 8192
  v_mfma_f32_16x16x32_bf16 v[212:215], a[136:139], a[164:167], v[212:215]
  s_add_u32 s61, s73, 8192
  v_mfma_f32_16x16x32_bf16 v[212:215], a[140:143], a[180:183], v[212:215]
  ds_read_b64_tr_b16 a[132:133], v16 offset:49152
  ds_read_b64_tr_b16 a[134:135], v16 offset:50176
  v_mfma_f32_16x16x32_bf16 v[196:199], a[140:143], a[176:179], v[196:199]
  v_mfma_f32_16x16x32_bf16 v[196:199], a[136:139], a[160:163], v[196:199]
  s_waitcnt lgkmcnt(10)
  v_mfma_f32_16x16x32_bf16 v[200:203], a[144:147], a[160:163], v[200:203]
  s_waitcnt lgkmcnt(8)
  buffer_store_dwordx4 v[92:95], v7, s[4:7], s90 offen offset:3072 sc1
  v_mfma_f32_16x16x32_bf16 v[200:203], a[148:151], a[176:179], v[200:203]
  ds_read_b64_tr_b16 a[136:137], v17 offset:32768
  ds_read_b64_tr_b16 a[138:139], v17 offset:33792
  v_mfma_f32_16x16x32_bf16 v[216:219], a[148:151], a[180:183], v[216:219]
  v_mfma_f32_16x16x32_bf16 v[216:219], a[144:147], a[164:167], v[216:219]
  v_mfma_f32_16x16x32_bf16 v[232:235], a[144:147], a[168:171], v[232:235]
  v_mfma_f32_16x16x32_bf16 v[232:235], a[148:151], a[184:187], v[232:235]
  ds_read_b64_tr_b16 a[140:141], v17 offset:49152
  ds_read_b64_tr_b16 a[142:143], v17 offset:50176
  v_mfma_f32_16x16x32_bf16 v[248:251], a[148:151], a[188:191], v[248:251]
L_padA5:
  s_cbranch_execz L_padA9
  v_mfma_f32_16x16x32_bf16 v[248:251], a[144:147], a[172:175], v[248:251]
  s_waitcnt lgkmcnt(10)
  v_mfma_f32_16x16x32_bf16 v[252:255], a[152:155], a[172:175], v[252:255]
  s_waitcnt lgkmcnt(8)
  v_mfma_f32_16x16x32_bf16 v[252:255], a[156:159], a[188:191], v[252:255]
  ds_read_b64_tr_b16 a[144:145], v18 offset:32768
  ds_read_b64_tr_b16 a[146:147], v18 offset:33792
  v_mfma_f32_16x16x32_bf16 v[236:239], a[156:159], a[184:187], v[236:239]
  v_mfma_f32_16x16x32_bf16 v[236:239], a[152:155], a[168:171], v[236:239]
  v_mfma_f32_16x16x32_bf16 v[220:223], a[152:155], a[164:167], v[220:223]
  v_mfma_f32_16x16x32_bf16 v[220:223], a[156:159], a[180:183], v[220:223]
  ds_read_b64_tr_b16 a[148:149], v18 offset:49152
  ds_read_b64_tr_b16 a[150:151], v18 offset:50176
  v_mfma_f32_16x16x32_bf16 v[204:207], a[156:159], a[176:179], v[204:207]
  v_mfma_f32_16x16x32_bf16 v[204:207], a[152:155], a[160:163], v[204:207]
  s_waitcnt vmcnt(24) lgkmcnt(8)
  v_mfma_f32_16x16x32_bf16 a[0:3], a[128:131], a[192:195], a[0:3]
  s_barrier
  v_mfma_f32_16x16x32_bf16 a[0:3], a[132:135], a[208:211], a[0:3]
  s_waitcnt vmcnt(23)
  ds_read_b64_tr_b16 a[152:153], v19 offset:32768
  ds_read_b64_tr_b16 a[154:155], v19 offset:33792
  v_mfma_f32_16x16x32_bf16 a[32:35], a[132:135], a[212:215], a[32:35]
  buffer_load_dwordx4 v2, s[96:99], s87 offen offset:0 lds
  v_mfma_f32_16x16x32_bf16 a[32:35], a[128:131], a[196:199], a[32:35]
  v_mfma_f32_16x16x32_bf16 a[64:67], a[128:131], a[200:203], a[64:67]
  s_waitcnt vmcnt(23)
  v_mfma_f32_16x16x32_bf16 a[64:67], a[132:135], a[216:219], a[64:67]
  s_waitcnt vmcnt(22)
  ds_read_b64_tr_b16 a[156:157], v19 offset:49152
  ds_read_b64_tr_b16 a[158:159], v19 offset:50176
  v_mfma_f32_16x16x32_bf16 a[96:99], a[132:135], a[220:223], a[96:99]
  buffer_load_dwordx4 v3, s[96:99], s87 offen offset:1024 lds
  s_add_u32 m0, s1, 0
  v_mfma_f32_16x16x32_bf16 a[96:99], a[128:131], a[204:207], a[96:99]
  s_waitcnt lgkmcnt(10)
  v_mfma_f32_16x16x32_bf16 a[100:103], a[136:139], a[204:207], a[100:103]
  s_waitcnt lgkmcnt(8)
  v_mfma_f32_16x16x32_bf16 a[100:103], a[140:143], a[220:223], a[100:103]
  s_add_u32 s87, s87, 262144
  ds_read_b64_tr_b16 a[128:129], v20 offset:32768
  ds_read_b64_tr_b16 a[130:131], v20 offset:33792
  v_mfma_f32_16x16x32_bf16 a[68:71], a[140:143], a[216:219], a[68:71]
  buffer_load_dwordx4 v4, s[16:19], s89 offen lds
  v_mfma_f32_16x16x32_bf16 a[68:71], a[136:139], a[200:203], a[68:71]
  s_add_u32 s89, s89, 110592
  v_mfma_f32_16x16x32_bf16 a[36:39], a[136:139], a[196:199], a[36:39]
  s_add_u32 m0, s0, 16384
  v_mfma_f32_16x16x32_bf16 a[36:39], a[140:143], a[212:215], a[36:39]
  ds_read_b64_tr_b16 a[132:133], v20 offset:49152
  ds_read_b64_tr_b16 a[134:135], v20 offset:50176
  v_mfma_f32_16x16x32_bf16 a[4:7], a[140:143], a[208:211], a[4:7]
  buffer_store_dwordx4 v[96:99], v6, s[4:7], s91 offen offset:0 sc1
  v_mfma_f32_16x16x32_bf16 a[4:7], a[136:139], a[192:195], a[4:7]
  s_waitcnt lgkmcnt(10)
  v_mfma_f32_16x16x32_bf16 a[8:11], a[144:147], a[192:195], a[8:11]
  s_waitcnt lgkmcnt(8)
  v_mfma_f32_16x16x32_bf16 a[8:11], a[148:151], a[208:211], a[8:11]
  ds_read_b64_tr_b16 a[136:137], v21 offset:32768
  ds_read_b64_tr_b16 a[138:139], v21 offset:33792
  v_mfma_f32_16x16x32_bf16 a[40:43], a[148:151], a[212:215], a[40:43]
  buffer_load_dwordx4 a[160:163], v10, s[44:47], s60 offen offset:0 sc1
  v_mfma_f32_16x16x32_bf16 a[40:43], a[144:147], a[196:199], a[40:43]
  v_mfma_f32_16x16x32_bf16 a[72:75], a[144:147], a[200:203], a[72:75]
  v_mfma_f32_16x16x32_bf16 a[72:75], a[148:151], a[216:219], a[72:75]
  ds_read_b64_tr_b16 a[140:141], v21 offset:49152
  ds_read_b64_tr_b16 a[142:143], v21 offset:50176
  v_mfma_f32_16x16x32_bf16 a[104:107], a[148:151], a[220:223], a[104:107]
  buffer_load_dwordx4 a[164:167], v10, s[44:47], s61 offen offset:0 sc1
  v_mfma_f32_16x16x32_bf16 a[104:107], a[144:147], a[204:207], a[104:107]
  s_waitcnt lgkmcnt(10)
  v_mfma_f32_16x16x32_bf16 a[108:111], a[152:155], a[204:207], a[108:111]
  s_waitcnt lgkmcnt(8)
  v_mfma_f32_16x16x32_bf16 a[108:111], a[156:159], a[220:223], a[108:111]
  ds_read_b64_tr_b16 a[144:145], v22 offset:32768
  ds_read_b64_tr_b16 a[146:147], v22 offset:33792
  v_mfma_f32_16x16x32_bf16 a[76:79], a[156:159], a[216:219], a[76:79]
  buffer_load_dwordx4 a[168:171], v11, s[44:47], s60 offen offset:0 sc1
  v_mfma_f32_16x16x32_bf16 a[76:79], a[152:155], a[200:203], a[76:79]
  v_mfma_f32_16x16x32_bf16 a[44:47], a[152:155], a[196:199], a[44:47]
  v_mfma_f32_16x16x32_bf16 a[44:47], a[156:159], a[212:215], a[44:47]
  ds_read_b64_tr_b16 a[148:149], v22 offset:49152
  ds_read_b64_tr_b16 a[150:151], v22 offset:50176
  v_mfma_f32_16x16x32_bf16 a[12:15], a[156:159], a[208:211], a[12:15]
  buffer_load_dwordx4 a[172:175], v11, s[44:47], s61 offen offset:0 sc1
  v_mfma_f32_16x16x32_bf16 a[12:15], a[152:155], a[192:195], a[12:15]
  s_waitcnt lgkmcnt(10)
  v_mfma_f32_16x16x32_bf16 a[16:19], a[128:131], a[192:195], a[16:19]
  s_waitcnt lgkmcnt(8)
  v_mfma_f32_16x16x32_bf16 a[16:19], a[132:135], a[208:211], a[16:19]
  ds_read_b64_tr_b16 a[152:153], v23 offset:32768
  ds_read_b64_tr_b16 a[154:155], v23 offset:33792
  v_mfma_f32_16x16x32_bf16 a[48:51], a[132:135], a[212:215], a[48:51]
  buffer_store_dwordx4 v[100:103], v6, s[4:7], s91 offen offset:1024 sc1
  v_mfma_f32_16x16x32_bf16 a[48:51], a[128:131], a[196:199], a[48:51]
  v_mfma_f32_16x16x32_bf16 a[80:83], a[128:131], a[200:203], a[80:83]
  v_mfma_f32_16x16x32_bf16 a[80:83], a[132:135], a[216:219], a[80:83]
  ds_read_b64_tr_b16 a[156:157], v23 offset:49152
  ds_read_b64_tr_b16 a[158:159], v23 offset:50176
  v_mfma_f32_16x16x32_bf16 a[112:115], a[132:135], a[220:223], a[112:115]
  buffer_load_dwordx4 v2, s[96:99], s87 offen offset:0 lds
  v_mfma_f32_16x16x32_bf16 a[112:115], a[128:131], a[204:207], a[112:115]
  s_waitcnt lgkmcnt(10)
  v_mfma_f32_16x16x32_bf16 a[116:119], a[136:139], a[204:207], a[116:119]
  s_waitcnt lgkmcnt(8)
  v_mfma_f32_16x16x32_bf16 a[116:119], a[140:143], a[220:223], a[116:119]
  ds_read_b64_tr_b16 a[128:129], v32 offset:32768
  ds_read_b64_tr_b16 a[130:131], v32 offset:33280
  v_mfma_f32_16x16x32_bf16 a[84:87], a[140:143], a[216:219], a[84:87]
  buffer_load_dwordx4 v3, s[96:99], s87 offen offset:1024 lds
  v_mfma_f32_16x16x32_bf16 a[84:87], a[136:139], a[200:203], a[84:87]
  s_add_u32 s87, s87, 262144
  v_mfma_f32_16x16x32_bf16 a[52:55], a[136:139], a[196:199], a[52:55]
  s_add_u32 m0, s1, 16384
  v_mfma_f32_16x16x32_bf16 a[52:55], a[140:143], a[212:215], a[52:55]
  ds_read_b64_tr_b16 a[132:133], v32 offset:49152
  ds_read_b64_tr_b16 a[134:135], v32 offset:49664
  v_mfma_f32_16x16x32_bf16 a[20:23], a[140:143], a[208:211], a[20:23]
  buffer_load_dwordx4 v4, s[16:19], s89 offen lds
  v_mfma_f32_16x16x32_bf16 a[20:23], a[136:139], a[192:195], a[20:23]
  s_waitcnt lgkmcnt(10)
  v_mfma_f32_16x16x32_bf16 a[24:27], a[144:147], a[192:195], a[24:27]
  s_waitcnt lgkmcnt(8)
  v_mfma_f32_16x16x32_bf16 a[24:27], a[148:151], a[208:211], a[24:27]
  s_add_u32 s89, s89, 110592
  ds_read_b64_tr_b16 a[136:137], v33 offset:32768
  ds_read_b64_tr_b16 a[138:139], v33 offset:33280
  v_mfma_f32_16x16x32_bf16 a[56:59], a[148:151], a[212:215], a[56:59]
  s_add_u32 m0, s0, 32768
  v_mfma_f32_16x16x32_bf16 a[56:59], a[144:147], a[196:199], a[56:59]
  v_mfma_f32_16x16x32_bf16 a[88:91], a[144:147], a[200:203], a[88:91]
  v_mfma_f32_16x16x32_bf16 a[88:91], a[148:151], a[216:219], a[88:91]
  ds_read_b64_tr_b16 a[140:141], v33 offset:49152
  ds_read_b64_tr_b16 a[142:143], v33 offset:49664
  v_mfma_f32_16x16x32_bf16 a[120:123], a[148:151], a[220:223], a[120:123]
  v_mfma_f32_16x16x32_bf16 a[120:123], a[144:147], a[204:207], a[120:123]
  s_waitcnt lgkmcnt(10)
  v_mfma_f32_16x16x32_bf16 a[124:127], a[152:155], a[204:207], a[124:127]
  s_waitcnt lgkmcnt(8)
  buffer_store_dwordx4 v[104:107], v6, s[4:7], s91 offen offset:2048 sc1
  v_mfma_f32_16x16x32_bf16 a[124:127], a[156:159], a[220:223], a[124:127]
  ds_read_b64_tr_b16 a[144:145], v34 offset:32768
  ds_read_b64_tr_b16 a[146:147], v34 offset:33280
  v_mfma_f32_16x16x32_bf16 a[92:95], a[156:159], a[216:219], a[92:95]
  v_mfma_f32_16x16x32_bf16 a[92:95], a[152:155], a[200:203], a[92:95]
  v_mfma_f32_16x16x32_bf16 a[60:63], a[152:155], a[196:199], a[60:63]
  v_mfma_f32_16x16x32_bf16 a[60:63], a[156:159], a[212:215], a[60:63]
  ds_read_b64_tr_b16 a[148:149], v34 offset:49152
  ds_read_b64_tr_b16 a[150:151], v34 offset:49664
  v_mfma_f32_16x16x32_bf16 a[28:31], a[156:159], a[208:211], a[28:31]
  buffer_load_dwordx4 a[176:179], v10, s[44:47], s60 offen offset:1024 sc1
  v_mfma_f32_16x16x32_bf16 a[28:31], a[152:155], a[192:195], a[28:31]
  s_waitcnt lgkmcnt(10)
  v_mfma_f32_16x16x32_bf16 v[192:195], a[128:131], a[192:195], v[192:195]
  s_waitcnt lgkmcnt(8)
  v_mfma_f32_16x16x32_bf16 v[192:195], a[132:135], a[208:211], v[192:195]
  ds_read_b64_tr_b16 a[152:153], v35 offset:32768
  ds_read_b64_tr_b16 a[154:155], v35 offset:33280
  v_mfma_f32_16x16x32_bf16 v[208:211], a[132:135], a[212:215], v[208:211]
  buffer_load_dwordx4 a[180:183], v10, s[44:47], s61 offen offset:1024 sc1
  v_mfma_f32_16x16x32_bf16 v[208:211], a[128:131], a[196:199], v[208:211]
  v_mfma_f32_16x16x32_bf16 v[224:227], a[128:131], a[200:203], v[224:227]
  v_mfma_f32_16x16x32_bf16 v[224:227], a[132:135], a[216:219], v[224:227]
  ds_read_b64_tr_b16 a[156:157], v35 offset:49152
  ds_read_b64_tr_b16 a[158:159], v35 offset:49664
  v_mfma_f32_16x16x32_bf16 v[240:243], a[132:135], a[220:223], v[240:243]
  s_waitcnt vmcnt(21) lgkmcnt(10)
  buffer_load_dwordx4 a[184:187], v11, s[44:47], s60 offen offset:1024 sc1
  v_mfma_f32_16x16x32_bf16 v[240:243], a[128:131], a[204:207], v[240:243]
  s_barrier
  v_mfma_f32_16x16x32_bf16 v[244:247], a[136:139], a[204:207], v[244:247]
  s_waitcnt lgkmcnt(8)
  v_mfma_f32_16x16x32_bf16 v[244:247], a[140:143], a[220:223], v[244:247]
  ds_read_b64_tr_b16 a[128:129], v24 offset:0
  ds_read_b64_tr_b16 a[130:131], v24 offset:1024
  v_mfma_f32_16x16x32_bf16 v[228:231], a[140:143], a[216:219], v[228:231]
  buffer_load_dwordx4 a[188:191], v11, s[44:47], s61 offen offset:1024 sc1
  v_mfma_f32_16x16x32_bf16 v[228:231], a[136:139], a[200:203], v[228:231]
  v_mfma_f32_16x16x32_bf16 v[212:215], a[136:139], a[196:199], v[212:215]
  v_mfma_f32_16x16x32_bf16 v[212:215], a[140:143], a[212:215], v[212:215]
  ds_read_b64_tr_b16 a[132:133], v24 offset:16384
  ds_read_b64_tr_b16 a[134:135], v24 offset:17408
  v_mfma_f32_16x16x32_bf16 v[196:199], a[140:143], a[208:211], v[196:199]
  v_mfma_f32_16x16x32_bf16 v[196:199], a[136:139], a[192:195], v[196:199]
  s_waitcnt lgkmcnt(10)
  v_mfma_f32_16x16x32_bf16 v[200:203], a[144:147], a[192:195], v[200:203]
  s_waitcnt lgkmcnt(8)
  buffer_store_dwordx4 v[108:111], v6, s[4:7], s91 offen offset:3072 sc1
  v_mfma_f32_16x16x32_bf16 v[200:203], a[148:151], a[208:211], v[200:203]
  ds_read_b64_tr_b16 a[136:137], v25 offset:0
  ds_read_b64_tr_b16 a[138:139], v25 offset:1024
  v_mfma_f32_16x16x32_bf16 v[216:219], a[148:151], a[212:215], v[216:219]
  v_mfma_f32_16x16x32_bf16 v[216:219], a[144:147], a[196:199], v[216:219]
  v_mfma_f32_16x16x32_bf16 v[232:235], a[144:147], a[200:203], v[232:235]
  v_mfma_f32_16x16x32_bf16 v[232:235], a[148:151], a[216:219], v[232:235]
  ds_read_b64_tr_b16 a[140:141], v25 offset:16384
  ds_read_b64_tr_b16 a[142:143], v25 offset:17408
  v_mfma_f32_16x16x32_bf16 v[248:251], a[148:151], a[220:223], v[248:251]
  v_mfma_f32_16x16x32_bf16 v[248:251], a[144:147], a[204:207], v[248:251]
  s_waitcnt lgkmcnt(10)
  v_mfma_f32_16x16x32_bf16 v[252:255], a[152:155], a[204:207], v[252:255]
  s_waitcnt lgkmcnt(8)
  v_mfma_f32_16x16x32_bf16 v[252:255], a[156:159], a[220:223], v[252:255]
  ds_read_b64_tr_b16 a[144:145], v26 offset:0
  ds_read_b64_tr_b16 a[146:147], v26 offset:1024
  v_mfma_f32_16x16x32_bf16 v[236:239], a[156:159], a[216:219], v[236:239]
  v_mfma_f32_16x16x32_bf16 v[236:239], a[152:155], a[200:203], v[236:239]
  v_mfma_f32_16x16x32_bf16 v[220:223], a[152:155], a[196:199], v[220:223]
  v_mfma_f32_16x16x32_bf16 v[220:223], a[156:159], a[212:215], v[220:223]
  ds_read_b64_tr_b16 a[148:149], v26 offset:16384
  ds_read_b64_tr_b16 a[150:151], v26 offset:17408
  v_mfma_f32_16x16x32_bf16 v[204:207], a[156:159], a[208:211], v[204:207]
  v_mfma_f32_16x16x32_bf16 v[204:207], a[152:155], a[192:195], v[204:207]
  s_waitcnt vmcnt(22) lgkmcnt(8)
  v_mfma_f32_16x16x32_bf16 a[0:3], a[128:131], a[224:227], a[0:3]
  s_barrier
  v_mfma_f32_16x16x32_bf16 a[0:3], a[132:135], a[240:243], a[0:3]
  s_waitcnt vmcnt(21)
  ds_read_b64_tr_b16 a[152:153], v27 offset:0
  ds_read_b64_tr_b16 a[154:155], v27 offset:1024
  v_mfma_f32_16x16x32_bf16 a[32:35], a[132:135], a[244:247], a[32:35]
  buffer_load_dwordx4 v2, s[96:99], s87 offen offset:0 lds
  v_mfma_f32_16x16x32_bf16 a[32:35], a[128:131], a[228:231], a[32:35]
  v_mfma_f32_16x16x32_bf16 a[64:67], a[128:131], a[232:235], a[64:67]
  s_waitcnt vmcnt(21)
  v_mfma_f32_16x16x32_bf16 a[64:67], a[132:135], a[248:251], a[64:67]
  s_waitcnt vmcnt(20)
  ds_read_b64_tr_b16 a[156:157], v27 offset:16384
  ds_read_b64_tr_b16 a[158:159], v27 offset:17408
  v_mfma_f32_16x16x32_bf16 a[96:99], a[132:135], a[252:255], a[96:99]
  buffer_load_dwordx4 v3, s[96:99], s87 offen offset:1024 lds
  s_add_u32 m0, s1, 32768
  v_mfma_f32_16x16x32_bf16 a[96:99], a[128:131], a[236:239], a[96:99]
  s_waitcnt lgkmcnt(10)
  v_mfma_f32_16x16x32_bf16 a[100:103], a[136:139], a[236:239], a[100:103]
  s_waitcnt lgkmcnt(8)
  v_mfma_f32_16x16x32_bf16 a[100:103], a[140:143], a[252:255], a[100:103]
  s_add_u32 s87, s87, 262144
  ds_read_b64_tr_b16 a[128:129], v28 offset:0
  ds_read_b64_tr_b16 a[130:131], v28 offset:1024
  v_mfma_f32_16x16x32_bf16 a[68:71], a[140:143], a[248:251], a[68:71]
  buffer_load_dwordx4 v4, s[16:19], s89 offen lds
  v_mfma_f32_16x16x32_bf16 a[68:71], a[136:139], a[232:235], a[68:71]
  s_add_u32 s89, s89, 110592
  v_mfma_f32_16x16x32_bf16 a[36:39], a[136:139], a[228:231], a[36:39]
  s_add_u32 m0, s0, 49152
  v_mfma_f32_16x16x32_bf16 a[36:39], a[140:143], a[244:247], a[36:39]
  ds_read_b64_tr_b16 a[132:133], v28 offset:16384
  ds_read_b64_tr_b16 a[134:135], v28 offset:17408
  v_mfma_f32_16x16x32_bf16 a[4:7], a[140:143], a[240:243], a[4:7]
  buffer_store_dwordx4 v[112:115], v7, s[4:7], s91 offen offset:0 sc1
  v_mfma_f32_16x16x32_bf16 a[4:7], a[136:139], a[224:227], a[4:7]
  s_waitcnt lgkmcnt(10)
  v_mfma_f32_16x16x32_bf16 a[8:11], a[144:147], a[224:227], a[8:11]
  s_waitcnt lgkmcnt(8)
  v_mfma_f32_16x16x32_bf16 a[8:11], a[148:151], a[240:243], a[8:11]
  ds_read_b64_tr_b16 a[136:137], v29 offset:0
  ds_read_b64_tr_b16 a[138:139], v29 offset:1024
  v_mfma_f32_16x16x32_bf16 a[40:43], a[148:151], a[244:247], a[40:43]
  buffer_load_dwordx4 a[192:195], v10, s[44:47], s60 offen offset:2048 sc1
  v_mfma_f32_16x16x32_bf16 a[40:43], a[144:147], a[228:231], a[40:43]
  v_mfma_f32_16x16x32_bf16 a[72:75], a[144:147], a[232:235], a[72:75]
  v_mfma_f32_16x16x32_bf16 a[72:75], a[148:151], a[248:251], a[72:75]
  ds_read_b64_tr_b16 a[140:141], v29 offset:16384
  ds_read_b64_tr_b16 a[142:143], v29 offset:17408
  v_mfma_f32_16x16x32_bf16 a[104:107], a[148:151], a[252:255], a[104:107]
  buffer_load_dwordx4 a[196:199], v10, s[44:47], s61 offen offset:2048 sc1
  v_mfma_f32_16x16x32_bf16 a[104:107], a[144:147], a[236:239], a[104:107]
  s_waitcnt lgkmcnt(10)
  v_mfma_f32_16x16x32_bf16 a[108:111], a[152:155], a[236:239], a[108:111]
  s_waitcnt lgkmcnt(8)
  v_mfma_f32_16x16x32_bf16 a[108:111], a[156:159], a[252:255], a[108:111]
  ds_read_b64_tr_b16 a[144:145], v30 offset:0
  ds_read_b64_tr_b16 a[146:147], v30 offset:1024
  v_mfma_f32_16x16x32_bf16 a[76:79], a[156:159], a[248:251], a[76:79]
  buffer_load_dwordx4 a[200:203], v11, s[44:47], s60 offen offset:2048 sc1
  v_mfma_f32_16x16x32_bf16 a[76:79], a[152:155], a[232:235], a[76:79]
  v_mfma_f32_16x16x32_bf16 a[44:47], a[152:155], a[228:231], a[44:47]
  v_mfma_f32_16x16x32_bf16 a[44:47], a[156:159], a[244:247], a[44:47]
  ds_read_b64_tr_b16 a[148:149], v30 offset:16384
  ds_read_b64_tr_b16 a[150:151], v30 offset:17408
  v_mfma_f32_16x16x32_bf16 a[12:15], a[156:159], a[240:243], a[12:15]
  buffer_load_dwordx4 a[204:207], v11, s[44:47], s61 offen offset:2048 sc1
  v_mfma_f32_16x16x32_bf16 a[12:15], a[152:155], a[224:227], a[12:15]
  s_waitcnt lgkmcnt(10)
  v_mfma_f32_16x16x32_bf16 a[16:19], a[128:131], a[224:227], a[16:19]
  s_waitcnt lgkmcnt(8)
  v_mfma_f32_16x16x32_bf16 a[16:19], a[132:135], a[240:243], a[16:19]
  ds_read_b64_tr_b16 a[152:153], v31 offset:0
  ds_read_b64_tr_b16 a[154:155], v31 offset:1024
  v_mfma_f32_16x16x32_bf16 a[48:51], a[132:135], a[244:247], a[48:51]
  buffer_store_dwordx4 v[116:119], v7, s[4:7], s91 offen offset:1024 sc1
  v_mfma_f32_16x16x32_bf16 a[48:51], a[128:131], a[228:231], a[48:51]
  v_mfma_f32_16x16x32_bf16 a[80:83], a[128:131], a[232:235], a[80:83]
  v_mfma_f32_16x16x32_bf16 a[80:83], a[132:135], a[248:251], a[80:83]
  ds_read_b64_tr_b16 a[156:157], v31 offset:16384
  ds_read_b64_tr_b16 a[158:159], v31 offset:17408
  v_mfma_f32_16x16x32_bf16 a[112:115], a[132:135], a[252:255], a[112:115]
  buffer_load_dwordx4 v2, s[96:99], s87 offen offset:0 lds
  v_mfma_f32_16x16x32_bf16 a[112:115], a[128:131], a[236:239], a[112:115]
  s_waitcnt lgkmcnt(10)
  v_mfma_f32_16x16x32_bf16 a[116:119], a[136:139], a[236:239], a[116:119]
  s_waitcnt lgkmcnt(8)
  v_mfma_f32_16x16x32_bf16 a[116:119], a[140:143], a[252:255], a[116:119]
  ds_read_b64_tr_b16 a[128:129], v36 offset:0
  ds_read_b64_tr_b16 a[130:131], v36 offset:512
  v_mfma_f32_16x16x32_bf16 a[84:87], a[140:143], a[248:251], a[84:87]
  buffer_load_dwordx4 v3, s[96:99], s87 offen offset:1024 lds
  v_mfma_f32_16x16x32_bf16 a[84:87], a[136:139], a[232:235], a[84:87]
  s_add_u32 s87, s87, 262144
  v_mfma_f32_16x16x32_bf16 a[52:55], a[136:139], a[228:231], a[52:55]
  s_add_u32 m0, s1, 49152
  v_mfma_f32_16x16x32_bf16 a[52:55], a[140:143], a[244:247], a[52:55]
  ds_read_b64_tr_b16 a[132:133], v36 offset:16384
  ds_read_b64_tr_b16 a[134:135], v36 offset:16896
  v_mfma_f32_16x16x32_bf16 a[20:23], a[140:143], a[240:243], a[20:23]
  buffer_load_dwordx4 v4, s[16:19], s89 offen lds
  v_mfma_f32_16x16x32_bf16 a[20:23], a[136:139], a[224:227], a[20:23]
  s_waitcnt lgkmcnt(10)
  v_mfma_f32_16x16x32_bf16 a[24:27], a[144:147], a[224:227], a[24:27]
  s_waitcnt lgkmcnt(8)
  v_mfma_f32_16x16x32_bf16 a[24:27], a[148:151], a[240:243], a[24:27]
  s_add_u32 s89, s89, 110592
  ds_read_b64_tr_b16 a[136:137], v37 offset:0
  ds_read_b64_tr_b16 a[138:139], v37 offset:512
  v_mfma_f32_16x16x32_bf16 a[56:59], a[148:151], a[244:247], a[56:59]
  s_add_u32 m0, s0, 65536
  v_mfma_f32_16x16x32_bf16 a[56:59], a[144:147], a[228:231], a[56:59]
  v_mfma_f32_16x16x32_bf16 a[88:91], a[144:147], a[232:235], a[88:91]
  v_mfma_f32_16x16x32_bf16 a[88:91], a[148:151], a[248:251], a[88:91]
  ds_read_b64_tr_b16 a[140:141], v37 offset:16384
  ds_read_b64_tr_b16 a[142:143], v37 offset:16896
  v_mfma_f32_16x16x32_bf16 a[120:123], a[148:151], a[252:255], a[120:123]
  v_mfma_f32_16x16x32_bf16 a[120:123], a[144:147], a[236:239], a[120:123]
  s_waitcnt lgkmcnt(10)
  v_mfma_f32_16x16x32_bf16 a[124:127], a[152:155], a[236:239], a[124:127]
  s_waitcnt lgkmcnt(8)
  buffer_store_dwordx4 v[120:123], v7, s[4:7], s91 offen offset:2048 sc1
  v_mfma_f32_16x16x32_bf16 a[124:127], a[156:159], a[252:255], a[124:127]
  ds_read_b64_tr_b16 a[144:145], v38 offset:0
  ds_read_b64_tr_b16 a[146:147], v38 offset:512
  v_mfma_f32_16x16x32_bf16 a[92:95], a[156:159], a[248:251], a[92:95]
  v_mfma_f32_16x16x32_bf16 a[92:95], a[152:155], a[232:235], a[92:95]
  v_mfma_f32_16x16x32_bf16 a[60:63], a[152:155], a[228:231], a[60:63]
  v_mfma_f32_16x16x32_bf16 a[60:63], a[156:159], a[244:247], a[60:63]
  ds_read_b64_tr_b16 a[148:149], v38 offset:16384
  ds_read_b64_tr_b16 a[150:151], v38 offset:16896
  v_mfma_f32_16x16x32_bf16 a[28:31], a[156:159], a[240:243], a[28:31]
  buffer_load_dwordx4 a[208:211], v10, s[44:47], s60 offen offset:3072 sc1
  v_mfma_f32_16x16x32_bf16 a[28:31], a[152:155], a[224:227], a[28:31]
  s_waitcnt lgkmcnt(10)
  v_mfma_f32_16x16x32_bf16 v[192:195], a[128:131], a[224:227], v[192:195]
  s_waitcnt lgkmcnt(8)
  v_mfma_f32_16x16x32_bf16 v[192:195], a[132:135], a[240:243], v[192:195]
  ds_read_b64_tr_b16 a[152:153], v39 offset:0
  ds_read_b64_tr_b16 a[154:155], v39 offset:512
  v_mfma_f32_16x16x32_bf16 v[208:211], a[132:135], a[244:247], v[208:211]
  buffer_load_dwordx4 a[212:215], v10, s[44:47], s61 offen offset:3072 sc1
  v_mfma_f32_16x16x32_bf16 v[208:211], a[128:131], a[228:231], v[208:211]
  v_mfma_f32_16x16x32_bf16 v[224:227], a[128:131], a[232:235], v[224:227]
  v_mfma_f32_16x16x32_bf16 v[224:227], a[132:135], a[248:251], v[224:227]
  ds_read_b64_tr_b16 a[156:157], v39 offset:16384
  ds_read_b64_tr_b16 a[158:159], v39 offset:16896
  v_mfma_f32_16x16x32_bf16 v[240:243], a[132:135], a[252:255], v[240:243]
  s_waitcnt vmcnt(21) lgkmcnt(10)
  buffer_load_dwordx4 a[216:219], v11, s[44:47], s60 offen offset:3072 sc1
  v_mfma_f32_16x16x32_bf16 v[240:243], a[128:131], a[236:239], v[240:243]
  s_barrier
  v_mfma_f32_16x16x32_bf16 v[244:247], a[136:139], a[236:239], v[244:247]
  s_waitcnt lgkmcnt(8)
  v_mfma_f32_16x16x32_bf16 v[244:247], a[140:143], a[252:255], v[244:247]
  ds_read_b64_tr_b16 a[128:129], v16 offset:0
  ds_read_b64_tr_b16 a[130:131], v16 offset:1024
  v_mfma_f32_16x16x32_bf16 v[228:231], a[140:143], a[248:251], v[228:231]
  buffer_load_dwordx4 a[220:223], v11, s[44:47], s61 offen offset:3072 sc1
  v_mfma_f32_16x16x32_bf16 v[228:231], a[136:139], a[232:235], v[228:231]
  s_mov_b32 s60, 12288
  v_mfma_f32_16x16x32_bf16 v[212:215], a[136:139], a[228:231], v[212:215]
  s_add_u32 s61, s73, 12288
  v_mfma_f32_16x16x32_bf16 v[212:215], a[140:143], a[244:247], v[212:215]
  ds_read_b64_tr_b16 a[132:133], v16 offset:16384
  ds_read_b64_tr_b16 a[134:135], v16 offset:17408
  v_mfma_f32_16x16x32_bf16 v[196:199], a[140:143], a[240:243], v[196:199]
  v_mfma_f32_16x16x32_bf16 v[196:199], a[136:139], a[224:227], v[196:199]
  s_waitcnt lgkmcnt(10)
  v_mfma_f32_16x16x32_bf16 v[200:203], a[144:147], a[224:227], v[200:203]
  s_waitcnt lgkmcnt(8)
  buffer_store_dwordx4 v[124:127], v7, s[4:7], s91 offen offset:3072 sc1
  v_mfma_f32_16x16x32_bf16 v[200:203], a[148:151], a[240:243], v[200:203]
  ds_read_b64_tr_b16 a[136:137], v17 offset:0
  ds_read_b64_tr_b16 a[138:139], v17 offset:1024
  v_mfma_f32_16x16x32_bf16 v[216:219], a[148:151], a[244:247], v[216:219]
  v_mfma_f32_16x16x32_bf16 v[216:219], a[144:147], a[228:231], v[216:219]
  v_mfma_f32_16x16x32_bf16 v[232:235], a[144:147], a[232:235], v[232:235]
  v_mfma_f32_16x16x32_bf16 v[232:235], a[148:151], a[248:251], v[232:235]
  ds_read_b64_tr_b16 a[140:141], v17 offset:16384
  ds_read_b64_tr_b16 a[142:143], v17 offset:17408
  v_mfma_f32_16x16x32_bf16 v[248:251], a[148:151], a[252:255], v[248:251]
  v_mfma_f32_16x16x32_bf16 v[248:251], a[144:147], a[236:239], v[248:251]
  s_waitcnt lgkmcnt(10)
  v_mfma_f32_16x16x32_bf16 v[252:255], a[152:155], a[236:239], v[252:255]
  s_waitcnt lgkmcnt(8)
  v_mfma_f32_16x16x32_bf16 v[252:255], a[156:159], a[252:255], v[252:255]
  ds_read_b64_tr_b16 a[144:145], v18 offset:0
  ds_read_b64_tr_b16 a[146:147], v18 offset:1024
  v_mfma_f32_16x16x32_bf16 v[236:239], a[156:159], a[248:251], v[236:239]
  v_mfma_f32_16x16x32_bf16 v[236:239], a[152:155], a[232:235], v[236:239]
  v_mfma_f32_16x16x32_bf16 v[220:223], a[152:155], a[228:231], v[220:223]
  v_mfma_f32_16x16x32_bf16 v[220:223], a[156:159], a[244:247], v[220:223]
  ds_read_b64_tr_b16 a[148:149], v18 offset:16384
  ds_read_b64_tr_b16 a[150:151], v18 offset:17408
  v_mfma_f32_16x16x32_bf16 v[204:207], a[156:159], a[240:243], v[204:207]
  v_mfma_f32_16x16x32_bf16 v[204:207], a[152:155], a[224:227], v[204:207]
  s_waitcnt vmcnt(22) lgkmcnt(8)
  v_mfma_f32_16x16x32_bf16 a[0:3], a[128:131], a[160:163], a[0:3]
  s_barrier
  v_mfma_f32_16x16x32_bf16 a[0:3], a[132:135], a[176:179], a[0:3]
  s_waitcnt vmcnt(21)
  ds_read_b64_tr_b16 a[152:153], v19 offset:0
  ds_read_b64_tr_b16 a[154:155], v19 offset:1024
  v_mfma_f32_16x16x32_bf16 a[32:35], a[132:135], a[180:183], a[32:35]
  buffer_load_dwordx4 v2, s[96:99], s87 offen offset:0 lds
  v_mfma_f32_16x16x32_bf16 a[32:35], a[128:131], a[164:167], a[32:35]
  v_mfma_f32_16x16x32_bf16 a[64:67], a[128:131], a[168:171], a[64:67]
  s_waitcnt vmcnt(21)
  v_mfma_f32_16x16x32_bf16 a[64:67], a[132:135], a[184:187], a[64:67]
  s_waitcnt vmcnt(20)
  ds_read_b64_tr_b16 a[156:157], v19 offset:16384
  ds_read_b64_tr_b16 a[158:159], v19 offset:17408
  v_mfma_f32_16x16x32_bf16 a[96:99], a[132:135], a[188:191], a[96:99]
  buffer_load_dwordx4 v3, s[96:99], s87 offen offset:1024 lds
  s_add_u32 m0, s1, 65536
  v_mfma_f32_16x16x32_bf16 a[96:99], a[128:131], a[172:175], a[96:99]
  s_waitcnt lgkmcnt(10)
  v_mfma_f32_16x16x32_bf16 a[100:103], a[136:139], a[172:175], a[100:103]
  s_waitcnt lgkmcnt(8)
  v_mfma_f32_16x16x32_bf16 a[100:103], a[140:143], a[188:191], a[100:103]
  s_add_u32 s87, s87, 262144
  ds_read_b64_tr_b16 a[128:129], v20 offset:0
  ds_read_b64_tr_b16 a[130:131], v20 offset:1024
  v_mfma_f32_16x16x32_bf16 a[68:71], a[140:143], a[184:187], a[68:71]
  buffer_load_dwordx4 v4, s[16:19], s89 offen lds
  v_mfma_f32_16x16x32_bf16 a[68:71], a[136:139], a[168:171], a[68:71]
  s_add_u32 s89, s89, 110592
  v_mfma_f32_16x16x32_bf16 a[36:39], a[136:139], a[164:167], a[36:39]
  s_add_u32 m0, s0, 81920
  v_mfma_f32_16x16x32_bf16 a[36:39], a[140:143], a[180:183], a[36:39]
  ds_read_b64_tr_b16 a[132:133], v20 offset:16384
  ds_read_b64_tr_b16 a[134:135], v20 offset:17408
  v_mfma_f32_16x16x32_bf16 a[4:7], a[140:143], a[176:179], a[4:7]
  buffer_store_dwordx4 v[128:131], v6, s[4:7], s92 offen offset:0 sc1
  v_mfma_f32_16x16x32_bf16 a[4:7], a[136:139], a[160:163], a[4:7]
  s_waitcnt lgkmcnt(10)
  v_mfma_f32_16x16x32_bf16 a[8:11], a[144:147], a[160:163], a[8:11]
  s_waitcnt lgkmcnt(8)
  v_mfma_f32_16x16x32_bf16 a[8:11], a[148:151], a[176:179], a[8:11]
  ds_read_b64_tr_b16 a[136:137], v21 offset:0
  ds_read_b64_tr_b16 a[138:139], v21 offset:1024
  v_mfma_f32_16x16x32_bf16 a[40:43], a[148:151], a[180:183], a[40:43]
  buffer_load_dwordx4 a[224:227], v10, s[44:47], s60 offen offset:0 sc1
  v_mfma_f32_16x16x32_bf16 a[40:43], a[144:147], a[164:167], a[40:43]
  v_mfma_f32_16x16x32_bf16 a[72:75], a[144:147], a[168:171], a[72:75]
  v_mfma_f32_16x16x32_bf16 a[72:75], a[148:151], a[184:187], a[72:75]
  ds_read_b64_tr_b16 a[140:141], v21 offset:16384
  ds_read_b64_tr_b16 a[142:143], v21 offset:17408
  v_mfma_f32_16x16x32_bf16 a[104:107], a[148:151], a[188:191], a[104:107]
  buffer_load_dwordx4 a[228:231], v10, s[44:47], s61 offen offset:0 sc1
  v_mfma_f32_16x16x32_bf16 a[104:107], a[144:147], a[172:175], a[104:107]
  s_waitcnt lgkmcnt(10)
  v_mfma_f32_16x16x32_bf16 a[108:111], a[152:155], a[172:175], a[108:111]
  s_waitcnt lgkmcnt(8)
  v_mfma_f32_16x16x32_bf16 a[108:111], a[156:159], a[188:191], a[108:111]
  ds_read_b64_tr_b16 a[144:145], v22 offset:0
  ds_read_b64_tr_b16 a[146:147], v22 offset:1024
  v_mfma_f32_16x16x32_bf16 a[76:79], a[156:159], a[184:187], a[76:79]
  buffer_load_dwordx4 a[232:235], v11, s[44:47], s60 offen offset:0 sc1
  v_mfma_f32_16x16x32_bf16 a[76:79], a[152:155], a[168:171], a[76:79]
  v_mfma_f32_16x16x32_bf16 a[44:47], a[152:155], a[164:167], a[44:47]
  v_mfma_f32_16x16x32_bf16 a[44:47], a[156:159], a[180:183], a[44:47]
  ds_read_b64_tr_b16 a[148:149], v22 offset:16384
  ds_read_b64_tr_b16 a[150:151], v22 offset:17408
  v_mfma_f32_16x16x32_bf16 a[12:15], a[156:159], a[176:179], a[12:15]
  buffer_load_dwordx4 a[236:239], v11, s[44:47], s61 offen offset:0 sc1
  v_mfma_f32_16x16x32_bf16 a[12:15], a[152:155], a[160:163], a[12:15]
  s_waitcnt lgkmcnt(10)
  v_mfma_f32_16x16x32_bf16 a[16:19], a[128:131], a[160:163], a[16:19]
  s_waitcnt lgkmcnt(8)
  v_mfma_f32_16x16x32_bf16 a[16:19], a[132:135], a[176:179], a[16:19]
  ds_read_b64_tr_b16 a[152:153], v23 offset:0
  ds_read_b64_tr_b16 a[154:155], v23 offset:1024
  v_mfma_f32_16x16x32_bf16 a[48:51], a[132:135], a[180:183], a[48:51]
  buffer_store_dwordx4 v[136:139], v6, s[4:7], s92 offen offset:1024 sc1
  v_mfma_f32_16x16x32_bf16 a[48:51], a[128:131], a[164:167], a[48:51]
  v_mfma_f32_16x16x32_bf16 a[80:83], a[128:131], a[168:171], a[80:83]
  v_mfma_f32_16x16x32_bf16 a[80:83], a[132:135], a[184:187], a[80:83]
  ds_read_b64_tr_b16 a[156:157], v23 offset:16384
  ds_read_b64_tr_b16 a[158:159], v23 offset:17408
  v_mfma_f32_16x16x32_bf16 a[112:115], a[132:135], a[188:191], a[112:115]
  buffer_load_dwordx4 v2, s[96:99], s87 offen offset:0 lds
  v_mfma_f32_16x16x32_bf16 a[112:115], a[128:131], a[172:175], a[112:115]
  s_waitcnt lgkmcnt(10)
  v_mfma_f32_16x16x32_bf16 a[116:119], a[136:139], a[172:175], a[116:119]
  s_waitcnt lgkmcnt(8)
  v_mfma_f32_16x16x32_bf16 a[116:119], a[140:143], a[188:191], a[116:119]
  ds_read_b64_tr_b16 a[128:129], v32 offset:0
  ds_read_b64_tr_b16 a[130:131], v32 offset:512
  v_mfma_f32_16x16x32_bf16 a[84:87], a[140:143], a[184:187], a[84:87]
  buffer_load_dwordx4 v3, s[96:99], s87 offen offset:1024 lds
  v_mfma_f32_16x16x32_bf16 a[84:87], a[136:139], a[168:171], a[84:87]
  s_add_u32 s87, s87, 262144
  v_mfma_f32_16x16x32_bf16 a[52:55], a[136:139], a[164:167], a[52:55]
  s_add_u32 m0, s1, 81920
  v_mfma_f32_16x16x32_bf16 a[52:55], a[140:143], a[180:183], a[52:55]
  ds_read_b64_tr_b16 a[132:133], v32 offset:16384
  ds_read_b64_tr_b16 a[134:135], v32 offset:16896
  v_mfma_f32_16x16x32_bf16 a[20:23], a[140:143], a[176:179], a[20:23]
  buffer_load_dwordx4 v4, s[16:19], s89 offen lds
  v_mfma_f32_16x16x32_bf16 a[20:23], a[136:139], a[160:163], a[20:23]
  s_waitcnt lgkmcnt(10)
  v_mfma_f32_16x16x32_bf16 a[24:27], a[144:147], a[160:163], a[24:27]
  s_waitcnt lgkmcnt(8)
  v_mfma_f32_16x16x32_bf16 a[24:27], a[148:151], a[176:179], a[24:27]
  s_add_u32 s89, s89, 110592
  ds_read_b64_tr_b16 a[136:137], v33 offset:0
  ds_read_b64_tr_b16 a[138:139], v33 offset:512
  v_mfma_f32_16x16x32_bf16 a[56:59], a[148:151], a[180:183], a[56:59]
  s_add_u32 m0, s0, 0
  v_mfma_f32_16x16x32_bf16 a[56:59], a[144:147], a[164:167], a[56:59]
  v_mfma_f32_16x16x32_bf16 a[88:91], a[144:147], a[168:171], a[88:91]
  v_mfma_f32_16x16x32_bf16 a[88:91], a[148:151], a[184:187], a[88:91]
  ds_read_b64_tr_b16 a[140:141], v33 offset:16384
  ds_read_b64_tr_b16 a[142:143], v33 offset:16896
  v_mfma_f32_16x16x32_bf16 a[120:123], a[148:151], a[188:191], a[120:123]
  v_mfma_f32_16x16x32_bf16 a[120:123], a[144:147], a[172:175], a[120:123]
  s_waitcnt lgkmcnt(10)
  v_mfma_f32_16x16x32_bf16 a[124:127], a[152:155], a[172:175], a[124:127]
  s_waitcnt lgkmcnt(8)
  buffer_store_dwordx4 v[144:147], v6, s[4:7], s92 offen offset:2048 sc1
  v_mfma_f32_16x16x32_bf16 a[124:127], a[156:159], a[188:191], a[124:127]
  ds_read_b64_tr_b16 a[144:145], v34 offset:0
  ds_read_b64_tr_b16 a[146:147], v34 offset:512
  v_mfma_f32_16x16x32_bf16 a[92:95], a[156:159], a[184:187], a[92:95]
  v_mfma_f32_16x16x32_bf16 a[92:95], a[152:155], a[168:171], a[92:95]
  v_mfma_f32_16x16x32_bf16 a[60:63], a[152:155], a[164:167], a[60:63]
  v_mfma_f32_16x16x32_bf16 a[60:63], a[156:159], a[180:183], a[60:63]
  ds_read_b64_tr_b16 a[148:149], v34 offset:16384
  ds_read_b64_tr_b16 a[150:151], v34 offset:16896
  v_mfma_f32_16x16x32_bf16 a[28:31], a[156:159], a[176:179], a[28:31]
  buffer_load_dwordx4 a[240:243], v10, s[44:47], s60 offen offset:1024 sc1
  v_mfma_f32_16x16x32_bf16 a[28:31], a[152:155], a[160:163], a[28:31]
  s_waitcnt lgkmcnt(10)
  v_mfma_f32_16x16x32_bf16 v[192:195], a[128:131], a[160:163], v[192:195]
  s_waitcnt lgkmcnt(8)
  v_mfma_f32_16x16x32_bf16 v[192:195], a[132:135], a[176:179], v[192:195]
L_padA6:
  s_cbranch_execz L_padA10
  ds_read_b64_tr_b16 a[152:153], v35 offset:0
  ds_read_b64_tr_b16 a[154:155], v35 offset:512
  v_mfma_f32_16x16x32_bf16 v[208:211], a[132:135], a[180:183], v[208:211]
  buffer_load_dwordx4 a[244:247], v10, s[44:47], s61 offen offset:1024 sc1
  v_mfma_f32_16x16x32_bf16 v[208:211], a[128:131], a[164:167], v[208:211]
  v_mfma_f32_16x16x32_bf16 v[224:227], a[128:131], a[168:171], v[224:227]
  v_mfma_f32_16x16x32_bf16 v[224:227], a[132:135], a[184:187], v[224:227]
  ds_read_b64_tr_b16 a[156:157], v35 offset:16384
  ds_read_b64_tr_b16 a[158:159], v35 offset:16896
  v_mfma_f32_16x16x32_bf16 v[240:243], a[132:135], a[188:191], v[240:243]
  s_waitcnt vmcnt(21) lgkmcnt(10)
  buffer_load_dwordx4 a[248:251], v11, s[44:47], s60 offen offset:1024 sc1
  v_mfma_f32_16x16x32_bf16 v[240:243], a[128:131], a[172:175], v[240:243]
  s_barrier
  v_mfma_f32_16x16x32_bf16 v[244:247], a[136:139], a[172:175], v[244:247]
  s_waitcnt lgkmcnt(8)
  v_mfma_f32_16x16x32_bf16 v[244:247], a[140:143], a[188:191], v[244:247]
  ds_read_b64_tr_b16 a[128:129], v16 offset:32768
  ds_read_b64_tr_b16 a[130:131], v16 offset:33792
  v_mfma_f32_16x16x32_bf16 v[228:231], a[140:143], a[184:187], v[228:231]
  buffer_load_dwordx4 a[252:255], v11, s[44:47], s61 offen offset:1024 sc1
  v_mfma_f32_16x16x32_bf16 v[228:231], a[136:139], a[168:171], v[228:231]
  v_mfma_f32_16x16x32_bf16 v[212:215], a[136:139], a[164:167], v[212:215]
  v_mfma_f32_16x16x32_bf16 v[212:215], a[140:143], a[180:183], v[212:215]
  ds_read_b64_tr_b16 a[132:133], v16 offset:49152
  ds_read_b64_tr_b16 a[134:135], v16 offset:50176
  v_mfma_f32_16x16x32_bf16 v[196:199], a[140:143], a[176:179], v[196:199]
  v_mfma_f32_16x16x32_bf16 v[196:199], a[136:139], a[160:163], v[196:199]
  s_waitcnt lgkmcnt(10)
  v_mfma_f32_16x16x32_bf16 v[200:203], a[144:147], a[160:163], v[200:203]
  s_waitcnt lgkmcnt(8)
  buffer_store_dwordx4 v[152:155], v6, s[4:7], s92 offen offset:3072 sc1
  v_mfma_f32_16x16x32_bf16 v[200:203], a[148:151], a[176:179], v[200:203]
  ds_read_b64_tr_b16 a[136:137], v17 offset:32768
  ds_read_b64_tr_b16 a[138:139], v17 offset:33792
  v_mfma_f32_16x16x32_bf16 v[216:219], a[148:151], a[180:183], v[216:219]
  v_mfma_f32_16x16x32_bf16 v[216:219], a[144:147], a[164:167], v[216:219]
  v_mfma_f32_16x16x32_bf16 v[232:235], a[144:147], a[168:171], v[232:235]
  v_mfma_f32_16x16x32_bf16 v[232:235], a[148:151], a[184:187], v[232:235]
  ds_read_b64_tr_b16 a[140:141], v17 offset:49152
  ds_read_b64_tr_b16 a[142:143], v17 offset:50176
  v_mfma_f32_16x16x32_bf16 v[248:251], a[148:151], a[188:191], v[248:251]
  v_mfma_f32_16x16x32_bf16 v[248:251], a[144:147], a[172:175], v[248:251]
  s_waitcnt lgkmcnt(10)
  v_mfma_f32_16x16x32_bf16 v[252:255], a[152:155], a[172:175], v[252:255]
  s_waitcnt lgkmcnt(8)
  v_mfma_f32_16x16x32_bf16 v[252:255], a[156:159], a[188:191], v[252:255]
  ds_read_b64_tr_b16 a[144:145], v18 offset:32768
  ds_read_b64_tr_b16 a[146:147], v18 offset:33792
  v_mfma_f32_16x16x32_bf16 v[236:239], a[156:159], a[184:187], v[236:239]
  v_mfma_f32_16x16x32_bf16 v[236:239], a[152:155], a[168:171], v[236:239]
  v_mfma_f32_16x16x32_bf16 v[220:223], a[152:155], a[164:167], v[220:223]
  v_mfma_f32_16x16x32_bf16 v[220:223], a[156:159], a[180:183], v[220:223]
  ds_read_b64_tr_b16 a[148:149], v18 offset:49152
  ds_read_b64_tr_b16 a[150:151], v18 offset:50176
  v_mfma_f32_16x16x32_bf16 v[204:207], a[156:159], a[176:179], v[204:207]
  v_mfma_f32_16x16x32_bf16 v[204:207], a[152:155], a[160:163], v[204:207]
  s_waitcnt vmcnt(22) lgkmcnt(8)
  v_mfma_f32_16x16x32_bf16 a[0:3], a[128:131], a[192:195], a[0:3]
  s_barrier
  v_mfma_f32_16x16x32_bf16 a[0:3], a[132:135], a[208:211], a[0:3]
  s_waitcnt vmcnt(21)
  ds_read_b64_tr_b16 a[152:153], v19 offset:32768
  ds_read_b64_tr_b16 a[154:155], v19 offset:33792
  v_mfma_f32_16x16x32_bf16 a[32:35], a[132:135], a[212:215], a[32:35]
  buffer_load_dwordx4 v2, s[96:99], s87 offen offset:0 lds
  v_mfma_f32_16x16x32_bf16 a[32:35], a[128:131], a[196:199], a[32:35]
  v_mfma_f32_16x16x32_bf16 a[64:67], a[128:131], a[200:203], a[64:67]
  s_waitcnt vmcnt(21)
  v_mfma_f32_16x16x32_bf16 a[64:67], a[132:135], a[216:219], a[64:67]
  s_waitcnt vmcnt(20)
  ds_read_b64_tr_b16 a[156:157], v19 offset:49152
  ds_read_b64_tr_b16 a[158:159], v19 offset:50176
  v_mfma_f32_16x16x32_bf16 a[96:99], a[132:135], a[220:223], a[96:99]
  buffer_load_dwordx4 v3, s[96:99], s87 offen offset:1024 lds
  s_add_u32 m0, s1, 0
  v_mfma_f32_16x16x32_bf16 a[96:99], a[128:131], a[204:207], a[96:99]
  s_waitcnt lgkmcnt(10)
  v_mfma_f32_16x16x32_bf16 a[100:103], a[136:139], a[204:207], a[100:103]
  s_waitcnt lgkmcnt(8)
  v_mfma_f32_16x16x32_bf16 a[100:103], a[140:143], a[220:223], a[100:103]
  s_add_u32 s87, s87, 262144
  ds_read_b64_tr_b16 a[128:129], v20 offset:32768
  ds_read_b64_tr_b16 a[130:131], v20 offset:33792
  v_mfma_f32_16x16x32_bf16 a[68:71], a[140:143], a[216:219], a[68:71]
  buffer_load_dwordx4 v4, s[16:19], s89 offen lds
  v_mfma_f32_16x16x32_bf16 a[68:71], a[136:139], a[200:203], a[68:71]
  s_add_u32 s89, s89, 110592
  v_mfma_f32_16x16x32_bf16 a[36:39], a[136:139], a[196:199], a[36:39]
  s_add_u32 m0, s0, 16384
  v_mfma_f32_16x16x32_bf16 a[36:39], a[140:143], a[212:215], a[36:39]
  ds_read_b64_tr_b16 a[132:133], v20 offset:49152
  ds_read_b64_tr_b16 a[134:135], v20 offset:50176
  v_mfma_f32_16x16x32_bf16 a[4:7], a[140:143], a[208:211], a[4:7]
  buffer_store_dwordx4 v[160:163], v7, s[4:7], s92 offen offset:0 sc1
  v_mfma_f32_16x16x32_bf16 a[4:7], a[136:139], a[192:195], a[4:7]
  s_waitcnt lgkmcnt(10)
  v_mfma_f32_16x16x32_bf16 a[8:11], a[144:147], a[192:195], a[8:11]
  s_waitcnt lgkmcnt(8)
  v_mfma_f32_16x16x32_bf16 a[8:11], a[148:151], a[208:211], a[8:11]
  ds_read_b64_tr_b16 a[136:137], v21 offset:32768
  ds_read_b64_tr_b16 a[138:139], v21 offset:33792
  v_mfma_f32_16x16x32_bf16 a[40:43], a[148:151], a[212:215], a[40:43]
  buffer_load_dwordx4 a[160:163], v10, s[44:47], s60 offen offset:2048 sc1
  v_mfma_f32_16x16x32_bf16 a[40:43], a[144:147], a[196:199], a[40:43]
  v_mfma_f32_16x16x32_bf16 a[72:75], a[144:147], a[200:203], a[72:75]
  v_mfma_f32_16x16x32_bf16 a[72:75], a[148:151], a[216:219], a[72:75]
  ds_read_b64_tr_b16 a[140:141], v21 offset:49152
  ds_read_b64_tr_b16 a[142:143], v21 offset:50176
  v_mfma_f32_16x16x32_bf16 a[104:107], a[148:151], a[220:223], a[104:107]
  buffer_load_dwordx4 a[164:167], v10, s[44:47], s61 offen offset:2048 sc1
  v_mfma_f32_16x16x32_bf16 a[104:107], a[144:147], a[204:207], a[104:107]
  s_waitcnt lgkmcnt(10)
  v_mfma_f32_16x16x32_bf16 a[108:111], a[152:155], a[204:207], a[108:111]
  s_waitcnt lgkmcnt(8)
  v_mfma_f32_16x16x32_bf16 a[108:111], a[156:159], a[220:223], a[108:111]
  ds_read_b64_tr_b16 a[144:145], v22 offset:32768
  ds_read_b64_tr_b16 a[146:147], v22 offset:33792
  v_mfma_f32_16x16x32_bf16 a[76:79], a[156:159], a[216:219], a[76:79]
  buffer_load_dwordx4 a[168:171], v11, s[44:47], s60 offen offset:2048 sc1
  v_mfma_f32_16x16x32_bf16 a[76:79], a[152:155], a[200:203], a[76:79]
  v_mfma_f32_16x16x32_bf16 a[44:47], a[152:155], a[196:199], a[44:47]
  v_mfma_f32_16x16x32_bf16 a[44:47], a[156:159], a[212:215], a[44:47]
  ds_read_b64_tr_b16 a[148:149], v22 offset:49152
  ds_read_b64_tr_b16 a[150:151], v22 offset:50176
  v_mfma_f32_16x16x32_bf16 a[12:15], a[156:159], a[208:211], a[12:15]
  buffer_load_dwordx4 a[172:175], v11, s[44:47], s61 offen offset:2048 sc1
  v_mfma_f32_16x16x32_bf16 a[12:15], a[152:155], a[192:195], a[12:15]
  s_waitcnt lgkmcnt(10)
  v_mfma_f32_16x16x32_bf16 a[16:19], a[128:131], a[192:195], a[16:19]
  s_waitcnt lgkmcnt(8)
  v_mfma_f32_16x16x32_bf16 a[16:19], a[132:135], a[208:211], a[16:19]
  ds_read_b64_tr_b16 a[152:153], v23 offset:32768
  ds_read_b64_tr_b16 a[154:155], v23 offset:33792
  v_mfma_f32_16x16x32_bf16 a[48:51], a[132:135], a[212:215], a[48:51]
  buffer_store_dwordx4 v[168:171], v7, s[4:7], s92 offen offset:1024 sc1
  v_mfma_f32_16x16x32_bf16 a[48:51], a[128:131], a[196:199], a[48:51]
  v_mfma_f32_16x16x32_bf16 a[80:83], a[128:131], a[200:203], a[80:83]
  v_mfma_f32_16x16x32_bf16 a[80:83], a[132:135], a[216:219], a[80:83]
  ds_read_b64_tr_b16 a[156:157], v23 offset:49152
  ds_read_b64_tr_b16 a[158:159], v23 offset:50176
  v_mfma_f32_16x16x32_bf16 a[112:115], a[132:135], a[220:223], a[112:115]
  buffer_load_dwordx4 v2, s[96:99], s87 offen offset:0 lds
  v_mfma_f32_16x16x32_bf16 a[112:115], a[128:131], a[204:207], a[112:115]
  s_waitcnt lgkmcnt(10)
  v_mfma_f32_16x16x32_bf16 a[116:119], a[136:139], a[204:207], a[116:119]
  s_waitcnt lgkmcnt(8)
  v_mfma_f32_16x16x32_bf16 a[116:119], a[140:143], a[220:223], a[116:119]
  ds_read_b64_tr_b16 a[128:129], v32 offset:32768
  ds_read_b64_tr_b16 a[130:131], v32 offset:33280
  v_mfma_f32_16x16x32_bf16 a[84:87], a[140:143], a[216:219], a[84:87]
  buffer_load_dwordx4 v3, s[96:99], s87 offen offset:1024 lds
  v_mfma_f32_16x16x32_bf16 a[84:87], a[136:139], a[200:203], a[84:87]
  s_add_u32 s87, s87, 262144
  v_mfma_f32_16x16x32_bf16 a[52:55], a[136:139], a[196:199], a[52:55]
  s_add_u32 m0, s1, 16384
  v_mfma_f32_16x16x32_bf16 a[52:55], a[140:143], a[212:215], a[52:55]
  ds_read_b64_tr_b16 a[132:133], v32 offset:49152
  ds_read_b64_tr_b16 a[134:135], v32 offset:49664
  v_mfma_f32_16x16x32_bf16 a[20:23], a[140:143], a[208:211], a[20:23]
  buffer_load_dwordx4 v4, s[16:19], s89 offen lds
  v_mfma_f32_16x16x32_bf16 a[20:23], a[136:139], a[192:195], a[20:23]
  s_waitcnt lgkmcnt(10)
  v_mfma_f32_16x16x32_bf16 a[24:27], a[144:147], a[192:195], a[24:27]
  s_waitcnt lgkmcnt(8)
  v_mfma_f32_16x16x32_bf16 a[24:27], a[148:151], a[208:211], a[24:27]
  s_add_u32 s89, s89, 110592
  ds_read_b64_tr_b16 a[136:137], v33 offset:32768
  ds_read_b64_tr_b16 a[138:139], v33 offset:33280
  v_mfma_f32_16x16x32_bf16 a[56:59], a[148:151], a[212:215], a[56:59]
  s_add_u32 m0, s0, 32768
  v_mfma_f32_16x16x32_bf16 a[56:59], a[144:147], a[196:199], a[56:59]
  v_mfma_f32_16x16x32_bf16 a[88:91], a[144:147], a[200:203], a[88:91]
  v_mfma_f32_16x16x32_bf16 a[88:91], a[148:151], a[216:219], a[88:91]
  ds_read_b64_tr_b16 a[140:141], v33 offset:49152
  ds_read_b64_tr_b16 a[142:143], v33 offset:49664
  v_mfma_f32_16x16x32_bf16 a[120:123], a[148:151], a[220:223], a[120:123]
  v_mfma_f32_16x16x32_bf16 a[120:123], a[144:147], a[204:207], a[120:123]
  s_waitcnt lgkmcnt(10)
  v_mfma_f32_16x16x32_bf16 a[124:127], a[152:155], a[204:207], a[124:127]
  s_waitcnt lgkmcnt(8)
  buffer_store_dwordx4 v[176:179], v7, s[4:7], s92 offen offset:2048 sc1
  v_mfma_f32_16x16x32_bf16 a[124:127], a[156:159], a[220:223], a[124:127]
  ds_read_b64_tr_b16 a[144:145], v34 offset:32768
  ds_read_b64_tr_b16 a[146:147], v34 offset:33280
  v_mfma_f32_16x16x32_bf16 a[92:95], a[156:159], a[216:219], a[92:95]
  v_mfma_f32_16x16x32_bf16 a[92:95], a[152:155], a[200:203], a[92:95]
  v_mfma_f32_16x16x32_bf16 a[60:63], a[152:155], a[196:199], a[60:63]
  v_mfma_f32_16x16x32_bf16 a[60:63], a[156:159], a[212:215], a[60:63]
  ds_read_b64_tr_b16 a[148:149], v34 offset:49152
  ds_read_b64_tr_b16 a[150:151], v34 offset:49664
  v_mfma_f32_16x16x32_bf16 a[28:31], a[156:159], a[208:211], a[28:31]
  buffer_load_dwordx4 a[176:179], v10, s[44:47], s60 offen offset:3072 sc1
  v_mfma_f32_16x16x32_bf16 a[28:31], a[152:155], a[192:195], a[28:31]
  s_waitcnt lgkmcnt(10)
  v_mfma_f32_16x16x32_bf16 v[192:195], a[128:131], a[192:195], v[192:195]
  s_waitcnt lgkmcnt(8)
  v_mfma_f32_16x16x32_bf16 v[192:195], a[132:135], a[208:211], v[192:195]
  ds_read_b64_tr_b16 a[152:153], v35 offset:32768
  ds_read_b64_tr_b16 a[154:155], v35 offset:33280
  v_mfma_f32_16x16x32_bf16 v[208:211], a[132:135], a[212:215], v[208:211]
  buffer_load_dwordx4 a[180:183], v10, s[44:47], s61 offen offset:3072 sc1
  v_mfma_f32_16x16x32_bf16 v[208:211], a[128:131], a[196:199], v[208:211]
  v_mfma_f32_16x16x32_bf16 v[224:227], a[128:131], a[200:203], v[224:227]
  v_mfma_f32_16x16x32_bf16 v[224:227], a[132:135], a[216:219], v[224:227]
  ds_read_b64_tr_b16 a[156:157], v35 offset:49152
  ds_read_b64_tr_b16 a[158:159], v35 offset:49664
  v_mfma_f32_16x16x32_bf16 v[240:243], a[132:135], a[220:223], v[240:243]
  s_waitcnt vmcnt(21) lgkmcnt(10)
  buffer_load_dwordx4 a[184:187], v11, s[44:47], s60 offen offset:3072 sc1
  v_mfma_f32_16x16x32_bf16 v[240:243], a[128:131], a[204:207], v[240:243]
  s_barrier
  v_mfma_f32_16x16x32_bf16 v[244:247], a[136:139], a[204:207], v[244:247]
  s_waitcnt lgkmcnt(8)
  v_mfma_f32_16x16x32_bf16 v[244:247], a[140:143], a[220:223], v[244:247]
  ds_read_b64_tr_b16 a[128:129], v24 offset:0
  ds_read_b64_tr_b16 a[130:131], v24 offset:1024
  v_mfma_f32_16x16x32_bf16 v[228:231], a[140:143], a[216:219], v[228:231]
  buffer_load_dwordx4 a[188:191], v11, s[44:47], s61 offen offset:3072 sc1
  v_mfma_f32_16x16x32_bf16 v[228:231], a[136:139], a[200:203], v[228:231]
  s_mov_b32 s60, 16384
  v_mfma_f32_16x16x32_bf16 v[212:215], a[136:139], a[196:199], v[212:215]
  s_add_u32 s61, s73, 16384
  v_mfma_f32_16x16x32_bf16 v[212:215], a[140:143], a[212:215], v[212:215]
  ds_read_b64_tr_b16 a[132:133], v24 offset:16384
  ds_read_b64_tr_b16 a[134:135], v24 offset:17408
  v_mfma_f32_16x16x32_bf16 v[196:199], a[140:143], a[208:211], v[196:199]
  v_mfma_f32_16x16x32_bf16 v[196:199], a[136:139], a[192:195], v[196:199]
  s_waitcnt lgkmcnt(10)
  v_mfma_f32_16x16x32_bf16 v[200:203], a[144:147], a[192:195], v[200:203]
  s_waitcnt lgkmcnt(8)
  buffer_store_dwordx4 v[184:187], v7, s[4:7], s92 offen offset:3072 sc1
  v_mfma_f32_16x16x32_bf16 v[200:203], a[148:151], a[208:211], v[200:203]
  ds_read_b64_tr_b16 a[136:137], v25 offset:0
  ds_read_b64_tr_b16 a[138:139], v25 offset:1024
  v_mfma_f32_16x16x32_bf16 v[216:219], a[148:151], a[212:215], v[216:219]
  v_mfma_f32_16x16x32_bf16 v[216:219], a[144:147], a[196:199], v[216:219]
  v_mfma_f32_16x16x32_bf16 v[232:235], a[144:147], a[200:203], v[232:235]
  v_mfma_f32_16x16x32_bf16 v[232:235], a[148:151], a[216:219], v[232:235]
  ds_read_b64_tr_b16 a[140:141], v25 offset:16384
  ds_read_b64_tr_b16 a[142:143], v25 offset:17408
  v_mfma_f32_16x16x32_bf16 v[248:251], a[148:151], a[220:223], v[248:251]
  v_mfma_f32_16x16x32_bf16 v[248:251], a[144:147], a[204:207], v[248:251]
  s_waitcnt lgkmcnt(10)
  v_mfma_f32_16x16x32_bf16 v[252:255], a[152:155], a[204:207], v[252:255]
  s_waitcnt lgkmcnt(8)
  v_mfma_f32_16x16x32_bf16 v[252:255], a[156:159], a[220:223], v[252:255]
  ds_read_b64_tr_b16 a[144:145], v26 offset:0
  ds_read_b64_tr_b16 a[146:147], v26 offset:1024
  v_mfma_f32_16x16x32_bf16 v[236:239], a[156:159], a[216:219], v[236:239]
  v_mfma_f32_16x16x32_bf16 v[236:239], a[152:155], a[200:203], v[236:239]
  v_mfma_f32_16x16x32_bf16 v[220:223], a[152:155], a[196:199], v[220:223]
  v_mfma_f32_16x16x32_bf16 v[220:223], a[156:159], a[212:215], v[220:223]
  ds_read_b64_tr_b16 a[148:149], v26 offset:16384
  ds_read_b64_tr_b16 a[150:151], v26 offset:17408
  v_mfma_f32_16x16x32_bf16 v[204:207], a[156:159], a[208:211], v[204:207]
  v_mfma_f32_16x16x32_bf16 v[204:207], a[152:155], a[192:195], v[204:207]
  s_waitcnt vmcnt(22) lgkmcnt(8)
  v_mfma_f32_16x16x32_bf16 a[0:3], a[128:131], a[224:227], a[0:3]
  s_barrier
  v_mfma_f32_16x16x32_bf16 a[0:3], a[132:135], a[240:243], a[0:3]
  s_waitcnt vmcnt(21)
  ds_read_b64_tr_b16 a[152:153], v27 offset:0
  ds_read_b64_tr_b16 a[154:155], v27 offset:1024
  v_mfma_f32_16x16x32_bf16 a[32:35], a[132:135], a[244:247], a[32:35]
  buffer_load_dwordx4 v2, s[96:99], s87 offen offset:0 lds
  v_mfma_f32_16x16x32_bf16 a[32:35], a[128:131], a[228:231], a[32:35]
  v_mfma_f32_16x16x32_bf16 a[64:67], a[128:131], a[232:235], a[64:67]
  s_waitcnt vmcnt(21)
  v_mfma_f32_16x16x32_bf16 a[64:67], a[132:135], a[248:251], a[64:67]
  s_waitcnt vmcnt(20)
  ds_read_b64_tr_b16 a[156:157], v27 offset:16384
  ds_read_b64_tr_b16 a[158:159], v27 offset:17408
  v_mfma_f32_16x16x32_bf16 a[96:99], a[132:135], a[252:255], a[96:99]
  buffer_load_dwordx4 v3, s[96:99], s87 offen offset:1024 lds
  s_add_u32 m0, s1, 32768
  v_mfma_f32_16x16x32_bf16 a[96:99], a[128:131], a[236:239], a[96:99]
  s_waitcnt lgkmcnt(10)
  v_mfma_f32_16x16x32_bf16 a[100:103], a[136:139], a[236:239], a[100:103]
  s_waitcnt lgkmcnt(8)
  v_mfma_f32_16x16x32_bf16 a[100:103], a[140:143], a[252:255], a[100:103]
  s_add_u32 s87, s87, 262144
  ds_read_b64_tr_b16 a[128:129], v28 offset:0
  ds_read_b64_tr_b16 a[130:131], v28 offset:1024
  v_mfma_f32_16x16x32_bf16 a[68:71], a[140:143], a[248:251], a[68:71]
  buffer_load_dwordx4 v4, s[16:19], s89 offen lds
  v_mfma_f32_16x16x32_bf16 a[68:71], a[136:139], a[232:235], a[68:71]
  s_add_u32 s89, s89, 110592
  v_mfma_f32_16x16x32_bf16 a[36:39], a[136:139], a[228:231], a[36:39]
  s_add_u32 m0, s0, 49152
  v_mfma_f32_16x16x32_bf16 a[36:39], a[140:143], a[244:247], a[36:39]
  ds_read_b64_tr_b16 a[132:133], v28 offset:16384
  ds_read_b64_tr_b16 a[134:135], v28 offset:17408
  v_mfma_f32_16x16x32_bf16 a[4:7], a[140:143], a[240:243], a[4:7]
  buffer_store_dwordx4 v[132:135], v6, s[4:7], s93 offen offset:0 sc1
  v_mfma_f32_16x16x32_bf16 a[4:7], a[136:139], a[224:227], a[4:7]
  s_waitcnt lgkmcnt(10)
  v_mfma_f32_16x16x32_bf16 a[8:11], a[144:147], a[224:227], a[8:11]
  s_waitcnt lgkmcnt(8)
  v_mfma_f32_16x16x32_bf16 a[8:11], a[148:151], a[240:243], a[8:11]
  ds_read_b64_tr_b16 a[136:137], v29 offset:0
  ds_read_b64_tr_b16 a[138:139], v29 offset:1024
  v_mfma_f32_16x16x32_bf16 a[40:43], a[148:151], a[244:247], a[40:43]
  buffer_load_dwordx4 a[192:195], v10, s[44:47], s60 offen offset:0 sc1
  v_mfma_f32_16x16x32_bf16 a[40:43], a[144:147], a[228:231], a[40:43]
  v_mfma_f32_16x16x32_bf16 a[72:75], a[144:147], a[232:235], a[72:75]
  v_mfma_f32_16x16x32_bf16 a[72:75], a[148:151], a[248:251], a[72:75]
  ds_read_b64_tr_b16 a[140:141], v29 offset:16384
  ds_read_b64_tr_b16 a[142:143], v29 offset:17408
  v_mfma_f32_16x16x32_bf16 a[104:107], a[148:151], a[252:255], a[104:107]
  buffer_load_dwordx4 a[196:199], v10, s[44:47], s61 offen offset:0 sc1
  v_mfma_f32_16x16x32_bf16 a[104:107], a[144:147], a[236:239], a[104:107]
  s_waitcnt lgkmcnt(10)
  v_mfma_f32_16x16x32_bf16 a[108:111], a[152:155], a[236:239], a[108:111]
  s_waitcnt lgkmcnt(8)
  v_mfma_f32_16x16x32_bf16 a[108:111], a[156:159], a[252:255], a[108:111]
  ds_read_b64_tr_b16 a[144:145], v30 offset:0
  ds_read_b64_tr_b16 a[146:147], v30 offset:1024
  v_mfma_f32_16x16x32_bf16 a[76:79], a[156:159], a[248:251], a[76:79]
  buffer_load_dwordx4 a[200:203], v11, s[44:47], s60 offen offset:0 sc1
  v_mfma_f32_16x16x32_bf16 a[76:79], a[152:155], a[232:235], a[76:79]
  v_mfma_f32_16x16x32_bf16 a[44:47], a[152:155], a[228:231], a[44:47]
  v_mfma_f32_16x16x32_bf16 a[44:47], a[156:159], a[244:247], a[44:47]
  ds_read_b64_tr_b16 a[148:149], v30 offset:16384
  ds_read_b64_tr_b16 a[150:151], v30 offset:17408
  v_mfma_f32_16x16x32_bf16 a[12:15], a[156:159], a[240:243], a[12:15]
  buffer_load_dwordx4 a[204:207], v11, s[44:47], s61 offen offset:0 sc1
  v_mfma_f32_16x16x32_bf16 a[12:15], a[152:155], a[224:227], a[12:15]
  s_waitcnt lgkmcnt(10)
  v_mfma_f32_16x16x32_bf16 a[16:19], a[128:131], a[224:227], a[16:19]
  s_waitcnt lgkmcnt(8)
  v_mfma_f32_16x16x32_bf16 a[16:19], a[132:135], a[240:243], a[16:19]
  ds_read_b64_tr_b16 a[152:153], v31 offset:0
  ds_read_b64_tr_b16 a[154:155], v31 offset:1024
  v_mfma_f32_16x16x32_bf16 a[48:51], a[132:135], a[244:247], a[48:51]
  buffer_store_dwordx4 v[140:143], v6, s[4:7], s93 offen offset:1024 sc1
  v_mfma_f32_16x16x32_bf16 a[48:51], a[128:131], a[228:231], a[48:51]
  v_mfma_f32_16x16x32_bf16 a[80:83], a[128:131], a[232:235], a[80:83]
  v_mfma_f32_16x16x32_bf16 a[80:83], a[132:135], a[248:251], a[80:83]
  ds_read_b64_tr_b16 a[156:157], v31 offset:16384
  ds_read_b64_tr_b16 a[158:159], v31 offset:17408
  v_mfma_f32_16x16x32_bf16 a[112:115], a[132:135], a[252:255], a[112:115]
  buffer_load_dwordx4 v2, s[96:99], s87 offen offset:0 lds
  v_mfma_f32_16x16x32_bf16 a[112:115], a[128:131], a[236:239], a[112:115]
  s_waitcnt lgkmcnt(10)
  v_mfma_f32_16x16x32_bf16 a[116:119], a[136:139], a[236:239], a[116:119]
  s_waitcnt lgkmcnt(8)
  v_mfma_f32_16x16x32_bf16 a[116:119], a[140:143], a[252:255], a[116:119]
  ds_read_b64_tr_b16 a[128:129], v36 offset:0
  ds_read_b64_tr_b16 a[130:131], v36 offset:512
  v_mfma_f32_16x16x32_bf16 a[84:87], a[140:143], a[248:251], a[84:87]
  buffer_load_dwordx4 v3, s[96:99], s87 offen offset:1024 lds
  v_mfma_f32_16x16x32_bf16 a[84:87], a[136:139], a[232:235], a[84:87]
  s_add_u32 s87, s87, 262144
  v_mfma_f32_16x16x32_bf16 a[52:55], a[136:139], a[228:231], a[52:55]
  s_add_u32 m0, s1, 49152
  v_mfma_f32_16x16x32_bf16 a[52:55], a[140:143], a[244:247], a[52:55]
  ds_read_b64_tr_b16 a[132:133], v36 offset:16384
  ds_read_b64_tr_b16 a[134:135], v36 offset:16896
  v_mfma_f32_16x16x32_bf16 a[20:23], a[140:143], a[240:243], a[20:23]
  buffer_load_dwordx4 v4, s[16:19], s89 offen lds
  v_mfma_f32_16x16x32_bf16 a[20:23], a[136:139], a[224:227], a[20:23]
  s_waitcnt lgkmcnt(10)
  v_mfma_f32_16x16x32_bf16 a[24:27], a[144:147], a[224:227], a[24:27]
  s_waitcnt lgkmcnt(8)
  v_mfma_f32_16x16x32_bf16 a[24:27], a[148:151], a[240:243], a[24:27]
  s_add_u32 s89, s89, 110592
  ds_read_b64_tr_b16 a[136:137], v37 offset:0
  ds_read_b64_tr_b16 a[138:139], v37 offset:512
  v_mfma_f32_16x16x32_bf16 a[56:59], a[148:151], a[244:247], a[56:59]
  s_add_u32 m0, s0, 65536
  v_mfma_f32_16x16x32_bf16 a[56:59], a[144:147], a[228:231], a[56:59]
  v_mfma_f32_16x16x32_bf16 a[88:91], a[144:147], a[232:235], a[88:91]
  v_mfma_f32_16x16x32_bf16 a[88:91], a[148:151], a[248:251], a[88:91]
  ds_read_b64_tr_b16 a[140:141], v37 offset:16384
  ds_read_b64_tr_b16 a[142:143], v37 offset:16896
  v_mfma_f32_16x16x32_bf16 a[120:123], a[148:151], a[252:255], a[120:123]
  v_mfma_f32_16x16x32_bf16 a[120:123], a[144:147], a[236:239], a[120:123]
  s_waitcnt lgkmcnt(10)
  v_mfma_f32_16x16x32_bf16 a[124:127], a[152:155], a[236:239], a[124:127]
  s_waitcnt lgkmcnt(8)
  buffer_store_dwordx4 v[148:151], v6, s[4:7], s93 offen offset:2048 sc1
  v_mfma_f32_16x16x32_bf16 a[124:127], a[156:159], a[252:255], a[124:127]
  ds_read_b64_tr_b16 a[144:145], v38 offset:0
  ds_read_b64_tr_b16 a[146:147], v38 offset:512
  v_mfma_f32_16x16x32_bf16 a[92:95], a[156:159], a[248:251], a[92:95]
  v_mfma_f32_16x16x32_bf16 a[92:95], a[152:155], a[232:235], a[92:95]
  v_mfma_f32_16x16x32_bf16 a[60:63], a[152:155], a[228:231], a[60:63]
  v_mfma_f32_16x16x32_bf16 a[60:63], a[156:159], a[244:247], a[60:63]
  ds_read_b64_tr_b16 a[148:149], v38 offset:16384
  ds_read_b64_tr_b16 a[150:151], v38 offset:16896
  v_mfma_f32_16x16x32_bf16 a[28:31], a[156:159], a[240:243], a[28:31]
  buffer_load_dwordx4 a[208:211], v10, s[44:47], s60 offen offset:1024 sc1
  v_mfma_f32_16x16x32_bf16 a[28:31], a[152:155], a[224:227], a[28:31]
  s_waitcnt lgkmcnt(10)
  v_mfma_f32_16x16x32_bf16 v[192:195], a[128:131], a[224:227], v[192:195]
  s_waitcnt lgkmcnt(8)
  v_mfma_f32_16x16x32_bf16 v[192:195], a[132:135], a[240:243], v[192:195]
  ds_read_b64_tr_b16 a[152:153], v39 offset:0
  ds_read_b64_tr_b16 a[154:155], v39 offset:512
  v_mfma_f32_16x16x32_bf16 v[208:211], a[132:135], a[244:247], v[208:211]
  buffer_load_dwordx4 a[212:215], v10, s[44:47], s61 offen offset:1024 sc1
  v_mfma_f32_16x16x32_bf16 v[208:211], a[128:131], a[228:231], v[208:211]
  v_mfma_f32_16x16x32_bf16 v[224:227], a[128:131], a[232:235], v[224:227]
  v_mfma_f32_16x16x32_bf16 v[224:227], a[132:135], a[248:251], v[224:227]
  ds_read_b64_tr_b16 a[156:157], v39 offset:16384
  ds_read_b64_tr_b16 a[158:159], v39 offset:16896
  v_mfma_f32_16x16x32_bf16 v[240:243], a[132:135], a[252:255], v[240:243]
  s_waitcnt vmcnt(21) lgkmcnt(10)
  buffer_load_dwordx4 a[216:219], v11, s[44:47], s60 offen offset:1024 sc1
  v_mfma_f32_16x16x32_bf16 v[240:243], a[128:131], a[236:239], v[240:243]
  s_barrier
  v_mfma_f32_16x16x32_bf16 v[244:247], a[136:139], a[236:239], v[244:247]
  s_waitcnt lgkmcnt(8)
  v_mfma_f32_16x16x32_bf16 v[244:247], a[140:143], a[252:255], v[244:247]
  ds_read_b64_tr_b16 a[128:129], v16 offset:0
  ds_read_b64_tr_b16 a[130:131], v16 offset:1024
  v_mfma_f32_16x16x32_bf16 v[228:231], a[140:143], a[248:251], v[228:231]
  buffer_load_dwordx4 a[220:223], v11, s[44:47], s61 offen offset:1024 sc1
  v_mfma_f32_16x16x32_bf16 v[228:231], a[136:139], a[232:235], v[228:231]
  v_mfma_f32_16x16x32_bf16 v[212:215], a[136:139], a[228:231], v[212:215]
  v_mfma_f32_16x16x32_bf16 v[212:215], a[140:143], a[244:247], v[212:215]
  ds_read_b64_tr_b16 a[132:133], v16 offset:16384
  ds_read_b64_tr_b16 a[134:135], v16 offset:17408
  v_mfma_f32_16x16x32_bf16 v[196:199], a[140:143], a[240:243], v[196:199]
  v_mfma_f32_16x16x32_bf16 v[196:199], a[136:139], a[224:227], v[196:199]
  s_waitcnt lgkmcnt(10)
  v_mfma_f32_16x16x32_bf16 v[200:203], a[144:147], a[224:227], v[200:203]
  s_waitcnt lgkmcnt(8)
  buffer_store_dwordx4 v[156:159], v6, s[4:7], s93 offen offset:3072 sc1
  v_mfma_f32_16x16x32_bf16 v[200:203], a[148:151], a[240:243], v[200:203]
  ds_read_b64_tr_b16 a[136:137], v17 offset:0
  ds_read_b64_tr_b16 a[138:139], v17 offset:1024
  v_mfma_f32_16x16x32_bf16 v[216:219], a[148:151], a[244:247], v[216:219]
  v_mfma_f32_16x16x32_bf16 v[216:219], a[144:147], a[228:231], v[216:219]
  v_mfma_f32_16x16x32_bf16 v[232:235], a[144:147], a[232:235], v[232:235]
  v_mfma_f32_16x16x32_bf16 v[232:235], a[148:151], a[248:251], v[232:235]
  ds_read_b64_tr_b16 a[140:141], v17 offset:16384
  ds_read_b64_tr_b16 a[142:143], v17 offset:17408
  v_mfma_f32_16x16x32_bf16 v[248:251], a[148:151], a[252:255], v[248:251]
  v_mfma_f32_16x16x32_bf16 v[248:251], a[144:147], a[236:239], v[248:251]
  s_waitcnt lgkmcnt(10)
  v_mfma_f32_16x16x32_bf16 v[252:255], a[152:155], a[236:239], v[252:255]
  s_waitcnt lgkmcnt(8)
  v_mfma_f32_16x16x32_bf16 v[252:255], a[156:159], a[252:255], v[252:255]
  ds_read_b64_tr_b16 a[144:145], v18 offset:0
  ds_read_b64_tr_b16 a[146:147], v18 offset:1024
  v_mfma_f32_16x16x32_bf16 v[236:239], a[156:159], a[248:251], v[236:239]
  v_mfma_f32_16x16x32_bf16 v[236:239], a[152:155], a[232:235], v[236:239]
  v_mfma_f32_16x16x32_bf16 v[220:223], a[152:155], a[228:231], v[220:223]
  v_mfma_f32_16x16x32_bf16 v[220:223], a[156:159], a[244:247], v[220:223]
  ds_read_b64_tr_b16 a[148:149], v18 offset:16384
  ds_read_b64_tr_b16 a[150:151], v18 offset:17408
  v_mfma_f32_16x16x32_bf16 v[204:207], a[156:159], a[240:243], v[204:207]
  v_mfma_f32_16x16x32_bf16 v[204:207], a[152:155], a[224:227], v[204:207]
  s_waitcnt vmcnt(22) lgkmcnt(8)
  v_mfma_f32_16x16x32_bf16 a[0:3], a[128:131], a[160:163], a[0:3]
  s_barrier
  v_mfma_f32_16x16x32_bf16 a[0:3], a[132:135], a[176:179], a[0:3]
  s_waitcnt vmcnt(21)
  ds_read_b64_tr_b16 a[152:153], v19 offset:0
  ds_read_b64_tr_b16 a[154:155], v19 offset:1024
  v_mfma_f32_16x16x32_bf16 a[32:35], a[132:135], a[180:183], a[32:35]
  buffer_load_dwordx4 v2, s[96:99], s87 offen offset:0 lds
  v_mfma_f32_16x16x32_bf16 a[32:35], a[128:131], a[164:167], a[32:35]
  v_mfma_f32_16x16x32_bf16 a[64:67], a[128:131], a[168:171], a[64:67]
  s_waitcnt vmcnt(21)
  v_mfma_f32_16x16x32_bf16 a[64:67], a[132:135], a[184:187], a[64:67]
  s_waitcnt vmcnt(20)
  ds_read_b64_tr_b16 a[156:157], v19 offset:16384
  ds_read_b64_tr_b16 a[158:159], v19 offset:17408
  v_mfma_f32_16x16x32_bf16 a[96:99], a[132:135], a[188:191], a[96:99]
  buffer_load_dwordx4 v3, s[96:99], s87 offen offset:1024 lds
  s_add_u32 m0, s1, 65536
  v_mfma_f32_16x16x32_bf16 a[96:99], a[128:131], a[172:175], a[96:99]
  s_waitcnt lgkmcnt(10)
  v_mfma_f32_16x16x32_bf16 a[100:103], a[136:139], a[172:175], a[100:103]
  s_waitcnt lgkmcnt(8)
  v_mfma_f32_16x16x32_bf16 a[100:103], a[140:143], a[188:191], a[100:103]
  s_add_u32 s87, s87, 262144
  ds_read_b64_tr_b16 a[128:129], v20 offset:0
  ds_read_b64_tr_b16 a[130:131], v20 offset:1024
  v_mfma_f32_16x16x32_bf16 a[68:71], a[140:143], a[184:187], a[68:71]
  buffer_load_dwordx4 v4, s[16:19], s89 offen lds
  v_mfma_f32_16x16x32_bf16 a[68:71], a[136:139], a[168:171], a[68:71]
  s_add_u32 s89, s89, 110592
  v_mfma_f32_16x16x32_bf16 a[36:39], a[136:139], a[164:167], a[36:39]
  s_add_u32 m0, s0, 81920
  v_mfma_f32_16x16x32_bf16 a[36:39], a[140:143], a[180:183], a[36:39]
  ds_read_b64_tr_b16 a[132:133], v20 offset:16384
  ds_read_b64_tr_b16 a[134:135], v20 offset:17408
  v_mfma_f32_16x16x32_bf16 a[4:7], a[140:143], a[176:179], a[4:7]
  buffer_store_dwordx4 v[164:167], v7, s[4:7], s93 offen offset:0 sc1
  v_mfma_f32_16x16x32_bf16 a[4:7], a[136:139], a[160:163], a[4:7]
  s_waitcnt lgkmcnt(10)
  v_mfma_f32_16x16x32_bf16 a[8:11], a[144:147], a[160:163], a[8:11]
  s_waitcnt lgkmcnt(8)
  v_mfma_f32_16x16x32_bf16 a[8:11], a[148:151], a[176:179], a[8:11]
  ds_read_b64_tr_b16 a[136:137], v21 offset:0
  ds_read_b64_tr_b16 a[138:139], v21 offset:1024
  v_mfma_f32_16x16x32_bf16 a[40:43], a[148:151], a[180:183], a[40:43]
  buffer_load_dwordx4 a[224:227], v10, s[44:47], s60 offen offset:2048 sc1
  v_mfma_f32_16x16x32_bf16 a[40:43], a[144:147], a[164:167], a[40:43]
  v_mfma_f32_16x16x32_bf16 a[72:75], a[144:147], a[168:171], a[72:75]
  v_mfma_f32_16x16x32_bf16 a[72:75], a[148:151], a[184:187], a[72:75]
  ds_read_b64_tr_b16 a[140:141], v21 offset:16384
  ds_read_b64_tr_b16 a[142:143], v21 offset:17408
  v_mfma_f32_16x16x32_bf16 a[104:107], a[148:151], a[188:191], a[104:107]
  buffer_load_dwordx4 a[228:231], v10, s[44:47], s61 offen offset:2048 sc1
  v_mfma_f32_16x16x32_bf16 a[104:107], a[144:147], a[172:175], a[104:107]
  s_waitcnt lgkmcnt(10)
  v_mfma_f32_16x16x32_bf16 a[108:111], a[152:155], a[172:175], a[108:111]
  s_waitcnt lgkmcnt(8)
  v_mfma_f32_16x16x32_bf16 a[108:111], a[156:159], a[188:191], a[108:111]
  ds_read_b64_tr_b16 a[144:145], v22 offset:0
  ds_read_b64_tr_b16 a[146:147], v22 offset:1024
  v_mfma_f32_16x16x32_bf16 a[76:79], a[156:159], a[184:187], a[76:79]
  buffer_load_dwordx4 a[232:235], v11, s[44:47], s60 offen offset:2048 sc1
  v_mfma_f32_16x16x32_bf16 a[76:79], a[152:155], a[168:171], a[76:79]
  v_mfma_f32_16x16x32_bf16 a[44:47], a[152:155], a[164:167], a[44:47]
  v_mfma_f32_16x16x32_bf16 a[44:47], a[156:159], a[180:183], a[44:47]
  ds_read_b64_tr_b16 a[148:149], v22 offset:16384
  ds_read_b64_tr_b16 a[150:151], v22 offset:17408
  v_mfma_f32_16x16x32_bf16 a[12:15], a[156:159], a[176:179], a[12:15]
  buffer_load_dwordx4 a[236:239], v11, s[44:47], s61 offen offset:2048 sc1
  v_mfma_f32_16x16x32_bf16 a[12:15], a[152:155], a[160:163], a[12:15]
  s_waitcnt lgkmcnt(10)
  v_mfma_f32_16x16x32_bf16 a[16:19], a[128:131], a[160:163], a[16:19]
  s_waitcnt lgkmcnt(8)
  v_mfma_f32_16x16x32_bf16 a[16:19], a[132:135], a[176:179], a[16:19]
  ds_read_b64_tr_b16 a[152:153], v23 offset:0
  ds_read_b64_tr_b16 a[154:155], v23 offset:1024
  v_mfma_f32_16x16x32_bf16 a[48:51], a[132:135], a[180:183], a[48:51]
  buffer_store_dwordx4 v[172:175], v7, s[4:7], s93 offen offset:1024 sc1
  v_mfma_f32_16x16x32_bf16 a[48:51], a[128:131], a[164:167], a[48:51]
  v_mfma_f32_16x16x32_bf16 a[80:83], a[128:131], a[168:171], a[80:83]
  v_mfma_f32_16x16x32_bf16 a[80:83], a[132:135], a[184:187], a[80:83]
  ds_read_b64_tr_b16 a[156:157], v23 offset:16384
  ds_read_b64_tr_b16 a[158:159], v23 offset:17408
  v_mfma_f32_16x16x32_bf16 a[112:115], a[132:135], a[188:191], a[112:115]
  buffer_load_dwordx4 v2, s[96:99], s87 offen offset:0 lds
  v_mfma_f32_16x16x32_bf16 a[112:115], a[128:131], a[172:175], a[112:115]
  s_waitcnt lgkmcnt(10)
  v_mfma_f32_16x16x32_bf16 a[116:119], a[136:139], a[172:175], a[116:119]
  s_waitcnt lgkmcnt(8)
  v_mfma_f32_16x16x32_bf16 a[116:119], a[140:143], a[188:191], a[116:119]
  ds_read_b64_tr_b16 a[128:129], v32 offset:0
  ds_read_b64_tr_b16 a[130:131], v32 offset:512
  v_mfma_f32_16x16x32_bf16 a[84:87], a[140:143], a[184:187], a[84:87]
L_padA7:
  s_cbranch_execz L_padA11
  buffer_load_dwordx4 v3, s[96:99], s87 offen offset:1024 lds
  v_mfma_f32_16x16x32_bf16 a[84:87], a[136:139], a[168:171], a[84:87]
  s_add_u32 s87, s87, 262144
  v_mfma_f32_16x16x32_bf16 a[52:55], a[136:139], a[164:167], a[52:55]
  s_add_u32 m0, s1, 81920
  v_mfma_f32_16x16x32_bf16 a[52:55], a[140:143], a[180:183], a[52:55]
  ds_read_b64_tr_b16 a[132:133], v32 offset:16384
  ds_read_b64_tr_b16 a[134:135], v32 offset:16896
  v_mfma_f32_16x16x32_bf16 a[20:23], a[140:143], a[176:179], a[20:23]
  buffer_load_dwordx4 v4, s[16:19], s89 offen lds
  v_mfma_f32_16x16x32_bf16 a[20:23], a[136:139], a[160:163], a[20:23]
  s_waitcnt lgkmcnt(10)
  v_mfma_f32_16x16x32_bf16 a[24:27], a[144:147], a[160:163], a[24:27]
  s_waitcnt lgkmcnt(8)
  v_mfma_f32_16x16x32_bf16 a[24:27], a[148:151], a[176:179], a[24:27]
  s_add_u32 s89, s89, 110592
  ds_read_b64_tr_b16 a[136:137], v33 offset:0
  ds_read_b64_tr_b16 a[138:139], v33 offset:512
  v_mfma_f32_16x16x32_bf16 a[56:59], a[148:151], a[180:183], a[56:59]
  v_mfma_f32_16x16x32_bf16 a[56:59], a[144:147], a[164:167], a[56:59]
  v_mfma_f32_16x16x32_bf16 a[88:91], a[144:147], a[168:171], a[88:91]
  v_mfma_f32_16x16x32_bf16 a[88:91], a[148:151], a[184:187], a[88:91]
  ds_read_b64_tr_b16 a[140:141], v33 offset:16384
  ds_read_b64_tr_b16 a[142:143], v33 offset:16896
  v_mfma_f32_16x16x32_bf16 a[120:123], a[148:151], a[188:191], a[120:123]
  v_mfma_f32_16x16x32_bf16 a[120:123], a[144:147], a[172:175], a[120:123]
  s_waitcnt lgkmcnt(10)
  v_mfma_f32_16x16x32_bf16 a[124:127], a[152:155], a[172:175], a[124:127]
  s_waitcnt lgkmcnt(8)
  buffer_store_dwordx4 v[180:183], v7, s[4:7], s93 offen offset:2048 sc1
  v_mfma_f32_16x16x32_bf16 a[124:127], a[156:159], a[188:191], a[124:127]
  ds_read_b64_tr_b16 a[144:145], v34 offset:0
  ds_read_b64_tr_b16 a[146:147], v34 offset:512
  v_mfma_f32_16x16x32_bf16 a[92:95], a[156:159], a[184:187], a[92:95]
  v_mfma_f32_16x16x32_bf16 a[92:95], a[152:155], a[168:171], a[92:95]
  v_mfma_f32_16x16x32_bf16 a[60:63], a[152:155], a[164:167], a[60:63]
  v_mfma_f32_16x16x32_bf16 a[60:63], a[156:159], a[180:183], a[60:63]
  ds_read_b64_tr_b16 a[148:149], v34 offset:16384
  ds_read_b64_tr_b16 a[150:151], v34 offset:16896
  v_mfma_f32_16x16x32_bf16 a[28:31], a[156:159], a[176:179], a[28:31]
  buffer_load_dwordx4 a[240:243], v10, s[44:47], s60 offen offset:3072 sc1
  v_mfma_f32_16x16x32_bf16 a[28:31], a[152:155], a[160:163], a[28:31]
  s_waitcnt lgkmcnt(10)
  v_mfma_f32_16x16x32_bf16 v[192:195], a[128:131], a[160:163], v[192:195]
  s_waitcnt lgkmcnt(8)
  v_mfma_f32_16x16x32_bf16 v[192:195], a[132:135], a[176:179], v[192:195]
  ds_read_b64_tr_b16 a[152:153], v35 offset:0
  ds_read_b64_tr_b16 a[154:155], v35 offset:512
  v_mfma_f32_16x16x32_bf16 v[208:211], a[132:135], a[180:183], v[208:211]
  buffer_load_dwordx4 a[244:247], v10, s[44:47], s61 offen offset:3072 sc1
  v_mfma_f32_16x16x32_bf16 v[208:211], a[128:131], a[164:167], v[208:211]
  v_mfma_f32_16x16x32_bf16 v[224:227], a[128:131], a[168:171], v[224:227]
  v_mfma_f32_16x16x32_bf16 v[224:227], a[132:135], a[184:187], v[224:227]
  ds_read_b64_tr_b16 a[156:157], v35 offset:16384
  ds_read_b64_tr_b16 a[158:159], v35 offset:16896
  v_mfma_f32_16x16x32_bf16 v[240:243], a[132:135], a[188:191], v[240:243]
  s_waitcnt vmcnt(21) lgkmcnt(10)
  buffer_load_dwordx4 a[248:251], v11, s[44:47], s60 offen offset:3072 sc1
  v_mfma_f32_16x16x32_bf16 v[240:243], a[128:131], a[172:175], v[240:243]
  s_barrier
  v_mfma_f32_16x16x32_bf16 v[244:247], a[136:139], a[172:175], v[244:247]
  s_waitcnt lgkmcnt(8)
  v_mfma_f32_16x16x32_bf16 v[244:247], a[140:143], a[188:191], v[244:247]
  ds_read_b64_tr_b16 a[128:129], v16 offset:32768
  ds_read_b64_tr_b16 a[130:131], v16 offset:33792
  v_mfma_f32_16x16x32_bf16 v[228:231], a[140:143], a[184:187], v[228:231]
  buffer_load_dwordx4 a[252:255], v11, s[44:47], s61 offen offset:3072 sc1
  v_mfma_f32_16x16x32_bf16 v[228:231], a[136:139], a[168:171], v[228:231]
  v_mfma_f32_16x16x32_bf16 v[212:215], a[136:139], a[164:167], v[212:215]
  v_mfma_f32_16x16x32_bf16 v[212:215], a[140:143], a[180:183], v[212:215]
  ds_read_b64_tr_b16 a[132:133], v16 offset:49152
  ds_read_b64_tr_b16 a[134:135], v16 offset:50176
  v_mfma_f32_16x16x32_bf16 v[196:199], a[140:143], a[176:179], v[196:199]
  v_mfma_f32_16x16x32_bf16 v[196:199], a[136:139], a[160:163], v[196:199]
  s_waitcnt lgkmcnt(10)
  v_mfma_f32_16x16x32_bf16 v[200:203], a[144:147], a[160:163], v[200:203]
  s_waitcnt lgkmcnt(8)
  buffer_store_dwordx4 v[188:191], v7, s[4:7], s93 offen offset:3072 sc1
  v_mfma_f32_16x16x32_bf16 v[200:203], a[148:151], a[176:179], v[200:203]
  ds_read_b64_tr_b16 a[136:137], v17 offset:32768
  ds_read_b64_tr_b16 a[138:139], v17 offset:33792
  v_mfma_f32_16x16x32_bf16 v[216:219], a[148:151], a[180:183], v[216:219]
  v_mfma_f32_16x16x32_bf16 v[216:219], a[144:147], a[164:167], v[216:219]
  v_mfma_f32_16x16x32_bf16 v[232:235], a[144:147], a[168:171], v[232:235]
  v_mfma_f32_16x16x32_bf16 v[232:235], a[148:151], a[184:187], v[232:235]
  ds_read_b64_tr_b16 a[140:141], v17 offset:49152
  ds_read_b64_tr_b16 a[142:143], v17 offset:50176
  v_mfma_f32_16x16x32_bf16 v[248:251], a[148:151], a[188:191], v[248:251]
  v_mfma_f32_16x16x32_bf16 v[248:251], a[144:147], a[172:175], v[248:251]
  s_waitcnt lgkmcnt(10)
  v_mfma_f32_16x16x32_bf16 v[252:255], a[152:155], a[172:175], v[252:255]
  s_waitcnt lgkmcnt(8)
  v_mfma_f32_16x16x32_bf16 v[252:255], a[156:159], a[188:191], v[252:255]
  ds_read_b64_tr_b16 a[144:145], v18 offset:32768
  ds_read_b64_tr_b16 a[146:147], v18 offset:33792
  v_mfma_f32_16x16x32_bf16 v[236:239], a[156:159], a[184:187], v[236:239]
  v_mfma_f32_16x16x32_bf16 v[236:239], a[152:155], a[168:171], v[236:239]
  v_mfma_f32_16x16x32_bf16 v[220:223], a[152:155], a[164:167], v[220:223]
  v_mfma_f32_16x16x32_bf16 v[220:223], a[156:159], a[180:183], v[220:223]
  ds_read_b64_tr_b16 a[148:149], v18 offset:49152
  ds_read_b64_tr_b16 a[150:151], v18 offset:50176
  v_mfma_f32_16x16x32_bf16 v[204:207], a[156:159], a[176:179], v[204:207]
  v_mfma_f32_16x16x32_bf16 v[204:207], a[152:155], a[160:163], v[204:207]
  s_waitcnt lgkmcnt(10)
  v_mfma_f32_16x16x32_bf16 a[0:3], a[128:131], a[192:195], a[0:3]
  s_waitcnt vmcnt(22) lgkmcnt(8)
  v_mfma_f32_16x16x32_bf16 a[0:3], a[132:135], a[208:211], a[0:3]
  s_waitcnt vmcnt(21)
  ds_read_b64_tr_b16 a[152:153], v19 offset:32768
  ds_read_b64_tr_b16 a[154:155], v19 offset:33792
  v_mfma_f32_16x16x32_bf16 a[32:35], a[132:135], a[212:215], a[32:35]
  v_mfma_f32_16x16x32_bf16 a[32:35], a[128:131], a[196:199], a[32:35]
  v_mfma_f32_16x16x32_bf16 a[64:67], a[128:131], a[200:203], a[64:67]
  s_waitcnt vmcnt(20)
  v_mfma_f32_16x16x32_bf16 a[64:67], a[132:135], a[216:219], a[64:67]
  s_waitcnt vmcnt(19)
  ds_read_b64_tr_b16 a[156:157], v19 offset:49152
  ds_read_b64_tr_b16 a[158:159], v19 offset:50176
  v_mfma_f32_16x16x32_bf16 a[96:99], a[132:135], a[220:223], a[96:99]
  v_mfma_f32_16x16x32_bf16 a[96:99], a[128:131], a[204:207], a[96:99]
  s_waitcnt lgkmcnt(10)
  v_mfma_f32_16x16x32_bf16 a[100:103], a[136:139], a[204:207], a[100:103]
  s_waitcnt lgkmcnt(8)
  v_mfma_f32_16x16x32_bf16 a[100:103], a[140:143], a[220:223], a[100:103]
  ds_read_b64_tr_b16 a[128:129], v20 offset:32768
  ds_read_b64_tr_b16 a[130:131], v20 offset:33792
  v_mfma_f32_16x16x32_bf16 a[68:71], a[140:143], a[216:219], a[68:71]
  v_mfma_f32_16x16x32_bf16 a[68:71], a[136:139], a[200:203], a[68:71]
  v_mfma_f32_16x16x32_bf16 a[36:39], a[136:139], a[196:199], a[36:39]
  v_mfma_f32_16x16x32_bf16 a[36:39], a[140:143], a[212:215], a[36:39]
  ds_read_b64_tr_b16 a[132:133], v20 offset:49152
  ds_read_b64_tr_b16 a[134:135], v20 offset:50176
  v_mfma_f32_16x16x32_bf16 a[4:7], a[140:143], a[208:211], a[4:7]
  v_mfma_f32_16x16x32_bf16 a[4:7], a[136:139], a[192:195], a[4:7]
  s_waitcnt lgkmcnt(10)
  v_mfma_f32_16x16x32_bf16 a[8:11], a[144:147], a[192:195], a[8:11]
  s_waitcnt lgkmcnt(8)
  v_mfma_f32_16x16x32_bf16 a[8:11], a[148:151], a[208:211], a[8:11]
  ds_read_b64_tr_b16 a[136:137], v21 offset:32768
  ds_read_b64_tr_b16 a[138:139], v21 offset:33792
  v_mfma_f32_16x16x32_bf16 a[40:43], a[148:151], a[212:215], a[40:43]
  v_mfma_f32_16x16x32_bf16 a[40:43], a[144:147], a[196:199], a[40:43]
  v_mfma_f32_16x16x32_bf16 a[72:75], a[144:147], a[200:203], a[72:75]
  v_mfma_f32_16x16x32_bf16 a[72:75], a[148:151], a[216:219], a[72:75]
  ds_read_b64_tr_b16 a[140:141], v21 offset:49152
  ds_read_b64_tr_b16 a[142:143], v21 offset:50176
  v_mfma_f32_16x16x32_bf16 a[104:107], a[148:151], a[220:223], a[104:107]
  v_mfma_f32_16x16x32_bf16 a[104:107], a[144:147], a[204:207], a[104:107]
  s_waitcnt lgkmcnt(10)
  v_mfma_f32_16x16x32_bf16 a[108:111], a[152:155], a[204:207], a[108:111]
  s_waitcnt lgkmcnt(8)
  v_mfma_f32_16x16x32_bf16 a[108:111], a[156:159], a[220:223], a[108:111]
  ds_read_b64_tr_b16 a[144:145], v22 offset:32768
  ds_read_b64_tr_b16 a[146:147], v22 offset:33792
  v_mfma_f32_16x16x32_bf16 a[76:79], a[156:159], a[216:219], a[76:79]
  v_mfma_f32_16x16x32_bf16 a[76:79], a[152:155], a[200:203], a[76:79]
  v_mfma_f32_16x16x32_bf16 a[44:47], a[152:155], a[196:199], a[44:47]
  v_mfma_f32_16x16x32_bf16 a[44:47], a[156:159], a[212:215], a[44:47]
  ds_read_b64_tr_b16 a[148:149], v22 offset:49152
  ds_read_b64_tr_b16 a[150:151], v22 offset:50176
  v_mfma_f32_16x16x32_bf16 a[12:15], a[156:159], a[208:211], a[12:15]
  v_mfma_f32_16x16x32_bf16 a[12:15], a[152:155], a[192:195], a[12:15]
  s_waitcnt lgkmcnt(10)
  v_mfma_f32_16x16x32_bf16 a[16:19], a[128:131], a[192:195], a[16:19]
  s_waitcnt lgkmcnt(8)
  v_mfma_f32_16x16x32_bf16 a[16:19], a[132:135], a[208:211], a[16:19]
  ds_read_b64_tr_b16 a[152:153], v23 offset:32768
  ds_read_b64_tr_b16 a[154:155], v23 offset:33792
  v_mfma_f32_16x16x32_bf16 a[48:51], a[132:135], a[212:215], a[48:51]
  v_mfma_f32_16x16x32_bf16 a[48:51], a[128:131], a[196:199], a[48:51]
  v_mfma_f32_16x16x32_bf16 a[80:83], a[128:131], a[200:203], a[80:83]
  v_mfma_f32_16x16x32_bf16 a[80:83], a[132:135], a[216:219], a[80:83]
  ds_read_b64_tr_b16 a[156:157], v23 offset:49152
  ds_read_b64_tr_b16 a[158:159], v23 offset:50176
  v_mfma_f32_16x16x32_bf16 a[112:115], a[132:135], a[220:223], a[112:115]
  v_mfma_f32_16x16x32_bf16 a[112:115], a[128:131], a[204:207], a[112:115]
  s_waitcnt lgkmcnt(10)
  v_mfma_f32_16x16x32_bf16 a[116:119], a[136:139], a[204:207], a[116:119]
  s_waitcnt lgkmcnt(8)
  v_mfma_f32_16x16x32_bf16 a[116:119], a[140:143], a[220:223], a[116:119]
  ds_read_b64_tr_b16 a[128:129], v32 offset:32768
  ds_read_b64_tr_b16 a[130:131], v32 offset:33280
  v_mfma_f32_16x16x32_bf16 a[84:87], a[140:143], a[216:219], a[84:87]
  v_mfma_f32_16x16x32_bf16 a[84:87], a[136:139], a[200:203], a[84:87]
  v_mfma_f32_16x16x32_bf16 a[52:55], a[136:139], a[196:199], a[52:55]
  v_mfma_f32_16x16x32_bf16 a[52:55], a[140:143], a[212:215], a[52:55]
  ds_read_b64_tr_b16 a[132:133], v32 offset:49152
  ds_read_b64_tr_b16 a[134:135], v32 offset:49664
  v_mfma_f32_16x16x32_bf16 a[20:23], a[140:143], a[208:211], a[20:23]
  v_mfma_f32_16x16x32_bf16 a[20:23], a[136:139], a[192:195], a[20:23]
  s_waitcnt lgkmcnt(8)
  v_mfma_f32_16x16x32_bf16 a[24:27], a[144:147], a[192:195], a[24:27]
  s_lshl_b32 s81, s76, 11
  s_sub_u32 s81, 7168, s81
  v_add_u32 v7, s81, v1
  v_mfma_f32_16x16x32_bf16 a[24:27], a[148:151], a[208:211], a[24:27]
  ds_read_b64_tr_b16 a[136:137], v33 offset:32768
  ds_read_b64_tr_b16 a[138:139], v33 offset:33280
  v_mfma_f32_16x16x32_bf16 a[56:59], a[148:151], a[212:215], a[56:59]
  v_mfma_f32_16x16x32_bf16 a[56:59], a[144:147], a[196:199], a[56:59]
  ds_read_b64_tr_b16 v[40:41], v58 offset:0
  ds_read_b64_tr_b16 v[42:43], v58 offset:1024
  v_mfma_f32_16x16x32_bf16 a[88:91], a[144:147], a[200:203], a[88:91]
  v_mfma_f32_16x16x32_bf16 a[88:91], a[148:151], a[216:219], a[88:91]
  ds_read_b64_tr_b16 a[140:141], v33 offset:49152
  ds_read_b64_tr_b16 a[142:143], v33 offset:49664
  v_mfma_f32_16x16x32_bf16 a[120:123], a[148:151], a[220:223], a[120:123]
  v_mfma_f32_16x16x32_bf16 a[120:123], a[144:147], a[204:207], a[120:123]
  s_waitcnt lgkmcnt(12)
  v_mfma_f32_16x16x32_bf16 a[124:127], a[152:155], a[204:207], a[124:127]
  s_waitcnt lgkmcnt(10)
  v_mfma_f32_16x16x32_bf16 a[124:127], a[156:159], a[220:223], a[124:127]
  ds_read_b64_tr_b16 a[144:145], v34 offset:32768
  ds_read_b64_tr_b16 a[146:147], v34 offset:33280
  v_mfma_f32_16x16x32_bf16 a[92:95], a[156:159], a[216:219], a[92:95]
  v_mfma_f32_16x16x32_bf16 a[92:95], a[152:155], a[200:203], a[92:95]
  v_mfma_f32_16x16x32_bf16 a[60:63], a[152:155], a[196:199], a[60:63]
  v_mfma_f32_16x16x32_bf16 a[60:63], a[156:159], a[212:215], a[60:63]
  ds_read_b64_tr_b16 a[148:149], v34 offset:49152
  ds_read_b64_tr_b16 a[150:151], v34 offset:49664
  v_mfma_f32_16x16x32_bf16 a[28:31], a[156:159], a[208:211], a[28:31]
  v_mfma_f32_16x16x32_bf16 a[28:31], a[152:155], a[192:195], a[28:31]
  s_waitcnt lgkmcnt(6)
  buffer_store_dwordx4 v[40:43], v1, s[40:43], s54 offen offset:0 sc1
  v_mfma_f32_16x16x32_bf16 v[192:195], a[128:131], a[192:195], v[192:195]
  v_mfma_f32_16x16x32_bf16 v[192:195], a[132:135], a[208:211], v[192:195]
  ds_read_b64_tr_b16 a[152:153], v35 offset:32768
  ds_read_b64_tr_b16 a[154:155], v35 offset:33280
  v_mfma_f32_16x16x32_bf16 v[208:211], a[132:135], a[212:215], v[208:211]
  ds_read_b64_tr_b16 v[44:45], v58 offset:32
  ds_read_b64_tr_b16 v[46:47], v58 offset:1056
  v_mfma_f32_16x16x32_bf16 v[208:211], a[128:131], a[196:199], v[208:211]
  v_mfma_f32_16x16x32_bf16 v[224:227], a[128:131], a[200:203], v[224:227]
  v_mfma_f32_16x16x32_bf16 v[224:227], a[132:135], a[216:219], v[224:227]
  ds_read_b64_tr_b16 a[156:157], v35 offset:49152
  ds_read_b64_tr_b16 a[158:159], v35 offset:49664
  v_mfma_f32_16x16x32_bf16 v[240:243], a[132:135], a[220:223], v[240:243]
  s_waitcnt vmcnt(7)
  v_mfma_f32_16x16x32_bf16 v[240:243], a[128:131], a[204:207], v[240:243]
  s_barrier
  v_mfma_f32_16x16x32_bf16 v[244:247], a[136:139], a[204:207], v[244:247]
  s_waitcnt lgkmcnt(10)
  v_mfma_f32_16x16x32_bf16 v[244:247], a[140:143], a[220:223], v[244:247]
  ds_read_b64_tr_b16 a[128:129], v36 offset:0
  ds_read_b64_tr_b16 a[130:131], v36 offset:512
  v_mfma_f32_16x16x32_bf16 v[228:231], a[140:143], a[216:219], v[228:231]
  v_mfma_f32_16x16x32_bf16 v[228:231], a[136:139], a[200:203], v[228:231]
  v_mfma_f32_16x16x32_bf16 v[212:215], a[136:139], a[196:199], v[212:215]
  s_waitcnt vmcnt(1)
  v_mfma_f32_16x16x32_bf16 v[212:215], a[140:143], a[212:215], v[212:215]
  buffer_store_dword v56, v12, s[36:39], 0 offen sc1
  v_mfma_f32_16x16x32_bf16 v[196:199], a[140:143], a[208:211], v[196:199]
  ds_read_b64_tr_b16 a[132:133], v36 offset:16384
  ds_read_b64_tr_b16 a[134:135], v36 offset:16896
  v_mfma_f32_16x16x32_bf16 v[196:199], a[136:139], a[192:195], v[196:199]
  s_waitcnt lgkmcnt(12)
  ds_read_b64_tr_b16 v[48:49], v58 offset:2048
  ds_read_b64_tr_b16 v[50:51], v58 offset:3072
  v_mfma_f32_16x16x32_bf16 v[200:203], a[144:147], a[192:195], v[200:203]
  s_waitcnt lgkmcnt(8)
  buffer_store_dwordx4 v[44:47], v1, s[40:43], s54 offen offset:1024 sc1
  v_mfma_f32_16x16x32_bf16 v[200:203], a[148:151], a[208:211], v[200:203]
  ds_read_b64_tr_b16 a[136:137], v37 offset:0
  ds_read_b64_tr_b16 a[138:139], v37 offset:512
  v_mfma_f32_16x16x32_bf16 v[216:219], a[148:151], a[212:215], v[216:219]
  v_mfma_f32_16x16x32_bf16 v[216:219], a[144:147], a[196:199], v[216:219]
  v_mfma_f32_16x16x32_bf16 v[232:235], a[144:147], a[200:203], v[232:235]
  v_mfma_f32_16x16x32_bf16 v[232:235], a[148:151], a[216:219], v[232:235]
  ds_read_b64_tr_b16 a[140:141], v37 offset:16384
  ds_read_b64_tr_b16 a[142:143], v37 offset:16896
  v_mfma_f32_16x16x32_bf16 v[248:251], a[148:151], a[220:223], v[248:251]
  v_mfma_f32_16x16x32_bf16 v[248:251], a[144:147], a[204:207], v[248:251]
  v_mfma_f32_16x16x32_bf16 v[252:255], a[152:155], a[204:207], v[252:255]
  s_waitcnt lgkmcnt(10)
  v_mfma_f32_16x16x32_bf16 v[252:255], a[156:159], a[220:223], v[252:255]
  ds_read_b64_tr_b16 a[144:145], v38 offset:0
  ds_read_b64_tr_b16 a[146:147], v38 offset:512
  v_mfma_f32_16x16x32_bf16 v[236:239], a[156:159], a[216:219], v[236:239]
  v_mfma_f32_16x16x32_bf16 v[236:239], a[152:155], a[200:203], v[236:239]
  s_waitcnt lgkmcnt(6)
  buffer_store_dwordx4 v[48:51], v1, s[40:43], s55 offen offset:0 sc1
  v_mfma_f32_16x16x32_bf16 v[220:223], a[152:155], a[196:199], v[220:223]
  v_mfma_f32_16x16x32_bf16 v[220:223], a[156:159], a[212:215], v[220:223]
  ds_read_b64_tr_b16 a[148:149], v38 offset:16384
  ds_read_b64_tr_b16 a[150:151], v38 offset:16896
  v_mfma_f32_16x16x32_bf16 v[204:207], a[156:159], a[208:211], v[204:207]
  ds_read_b64_tr_b16 v[52:53], v58 offset:2080
  ds_read_b64_tr_b16 v[54:55], v58 offset:3104
  v_mfma_f32_16x16x32_bf16 v[204:207], a[152:155], a[192:195], v[204:207]
  v_mfma_f32_16x16x32_bf16 v[192:195], a[128:131], a[224:227], v[192:195]
  v_mfma_f32_16x16x32_bf16 v[192:195], a[132:135], a[240:243], v[192:195]
  ds_read_b64_tr_b16 a[152:153], v39 offset:0
  ds_read_b64_tr_b16 a[154:155], v39 offset:512
  v_mfma_f32_16x16x32_bf16 v[208:211], a[132:135], a[244:247], v[208:211]
  v_mfma_f32_16x16x32_bf16 v[208:211], a[128:131], a[228:231], v[208:211]
  v_mfma_f32_16x16x32_bf16 v[224:227], a[128:131], a[232:235], v[224:227]
  v_mfma_f32_16x16x32_bf16 v[224:227], a[132:135], a[248:251], v[224:227]
  ds_read_b64_tr_b16 a[156:157], v39 offset:16384
  ds_read_b64_tr_b16 a[158:159], v39 offset:16896
  v_mfma_f32_16x16x32_bf16 v[240:243], a[132:135], a[252:255], v[240:243]
  v_mfma_f32_16x16x32_bf16 v[240:243], a[128:131], a[236:239], v[240:243]
  s_waitcnt lgkmcnt(12)
  v_mfma_f32_16x16x32_bf16 v[244:247], a[136:139], a[236:239], v[244:247]
  s_waitcnt lgkmcnt(10)
  v_mfma_f32_16x16x32_bf16 v[244:247], a[140:143], a[252:255], v[244:247]
  ds_read_b64_tr_b16 a[128:129], v24 offset:0
  ds_read_b64_tr_b16 a[130:131], v24 offset:1024
  v_mfma_f32_16x16x32_bf16 v[228:231], a[140:143], a[248:251], v[228:231]
  s_waitcnt lgkmcnt(6)
  buffer_store_dwordx4 v[52:55], v1, s[40:43], s55 offen offset:1024 sc1
  v_mfma_f32_16x16x32_bf16 v[228:231], a[136:139], a[232:235], v[228:231]
  ds_read_b64_tr_b16 v[40:41], v58 offset:4096
  ds_read_b64_tr_b16 v[42:43], v58 offset:5120
  v_mfma_f32_16x16x32_bf16 v[212:215], a[136:139], a[228:231], v[212:215]
  v_mfma_f32_16x16x32_bf16 v[212:215], a[140:143], a[244:247], v[212:215]
  ds_read_b64_tr_b16 a[132:133], v24 offset:16384
  ds_read_b64_tr_b16 a[134:135], v24 offset:17408
  v_mfma_f32_16x16x32_bf16 v[196:199], a[140:143], a[240:243], v[196:199]
  v_mfma_f32_16x16x32_bf16 v[196:199], a[136:139], a[224:227], v[196:199]
  v_mfma_f32_16x16x32_bf16 v[200:203], a[144:147], a[224:227], v[200:203]
  v_mfma_f32_16x16x32_bf16 v[200:203], a[148:151], a[240:243], v[200:203]
  ds_read_b64_tr_b16 a[136:137], v25 offset:0
  ds_read_b64_tr_b16 a[138:139], v25 offset:1024
  v_mfma_f32_16x16x32_bf16 v[216:219], a[148:151], a[244:247], v[216:219]
  v_mfma_f32_16x16x32_bf16 v[216:219], a[144:147], a[228:231], v[216:219]
  v_mfma_f32_16x16x32_bf16 v[232:235], a[144:147], a[232:235], v[232:235]
  v_mfma_f32_16x16x32_bf16 v[232:235], a[148:151], a[248:251], v[232:235]
  ds_read_b64_tr_b16 a[140:141], v25 offset:16384
  ds_read_b64_tr_b16 a[142:143], v25 offset:17408
  v_mfma_f32_16x16x32_bf16 v[248:251], a[148:151], a[252:255], v[248:251]
  v_mfma_f32_16x16x32_bf16 v[248:251], a[144:147], a[236:239], v[248:251]
  s_waitcnt lgkmcnt(6)
  buffer_store_dwordx4 v[40:43], v1, s[40:43], s56 offen offset:0 sc1
  v_mfma_f32_16x16x32_bf16 v[252:255], a[152:155], a[236:239], v[252:255]
  v_mfma_f32_16x16x32_bf16 v[252:255], a[156:159], a[252:255], v[252:255]
  ds_read_b64_tr_b16 a[144:145], v26 offset:0
  ds_read_b64_tr_b16 a[146:147], v26 offset:1024
  v_mfma_f32_16x16x32_bf16 v[236:239], a[156:159], a[248:251], v[236:239]
  ds_read_b64_tr_b16 v[44:45], v58 offset:4128
  ds_read_b64_tr_b16 v[46:47], v58 offset:5152
  v_mfma_f32_16x16x32_bf16 v[236:239], a[152:155], a[232:235], v[236:239]
  v_mfma_f32_16x16x32_bf16 v[220:223], a[152:155], a[228:231], v[220:223]
  v_mfma_f32_16x16x32_bf16 v[220:223], a[156:159], a[244:247], v[220:223]
  ds_read_b64_tr_b16 a[148:149], v26 offset:16384
  ds_read_b64_tr_b16 a[150:151], v26 offset:17408
  v_mfma_f32_16x16x32_bf16 v[204:207], a[156:159], a[240:243], v[204:207]
  v_mfma_f32_16x16x32_bf16 v[204:207], a[152:155], a[224:227], v[204:207]
  v_mfma_f32_16x16x32_bf16 a[0:3], a[128:131], a[224:227], a[0:3]
  s_waitcnt lgkmcnt(10)
  v_mfma_f32_16x16x32_bf16 a[0:3], a[132:135], a[240:243], a[0:3]
  ds_read_b64_tr_b16 a[152:153], v27 offset:0
  ds_read_b64_tr_b16 a[154:155], v27 offset:1024
  v_mfma_f32_16x16x32_bf16 a[32:35], a[132:135], a[244:247], a[32:35]
  v_mfma_f32_16x16x32_bf16 a[32:35], a[128:131], a[228:231], a[32:35]
  v_mfma_f32_16x16x32_bf16 a[64:67], a[128:131], a[232:235], a[64:67]
  v_mfma_f32_16x16x32_bf16 a[64:67], a[132:135], a[248:251], a[64:67]
  ds_read_b64_tr_b16 a[156:157], v27 offset:16384
  ds_read_b64_tr_b16 a[158:159], v27 offset:17408
  v_mfma_f32_16x16x32_bf16 a[96:99], a[132:135], a[252:255], a[96:99]
  s_waitcnt lgkmcnt(6)
  buffer_store_dwordx4 v[44:47], v1, s[40:43], s56 offen offset:1024 sc1
  v_mfma_f32_16x16x32_bf16 a[96:99], a[128:131], a[236:239], a[96:99]
  ds_read_b64_tr_b16 v[48:49], v58 offset:6144
  ds_read_b64_tr_b16 v[50:51], v58 offset:7168
  v_mfma_f32_16x16x32_bf16 a[100:103], a[136:139], a[236:239], a[100:103]
  v_mov_b32 v120, 0xc1906ebb
  v_mov_b32 v121, 0xc1906ebb
  v_mfma_f32_16x16x32_bf16 a[100:103], a[140:143], a[252:255], a[100:103]
  ds_read_b64_tr_b16 a[128:129], v28 offset:0
  ds_read_b64_tr_b16 a[130:131], v28 offset:1024
  v_mfma_f32_16x16x32_bf16 a[68:71], a[140:143], a[248:251], a[68:71]
  v_mov_b32 v122, 0xc2469614
  v_mov_b32 v123, 0xc2469614
  v_mfma_f32_16x16x32_bf16 a[68:71], a[136:139], a[232:235], a[68:71]
  v_mov_b32 v124, 0x3e0293ee
  v_mov_b32 v125, 0x3e0293ee
  v_mfma_f32_16x16x32_bf16 a[36:39], a[136:139], a[228:231], a[36:39]
  v_mov_b32 v128, 0
  v_mov_b32 v129, 0
  v_mfma_f32_16x16x32_bf16 a[36:39], a[140:143], a[244:247], a[36:39]
  ds_read_b64_tr_b16 a[132:133], v28 offset:16384
  ds_read_b64_tr_b16 a[134:135], v28 offset:17408
  v_mfma_f32_16x16x32_bf16 a[4:7], a[140:143], a[240:243], a[4:7]
  v_mov_b32 v130, 0
  v_mov_b32 v131, 0
  v_mfma_f32_16x16x32_bf16 a[4:7], a[136:139], a[224:227], a[4:7]
  s_mul_i32 s94, s80, 1490944
  s_lshl_b32 s95, s77, 14
  s_add_u32 s94, s94, s95
  v_mfma_f32_16x16x32_bf16 a[8:11], a[144:147], a[224:227], a[8:11]
  s_lshl_b32 s95, s76, 10
  s_add_u32 s94, s94, s95
  s_waitcnt lgkmcnt(10)
  v_mfma_f32_16x16x32_bf16 a[8:11], a[148:151], a[240:243], a[8:11]
  s_cmp_lt_u32 s77, 27
  s_cselect_b32 s94, s94, 2146435072
  ds_read_b64_tr_b16 a[136:137], v29 offset:0
  ds_read_b64_tr_b16 a[138:139], v29 offset:1024
  v_mfma_f32_16x16x32_bf16 a[40:43], a[148:151], a[244:247], a[40:43]
  s_add_u32 s95, s94, 8192
  v_mul_f32 v80, v240, v240
  v_mfma_f32_16x16x32_bf16 a[40:43], a[144:147], a[228:231], a[40:43]
  s_waitcnt lgkmcnt(6)
  buffer_store_dwordx4 v[48:51], v1, s[40:43], s57 offen offset:0 sc1
  v_mfma_f32_16x16x32_bf16 a[72:75], a[144:147], a[232:235], a[72:75]
  v_mul_f32 v81, v241, v241
  v_mul_f32 v82, v242, v242
  v_mfma_f32_16x16x32_bf16 a[72:75], a[148:151], a[248:251], a[72:75]
  ds_read_b64_tr_b16 a[140:141], v29 offset:16384
  ds_read_b64_tr_b16 a[142:143], v29 offset:17408
  v_mfma_f32_16x16x32_bf16 a[104:107], a[148:151], a[252:255], a[104:107]
  ds_read_b64_tr_b16 v[52:53], v58 offset:6176
  ds_read_b64_tr_b16 v[54:55], v58 offset:7200
  v_mfma_f32_16x16x32_bf16 a[104:107], a[144:147], a[236:239], a[104:107]
  v_mul_f32 v83, v243, v243
  v_mul_f32 v84, v244, v244
  v_mfma_f32_16x16x32_bf16 a[108:111], a[152:155], a[236:239], a[108:111]
  v_mul_f32 v85, v245, v245
  v_mul_f32 v86, v246, v246
  v_mfma_f32_16x16x32_bf16 a[108:111], a[156:159], a[252:255], a[108:111]
  ds_read_b64_tr_b16 a[144:145], v30 offset:0
  ds_read_b64_tr_b16 a[146:147], v30 offset:1024
  v_mfma_f32_16x16x32_bf16 a[76:79], a[156:159], a[248:251], a[76:79]
  v_mul_f32 v87, v247, v247
  v_fma_f32 v80, v80, v122, v120
  v_mfma_f32_16x16x32_bf16 a[76:79], a[152:155], a[232:235], a[76:79]
  v_fma_f32 v81, v81, v122, v120
  v_fma_f32 v82, v82, v122, v120
  v_mfma_f32_16x16x32_bf16 a[44:47], a[152:155], a[228:231], a[44:47]
  v_fma_f32 v83, v83, v122, v120
  v_fma_f32 v84, v84, v122, v120
  v_mfma_f32_16x16x32_bf16 a[44:47], a[156:159], a[244:247], a[44:47]
  ds_read_b64_tr_b16 a[148:149], v30 offset:16384
  ds_read_b64_tr_b16 a[150:151], v30 offset:17408
  v_mfma_f32_16x16x32_bf16 a[12:15], a[156:159], a[240:243], a[12:15]
  v_fma_f32 v85, v85, v122, v120
  v_fma_f32 v86, v86, v122, v120
  v_mfma_f32_16x16x32_bf16 a[12:15], a[152:155], a[224:227], a[12:15]
  s_waitcnt lgkmcnt(12)
  v_fma_f32 v87, v87, v122, v120
  v_mul_f32 v80, v80, v240
  v_mfma_f32_16x16x32_bf16 a[16:19], a[128:131], a[224:227], a[16:19]
  s_waitcnt lgkmcnt(10)
  v_mul_f32 v81, v81, v241
  v_mul_f32 v82, v82, v242
  v_mfma_f32_16x16x32_bf16 a[16:19], a[132:135], a[240:243], a[16:19]
  ds_read_b64_tr_b16 a[152:153], v31 offset:0
  ds_read_b64_tr_b16 a[154:155], v31 offset:1024
  v_mfma_f32_16x16x32_bf16 a[48:51], a[132:135], a[244:247], a[48:51]
  s_waitcnt lgkmcnt(6)
  buffer_store_dwordx4 v[52:55], v1, s[40:43], s57 offen offset:1024 sc1
  v_mfma_f32_16x16x32_bf16 a[48:51], a[128:131], a[228:231], a[48:51]
  v_mul_f32 v83, v83, v243
  v_mul_f32 v84, v84, v244
  v_mfma_f32_16x16x32_bf16 a[80:83], a[128:131], a[232:235], a[80:83]
  v_mul_f32 v85, v85, v245
  v_mul_f32 v86, v86, v246
  v_mfma_f32_16x16x32_bf16 a[80:83], a[132:135], a[248:251], a[80:83]
  ds_read_b64_tr_b16 a[156:157], v31 offset:16384
  ds_read_b64_tr_b16 a[158:159], v31 offset:17408
  v_mfma_f32_16x16x32_bf16 a[112:115], a[132:135], a[252:255], a[112:115]
  v_mul_f32 v87, v87, v247
  v_mfma_f32_16x16x32_bf16 a[112:115], a[128:131], a[236:239], a[112:115]
  v_exp_f32 v80, v80
  v_mfma_f32_16x16x32_bf16 a[116:119], a[136:139], a[236:239], a[116:119]
  v_exp_f32 v81, v81
  v_mfma_f32_16x16x32_bf16 a[116:119], a[140:143], a[252:255], a[116:119]
  v_exp_f32 v82, v82
  v_mfma_f32_16x16x32_bf16 a[84:87], a[140:143], a[248:251], a[84:87]
  v_exp_f32 v83, v83
  v_mfma_f32_16x16x32_bf16 a[84:87], a[136:139], a[232:235], a[84:87]
  v_exp_f32 v84, v84
  v_mfma_f32_16x16x32_bf16 a[52:55], a[136:139], a[228:231], a[52:55]
  v_exp_f32 v85, v85
  v_mfma_f32_16x16x32_bf16 a[52:55], a[140:143], a[244:247], a[52:55]
  v_exp_f32 v86, v86
  v_mfma_f32_16x16x32_bf16 a[20:23], a[140:143], a[240:243], a[20:23]
  v_exp_f32 v87, v87
  v_mfma_f32_16x16x32_bf16 a[20:23], a[136:139], a[224:227], a[20:23]
  s_waitcnt lgkmcnt(6)
  v_fma_f32 v80, v80, v124, v124
  v_fma_f32 v81, v81, v124, v124
  v_mfma_f32_16x16x32_bf16 a[24:27], a[144:147], a[224:227], a[24:27]
  s_waitcnt lgkmcnt(4)
  v_fma_f32 v82, v82, v124, v124
  v_fma_f32 v83, v83, v124, v124
  v_mfma_f32_16x16x32_bf16 a[24:27], a[148:151], a[240:243], a[24:27]
  v_fma_f32 v84, v84, v124, v124
  v_fma_f32 v85, v85, v124, v124
  v_mfma_f32_16x16x32_bf16 a[56:59], a[148:151], a[244:247], a[56:59]
  v_fma_f32 v86, v86, v124, v124
  v_fma_f32 v87, v87, v124, v124
  v_mfma_f32_16x16x32_bf16 a[56:59], a[144:147], a[228:231], a[56:59]
  v_rcp_f32 v80, v80
  v_mfma_f32_16x16x32_bf16 a[88:91], a[144:147], a[232:235], a[88:91]
  v_rcp_f32 v81, v81
  v_mfma_f32_16x16x32_bf16 a[88:91], a[148:151], a[248:251], a[88:91]
  v_rcp_f32 v82, v82
  v_mfma_f32_16x16x32_bf16 a[120:123], a[148:151], a[252:255], a[120:123]
  v_rcp_f32 v83, v83
  v_mfma_f32_16x16x32_bf16 a[120:123], a[144:147], a[236:239], a[120:123]
  s_waitcnt lgkmcnt(2)
  v_rcp_f32 v84, v84
  v_mfma_f32_16x16x32_bf16 a[124:127], a[152:155], a[236:239], a[124:127]
  s_waitcnt lgkmcnt(0)
  v_rcp_f32 v85, v85
  v_mfma_f32_16x16x32_bf16 a[124:127], a[156:159], a[252:255], a[124:127]
  v_rcp_f32 v86, v86
  v_mfma_f32_16x16x32_bf16 a[92:95], a[156:159], a[248:251], a[92:95]
  v_rcp_f32 v87, v87
  v_mfma_f32_16x16x32_bf16 a[92:95], a[152:155], a[232:235], a[92:95]
  v_mul_f32 v80, v80, v240
  v_mul_f32 v81, v81, v241
  v_mfma_f32_16x16x32_bf16 a[60:63], a[152:155], a[228:231], a[60:63]
  v_mul_f32 v82, v82, v242
  v_mul_f32 v83, v83, v243
  v_mfma_f32_16x16x32_bf16 a[60:63], a[156:159], a[244:247], a[60:63]
  v_mul_f32 v84, v84, v244
  v_mul_f32 v85, v85, v245
  v_mfma_f32_16x16x32_bf16 a[28:31], a[156:159], a[240:243], a[28:31]
  v_mul_f32 v86, v86, v246
  v_mul_f32 v87, v87, v247
  v_cvt_pk_bf16_f32 v104, v80, v81
  v_cvt_pk_bf16_f32 v105, v82, v83
  v_cvt_pk_bf16_f32 v106, v84, v85
  v_cvt_pk_bf16_f32 v107, v86, v87
  buffer_store_dwordx4 v[104:107], v7, s[20:23], s94 offen sc1
  v_mul_f32 v88, v248, v248
  v_mul_f32 v89, v249, v249
  v_mul_f32 v90, v250, v250
  v_mul_f32 v91, v251, v251
  v_mul_f32 v92, v252, v252
  v_mul_f32 v93, v253, v253
  v_mul_f32 v94, v254, v254
  v_mul_f32 v95, v255, v255
  v_fma_f32 v88, v88, v122, v120
  v_fma_f32 v89, v89, v122, v120
  v_fma_f32 v90, v90, v122, v120
  v_fma_f32 v91, v91, v122, v120
  v_fma_f32 v92, v92, v122, v120
  v_fma_f32 v93, v93, v122, v120
  v_fma_f32 v94, v94, v122, v120
  v_fma_f32 v95, v95, v122, v120
  v_mul_f32 v88, v88, v248
  v_mul_f32 v89, v89, v249
  v_mul_f32 v90, v90, v250
  v_mul_f32 v91, v91, v251
  v_mul_f32 v92, v92, v252
  v_mul_f32 v93, v93, v253
  v_mul_f32 v94, v94, v254
  v_mul_f32 v95, v95, v255
  v_exp_f32 v88, v88
  v_exp_f32 v89, v89
  v_exp_f32 v90, v90
  v_exp_f32 v91, v91
  v_exp_f32 v92, v92
  v_exp_f32 v93, v93
  v_exp_f32 v94, v94
  v_exp_f32 v95, v95
  v_fma_f32 v88, v88, v124, v124
  v_fma_f32 v89, v89, v124, v124
  v_fma_f32 v90, v90, v124, v124
  v_fma_f32 v91, v91, v124, v124
  v_fma_f32 v92, v92, v124, v124
  v_fma_f32 v93, v93, v124, v124
  v_fma_f32 v94, v94, v124, v124
  v_fma_f32 v95, v95, v124, v124
  v_rcp_f32 v88, v88
  v_rcp_f32 v89, v89
  v_rcp_f32 v90, v90
  v_rcp_f32 v91, v91
  v_rcp_f32 v92, v92
  v_rcp_f32 v93, v93
  v_rcp_f32 v94, v94
  v_rcp_f32 v95, v95
  v_mul_f32 v88, v88, v248
  v_mul_f32 v89, v89, v249
  v_mul_f32 v90, v90, v250
  v_mul_f32 v91, v91, v251
  v_mul_f32 v92, v92, v252
  v_mul_f32 v93, v93, v253
  v_mul_f32 v94, v94, v254
  v_mul_f32 v95, v95, v255
  v_cvt_pk_bf16_f32 v108, v88, v89
  v_cvt_pk_bf16_f32 v109, v90, v91
  v_cvt_pk_bf16_f32 v110, v92, v93
  v_cvt_pk_bf16_f32 v111, v94, v95
  buffer_store_dwordx4 v[108:111], v7, s[20:23], s95 offen sc1
L_padA8:
  s_cbranch_execz L_padA12
  v_mfma_f32_16x16x32_bf16 a[28:31], a[152:155], a[224:227], a[28:31]
  buffer_load_dword v13, v8, s[36:39], 0 offen sc1
  v_accvgpr_read_b32 v112, a0
  v_accvgpr_read_b32 v113, a1
  v_cvt_pk_bf16_f32 v16, v112, v113
  v_accvgpr_read_b32 v114, a2
  v_accvgpr_read_b32 v115, a3
  v_cvt_pk_bf16_f32 v17, v114, v115
  v_accvgpr_read_b32 v116, a4
  v_accvgpr_read_b32 v117, a5
  v_cvt_pk_bf16_f32 v18, v116, v117
  v_accvgpr_read_b32 v118, a6
  v_accvgpr_read_b32 v119, a7
  v_cvt_pk_bf16_f32 v19, v118, v119
  v_accvgpr_read_b32 v112, a32
  v_accvgpr_read_b32 v113, a33
  v_cvt_pk_bf16_f32 v32, v112, v113
  v_accvgpr_read_b32 v114, a34
  v_accvgpr_read_b32 v115, a35
  v_cvt_pk_bf16_f32 v33, v114, v115
  v_accvgpr_read_b32 v116, a36
  v_accvgpr_read_b32 v117, a37
  v_cvt_pk_bf16_f32 v34, v116, v117
  v_accvgpr_read_b32 v118, a38
  v_accvgpr_read_b32 v119, a39
  v_cvt_pk_bf16_f32 v35, v118, v119
  v_accvgpr_read_b32 v112, a64
  v_accvgpr_read_b32 v113, a65
  v_cvt_pk_bf16_f32 v48, v112, v113
  v_accvgpr_read_b32 v114, a66
  v_accvgpr_read_b32 v115, a67
  v_cvt_pk_bf16_f32 v49, v114, v115
  v_accvgpr_read_b32 v116, a68
  v_accvgpr_read_b32 v117, a69
  v_cvt_pk_bf16_f32 v50, v116, v117
  v_accvgpr_read_b32 v118, a70
  v_accvgpr_read_b32 v119, a71
  v_cvt_pk_bf16_f32 v51, v118, v119
  v_accvgpr_read_b32 v112, a96
  v_accvgpr_read_b32 v113, a97
  v_cvt_pk_bf16_f32 v64, v112, v113
  v_accvgpr_read_b32 v114, a98
  v_accvgpr_read_b32 v115, a99
  v_cvt_pk_bf16_f32 v65, v114, v115
  v_accvgpr_read_b32 v116, a100
  v_accvgpr_read_b32 v117, a101
  v_cvt_pk_bf16_f32 v66, v116, v117
  v_accvgpr_read_b32 v118, a102
  v_accvgpr_read_b32 v119, a103
  v_cvt_pk_bf16_f32 v67, v118, v119
  v_accvgpr_read_b32 v112, a8
  v_accvgpr_read_b32 v113, a9
  v_cvt_pk_bf16_f32 v20, v112, v113
  v_accvgpr_read_b32 v114, a10
  v_accvgpr_read_b32 v115, a11
  v_cvt_pk_bf16_f32 v21, v114, v115
  v_accvgpr_read_b32 v116, a12
  v_accvgpr_read_b32 v117, a13
  v_cvt_pk_bf16_f32 v22, v116, v117
  v_accvgpr_read_b32 v118, a14
  v_accvgpr_read_b32 v119, a15
  v_cvt_pk_bf16_f32 v23, v118, v119
  v_accvgpr_read_b32 v112, a40
  v_accvgpr_read_b32 v113, a41
  v_cvt_pk_bf16_f32 v36, v112, v113
  v_accvgpr_read_b32 v114, a42
  v_accvgpr_read_b32 v115, a43
  v_cvt_pk_bf16_f32 v37, v114, v115
  v_accvgpr_read_b32 v116, a44
  v_accvgpr_read_b32 v117, a45
  v_cvt_pk_bf16_f32 v38, v116, v117
  v_accvgpr_read_b32 v118, a46
  v_accvgpr_read_b32 v119, a47
  v_cvt_pk_bf16_f32 v39, v118, v119
  v_accvgpr_read_b32 v112, a72
  v_accvgpr_read_b32 v113, a73
  v_cvt_pk_bf16_f32 v52, v112, v113
  v_accvgpr_read_b32 v114, a74
  v_accvgpr_read_b32 v115, a75
  v_cvt_pk_bf16_f32 v53, v114, v115
  v_accvgpr_read_b32 v116, a76
  v_accvgpr_read_b32 v117, a77
  v_cvt_pk_bf16_f32 v54, v116, v117
  v_accvgpr_read_b32 v118, a78
  v_accvgpr_read_b32 v119, a79
  v_cvt_pk_bf16_f32 v55, v118, v119
  v_accvgpr_read_b32 v112, a104
  v_accvgpr_read_b32 v113, a105
  v_cvt_pk_bf16_f32 v68, v112, v113
  v_accvgpr_read_b32 v114, a106
  v_accvgpr_read_b32 v115, a107
  v_cvt_pk_bf16_f32 v69, v114, v115
  v_accvgpr_read_b32 v116, a108
  v_accvgpr_read_b32 v117, a109
  v_cvt_pk_bf16_f32 v70, v116, v117
  v_accvgpr_read_b32 v118, a110
  v_accvgpr_read_b32 v119, a111
  v_cvt_pk_bf16_f32 v71, v118, v119
  v_accvgpr_read_b32 v112, a16
  v_accvgpr_read_b32 v113, a17
  v_cvt_pk_bf16_f32 v24, v112, v113
  v_accvgpr_read_b32 v114, a18
  v_accvgpr_read_b32 v115, a19
  v_cvt_pk_bf16_f32 v25, v114, v115
  v_accvgpr_read_b32 v116, a20
  v_accvgpr_read_b32 v117, a21
  v_cvt_pk_bf16_f32 v26, v116, v117
  v_accvgpr_read_b32 v118, a22
  v_accvgpr_read_b32 v119, a23
  v_cvt_pk_bf16_f32 v27, v118, v119
  v_accvgpr_read_b32 v112, a48
  v_accvgpr_read_b32 v113, a49
  v_cvt_pk_bf16_f32 v40, v112, v113
  v_accvgpr_read_b32 v114, a50
  v_accvgpr_read_b32 v115, a51
  v_cvt_pk_bf16_f32 v41, v114, v115
  v_accvgpr_read_b32 v116, a52
  v_accvgpr_read_b32 v117, a53
  v_cvt_pk_bf16_f32 v42, v116, v117
  v_accvgpr_read_b32 v118, a54
  v_accvgpr_read_b32 v119, a55
  v_cvt_pk_bf16_f32 v43, v118, v119
  v_accvgpr_read_b32 v112, a80
  v_accvgpr_read_b32 v113, a81
  v_cvt_pk_bf16_f32 v56, v112, v113
  v_accvgpr_read_b32 v114, a82
  v_accvgpr_read_b32 v115, a83
  v_cvt_pk_bf16_f32 v57, v114, v115
  v_accvgpr_read_b32 v116, a84
  v_accvgpr_read_b32 v117, a85
  v_cvt_pk_bf16_f32 v58, v116, v117
  v_accvgpr_read_b32 v118, a86
  v_accvgpr_read_b32 v119, a87
  v_cvt_pk_bf16_f32 v59, v118, v119
  v_accvgpr_read_b32 v112, a112
  v_accvgpr_read_b32 v113, a113
  v_cvt_pk_bf16_f32 v72, v112, v113
  v_accvgpr_read_b32 v114, a114
  v_accvgpr_read_b32 v115, a115
  v_cvt_pk_bf16_f32 v73, v114, v115
  v_accvgpr_read_b32 v116, a116
  v_accvgpr_read_b32 v117, a117
  v_cvt_pk_bf16_f32 v74, v116, v117
  v_accvgpr_read_b32 v118, a118
  v_accvgpr_read_b32 v119, a119
  v_cvt_pk_bf16_f32 v75, v118, v119
  v_accvgpr_read_b32 v112, a24
  v_accvgpr_read_b32 v113, a25
  v_cvt_pk_bf16_f32 v28, v112, v113
  v_accvgpr_read_b32 v114, a26
  v_accvgpr_read_b32 v115, a27
  v_cvt_pk_bf16_f32 v29, v114, v115
  v_accvgpr_read_b32 v116, a28
  v_accvgpr_read_b32 v117, a29
  v_cvt_pk_bf16_f32 v30, v116, v117
  v_accvgpr_read_b32 v118, a30
  v_accvgpr_read_b32 v119, a31
  v_cvt_pk_bf16_f32 v31, v118, v119
  v_accvgpr_read_b32 v112, a56
  v_accvgpr_read_b32 v113, a57
  v_cvt_pk_bf16_f32 v44, v112, v113
  v_accvgpr_read_b32 v114, a58
  v_accvgpr_read_b32 v115, a59
  v_cvt_pk_bf16_f32 v45, v114, v115
  v_accvgpr_read_b32 v116, a60
  v_accvgpr_read_b32 v117, a61
  v_cvt_pk_bf16_f32 v46, v116, v117
  v_accvgpr_read_b32 v118, a62
  v_accvgpr_read_b32 v119, a63
  v_cvt_pk_bf16_f32 v47, v118, v119
  v_accvgpr_read_b32 v112, a88
  v_accvgpr_read_b32 v113, a89
  v_cvt_pk_bf16_f32 v60, v112, v113
  v_accvgpr_read_b32 v114, a90
  v_accvgpr_read_b32 v115, a91
  v_cvt_pk_bf16_f32 v61, v114, v115
  v_accvgpr_read_b32 v116, a92
  v_accvgpr_read_b32 v117, a93
  v_cvt_pk_bf16_f32 v62, v116, v117
  v_accvgpr_read_b32 v118, a94
  v_accvgpr_read_b32 v119, a95
  v_cvt_pk_bf16_f32 v63, v118, v119
  v_accvgpr_read_b32 v112, a120
  v_accvgpr_read_b32 v113, a121
  v_cvt_pk_bf16_f32 v76, v112, v113
  v_accvgpr_read_b32 v114, a122
  v_accvgpr_read_b32 v115, a123
  v_cvt_pk_bf16_f32 v77, v114, v115
  v_accvgpr_read_b32 v116, a124
  v_accvgpr_read_b32 v117, a125
  v_cvt_pk_bf16_f32 v78, v116, v117
  v_accvgpr_read_b32 v118, a126
  v_accvgpr_read_b32 v119, a127
  v_cvt_pk_bf16_f32 v79, v118, v119
  s_mov_b32 s92, 0
  s_waitcnt vmcnt(0)
  v_cmp_ne_u32 vcc, v13, v9
  s_nop 1
  s_cbranch_vccnz L_kv_spin
L_kv_ok:
  s_barrier
  v_pk_mul_f32 v[80:81], v[224:225], v[224:225]
  v_pk_mul_f32 v[82:83], v[226:227], v[226:227]
  v_pk_mul_f32 v[84:85], v[228:229], v[228:229]
  v_pk_mul_f32 v[86:87], v[230:231], v[230:231]
  v_pk_fma_f32 v[80:81], v[80:81], v[122:123], v[120:121]
  s_and_b32 s85, s79, 1
  s_lshl_b32 s85, s85, 16
  v_or_b32 v10, s85, v1
  v_xor_b32 v11, 0x10000, v10
  v_pk_fma_f32 v[82:83], v[82:83], v[122:123], v[120:121]
  v_pk_fma_f32 v[84:85], v[84:85], v[122:123], v[120:121]
  v_pk_fma_f32 v[86:87], v[86:87], v[122:123], v[120:121]
  v_pk_mul_f32 v[80:81], v[80:81], v[224:225]
  v_pk_mul_f32 v[82:83], v[82:83], v[226:227]
  v_add_u32 v2, 0, v1
  v_add_u32 v3, 4096, v1
  v_add_u32 v4, 8192, v1
  v_add_u32 v5, 12288, v1
  v_pk_mul_f32 v[84:85], v[84:85], v[228:229]
  v_pk_mul_f32 v[86:87], v[86:87], v[230:231]
  v_mfma_f32_32x32x16_bf16 a[0:15], v[128:131], v[128:131], 0
  v_exp_f32 v80, v80
  v_exp_f32 v81, v81
  s_lshr_b32 s81, s76, 1
  s_lshl_b32 s81, s81, 14
  s_and_b32 s82, s76, 1
  s_lshl_b32 s82, s82, 12
  s_add_u32 s81, s81, s82
  s_add_u32 s81, s81, 8192
  s_xor_b32 s82, s85, 98304
  s_add_u32 m0, s81, s82
  s_lshl_b32 s84, s76, 14
  s_add_u32 s85, s85, s84
  s_add_u32 s84, s84, 32768
  v_exp_f32 v82, v82
  v_exp_f32 v83, v83
  v_exp_f32 v84, v84
  v_exp_f32 v85, v85
  v_exp_f32 v86, v86
  buffer_load_dwordx4 v2, s[4:7], s81 offen offset:0 sc1 lds
  v_exp_f32 v87, v87
  v_pk_fma_f32 v[80:81], v[80:81], v[124:125], v[124:125]
  v_pk_fma_f32 v[82:83], v[82:83], v[124:125], v[124:125]
  v_pk_fma_f32 v[84:85], v[84:85], v[124:125], v[124:125]
  v_pk_fma_f32 v[86:87], v[86:87], v[124:125], v[124:125]
  buffer_load_dwordx4 v2, s[4:7], s81 offen offset:1024 sc1 lds
  v_mfma_f32_32x32x16_bf16 a[16:31], v[128:131], v[128:131], 0
  v_rcp_f32 v80, v80
  v_rcp_f32 v81, v81
  v_rcp_f32 v82, v82
  v_rcp_f32 v83, v83
  buffer_load_dwordx4 v2, s[4:7], s81 offen offset:2048 sc1 lds
  v_rcp_f32 v84, v84
  v_rcp_f32 v85, v85
  v_rcp_f32 v86, v86
  v_rcp_f32 v87, v87
  v_pk_mul_f32 v[80:81], v[80:81], v[224:225]
  buffer_load_dwordx4 v2, s[4:7], s81 offen offset:3072 sc1 lds
  v_pk_mul_f32 v[82:83], v[82:83], v[226:227]
  v_pk_mul_f32 v[84:85], v[84:85], v[228:229]
  v_pk_mul_f32 v[86:87], v[86:87], v[230:231]
  v_cvt_pk_bf16_f32 v96, v80, v81
  v_cvt_pk_bf16_f32 v97, v82, v83
  v_cvt_pk_bf16_f32 v98, v84, v85
  v_cvt_pk_bf16_f32 v99, v86, v87
  buffer_store_dwordx4 v[96:99], v1, s[20:23], s94 offen sc1
  v_pk_mul_f32 v[88:89], v[232:233], v[232:233]
  v_pk_mul_f32 v[90:91], v[234:235], v[234:235]
  v_pk_mul_f32 v[92:93], v[236:237], v[236:237]
  v_pk_mul_f32 v[94:95], v[238:239], v[238:239]
  v_pk_fma_f32 v[88:89], v[88:89], v[122:123], v[120:121]
  v_pk_fma_f32 v[90:91], v[90:91], v[122:123], v[120:121]
  v_pk_fma_f32 v[92:93], v[92:93], v[122:123], v[120:121]
  s_add_u32 m0, s85, 0
  s_nop 0
  buffer_load_dwordx4 v2, s[4:7], s84 offen offset:0 sc1 lds
  v_pk_fma_f32 v[94:95], v[94:95], v[122:123], v[120:121]
  v_pk_mul_f32 v[88:89], v[88:89], v[232:233]
  v_pk_mul_f32 v[90:91], v[90:91], v[234:235]
  v_pk_mul_f32 v[92:93], v[92:93], v[236:237]
  v_pk_mul_f32 v[94:95], v[94:95], v[238:239]
  v_mfma_f32_32x32x16_bf16 a[32:47], v[128:131], v[128:131], 0
  v_exp_f32 v88, v88
  buffer_load_dwordx4 v2, s[4:7], s84 offen offset:1024 sc1 lds
  v_exp_f32 v89, v89
  v_exp_f32 v90, v90
  v_exp_f32 v91, v91
  v_exp_f32 v92, v92
  v_exp_f32 v93, v93
  v_exp_f32 v94, v94
  v_exp_f32 v95, v95
  buffer_load_dwordx4 v2, s[4:7], s84 offen offset:2048 sc1 lds
  v_pk_fma_f32 v[88:89], v[88:89], v[124:125], v[124:125]
  v_pk_fma_f32 v[90:91], v[90:91], v[124:125], v[124:125]
  v_pk_fma_f32 v[92:93], v[92:93], v[124:125], v[124:125]
  v_pk_fma_f32 v[94:95], v[94:95], v[124:125], v[124:125]
  v_mfma_f32_32x32x16_bf16 a[48:63], v[128:131], v[128:131], 0
  v_rcp_f32 v88, v88
  v_rcp_f32 v89, v89
  v_and_b32 v6, 15, v14
  v_lshrrev_b32 v252, 4, v14
  v_lshlrev_b32 v252, 2, v252
  v_sub_u32 v252, v6, v252
  v_rcp_f32 v90, v90
  v_rcp_f32 v91, v91
  v_rcp_f32 v92, v92
  v_rcp_f32 v93, v93
  v_rcp_f32 v94, v94
  v_rcp_f32 v95, v95
  v_pk_mul_f32 v[88:89], v[88:89], v[232:233]
  v_mov_b32 v253, 0xff800000
  v_mov_b32 v254, 0x3f803f80
  v_and_b32 v6, 3, v6
  v_pk_mul_f32 v[90:91], v[90:91], v[234:235]
  v_pk_mul_f32 v[92:93], v[92:93], v[236:237]
  v_pk_mul_f32 v[94:95], v[94:95], v[238:239]
  v_cvt_pk_bf16_f32 v100, v88, v89
  v_cvt_pk_bf16_f32 v101, v90, v91
  v_cvt_pk_bf16_f32 v102, v92, v93
  v_cvt_pk_bf16_f32 v103, v94, v95
  buffer_store_dwordx4 v[100:103], v1, s[20:23], s95 offen sc1
  s_mul_i32 s94, s79, 1490944
  s_lshl_b32 s95, s77, 14
  s_add_u32 s94, s94, s95
  s_lshl_b32 s95, s76, 10
  s_add_u32 s94, s94, s95
  s_cmp_lt_u32 s77, 27
  s_cselect_b32 s94, s94, 2146435072
  s_add_u32 s95, s94, 8192
  v_pk_mul_f32 v[80:81], v[208:209], v[208:209]
  v_pk_mul_f32 v[82:83], v[210:211], v[210:211]
  v_pk_mul_f32 v[84:85], v[212:213], v[212:213]
  v_pk_mul_f32 v[86:87], v[214:215], v[214:215]
  buffer_load_dwordx4 v2, s[4:7], s84 offen offset:3072 sc1 lds
  v_pk_fma_f32 v[80:81], v[80:81], v[122:123], v[120:121]
  v_pk_fma_f32 v[82:83], v[82:83], v[122:123], v[120:121]
  v_pk_fma_f32 v[84:85], v[84:85], v[122:123], v[120:121]
  v_pk_fma_f32 v[86:87], v[86:87], v[122:123], v[120:121]
  v_pk_mul_f32 v[80:81], v[80:81], v[208:209]
  s_add_u32 m0, s85, 4096
  s_nop 0
  buffer_load_dwordx4 v3, s[4:7], s84 offen offset:0 sc1 lds
  v_pk_mul_f32 v[82:83], v[82:83], v[210:211]
  v_pk_mul_f32 v[84:85], v[84:85], v[212:213]
  v_pk_mul_f32 v[86:87], v[86:87], v[214:215]
  v_mfma_f32_32x32x16_bf16 a[64:79], v[128:131], v[128:131], 0
  v_exp_f32 v80, v80
  buffer_load_dwordx4 v3, s[4:7], s84 offen offset:1024 sc1 lds
  v_exp_f32 v81, v81
  v_exp_f32 v82, v82
  v_exp_f32 v83, v83
  v_exp_f32 v84, v84
  v_exp_f32 v85, v85
  v_cmp_le_i32 vcc, 0, v252
  s_nop 1
  v_cndmask_b32_e64 v244, v253, 0, vcc
  v_exp_f32 v86, v86
  v_exp_f32 v87, v87
  v_pk_fma_f32 v[80:81], v[80:81], v[124:125], v[124:125]
  v_pk_fma_f32 v[82:83], v[82:83], v[124:125], v[124:125]
  v_pk_fma_f32 v[84:85], v[84:85], v[124:125], v[124:125]
  v_cmp_le_i32 vcc, 1, v252
  s_nop 1
  v_cndmask_b32_e64 v245, v253, 0, vcc
  v_pk_fma_f32 v[86:87], v[86:87], v[124:125], v[124:125]
  v_mfma_f32_32x32x16_bf16 a[80:95], v[128:131], v[128:131], 0
  v_rcp_f32 v80, v80
  v_rcp_f32 v81, v81
  v_rcp_f32 v82, v82
  v_cmp_le_i32 vcc, 2, v252
  s_nop 1
  v_cndmask_b32_e64 v246, v253, 0, vcc
  v_rcp_f32 v83, v83
  v_rcp_f32 v84, v84
  v_rcp_f32 v85, v85
  v_rcp_f32 v86, v86
  v_rcp_f32 v87, v87
  v_cmp_le_i32 vcc, 3, v252
  s_nop 1
  v_cndmask_b32_e64 v247, v253, 0, vcc
  v_pk_mul_f32 v[80:81], v[80:81], v[208:209]
  v_pk_mul_f32 v[82:83], v[82:83], v[210:211]
  v_pk_mul_f32 v[84:85], v[84:85], v[212:213]
  v_pk_mul_f32 v[86:87], v[86:87], v[214:215]
  v_cvt_pk_bf16_f32 v104, v80, v81
  v_cvt_pk_bf16_f32 v105, v82, v83
  v_cvt_pk_bf16_f32 v106, v84, v85
  v_cvt_pk_bf16_f32 v107, v86, v87
  buffer_store_dwordx4 v[104:107], v7, s[20:23], s94 offen sc1
  v_pk_mul_f32 v[88:89], v[216:217], v[216:217]
  v_pk_mul_f32 v[90:91], v[218:219], v[218:219]
  v_pk_mul_f32 v[92:93], v[220:221], v[220:221]
  v_pk_mul_f32 v[94:95], v[222:223], v[222:223]
  v_pk_fma_f32 v[88:89], v[88:89], v[122:123], v[120:121]
  v_pk_fma_f32 v[90:91], v[90:91], v[122:123], v[120:121]
  v_pk_fma_f32 v[92:93], v[92:93], v[122:123], v[120:121]
  buffer_load_dwordx4 v3, s[4:7], s84 offen offset:2048 sc1 lds
  v_pk_fma_f32 v[94:95], v[94:95], v[122:123], v[120:121]
  v_pk_mul_f32 v[88:89], v[88:89], v[216:217]
  v_pk_mul_f32 v[90:91], v[90:91], v[218:219]
  v_pk_mul_f32 v[92:93], v[92:93], v[220:221]
  v_pk_mul_f32 v[94:95], v[94:95], v[222:223]
  v_mfma_f32_32x32x16_bf16 a[96:111], v[128:131], v[128:131], 0
  v_exp_f32 v88, v88
  buffer_load_dwordx4 v3, s[4:7], s84 offen offset:3072 sc1 lds
  v_exp_f32 v89, v89
  v_exp_f32 v90, v90
  v_exp_f32 v91, v91
  v_exp_f32 v92, v92
  v_exp_f32 v93, v93
  v_exp_f32 v94, v94
  v_exp_f32 v95, v95
  s_add_u32 m0, s85, 8192
  s_nop 0
  buffer_load_dwordx4 v4, s[4:7], s84 offen offset:0 sc1 lds
  v_pk_fma_f32 v[88:89], v[88:89], v[124:125], v[124:125]
  v_pk_fma_f32 v[90:91], v[90:91], v[124:125], v[124:125]
  v_pk_fma_f32 v[92:93], v[92:93], v[124:125], v[124:125]
  v_pk_fma_f32 v[94:95], v[94:95], v[124:125], v[124:125]
  v_mfma_f32_32x32x16_bf16 a[112:127], v[128:131], v[128:131], 0
  v_rcp_f32 v88, v88
  v_rcp_f32 v89, v89
  v_cmp_eq_u32 vcc, 0, v6
  s_nop 1
  v_cndmask_b32_e64 v240, 0, v254, vcc
  v_cndmask_b32_e64 v241, 0, v254, vcc
  v_cndmask_b32_e64 v242, 0, v254, vcc
  v_cndmask_b32_e64 v243, 0, v254, vcc
  v_rcp_f32 v90, v90
  v_rcp_f32 v91, v91
  v_rcp_f32 v92, v92
  v_rcp_f32 v93, v93
  v_rcp_f32 v94, v94
  v_rcp_f32 v95, v95
  v_pk_mul_f32 v[88:89], v[88:89], v[216:217]
  v_and_b32 v6, 16, v14
  v_cmp_ne_u32 vcc, 0, v6
  v_mov_b32 v8, 2146435072
  v_mov_b32 v9, s72
  v_cndmask_b32 v8, v8, v0, vcc
  v_pk_mul_f32 v[90:91], v[90:91], v[218:219]
  v_pk_mul_f32 v[92:93], v[92:93], v[220:221]
  v_pk_mul_f32 v[94:95], v[94:95], v[222:223]
  v_cvt_pk_bf16_f32 v108, v88, v89
  v_cvt_pk_bf16_f32 v109, v90, v91
  v_cvt_pk_bf16_f32 v110, v92, v93
  v_cvt_pk_bf16_f32 v111, v94, v95
  buffer_store_dwordx4 v[108:111], v7, s[20:23], s95 offen sc1
  v_pk_mul_f32 v[80:81], v[192:193], v[192:193]
  v_pk_mul_f32 v[82:83], v[194:195], v[194:195]
  v_pk_mul_f32 v[84:85], v[196:197], v[196:197]
  v_pk_mul_f32 v[86:87], v[198:199], v[198:199]
  v_pk_fma_f32 v[80:81], v[80:81], v[122:123], v[120:121]
  v_pk_fma_f32 v[82:83], v[82:83], v[122:123], v[120:121]
  v_pk_fma_f32 v[84:85], v[84:85], v[122:123], v[120:121]
  v_pk_fma_f32 v[86:87], v[86:87], v[122:123], v[120:121]
  v_pk_mul_f32 v[80:81], v[80:81], v[192:193]
  v_pk_mul_f32 v[82:83], v[82:83], v[194:195]
  buffer_load_dwordx4 v4, s[4:7], s84 offen offset:1024 sc1 lds
  v_pk_mul_f32 v[84:85], v[84:85], v[196:197]
  v_pk_mul_f32 v[86:87], v[86:87], v[198:199]
  v_mfma_f32_32x32x16_bf16 v[224:239], v[128:131], v[128:131], 0
  v_exp_f32 v80, v80
  v_exp_f32 v81, v81
  v_exp_f32 v82, v82
  v_exp_f32 v83, v83
  v_exp_f32 v84, v84
  v_exp_f32 v85, v85
  v_exp_f32 v86, v86
  buffer_load_dwordx4 v4, s[4:7], s84 offen offset:2048 sc1 lds
  v_exp_f32 v87, v87
  v_pk_fma_f32 v[80:81], v[80:81], v[124:125], v[124:125]
  v_pk_fma_f32 v[82:83], v[82:83], v[124:125], v[124:125]
  v_pk_fma_f32 v[84:85], v[84:85], v[124:125], v[124:125]
  v_pk_fma_f32 v[86:87], v[86:87], v[124:125], v[124:125]
  v_mfma_f32_32x32x16_bf16 v[208:223], v[128:131], v[128:131], 0
  v_rcp_f32 v80, v80
  v_rcp_f32 v81, v81
  v_rcp_f32 v82, v82
  v_rcp_f32 v83, v83
  buffer_load_dwordx4 v4, s[4:7], s84 offen offset:3072 sc1 lds
  v_rcp_f32 v84, v84
  v_rcp_f32 v85, v85
  v_rcp_f32 v86, v86
  v_rcp_f32 v87, v87
  v_pk_mul_f32 v[80:81], v[80:81], v[192:193]
  v_pk_mul_f32 v[82:83], v[82:83], v[194:195]
  v_pk_mul_f32 v[84:85], v[84:85], v[196:197]
  v_pk_mul_f32 v[86:87], v[86:87], v[198:199]
  v_cvt_pk_bf16_f32 v96, v80, v81
  v_cvt_pk_bf16_f32 v97, v82, v83
  v_cvt_pk_bf16_f32 v98, v84, v85
  v_cvt_pk_bf16_f32 v99, v86, v87
  buffer_store_dwordx4 v[96:99], v1, s[20:23], s94 offen sc1
  s_waitcnt vmcnt(17)
  s_barrier
  ds_read_b128 a[128:131], v11 offset:40960
  ds_read_b128 a[132:135], v11 offset:41984
  ds_read_b128 a[136:139], v11 offset:43008
  ds_read_b128 a[140:143], v11 offset:44032
  ds_read_b128 a[144:147], v11 offset:45056
  ds_read_b128 a[148:151], v11 offset:46080
  ds_read_b128 a[152:155], v11 offset:47104
  ds_read_b128 a[156:159], v11 offset:48128
  v_pk_mul_f32 v[88:89], v[200:201], v[200:201]
  v_pk_mul_f32 v[90:91], v[202:203], v[202:203]
  v_pk_mul_f32 v[92:93], v[204:205], v[204:205]
  v_pk_mul_f32 v[94:95], v[206:207], v[206:207]
  v_pk_fma_f32 v[88:89], v[88:89], v[122:123], v[120:121]
  v_pk_fma_f32 v[90:91], v[90:91], v[122:123], v[120:121]
  v_pk_fma_f32 v[92:93], v[92:93], v[122:123], v[120:121]
  v_pk_fma_f32 v[94:95], v[94:95], v[122:123], v[120:121]
  v_pk_mul_f32 v[88:89], v[88:89], v[200:201]
  v_pk_mul_f32 v[90:91], v[90:91], v[202:203]
  s_add_u32 m0, s85, 12288
  s_nop 0
  buffer_load_dwordx4 v5, s[4:7], s84 offen offset:0 sc1 lds
  v_pk_mul_f32 v[92:93], v[92:93], v[204:205]
  v_pk_mul_f32 v[94:95], v[94:95], v[206:207]
  v_exp_f32 v88, v88
  v_exp_f32 v89, v89
  v_exp_f32 v90, v90
  v_exp_f32 v91, v91
  v_exp_f32 v92, v92
  v_exp_f32 v93, v93
  v_exp_f32 v94, v94
  buffer_load_dwordx4 v5, s[4:7], s84 offen offset:1024 sc1 lds
  v_exp_f32 v95, v95
  v_pk_fma_f32 v[88:89], v[88:89], v[124:125], v[124:125]
  v_pk_fma_f32 v[90:91], v[90:91], v[124:125], v[124:125]
  v_pk_fma_f32 v[92:93], v[92:93], v[124:125], v[124:125]
  v_pk_fma_f32 v[94:95], v[94:95], v[124:125], v[124:125]
  v_rcp_f32 v88, v88
  v_rcp_f32 v89, v89
  v_rcp_f32 v90, v90
  v_rcp_f32 v91, v91
  buffer_load_dwordx4 v5, s[4:7], s84 offen offset:2048 sc1 lds
  v_rcp_f32 v92, v92
  v_rcp_f32 v93, v93
  v_rcp_f32 v94, v94
  v_rcp_f32 v95, v95
  v_pk_mul_f32 v[88:89], v[88:89], v[200:201]
  v_pk_mul_f32 v[90:91], v[90:91], v[202:203]
  v_pk_mul_f32 v[92:93], v[92:93], v[204:205]
  v_pk_mul_f32 v[94:95], v[94:95], v[206:207]
  v_cvt_pk_bf16_f32 v100, v88, v89
  v_cvt_pk_bf16_f32 v101, v90, v91
  v_cvt_pk_bf16_f32 v102, v92, v93
  v_cvt_pk_bf16_f32 v103, v94, v95
  buffer_store_dwordx4 v[100:103], v1, s[20:23], s95 offen sc1
L_att_redo:
  s_lshr_b32 s81, s76, 1
  s_or_b32 s81, s80, s81
  s_cmp_eq_u32 s81, 0
  s_cbranch_scc1 L_p0d
L_p0:
  s_waitcnt lgkmcnt(0)
  v_mfma_f32_16x16x32_bf16 v[80:83], a[128:131], v[16:19], 0
  v_mfma_f32_16x16x32_bf16 v[80:83], a[132:135], v[20:23], v[80:83]
  buffer_load_dwordx4 v5, s[4:7], s84 offen offset:3072 sc1 lds
  v_mfma_f32_16x16x32_bf16 v[80:83], a[136:139], v[24:27], v[80:83]
  v_mfma_f32_16x16x32_bf16 v[80:83], a[140:143], v[28:31], v[80:83]
  v_mfma_f32_16x16x32_bf16 v[88:91], a[140:143], v[44:47], 0
  v_mfma_f32_16x16x32_bf16 v[88:91], a[136:139], v[40:43], v[88:91]
  s_xor_b32 s85, s85, 0x10000
  s_cmp_lt_u32 s76, 2
  s_cselect_b32 s87, 0, -1
  s_mov_b64 s[90:91], 0
  v_mfma_f32_16x16x32_bf16 v[88:91], a[132:135], v[36:39], v[88:91]
  v_mfma_f32_16x16x32_bf16 v[88:91], a[128:131], v[32:35], v[88:91]
  v_mfma_f32_16x16x32_bf16 v[96:99], a[128:131], v[48:51], v[208:211]
  v_mfma_f32_16x16x32_bf16 v[96:99], a[132:135], v[52:55], v[96:99]
  v_mfma_f32_16x16x32_bf16 v[96:99], a[136:139], v[56:59], v[96:99]
  v_mfma_f32_16x16x32_bf16 v[96:99], a[140:143], v[60:63], v[96:99]
  v_mfma_f32_16x16x32_bf16 v[104:107], a[140:143], v[76:79], 0
  v_mfma_f32_16x16x32_bf16 v[104:107], a[136:139], v[72:75], v[104:107]
  v_mfma_f32_16x16x32_bf16 v[104:107], a[132:135], v[68:71], v[104:107]
  v_mfma_f32_16x16x32_bf16 v[104:107], a[128:131], v[64:67], v[104:107]
  v_mfma_f32_16x16x32_bf16 v[108:111], a[144:147], v[64:67], 0
  ds_read_b128 a[128:131], v11 offset:57344
  v_mfma_f32_16x16x32_bf16 v[108:111], a[148:151], v[68:71], v[108:111]
  v_mfma_f32_16x16x32_bf16 v[108:111], a[152:155], v[72:75], v[108:111]
  v_mfma_f32_16x16x32_bf16 v[108:111], a[156:159], v[76:79], v[108:111]
  v_mfma_f32_16x16x32_bf16 v[100:103], a[156:159], v[60:63], v[212:215]
  ds_read_b128 a[132:135], v11 offset:58368
  v_mfma_f32_16x16x32_bf16 v[100:103], a[152:155], v[56:59], v[100:103]
L_padA9:
  s_cbranch_execz L_warm_done
  v_mfma_f32_16x16x32_bf16 v[100:103], a[148:151], v[52:55], v[100:103]
  v_mfma_f32_16x16x32_bf16 v[100:103], a[144:147], v[48:51], v[100:103]
  v_mfma_f32_16x16x32_bf16 v[92:95], a[144:147], v[32:35], 0
  ds_read_b128 a[136:139], v11 offset:59392
  v_mfma_f32_16x16x32_bf16 v[92:95], a[148:151], v[36:39], v[92:95]
  v_mfma_f32_16x16x32_bf16 v[92:95], a[152:155], v[40:43], v[92:95]
  v_mfma_f32_16x16x32_bf16 v[92:95], a[156:159], v[44:47], v[92:95]
  v_max3_f32 v252, v80, v81, v82
  v_mfma_f32_16x16x32_bf16 v[84:87], a[156:159], v[28:31], 0
  ds_read_b128 a[140:143], v11 offset:60416
  v_max3_f32 v253, v88, v89, v90
  v_mfma_f32_16x16x32_bf16 v[84:87], a[152:155], v[24:27], v[84:87]
  v_max3_f32 v254, v96, v97, v98
  v_mfma_f32_16x16x32_bf16 v[84:87], a[148:151], v[20:23], v[84:87]
  v_max3_f32 v255, v104, v105, v106
  v_mfma_f32_16x16x32_bf16 v[84:87], a[144:147], v[16:19], v[84:87]
  ds_read_b128 a[144:147], v11 offset:61440
  ds_read_b128 a[148:151], v11 offset:62464
  ds_read_b128 a[152:155], v11 offset:63488
  ds_read_b128 a[156:159], v11 offset:64512
  s_cmp_lg_u32 s92, 0
  s_cbranch_scc1 L_have_m
  v_max_f32 v252, v252, v83
  v_max_f32 v253, v253, v91
  v_max_f32 v254, v254, v99
  v_max_f32 v255, v255, v107
  v_max3_f32 v255, v255, v108, v109
  v_max3_f32 v254, v254, v100, v101
  v_max3_f32 v253, v253, v92, v93
  v_max3_f32 v252, v252, v84, v85
  v_max3_f32 v251, v255, v110, v111
  v_max3_f32 v250, v254, v102, v103
  v_max3_f32 v249, v253, v94, v95
  v_max3_f32 v248, v252, v86, v87
  v_mov_b32 v252, v248
  v_mov_b32 v253, v249
  v_mov_b32 v254, v250
  v_mov_b32 v255, v251
  v_permlane16_swap_b32 v248, v252
  v_permlane16_swap_b32 v249, v253
  v_permlane16_swap_b32 v250, v254
  v_permlane16_swap_b32 v251, v255
  v_max_f32 v248, v248, v252
  v_max_f32 v249, v249, v253
  v_max_f32 v250, v250, v254
  v_max_f32 v251, v251, v255
  v_mov_b32 v252, v248
  v_mov_b32 v253, v249
  v_mov_b32 v254, v250
  v_mov_b32 v255, v251
  v_permlane32_swap_b32 v248, v252
  v_permlane32_swap_b32 v249, v253
  v_permlane32_swap_b32 v250, v254
  v_permlane32_swap_b32 v251, v255
  v_max_f32 v248, v248, v252
  v_max_f32 v249, v249, v253
  v_max_f32 v250, v250, v254
  v_max_f32 v251, v251, v255
L_have_m1:
  v_sub_f32 v176, 0, v248
  v_sub_f32 v177, 0, v248
  v_sub_f32 v180, 0, v249
  v_sub_f32 v181, 0, v249
  v_sub_f32 v184, 0, v250
  v_sub_f32 v185, 0, v250
  v_sub_f32 v188, 0, v251
  v_sub_f32 v189, 0, v251
  v_pk_add_f32 v[80:81], v[80:81], v[176:177]
  v_pk_add_f32 v[82:83], v[82:83], v[176:177]
  v_pk_add_f32 v[88:89], v[88:89], v[180:181]
  v_pk_add_f32 v[90:91], v[90:91], v[180:181]
  v_pk_add_f32 v[96:97], v[96:97], v[184:185]
  v_pk_add_f32 v[98:99], v[98:99], v[184:185]
  v_pk_add_f32 v[104:105], v[104:105], v[188:189]
  v_pk_add_f32 v[106:107], v[106:107], v[188:189]
  v_pk_add_f32 v[84:85], v[84:85], v[176:177]
  v_pk_add_f32 v[86:87], v[86:87], v[176:177]
  v_pk_add_f32 v[92:93], v[92:93], v[180:181]
  v_pk_add_f32 v[94:95], v[94:95], v[180:181]
  v_pk_add_f32 v[100:101], v[100:101], v[184:185]
  v_pk_add_f32 v[102:103], v[102:103], v[184:185]
  v_pk_add_f32 v[108:109], v[108:109], v[188:189]
  v_pk_add_f32 v[110:111], v[110:111], v[188:189]
  v_exp_f32 v80, v80
  v_exp_f32 v81, v81
  v_pk_mov_b32 v[178:179], v[176:177], v[176:177] op_sel:[0,1]
  v_cvt_pk_bf16_f32 v144, v80, v81
  v_exp_f32 v82, v82
  v_exp_f32 v83, v83
  v_pk_mov_b32 v[182:183], v[180:181], v[180:181] op_sel:[0,1]
  v_cvt_pk_bf16_f32 v145, v82, v83
  v_exp_f32 v88, v88
  v_exp_f32 v89, v89
  v_pk_mov_b32 v[186:187], v[184:185], v[184:185] op_sel:[0,1]
  v_cvt_pk_bf16_f32 v148, v88, v89
  v_exp_f32 v90, v90
  v_exp_f32 v91, v91
  v_pk_mov_b32 v[190:191], v[188:189], v[188:189] op_sel:[0,1]
  v_cvt_pk_bf16_f32 v149, v90, v91
  v_exp_f32 v96, v96
  v_exp_f32 v97, v97
  v_pk_mov_b32 v[208:209], v[184:185], v[184:185] op_sel:[0,1]
  v_cvt_pk_bf16_f32 v152, v96, v97
  v_exp_f32 v98, v98
  v_exp_f32 v99, v99
  v_pk_mov_b32 v[210:211], v[184:185], v[184:185] op_sel:[0,1]
  v_cvt_pk_bf16_f32 v153, v98, v99
  v_exp_f32 v104, v104
  v_exp_f32 v105, v105
  v_pk_mov_b32 v[212:213], v[184:185], v[184:185] op_sel:[0,1]
  v_cvt_pk_bf16_f32 v156, v104, v105
  v_exp_f32 v106, v106
  v_exp_f32 v107, v107
  v_pk_mov_b32 v[214:215], v[184:185], v[184:185] op_sel:[0,1]
  v_cvt_pk_bf16_f32 v157, v106, v107
  v_exp_f32 v84, v84
  v_exp_f32 v85, v85
  v_mov_b32 v252, 0x53800000
  v_cvt_pk_bf16_f32 v146, v84, v85
  v_exp_f32 v86, v86
  v_exp_f32 v87, v87
  s_nop 0
  v_cvt_pk_bf16_f32 v147, v86, v87
  v_exp_f32 v92, v92
  v_exp_f32 v93, v93
  s_nop 0
  v_cvt_pk_bf16_f32 v150, v92, v93
  v_exp_f32 v94, v94
  v_exp_f32 v95, v95
  s_nop 0
  v_cvt_pk_bf16_f32 v151, v94, v95
  v_exp_f32 v100, v100
  v_exp_f32 v101, v101
  s_nop 0
  v_cvt_pk_bf16_f32 v154, v100, v101
  v_exp_f32 v102, v102
  v_exp_f32 v103, v103
  s_nop 0
  v_cvt_pk_bf16_f32 v155, v102, v103
  s_waitcnt vmcnt(0) lgkmcnt(0)
  s_sub_u32 s86, s80, 1
  s_cbranch_scc1 L_sfin
  .p2align 6
L_dual:
  s_cmp_eq_u32 s86, s87
  s_cbranch_scc1 L_dual_dg
L_dual_nd:
  s_add_u32 m0, s85, 0
  v_mfma_f32_16x16x32_bf16 v[112:115], a[128:131], v[16:19], v[176:179]
  s_barrier
  ds_read_b128 a[192:195], v10 offset:8192
  v_mfma_f32_16x16x32_bf16 v[112:115], a[132:135], v[20:23], v[112:115]
  s_add_u32 s84, s84, 0x10000
  ds_read_b128 a[196:199], v10 offset:9216
  v_mfma_f32_16x16x32_bf16 v[112:115], a[136:139], v[24:27], v[112:115]
  buffer_load_dwordx4 v2, s[4:7], s84 offen offset:0 sc1 lds
  v_mfma_f32_16x16x32_bf16 v[112:115], a[140:143], v[28:31], v[112:115]
  ds_read_b128 a[200:203], v10 offset:10240
  v_mfma_f32_16x16x32_bf16 v[120:123], a[140:143], v[44:47], v[180:183]
  ds_read_b128 a[204:207], v10 offset:11264
  v_mfma_f32_16x16x32_bf16 v[120:123], a[136:139], v[40:43], v[120:123]
  ds_read_b128 a[208:211], v10 offset:12288
  v_mfma_f32_16x16x32_bf16 v[120:123], a[132:135], v[36:39], v[120:123]
  ds_read_b128 a[212:215], v10 offset:13312
  v_mfma_f32_16x16x32_bf16 v[120:123], a[128:131], v[32:35], v[120:123]
  ds_read_b128 a[216:219], v10 offset:14336
  v_mfma_f32_16x16x32_bf16 v[128:131], a[128:131], v[48:51], v[184:187]
  v_exp_f32 v108, v108
  v_mfma_f32_16x16x32_bf16 v[128:131], a[132:135], v[52:55], v[128:131]
  v_exp_f32 v112, v112
  v_mfma_f32_16x16x32_bf16 v[128:131], a[136:139], v[56:59], v[128:131]
  v_exp_f32 v113, v113
  v_mfma_f32_16x16x32_bf16 v[128:131], a[140:143], v[60:63], v[128:131]
  v_exp_f32 v109, v109
  v_mfma_f32_16x16x32_bf16 v[136:139], a[140:143], v[76:79], v[188:191]
  v_exp_f32 v114, v114
  v_mfma_f32_16x16x32_bf16 v[136:139], a[136:139], v[72:75], v[136:139]
  v_exp_f32 v110, v110
  v_mfma_f32_16x16x32_bf16 v[136:139], a[132:135], v[68:71], v[136:139]
  v_exp_f32 v115, v115
  v_mfma_f32_16x16x32_bf16 v[136:139], a[128:131], v[64:67], v[136:139]
  buffer_load_dwordx4 v2, s[4:7], s84 offen offset:1024 sc1 lds
  v_mfma_f32_16x16x32_bf16 v[140:143], a[144:147], v[64:67], v[188:191]
  v_exp_f32 v111, v111
  v_mfma_f32_16x16x32_bf16 v[140:143], a[148:151], v[68:71], v[140:143]
  v_exp_f32 v120, v120
  v_mfma_f32_16x16x32_bf16 v[140:143], a[152:155], v[72:75], v[140:143]
  v_exp_f32 v121, v121
  v_mfma_f32_16x16x32_bf16 v[140:143], a[156:159], v[76:79], v[140:143]
  v_exp_f32 v122, v122
  v_mfma_f32_16x16x32_bf16 v[132:135], a[156:159], v[60:63], v[184:187]
  v_exp_f32 v123, v123
  v_mfma_f32_16x16x32_bf16 v[132:135], a[152:155], v[56:59], v[132:135]
  v_exp_f32 v128, v128
  v_mfma_f32_16x16x32_bf16 v[132:135], a[148:151], v[52:55], v[132:135]
  v_exp_f32 v129, v129
  v_mfma_f32_16x16x32_bf16 v[132:135], a[144:147], v[48:51], v[132:135]
  buffer_load_dwordx4 v2, s[4:7], s84 offen offset:2048 sc1 lds
  v_mfma_f32_16x16x32_bf16 v[124:127], a[144:147], v[32:35], v[180:183]
  v_exp_f32 v130, v130
  v_mfma_f32_16x16x32_bf16 v[124:127], a[148:151], v[36:39], v[124:127]
  ds_read_b128 a[220:223], v10 offset:15360
  v_cvt_pk_bf16_f32 v158, v108, v109
  v_mfma_f32_16x16x32_bf16 v[124:127], a[152:155], v[40:43], v[124:127]
  v_exp_f32 v131, v131
  v_mfma_f32_16x16x32_bf16 v[124:127], a[156:159], v[44:47], v[124:127]
  v_exp_f32 v136, v136
  v_mfma_f32_16x16x32_bf16 v[116:119], a[156:159], v[28:31], v[176:179]
  v_cvt_pk_bf16_f32 v159, v110, v111
  v_cvt_pk_bf16_f32 v160, v112, v113
  v_mfma_f32_16x16x32_bf16 v[116:119], a[152:155], v[24:27], v[116:119]
  v_exp_f32 v137, v137
  v_mfma_f32_16x16x32_bf16 v[116:119], a[148:151], v[20:23], v[116:119]
  ds_read_b128 a[224:227], v10 offset:16384
  v_cvt_pk_bf16_f32 v161, v114, v115
  v_mfma_f32_16x16x32_bf16 v[116:119], a[144:147], v[16:19], v[116:119]
  s_waitcnt lgkmcnt(8)
  v_exp_f32 v138, v138
  v_mfma_f32_16x16x32_bf16 v[80:83], a[192:195], v[16:19], v[176:179]
  s_waitcnt lgkmcnt(7)
  v_exp_f32 v139, v139
  v_mfma_f32_16x16x32_bf16 v[80:83], a[196:199], v[20:23], v[80:83]
  s_waitcnt lgkmcnt(6)
  buffer_load_dwordx4 v2, s[4:7], s84 offen offset:3072 sc1 lds
  v_mfma_f32_16x16x32_bf16 v[80:83], a[200:203], v[24:27], v[80:83]
  s_waitcnt lgkmcnt(5)
  ds_read_b128 a[160:163], v10 offset:0
  v_cvt_pk_bf16_f32 v164, v120, v121
  v_mfma_f32_16x16x32_bf16 v[80:83], a[204:207], v[28:31], v[80:83]
  s_add_u32 m0, s85, 4096
  v_exp_f32 v116, v116
  v_mfma_f32_16x16x32_bf16 v[88:91], a[204:207], v[44:47], v[180:183]
  v_exp_f32 v117, v117
  v_mfma_f32_16x16x32_bf16 v[88:91], a[200:203], v[40:43], v[88:91]
  v_exp_f32 v118, v118
  v_mfma_f32_16x16x32_bf16 v[88:91], a[196:199], v[36:39], v[88:91]
  v_cvt_pk_bf16_f32 v162, v116, v117
  v_cvt_pk_bf16_f32 v165, v122, v123
  v_mfma_f32_16x16x32_bf16 v[88:91], a[192:195], v[32:35], v[88:91]
  v_exp_f32 v119, v119
  v_mfma_f32_16x16x32_bf16 v[96:99], a[192:195], v[48:51], v[184:187]
  v_cvt_pk_bf16_f32 v163, v118, v119
  v_cvt_pk_bf16_f32 v168, v128, v129
  v_mfma_f32_16x16x32_bf16 v[96:99], a[196:199], v[52:55], v[96:99]
  v_exp_f32 v124, v124
  v_mfma_f32_16x16x32_bf16 v[96:99], a[200:203], v[56:59], v[96:99]
  v_exp_f32 v125, v125
  v_mfma_f32_16x16x32_bf16 v[96:99], a[204:207], v[60:63], v[96:99]
  buffer_load_dwordx4 v3, s[4:7], s84 offen offset:0 sc1 lds
  v_mfma_f32_16x16x32_bf16 v[104:107], a[204:207], v[76:79], v[188:191]
  v_exp_f32 v126, v126
  v_mfma_f32_16x16x32_bf16 v[104:107], a[200:203], v[72:75], v[104:107]
  v_cvt_pk_bf16_f32 v166, v124, v125
  v_cvt_pk_bf16_f32 v169, v130, v131
  v_mfma_f32_16x16x32_bf16 v[104:107], a[196:199], v[68:71], v[104:107]
  v_exp_f32 v127, v127
  v_mfma_f32_16x16x32_bf16 v[104:107], a[192:195], v[64:67], v[104:107]
  s_waitcnt lgkmcnt(5)
  v_exp_f32 v132, v132
  v_mfma_f32_16x16x32_bf16 v[108:111], a[208:211], v[64:67], v[188:191]
  s_waitcnt lgkmcnt(4)
  v_cvt_pk_bf16_f32 v167, v126, v127
  v_cvt_pk_bf16_f32 v172, v136, v137
  v_mfma_f32_16x16x32_bf16 v[108:111], a[212:215], v[68:71], v[108:111]
  s_waitcnt lgkmcnt(3)
  v_exp_f32 v133, v133
  v_mfma_f32_16x16x32_bf16 v[108:111], a[216:219], v[72:75], v[108:111]
  s_waitcnt lgkmcnt(2)
  v_cvt_pk_bf16_f32 v170, v132, v133
  v_cvt_pk_bf16_f32 v173, v138, v139
  v_mfma_f32_16x16x32_bf16 v[108:111], a[220:223], v[76:79], v[108:111]
  v_exp_f32 v134, v134
  v_mfma_f32_16x16x32_bf16 v[100:103], a[220:223], v[60:63], v[184:187]
  v_exp_f32 v135, v135
  v_mfma_f32_16x16x32_bf16 v[100:103], a[216:219], v[56:59], v[100:103]
  buffer_load_dwordx4 v3, s[4:7], s84 offen offset:1024 sc1 lds
  v_mfma_f32_16x16x32_bf16 v[100:103], a[212:215], v[52:55], v[100:103]
  v_exp_f32 v140, v140
  v_mfma_f32_16x16x32_bf16 v[100:103], a[208:211], v[48:51], v[100:103]
  ds_read_b128 a[228:231], v10 offset:17408
  v_cvt_pk_bf16_f32 v171, v134, v135
  v_mfma_f32_16x16x32_bf16 v[92:95], a[208:211], v[32:35], v[180:183]
  v_exp_f32 v141, v141
  v_mfma_f32_16x16x32_bf16 v[92:95], a[212:215], v[36:39], v[92:95]
  v_exp_f32 v142, v142
  v_mfma_f32_16x16x32_bf16 v[92:95], a[216:219], v[40:43], v[92:95]
  ds_read_b128 a[164:167], v10 offset:1024
  v_cvt_pk_bf16_f32 v174, v140, v141
  v_mfma_f32_16x16x32_bf16 v[92:95], a[220:223], v[44:47], v[92:95]
  v_exp_f32 v143, v143
  v_mfma_f32_16x16x32_bf16 v[84:87], a[220:223], v[28:31], v[176:179]
  ds_read_b128 a[232:235], v10 offset:18432
  v_cvt_pk_bf16_f32 v175, v142, v143
  v_mfma_f32_16x16x32_bf16 v[84:87], a[216:219], v[24:27], v[84:87]
  ds_read_b128 a[168:171], v10 offset:2048
  v_mfma_f32_16x16x32_bf16 v[84:87], a[212:215], v[20:23], v[84:87]
  ds_read_b128 a[236:239], v10 offset:19456
  v_mfma_f32_16x16x32_bf16 v[84:87], a[208:211], v[16:19], v[84:87]
  buffer_load_dwordx4 v3, s[4:7], s84 offen offset:2048 sc1 lds
  v_mfma_f32_16x16x32_bf16 v[224:227], v[240:243], v[144:147], v[224:227]
  v_exp_f32 v80, v80
  v_mfma_f32_16x16x32_bf16 v[224:227], v[240:243], v[160:163], v[224:227]
  ds_read_b128 a[172:175], v10 offset:3072
  v_mfma_f32_16x16x32_bf16 v[228:231], v[240:243], v[148:151], v[228:231]
  v_exp_f32 v81, v81
  v_mfma_f32_16x16x32_bf16 v[228:231], v[240:243], v[164:167], v[228:231]
  ds_read_b128 a[240:243], v10 offset:20480
  v_cvt_pk_bf16_f32 v192, v80, v81
  v_mfma_f32_16x16x32_bf16 v[232:235], v[240:243], v[152:155], v[232:235]
  ds_read_b128 a[176:179], v10 offset:4096
  v_mfma_f32_16x16x32_bf16 v[232:235], v[240:243], v[168:171], v[232:235]
  v_exp_f32 v82, v82
  v_mfma_f32_16x16x32_bf16 v[236:239], v[240:243], v[156:159], v[236:239]
  ds_read_b128 a[244:247], v10 offset:21504
  v_mfma_f32_16x16x32_bf16 v[236:239], v[240:243], v[172:175], v[236:239]
  s_waitcnt lgkmcnt(10)
  v_exp_f32 v83, v83
  v_mfma_f32_16x16x32_bf16 a[96:99], a[224:227], v[172:175], a[96:99]
  s_waitcnt lgkmcnt(9)
  ds_read_b128 a[180:183], v10 offset:5120
  v_cvt_pk_bf16_f32 v193, v82, v83
  v_mfma_f32_16x16x32_bf16 a[96:99], a[160:163], v[156:159], a[96:99]
  buffer_load_dwordx4 v3, s[4:7], s84 offen offset:3072 sc1 lds
  v_mfma_f32_16x16x32_bf16 a[64:67], a[160:163], v[152:155], a[64:67]
  s_add_u32 m0, s85, 8192
  v_exp_f32 v88, v88
  v_mfma_f32_16x16x32_bf16 a[64:67], a[224:227], v[168:171], a[64:67]
  ds_read_b128 a[248:251], v10 offset:22528
  v_mfma_f32_16x16x32_bf16 a[32:35], a[224:227], v[164:167], a[32:35]
  v_exp_f32 v89, v89
  v_mfma_f32_16x16x32_bf16 a[32:35], a[160:163], v[148:151], a[32:35]
  ds_read_b128 a[184:187], v10 offset:6144
  v_cvt_pk_bf16_f32 v196, v88, v89
  v_mfma_f32_16x16x32_bf16 a[0:3], a[160:163], v[144:147], a[0:3]
  ds_read_b128 a[252:255], v10 offset:23552
  v_mfma_f32_16x16x32_bf16 a[0:3], a[224:227], v[160:163], a[0:3]
  s_waitcnt lgkmcnt(12)
  v_exp_f32 v90, v90
  v_mfma_f32_16x16x32_bf16 a[4:7], a[228:231], v[160:163], a[4:7]
  s_waitcnt lgkmcnt(11)
  ds_read_b128 a[188:191], v10 offset:7168
  v_mfma_f32_16x16x32_bf16 a[4:7], a[164:167], v[144:147], a[4:7]
  v_exp_f32 v91, v91
  v_mfma_f32_16x16x32_bf16 a[36:39], a[164:167], v[148:151], a[36:39]
  ds_read_b128 a[128:131], v10 offset:24576
  v_cvt_pk_bf16_f32 v197, v90, v91
  v_mfma_f32_16x16x32_bf16 a[36:39], a[228:231], v[164:167], a[36:39]
  buffer_load_dwordx4 v4, s[4:7], s84 offen offset:0 sc1 lds
  v_mfma_f32_16x16x32_bf16 a[68:71], a[228:231], v[168:171], a[68:71]
  v_exp_f32 v96, v96
  v_mfma_f32_16x16x32_bf16 a[68:71], a[164:167], v[152:155], a[68:71]
  ds_read_b128 a[132:135], v10 offset:25600
  v_mfma_f32_16x16x32_bf16 a[100:103], a[164:167], v[156:159], a[100:103]
  v_exp_f32 v97, v97
  v_mfma_f32_16x16x32_bf16 a[100:103], a[228:231], v[172:175], a[100:103]
  s_waitcnt lgkmcnt(13)
  ds_read_b128 a[136:139], v10 offset:26624
  v_cvt_pk_bf16_f32 v200, v96, v97
  v_mfma_f32_16x16x32_bf16 a[104:107], a[232:235], v[172:175], a[104:107]
  s_waitcnt lgkmcnt(13)
  ds_read_b128 a[140:143], v10 offset:27648
  v_mfma_f32_16x16x32_bf16 a[104:107], a[168:171], v[156:159], a[104:107]
  v_exp_f32 v98, v98
  v_mfma_f32_16x16x32_bf16 a[72:75], a[168:171], v[152:155], a[72:75]
  v_mfma_f32_16x16x32_bf16 a[72:75], a[232:235], v[168:171], a[72:75]
  v_exp_f32 v99, v99
  v_mfma_f32_16x16x32_bf16 a[40:43], a[232:235], v[164:167], a[40:43]
  ds_read_b128 a[144:147], v10 offset:28672
  v_cvt_pk_bf16_f32 v201, v98, v99
  v_mfma_f32_16x16x32_bf16 a[40:43], a[168:171], v[148:151], a[40:43]
  buffer_load_dwordx4 v4, s[4:7], s84 offen offset:1024 sc1 lds
  v_mfma_f32_16x16x32_bf16 a[8:11], a[168:171], v[144:147], a[8:11]
  v_exp_f32 v104, v104
  v_mfma_f32_16x16x32_bf16 a[8:11], a[232:235], v[160:163], a[8:11]
  s_waitcnt lgkmcnt(14)
  ds_read_b128 a[148:151], v10 offset:29696
  v_mfma_f32_16x16x32_bf16 a[12:15], a[236:239], v[160:163], a[12:15]
  s_waitcnt lgkmcnt(14)
  v_exp_f32 v105, v105
  v_mfma_f32_16x16x32_bf16 a[12:15], a[172:175], v[144:147], a[12:15]
  ds_read_b128 a[152:155], v10 offset:30720
  v_cvt_pk_bf16_f32 v204, v104, v105
  v_mfma_f32_16x16x32_bf16 a[44:47], a[172:175], v[148:151], a[44:47]
  ds_read_b128 a[156:159], v10 offset:31744
  v_mfma_f32_16x16x32_bf16 a[44:47], a[236:239], v[164:167], a[44:47]
  v_exp_f32 v106, v106
  v_mfma_f32_16x16x32_bf16 a[76:79], a[236:239], v[168:171], a[76:79]
  v_mfma_f32_16x16x32_bf16 a[76:79], a[172:175], v[152:155], a[76:79]
  v_exp_f32 v107, v107
  v_mfma_f32_16x16x32_bf16 a[108:111], a[172:175], v[156:159], a[108:111]
  v_cvt_pk_bf16_f32 v205, v106, v107
  v_mfma_f32_16x16x32_bf16 a[108:111], a[236:239], v[172:175], a[108:111]
  s_waitcnt lgkmcnt(15)
  v_mfma_f32_16x16x32_bf16 a[112:115], a[240:243], v[172:175], a[112:115]
  s_waitcnt lgkmcnt(14)
  v_exp_f32 v84, v84
  v_mfma_f32_16x16x32_bf16 a[112:115], a[176:179], v[156:159], a[112:115]
  buffer_load_dwordx4 v4, s[4:7], s84 offen offset:2048 sc1 lds
  v_mfma_f32_16x16x32_bf16 a[80:83], a[176:179], v[152:155], a[80:83]
  v_exp_f32 v85, v85
  v_mfma_f32_16x16x32_bf16 a[80:83], a[240:243], v[168:171], a[80:83]
  v_cvt_pk_bf16_f32 v194, v84, v85
  v_mfma_f32_16x16x32_bf16 a[48:51], a[240:243], v[164:167], a[48:51]
  ds_read_b128 a[192:195], v10 offset:40960
  v_mfma_f32_16x16x32_bf16 a[48:51], a[176:179], v[148:151], a[48:51]
  v_exp_f32 v86, v86
  v_mfma_f32_16x16x32_bf16 a[16:19], a[176:179], v[144:147], a[16:19]
  ds_read_b128 a[196:199], v10 offset:41984
  v_mfma_f32_16x16x32_bf16 a[16:19], a[240:243], v[160:163], a[16:19]
  s_waitcnt lgkmcnt(15)
  v_exp_f32 v87, v87
  v_mfma_f32_16x16x32_bf16 a[20:23], a[244:247], v[160:163], a[20:23]
  s_waitcnt lgkmcnt(14)
  ds_read_b128 a[200:203], v10 offset:43008
  v_cvt_pk_bf16_f32 v195, v86, v87
  v_mfma_f32_16x16x32_bf16 a[20:23], a[180:183], v[144:147], a[20:23]
  ds_read_b128 a[204:207], v10 offset:44032
  v_mfma_f32_16x16x32_bf16 a[52:55], a[180:183], v[148:151], a[52:55]
  v_exp_f32 v92, v92
  v_mfma_f32_16x16x32_bf16 a[52:55], a[244:247], v[164:167], a[52:55]
  buffer_load_dwordx4 v4, s[4:7], s84 offen offset:3072 sc1 lds
  v_mfma_f32_16x16x32_bf16 a[84:87], a[244:247], v[168:171], a[84:87]
  s_add_u32 m0, s85, 12288
  v_exp_f32 v93, v93
  v_mfma_f32_16x16x32_bf16 a[84:87], a[180:183], v[152:155], a[84:87]
  v_cvt_pk_bf16_f32 v198, v92, v93
  v_mfma_f32_16x16x32_bf16 a[116:119], a[180:183], v[156:159], a[116:119]
  v_mfma_f32_16x16x32_bf16 a[116:119], a[244:247], v[172:175], a[116:119]
  s_waitcnt lgkmcnt(15)
  v_exp_f32 v94, v94
  v_mfma_f32_16x16x32_bf16 a[120:123], a[248:251], v[172:175], a[120:123]
  s_waitcnt lgkmcnt(14)
  v_mfma_f32_16x16x32_bf16 a[120:123], a[184:187], v[156:159], a[120:123]
  v_exp_f32 v95, v95
  v_mfma_f32_16x16x32_bf16 a[88:91], a[184:187], v[152:155], a[88:91]
  v_cvt_pk_bf16_f32 v199, v94, v95
  v_mfma_f32_16x16x32_bf16 a[88:91], a[248:251], v[168:171], a[88:91]
  v_mfma_f32_16x16x32_bf16 a[56:59], a[248:251], v[164:167], a[56:59]
  v_exp_f32 v100, v100
  v_mfma_f32_16x16x32_bf16 a[56:59], a[184:187], v[148:151], a[56:59]
  buffer_load_dwordx4 v5, s[4:7], s84 offen offset:0 sc1 lds
  v_mfma_f32_16x16x32_bf16 a[24:27], a[184:187], v[144:147], a[24:27]
  v_exp_f32 v101, v101
  v_mfma_f32_16x16x32_bf16 a[24:27], a[248:251], v[160:163], a[24:27]
  s_waitcnt lgkmcnt(13)
  ds_read_b128 a[208:211], v10 offset:45056
  v_cvt_pk_bf16_f32 v202, v100, v101
  v_mfma_f32_16x16x32_bf16 a[28:31], a[252:255], v[160:163], a[28:31]
  s_waitcnt lgkmcnt(13)
  ds_read_b128 a[212:215], v10 offset:46080
  v_mfma_f32_16x16x32_bf16 a[28:31], a[188:191], v[144:147], a[28:31]
  v_exp_f32 v102, v102
  v_mfma_f32_16x16x32_bf16 a[60:63], a[188:191], v[148:151], a[60:63]
  ds_read_b128 a[216:219], v10 offset:47104
  v_mfma_f32_16x16x32_bf16 a[60:63], a[252:255], v[164:167], a[60:63]
  v_exp_f32 v103, v103
  v_mfma_f32_16x16x32_bf16 a[92:95], a[252:255], v[168:171], a[92:95]
  ds_read_b128 a[220:223], v10 offset:48128
  v_cvt_pk_bf16_f32 v203, v102, v103
  v_mfma_f32_16x16x32_bf16 a[92:95], a[188:191], v[152:155], a[92:95]
  v_mfma_f32_16x16x32_bf16 a[124:127], a[188:191], v[156:159], a[124:127]
  v_exp_f32 v108, v108
  v_mfma_f32_16x16x32_bf16 a[124:127], a[252:255], v[172:175], a[124:127]
  s_waitcnt lgkmcnt(15)
  buffer_load_dwordx4 v5, s[4:7], s84 offen offset:1024 sc1 lds
  v_mfma_f32_16x16x32_bf16 v[112:115], a[128:131], v[16:19], v[176:179]
  s_waitcnt lgkmcnt(14)
  v_exp_f32 v109, v109
  v_mfma_f32_16x16x32_bf16 v[112:115], a[132:135], v[20:23], v[112:115]
  s_waitcnt lgkmcnt(13)
  v_cvt_pk_bf16_f32 v206, v108, v109
  v_mfma_f32_16x16x32_bf16 v[112:115], a[136:139], v[24:27], v[112:115]
  s_waitcnt lgkmcnt(12)
  v_mfma_f32_16x16x32_bf16 v[112:115], a[140:143], v[28:31], v[112:115]
  v_exp_f32 v110, v110
  v_mfma_f32_16x16x32_bf16 v[120:123], a[140:143], v[44:47], v[180:183]
  v_mfma_f32_16x16x32_bf16 v[120:123], a[136:139], v[40:43], v[120:123]
  v_exp_f32 v111, v111
  v_mfma_f32_16x16x32_bf16 v[120:123], a[132:135], v[36:39], v[120:123]
  v_cvt_pk_bf16_f32 v207, v110, v111
  v_mfma_f32_16x16x32_bf16 v[120:123], a[128:131], v[32:35], v[120:123]
  v_mfma_f32_16x16x32_bf16 v[128:131], a[128:131], v[48:51], v[184:187]
  buffer_load_dwordx4 v5, s[4:7], s84 offen offset:2048 sc1 lds
  v_mfma_f32_16x16x32_bf16 v[128:131], a[132:135], v[52:55], v[128:131]
  v_mfma_f32_16x16x32_bf16 v[128:131], a[136:139], v[56:59], v[128:131]
  v_mfma_f32_16x16x32_bf16 v[128:131], a[140:143], v[60:63], v[128:131]
  v_mfma_f32_16x16x32_bf16 v[136:139], a[140:143], v[76:79], v[188:191]
  v_exp_f32 v112, v112
  v_mfma_f32_16x16x32_bf16 v[136:139], a[136:139], v[72:75], v[136:139]
  v_exp_f32 v113, v113
  v_mfma_f32_16x16x32_bf16 v[136:139], a[132:135], v[68:71], v[136:139]
  ds_read_b128 a[224:227], v10 offset:49152
  v_cvt_pk_bf16_f32 v160, v112, v113
  v_mfma_f32_16x16x32_bf16 v[136:139], a[128:131], v[64:67], v[136:139]
  s_waitcnt lgkmcnt(12)
  v_exp_f32 v114, v114
  v_mfma_f32_16x16x32_bf16 v[140:143], a[144:147], v[64:67], v[188:191]
  s_waitcnt lgkmcnt(11)
  v_exp_f32 v115, v115
  v_mfma_f32_16x16x32_bf16 v[140:143], a[148:151], v[68:71], v[140:143]
  s_waitcnt lgkmcnt(10)
  ds_read_b128 a[160:163], v10 offset:32768
  v_cvt_pk_bf16_f32 v161, v114, v115
  v_mfma_f32_16x16x32_bf16 v[140:143], a[152:155], v[72:75], v[140:143]
  s_waitcnt lgkmcnt(10)
  v_exp_f32 v120, v120
  v_mfma_f32_16x16x32_bf16 v[140:143], a[156:159], v[76:79], v[140:143]
  v_exp_f32 v121, v121
  v_mfma_f32_16x16x32_bf16 v[132:135], a[156:159], v[60:63], v[184:187]
  buffer_load_dwordx4 v5, s[4:7], s84 offen offset:3072 sc1 lds
  v_mfma_f32_16x16x32_bf16 v[132:135], a[152:155], v[56:59], v[132:135]
  s_xor_b32 s85, s85, 0x10000
  v_exp_f32 v122, v122
  v_mfma_f32_16x16x32_bf16 v[132:135], a[148:151], v[52:55], v[132:135]
  v_exp_f32 v123, v123
  v_mfma_f32_16x16x32_bf16 v[132:135], a[144:147], v[48:51], v[132:135]
  v_cvt_pk_bf16_f32 v164, v120, v121
  v_cvt_pk_bf16_f32 v165, v122, v123
  v_mfma_f32_16x16x32_bf16 v[124:127], a[144:147], v[32:35], v[180:183]
  v_exp_f32 v128, v128
  v_mfma_f32_16x16x32_bf16 v[124:127], a[148:151], v[36:39], v[124:127]
  v_exp_f32 v129, v129
  v_mfma_f32_16x16x32_bf16 v[124:127], a[152:155], v[40:43], v[124:127]
  ds_read_b128 a[228:231], v10 offset:50176
  v_cvt_pk_bf16_f32 v168, v128, v129
  v_mfma_f32_16x16x32_bf16 v[124:127], a[156:159], v[44:47], v[124:127]
  v_exp_f32 v130, v130
  v_mfma_f32_16x16x32_bf16 v[116:119], a[156:159], v[28:31], v[176:179]
  v_exp_f32 v131, v131
  v_mfma_f32_16x16x32_bf16 v[116:119], a[152:155], v[24:27], v[116:119]
  ds_read_b128 a[164:167], v10 offset:33792
  v_cvt_pk_bf16_f32 v169, v130, v131
  v_mfma_f32_16x16x32_bf16 v[116:119], a[148:151], v[20:23], v[116:119]
  v_exp_f32 v136, v136
  v_mfma_f32_16x16x32_bf16 v[116:119], a[144:147], v[16:19], v[116:119]
  s_waitcnt lgkmcnt(11)
  v_exp_f32 v137, v137
  v_mfma_f32_16x16x32_bf16 v[80:83], a[192:195], v[16:19], v[176:179]
  s_waitcnt lgkmcnt(10)
  ds_read_b128 a[232:235], v10 offset:51200
  v_cvt_pk_bf16_f32 v172, v136, v137
  v_mfma_f32_16x16x32_bf16 v[80:83], a[196:199], v[20:23], v[80:83]
  s_waitcnt lgkmcnt(10)
  v_exp_f32 v138, v138
  v_mfma_f32_16x16x32_bf16 v[80:83], a[200:203], v[24:27], v[80:83]
  s_waitcnt lgkmcnt(9)
  v_exp_f32 v139, v139
  v_mfma_f32_16x16x32_bf16 v[80:83], a[204:207], v[28:31], v[80:83]
  ds_read_b128 a[168:171], v10 offset:34816
  v_cvt_pk_bf16_f32 v173, v138, v139
  v_mfma_f32_16x16x32_bf16 v[88:91], a[204:207], v[44:47], v[180:183]
  v_exp_f32 v116, v116
  v_mfma_f32_16x16x32_bf16 v[88:91], a[200:203], v[40:43], v[88:91]
  ds_read_b128 a[236:239], v10 offset:52224
  v_mfma_f32_16x16x32_bf16 v[88:91], a[196:199], v[36:39], v[88:91]
  v_exp_f32 v117, v117
  v_mfma_f32_16x16x32_bf16 v[88:91], a[192:195], v[32:35], v[88:91]
  v_exp_f32 v118, v118
  v_mfma_f32_16x16x32_bf16 v[96:99], a[192:195], v[48:51], v[208:211]
  ds_read_b128 a[172:175], v10 offset:35840
  v_cvt_pk_bf16_f32 v162, v116, v117
  v_mfma_f32_16x16x32_bf16 v[96:99], a[196:199], v[52:55], v[96:99]
  v_exp_f32 v119, v119
  v_mfma_f32_16x16x32_bf16 v[96:99], a[200:203], v[56:59], v[96:99]
  v_exp_f32 v124, v124
  v_mfma_f32_16x16x32_bf16 v[96:99], a[204:207], v[60:63], v[96:99]
  v_cvt_pk_bf16_f32 v163, v118, v119
  v_mfma_f32_16x16x32_bf16 v[104:107], a[204:207], v[76:79], v[188:191]
  v_exp_f32 v125, v125
  v_mfma_f32_16x16x32_bf16 v[104:107], a[200:203], v[72:75], v[104:107]
  v_exp_f32 v126, v126
  v_mfma_f32_16x16x32_bf16 v[104:107], a[196:199], v[68:71], v[104:107]
  ds_read_b128 a[240:243], v10 offset:53248
  v_cvt_pk_bf16_f32 v166, v124, v125
  v_mfma_f32_16x16x32_bf16 v[104:107], a[192:195], v[64:67], v[104:107]
  s_waitcnt lgkmcnt(12)
  v_exp_f32 v127, v127
  v_mfma_f32_16x16x32_bf16 v[108:111], a[208:211], v[64:67], v[188:191]
  s_waitcnt lgkmcnt(11)
  v_exp_f32 v132, v132
  v_mfma_f32_16x16x32_bf16 v[108:111], a[212:215], v[68:71], v[108:111]
  s_waitcnt lgkmcnt(10)
  ds_read_b128 a[176:179], v10 offset:36864
  v_cvt_pk_bf16_f32 v167, v126, v127
  v_mfma_f32_16x16x32_bf16 v[108:111], a[216:219], v[72:75], v[108:111]
  s_waitcnt lgkmcnt(10)
  v_exp_f32 v133, v133
  v_mfma_f32_16x16x32_bf16 v[108:111], a[220:223], v[76:79], v[108:111]
  v_exp_f32 v134, v134
  v_mfma_f32_16x16x32_bf16 v[100:103], a[220:223], v[60:63], v[212:215]
  ds_read_b128 a[128:131], v10 offset:57344
  v_cvt_pk_bf16_f32 v170, v132, v133
  v_mfma_f32_16x16x32_bf16 v[100:103], a[216:219], v[56:59], v[100:103]
  v_exp_f32 v135, v135
  v_mfma_f32_16x16x32_bf16 v[100:103], a[212:215], v[52:55], v[100:103]
  v_exp_f32 v140, v140
  v_mfma_f32_16x16x32_bf16 v[100:103], a[208:211], v[48:51], v[100:103]
  ds_read_b128 a[244:247], v10 offset:54272
  v_cvt_pk_bf16_f32 v171, v134, v135
  v_mfma_f32_16x16x32_bf16 v[92:95], a[208:211], v[32:35], v[180:183]
  v_exp_f32 v141, v141
  v_mfma_f32_16x16x32_bf16 v[92:95], a[212:215], v[36:39], v[92:95]
  v_exp_f32 v142, v142
  v_mfma_f32_16x16x32_bf16 v[92:95], a[216:219], v[40:43], v[92:95]
  ds_read_b128 a[180:183], v10 offset:37888
  v_cvt_pk_bf16_f32 v174, v140, v141
  v_mfma_f32_16x16x32_bf16 v[92:95], a[220:223], v[44:47], v[92:95]
  v_exp_f32 v143, v143
  v_mfma_f32_16x16x32_bf16 v[84:87], a[220:223], v[28:31], v[176:179]
  ds_read_b128 a[132:135], v10 offset:58368
  v_cvt_pk_bf16_f32 v175, v142, v143
  v_mfma_f32_16x16x32_bf16 v[84:87], a[216:219], v[24:27], v[84:87]
  ds_read_b128 a[136:139], v10 offset:59392
  v_mfma_f32_16x16x32_bf16 v[84:87], a[212:215], v[20:23], v[84:87]
  ds_read_b128 a[248:251], v10 offset:55296
  v_mfma_f32_16x16x32_bf16 v[84:87], a[208:211], v[16:19], v[84:87]
  ds_read_b128 a[184:187], v10 offset:38912
  v_mfma_f32_16x16x32_bf16 v[224:227], v[240:243], v[192:195], v[224:227]
L_padA10:
  s_cbranch_execz L_warm_done
  v_exp_f32 v80, v80
  v_mfma_f32_16x16x32_bf16 v[224:227], v[240:243], v[160:163], v[224:227]
  ds_read_b128 a[140:143], v10 offset:60416
  v_mfma_f32_16x16x32_bf16 v[228:231], v[240:243], v[196:199], v[228:231]
  v_exp_f32 v81, v81
  v_mfma_f32_16x16x32_bf16 v[228:231], v[240:243], v[164:167], v[228:231]
  v_cvt_pk_bf16_f32 v144, v80, v81
  v_mfma_f32_16x16x32_bf16 v[232:235], v[240:243], v[200:203], v[232:235]
  ds_read_b128 a[144:147], v10 offset:61440
  v_mfma_f32_16x16x32_bf16 v[232:235], v[240:243], v[168:171], v[232:235]
  v_exp_f32 v82, v82
  v_mfma_f32_16x16x32_bf16 v[236:239], v[240:243], v[204:207], v[236:239]
  ds_read_b128 a[252:255], v10 offset:56320
  v_mfma_f32_16x16x32_bf16 v[236:239], v[240:243], v[172:175], v[236:239]
  s_waitcnt lgkmcnt(15)
  v_exp_f32 v83, v83
  v_mfma_f32_16x16x32_bf16 a[96:99], a[224:227], v[172:175], a[96:99]
  ds_read_b128 a[188:191], v10 offset:39936
  v_cvt_pk_bf16_f32 v145, v82, v83
  v_mfma_f32_16x16x32_bf16 a[96:99], a[160:163], v[204:207], a[96:99]
  ds_read_b128 a[148:151], v10 offset:62464
  v_mfma_f32_16x16x32_bf16 a[64:67], a[160:163], v[200:203], a[64:67]
  v_exp_f32 v88, v88
  v_mfma_f32_16x16x32_bf16 a[64:67], a[224:227], v[168:171], a[64:67]
  v_mfma_f32_16x16x32_bf16 a[32:35], a[224:227], v[164:167], a[32:35]
  v_exp_f32 v89, v89
  v_mfma_f32_16x16x32_bf16 a[32:35], a[160:163], v[196:199], a[32:35]
  ds_read_b128 a[152:155], v10 offset:63488
  v_cvt_pk_bf16_f32 v148, v88, v89
  v_mfma_f32_16x16x32_bf16 a[0:3], a[160:163], v[192:195], a[0:3]
  v_mfma_f32_16x16x32_bf16 a[0:3], a[224:227], v[160:163], a[0:3]
  v_exp_f32 v90, v90
  v_mfma_f32_16x16x32_bf16 a[4:7], a[228:231], v[160:163], a[4:7]
  ds_read_b128 a[156:159], v10 offset:64512
  v_mfma_f32_16x16x32_bf16 a[4:7], a[164:167], v[192:195], a[4:7]
  v_exp_f32 v91, v91
  v_mfma_f32_16x16x32_bf16 a[36:39], a[164:167], v[196:199], a[36:39]
  v_cvt_pk_bf16_f32 v149, v90, v91
  v_xor_b32 v10, 0x10000, v10
  v_mfma_f32_16x16x32_bf16 a[36:39], a[228:231], v[164:167], a[36:39]
  v_mfma_f32_16x16x32_bf16 a[68:71], a[228:231], v[168:171], a[68:71]
  v_exp_f32 v96, v96
  v_mfma_f32_16x16x32_bf16 a[68:71], a[164:167], v[200:203], a[68:71]
  v_mfma_f32_16x16x32_bf16 a[100:103], a[164:167], v[204:207], a[100:103]
  v_exp_f32 v97, v97
  v_mfma_f32_16x16x32_bf16 a[100:103], a[228:231], v[172:175], a[100:103]
  v_cvt_pk_bf16_f32 v152, v96, v97
  v_mfma_f32_16x16x32_bf16 a[104:107], a[232:235], v[172:175], a[104:107]
  s_waitcnt lgkmcnt(15)
  v_mfma_f32_16x16x32_bf16 a[104:107], a[168:171], v[204:207], a[104:107]
  v_exp_f32 v98, v98
  v_mfma_f32_16x16x32_bf16 a[72:75], a[168:171], v[200:203], a[72:75]
  v_mfma_f32_16x16x32_bf16 a[72:75], a[232:235], v[168:171], a[72:75]
  v_exp_f32 v99, v99
  v_mfma_f32_16x16x32_bf16 a[40:43], a[232:235], v[164:167], a[40:43]
  v_cvt_pk_bf16_f32 v153, v98, v99
  v_mfma_f32_16x16x32_bf16 a[40:43], a[168:171], v[196:199], a[40:43]
  v_mfma_f32_16x16x32_bf16 a[8:11], a[168:171], v[192:195], a[8:11]
  v_exp_f32 v104, v104
  v_mfma_f32_16x16x32_bf16 a[8:11], a[232:235], v[160:163], a[8:11]
  v_mfma_f32_16x16x32_bf16 a[12:15], a[236:239], v[160:163], a[12:15]
  v_exp_f32 v105, v105
  v_mfma_f32_16x16x32_bf16 a[12:15], a[172:175], v[192:195], a[12:15]
  v_cvt_pk_bf16_f32 v156, v104, v105
  v_mfma_f32_16x16x32_bf16 a[44:47], a[172:175], v[196:199], a[44:47]
  v_mfma_f32_16x16x32_bf16 a[44:47], a[236:239], v[164:167], a[44:47]
  v_exp_f32 v106, v106
  v_mfma_f32_16x16x32_bf16 a[76:79], a[236:239], v[168:171], a[76:79]
  v_mfma_f32_16x16x32_bf16 a[76:79], a[172:175], v[200:203], a[76:79]
  v_exp_f32 v107, v107
  v_mfma_f32_16x16x32_bf16 a[108:111], a[172:175], v[204:207], a[108:111]
  v_cvt_pk_bf16_f32 v157, v106, v107
  v_mfma_f32_16x16x32_bf16 a[108:111], a[236:239], v[172:175], a[108:111]
  v_mfma_f32_16x16x32_bf16 a[112:115], a[240:243], v[172:175], a[112:115]
  s_waitcnt lgkmcnt(14)
  v_exp_f32 v84, v84
  v_mfma_f32_16x16x32_bf16 a[112:115], a[176:179], v[204:207], a[112:115]
  v_mfma_f32_16x16x32_bf16 a[80:83], a[176:179], v[200:203], a[80:83]
  v_exp_f32 v85, v85
  v_mfma_f32_16x16x32_bf16 a[80:83], a[240:243], v[168:171], a[80:83]
  v_cvt_pk_bf16_f32 v146, v84, v85
  v_mfma_f32_16x16x32_bf16 a[48:51], a[240:243], v[164:167], a[48:51]
  v_mfma_f32_16x16x32_bf16 a[48:51], a[176:179], v[196:199], a[48:51]
  v_exp_f32 v86, v86
  v_mfma_f32_16x16x32_bf16 a[16:19], a[176:179], v[192:195], a[16:19]
  v_mfma_f32_16x16x32_bf16 a[16:19], a[240:243], v[160:163], a[16:19]
  s_waitcnt lgkmcnt(12)
  v_exp_f32 v87, v87
  v_mfma_f32_16x16x32_bf16 a[20:23], a[244:247], v[160:163], a[20:23]
  s_waitcnt lgkmcnt(11)
  v_cvt_pk_bf16_f32 v147, v86, v87
  v_mfma_f32_16x16x32_bf16 a[20:23], a[180:183], v[192:195], a[20:23]
  v_mfma_f32_16x16x32_bf16 a[52:55], a[180:183], v[196:199], a[52:55]
  v_exp_f32 v92, v92
  v_mfma_f32_16x16x32_bf16 a[52:55], a[244:247], v[164:167], a[52:55]
  v_mfma_f32_16x16x32_bf16 a[84:87], a[244:247], v[168:171], a[84:87]
  v_exp_f32 v93, v93
  v_mfma_f32_16x16x32_bf16 a[84:87], a[180:183], v[200:203], a[84:87]
  v_cvt_pk_bf16_f32 v150, v92, v93
  v_mfma_f32_16x16x32_bf16 a[116:119], a[180:183], v[204:207], a[116:119]
  v_mfma_f32_16x16x32_bf16 a[116:119], a[244:247], v[172:175], a[116:119]
  s_waitcnt lgkmcnt(8)
  v_exp_f32 v94, v94
  v_mfma_f32_16x16x32_bf16 a[120:123], a[248:251], v[172:175], a[120:123]
  s_waitcnt lgkmcnt(7)
  v_mfma_f32_16x16x32_bf16 a[120:123], a[184:187], v[204:207], a[120:123]
  v_exp_f32 v95, v95
  v_mfma_f32_16x16x32_bf16 a[88:91], a[184:187], v[200:203], a[88:91]
  v_cvt_pk_bf16_f32 v151, v94, v95
  v_mfma_f32_16x16x32_bf16 a[88:91], a[248:251], v[168:171], a[88:91]
  v_mfma_f32_16x16x32_bf16 a[56:59], a[248:251], v[164:167], a[56:59]
  v_exp_f32 v100, v100
  v_mfma_f32_16x16x32_bf16 a[56:59], a[184:187], v[196:199], a[56:59]
  v_mfma_f32_16x16x32_bf16 a[24:27], a[184:187], v[192:195], a[24:27]
  v_exp_f32 v101, v101
  v_mfma_f32_16x16x32_bf16 a[24:27], a[248:251], v[160:163], a[24:27]
  s_waitcnt lgkmcnt(4)
  v_cvt_pk_bf16_f32 v154, v100, v101
  v_mfma_f32_16x16x32_bf16 a[28:31], a[252:255], v[160:163], a[28:31]
  s_waitcnt lgkmcnt(3)
  v_mfma_f32_16x16x32_bf16 a[28:31], a[188:191], v[192:195], a[28:31]
  s_sub_u32 s86, s86, 1
  v_exp_f32 v102, v102
  v_mfma_f32_16x16x32_bf16 a[60:63], a[188:191], v[196:199], a[60:63]
  v_mfma_f32_16x16x32_bf16 a[60:63], a[252:255], v[164:167], a[60:63]
  v_exp_f32 v103, v103
  v_mfma_f32_16x16x32_bf16 a[92:95], a[252:255], v[168:171], a[92:95]
  v_cvt_pk_bf16_f32 v155, v102, v103
  v_mfma_f32_16x16x32_bf16 a[92:95], a[188:191], v[200:203], a[92:95]
  v_mfma_f32_16x16x32_bf16 a[124:127], a[188:191], v[204:207], a[124:127]
  s_waitcnt vmcnt(0) lgkmcnt(0)
  v_mfma_f32_16x16x32_bf16 a[124:127], a[252:255], v[172:175], a[124:127]
  buffer_store_dword v9, v8, s[36:39], 0 offen sc1
  s_cbranch_scc0 L_dual
L_sfin:
  s_nop 0
L_padA11:
  s_cbranch_execz L_warm_done
  s_cmp_eq_u32 s76, 0
  s_cbranch_scc1 L_sfin0
  s_cmp_eq_u32 s76, 1
  s_cbranch_scc1 L_sfin1
  s_cmp_eq_u32 s76, 2
  s_cbranch_scc1 L_sfin2
  v_sub_f32 v216, v244, v250
  v_sub_f32 v217, v245, v250
  v_sub_f32 v218, v246, v250
  v_sub_f32 v219, v247, v250
  s_add_u32 m0, s85, 0
  v_mfma_f32_16x16x32_bf16 v[112:115], a[128:131], v[16:19], v[176:179]
  s_barrier
  ds_read_b128 a[160:163], v10 offset:0
  v_mfma_f32_16x16x32_bf16 v[112:115], a[132:135], v[20:23], v[112:115]
  s_add_u32 s84, s84, 0x10000
  ds_read_b128 a[164:167], v10 offset:1024
  v_mfma_f32_16x16x32_bf16 v[112:115], a[136:139], v[24:27], v[112:115]
  buffer_load_dwordx4 v2, s[4:7], s84 offen offset:0 sc1 lds
  v_mfma_f32_16x16x32_bf16 v[112:115], a[140:143], v[28:31], v[112:115]
  ds_read_b128 a[168:171], v10 offset:2048
  v_mfma_f32_16x16x32_bf16 v[120:123], a[140:143], v[44:47], v[180:183]
  ds_read_b128 a[172:175], v10 offset:3072
  v_mfma_f32_16x16x32_bf16 v[120:123], a[136:139], v[40:43], v[120:123]
  ds_read_b128 a[176:179], v10 offset:4096
  v_mfma_f32_16x16x32_bf16 v[120:123], a[132:135], v[36:39], v[120:123]
  ds_read_b128 a[180:183], v10 offset:5120
  v_mfma_f32_16x16x32_bf16 v[120:123], a[128:131], v[32:35], v[120:123]
  ds_read_b128 a[184:187], v10 offset:6144
  v_mfma_f32_16x16x32_bf16 v[128:131], a[128:131], v[48:51], v[184:187]
  v_exp_f32 v108, v108
  v_mfma_f32_16x16x32_bf16 v[128:131], a[132:135], v[52:55], v[128:131]
  buffer_load_dwordx4 v2, s[4:7], s84 offen offset:1024 sc1 lds
  v_mfma_f32_16x16x32_bf16 v[128:131], a[136:139], v[56:59], v[128:131]
  ds_read_b128 a[188:191], v10 offset:7168
  v_sub_f32 v220, v244, v251
  v_mfma_f32_16x16x32_bf16 v[128:131], a[140:143], v[60:63], v[128:131]
  v_sub_f32 v221, v245, v251
  v_sub_f32 v222, v246, v251
  v_mfma_f32_16x16x32_bf16 v[136:139], a[140:143], v[76:79], v[188:191]
  s_bfe_u32 s52, s2, 0x20001
  v_sub_f32 v223, v247, v251
  v_mov_b32 v192, v176
  v_mfma_f32_16x16x32_bf16 v[136:139], a[136:139], v[72:75], v[136:139]
  s_and_b32 s50, s2, 1
  v_exp_f32 v109, v109
  v_mfma_f32_16x16x32_bf16 v[136:139], a[132:135], v[68:71], v[136:139]
  v_cvt_pk_bf16_f32 v158, v108, v109
  v_mov_b32 v193, v176
  v_mfma_f32_16x16x32_bf16 v[136:139], a[128:131], v[64:67], v[136:139]
  s_lshl_b32 s50, s50, 3
  v_mov_b32 v194, v176
  v_mov_b32 v195, v176
  v_mfma_f32_16x16x32_bf16 v[140:143], a[144:147], v[64:67], v[188:191]
  s_bfe_u32 s51, s2, 0x30003
  v_mov_b32 v196, v176
  v_mov_b32 v197, v176
  v_mfma_f32_16x16x32_bf16 v[140:143], a[148:151], v[68:71], v[140:143]
  buffer_load_dwordx4 v2, s[4:7], s84 offen offset:2048 sc1 lds
  v_mfma_f32_16x16x32_bf16 v[140:143], a[152:155], v[72:75], v[140:143]
  v_exp_f32 v110, v110
  v_mfma_f32_16x16x32_bf16 v[140:143], a[156:159], v[76:79], v[140:143]
  s_add_u32 s50, s50, s51
  v_mov_b32 v198, v176
  v_mov_b32 v199, v176
  v_mfma_f32_16x16x32_bf16 v[132:135], a[156:159], v[60:63], v[216:219]
  s_lshr_b32 s51, s2, 6
  s_sub_u32 s81, 15, s50
  s_min_u32 s81, s81, s50
  v_mfma_f32_16x16x32_bf16 v[132:135], a[152:155], v[56:59], v[132:135]
  s_lshl_b32 s81, s81, 2
  s_add_u32 s81, s81, s52
  s_lshl_b32 s63, s81, 11
  v_mfma_f32_16x16x32_bf16 v[132:135], a[148:151], v[52:55], v[132:135]
  s_mul_i32 s81, s51, 1863680
  s_add_u32 s81, s81, 65011712
  v_mfma_f32_16x16x32_bf16 v[132:135], a[144:147], v[48:51], v[132:135]
  s_add_u32 s8, s74, s81
  s_addc_u32 s9, s75, 0
  v_exp_f32 v111, v111
  v_mfma_f32_16x16x32_bf16 v[124:127], a[144:147], v[32:35], v[180:183]
  buffer_load_dwordx4 v2, s[4:7], s84 offen offset:3072 sc1 lds
  v_mfma_f32_16x16x32_bf16 v[124:127], a[148:151], v[36:39], v[124:127]
  s_mov_b32 s11, 0x20000
  v_cvt_pk_bf16_f32 v159, v110, v111
  s_lshl_b32 s83, s52, 5
  v_mfma_f32_16x16x32_bf16 v[124:127], a[152:155], v[40:43], v[124:127]
  s_add_u32 m0, s85, 4096
  s_add_u32 s83, s83, 86
  s_mul_i32 s10, s83, 10240
  v_mfma_f32_16x16x32_bf16 v[124:127], a[156:159], v[44:47], v[124:127]
  s_lshl_b32 s83, s83, 13
  s_add_u32 s83, s83, 1024
  s_mul_i32 s82, s50, 1490944
  v_mfma_f32_16x16x32_bf16 v[116:119], a[156:159], v[28:31], v[176:179]
  s_add_u32 s82, s82, 39844864
  v_exp_f32 v112, v112
  v_mfma_f32_16x16x32_bf16 v[116:119], a[152:155], v[24:27], v[116:119]
  s_and_b32 s62, s76, 1
  v_exp_f32 v113, v113
  v_mfma_f32_16x16x32_bf16 v[116:119], a[148:151], v[20:23], v[116:119]
  v_cvt_pk_bf16_f32 v160, v112, v113
  v_mfma_f32_16x16x32_bf16 v[116:119], a[144:147], v[16:19], v[116:119]
  v_exp_f32 v114, v114
  v_mfma_f32_16x16x32_bf16 v[224:227], v[240:243], v[144:147], v[224:227]
  buffer_load_dwordx4 v3, s[4:7], s84 offen offset:0 sc1 lds
  v_mfma_f32_16x16x32_bf16 v[228:231], v[240:243], v[148:151], v[228:231]
  v_exp_f32 v115, v115
  v_mfma_f32_16x16x32_bf16 v[232:235], v[240:243], v[152:155], v[232:235]
  ds_read_b128 a[128:131], v10 offset:8192
  v_cvt_pk_bf16_f32 v161, v114, v115
  v_mfma_f32_16x16x32_bf16 v[236:239], v[240:243], v[156:159], v[236:239]
  s_waitcnt lgkmcnt(8)
  v_exp_f32 v120, v120
  v_mfma_f32_16x16x32_bf16 a[96:99], a[160:163], v[156:159], a[96:99]
  v_exp_f32 v121, v121
  v_mfma_f32_16x16x32_bf16 a[64:67], a[160:163], v[152:155], a[64:67]
  ds_read_b128 a[132:135], v10 offset:9216
  v_cvt_pk_bf16_f32 v164, v120, v121
  v_mfma_f32_16x16x32_bf16 a[32:35], a[160:163], v[148:151], a[32:35]
  v_exp_f32 v122, v122
  v_mfma_f32_16x16x32_bf16 a[0:3], a[160:163], v[144:147], a[0:3]
  s_waitcnt lgkmcnt(8)
  buffer_load_dwordx4 v3, s[4:7], s84 offen offset:1024 sc1 lds
  v_mfma_f32_16x16x32_bf16 a[4:7], a[164:167], v[144:147], a[4:7]
  v_exp_f32 v123, v123
  v_mfma_f32_16x16x32_bf16 a[36:39], a[164:167], v[148:151], a[36:39]
  ds_read_b128 a[136:139], v10 offset:10240
  v_cvt_pk_bf16_f32 v165, v122, v123
  v_mfma_f32_16x16x32_bf16 a[68:71], a[164:167], v[152:155], a[68:71]
  v_exp_f32 v128, v128
  v_mfma_f32_16x16x32_bf16 a[100:103], a[164:167], v[156:159], a[100:103]
  s_waitcnt lgkmcnt(8)
  v_exp_f32 v129, v129
  v_mfma_f32_16x16x32_bf16 a[104:107], a[168:171], v[156:159], a[104:107]
  v_cvt_pk_bf16_f32 v168, v128, v129
  v_mfma_f32_16x16x32_bf16 a[72:75], a[168:171], v[152:155], a[72:75]
  v_exp_f32 v130, v130
  v_mfma_f32_16x16x32_bf16 a[40:43], a[168:171], v[148:151], a[40:43]
  ds_read_b128 a[140:143], v10 offset:11264
  v_mfma_f32_16x16x32_bf16 a[8:11], a[168:171], v[144:147], a[8:11]
  s_waitcnt lgkmcnt(8)
  v_exp_f32 v131, v131
  v_mfma_f32_16x16x32_bf16 a[12:15], a[172:175], v[144:147], a[12:15]
  buffer_load_dwordx4 v3, s[4:7], s84 offen offset:2048 sc1 lds
  v_mfma_f32_16x16x32_bf16 a[44:47], a[172:175], v[148:151], a[44:47]
  v_exp_f32 v136, v136
  v_mfma_f32_16x16x32_bf16 a[76:79], a[172:175], v[152:155], a[76:79]
  v_exp_f32 v137, v137
  v_mfma_f32_16x16x32_bf16 a[108:111], a[172:175], v[156:159], a[108:111]
  s_waitcnt lgkmcnt(7)
  ds_read_b128 a[144:147], v10 offset:12288
  v_cvt_pk_bf16_f32 v169, v130, v131
  v_mfma_f32_16x16x32_bf16 a[112:115], a[176:179], v[156:159], a[112:115]
  v_exp_f32 v138, v138
  v_mfma_f32_16x16x32_bf16 a[80:83], a[176:179], v[152:155], a[80:83]
  v_cvt_pk_bf16_f32 v172, v136, v137
  v_mfma_f32_16x16x32_bf16 a[48:51], a[176:179], v[148:151], a[48:51]
  v_exp_f32 v139, v139
  v_mfma_f32_16x16x32_bf16 a[16:19], a[176:179], v[144:147], a[16:19]
  s_waitcnt lgkmcnt(7)
  buffer_load_dwordx4 v3, s[4:7], s84 offen offset:3072 sc1 lds
  v_mfma_f32_16x16x32_bf16 a[20:23], a[180:183], v[144:147], a[20:23]
  s_add_u32 m0, s85, 8192
  ds_read_b128 a[148:151], v10 offset:13312
  v_cvt_pk_bf16_f32 v173, v138, v139
  v_mfma_f32_16x16x32_bf16 a[52:55], a[180:183], v[148:151], a[52:55]
  v_exp_f32 v116, v116
  v_mfma_f32_16x16x32_bf16 a[84:87], a[180:183], v[152:155], a[84:87]
  v_exp_f32 v117, v117
  v_mfma_f32_16x16x32_bf16 a[116:119], a[180:183], v[156:159], a[116:119]
  s_waitcnt lgkmcnt(7)
  v_exp_f32 v118, v118
  v_mfma_f32_16x16x32_bf16 a[120:123], a[184:187], v[156:159], a[120:123]
  ds_read_b128 a[152:155], v10 offset:14336
  v_cvt_pk_bf16_f32 v162, v116, v117
  v_mfma_f32_16x16x32_bf16 a[88:91], a[184:187], v[152:155], a[88:91]
  v_exp_f32 v119, v119
  v_mfma_f32_16x16x32_bf16 a[56:59], a[184:187], v[148:151], a[56:59]
  buffer_load_dwordx4 v4, s[4:7], s84 offen offset:0 sc1 lds
  v_mfma_f32_16x16x32_bf16 a[24:27], a[184:187], v[144:147], a[24:27]
  s_waitcnt lgkmcnt(7)
  v_exp_f32 v124, v124
  v_mfma_f32_16x16x32_bf16 a[28:31], a[188:191], v[144:147], a[28:31]
  v_exp_f32 v125, v125
  v_mfma_f32_16x16x32_bf16 a[60:63], a[188:191], v[148:151], a[60:63]
  ds_read_b128 a[156:159], v10 offset:15360
  v_cvt_pk_bf16_f32 v163, v118, v119
  v_mfma_f32_16x16x32_bf16 a[92:95], a[188:191], v[152:155], a[92:95]
  v_exp_f32 v126, v126
  v_mfma_f32_16x16x32_bf16 a[124:127], a[188:191], v[156:159], a[124:127]
  s_waitcnt lgkmcnt(7)
  v_cvt_pk_bf16_f32 v166, v124, v125
  v_mfma_f32_16x16x32_bf16 v[80:83], a[128:131], v[16:19], v[176:179]
  s_waitcnt lgkmcnt(6)
  v_exp_f32 v127, v127
  v_mfma_f32_16x16x32_bf16 v[80:83], a[132:135], v[20:23], v[80:83]
  s_waitcnt lgkmcnt(5)
  buffer_load_dwordx4 v4, s[4:7], s84 offen offset:1024 sc1 lds
  v_mfma_f32_16x16x32_bf16 v[80:83], a[136:139], v[24:27], v[80:83]
  s_waitcnt lgkmcnt(4)
  ds_read_b128 a[160:163], v10 offset:16384
  v_cvt_pk_bf16_f32 v167, v126, v127
  v_mfma_f32_16x16x32_bf16 v[80:83], a[140:143], v[28:31], v[80:83]
  v_exp_f32 v132, v132
  v_mfma_f32_16x16x32_bf16 v[88:91], a[140:143], v[44:47], v[180:183]
  ds_read_b128 a[164:167], v10 offset:17408
  v_exp_f32 v133, v133
  v_mfma_f32_16x16x32_bf16 v[88:91], a[136:139], v[40:43], v[88:91]
  v_exp_f32 v134, v134
  v_mfma_f32_16x16x32_bf16 v[88:91], a[132:135], v[36:39], v[88:91]
  ds_read_b128 a[168:171], v10 offset:18432
  v_cvt_pk_bf16_f32 v170, v132, v133
  v_mfma_f32_16x16x32_bf16 v[88:91], a[128:131], v[32:35], v[88:91]
  v_exp_f32 v135, v135
  v_mfma_f32_16x16x32_bf16 v[104:107], a[128:131], v[64:67], v[220:223]
  ds_read_b128 a[172:175], v10 offset:19456
  v_cvt_pk_bf16_f32 v171, v134, v135
  v_mfma_f32_16x16x32_bf16 v[104:107], a[132:135], v[68:71], v[104:107]
  v_exp_f32 v140, v140
  v_mfma_f32_16x16x32_bf16 v[104:107], a[136:139], v[72:75], v[104:107]
  buffer_load_dwordx4 v4, s[4:7], s84 offen offset:2048 sc1 lds
  v_mfma_f32_16x16x32_bf16 v[104:107], a[140:143], v[76:79], v[104:107]
  s_waitcnt lgkmcnt(4)
  v_exp_f32 v141, v141
  v_mfma_f32_16x16x32_bf16 v[92:95], a[156:159], v[44:47], v[180:183]
  ds_read_b128 a[176:179], v10 offset:20480
  v_cvt_pk_bf16_f32 v174, v140, v141
  v_mfma_f32_16x16x32_bf16 v[92:95], a[152:155], v[40:43], v[92:95]
  v_exp_f32 v142, v142
  v_mfma_f32_16x16x32_bf16 v[92:95], a[148:151], v[36:39], v[92:95]
  ds_read_b128 a[180:183], v10 offset:21504
  v_mfma_f32_16x16x32_bf16 v[92:95], a[144:147], v[32:35], v[92:95]
  v_exp_f32 v143, v143
  v_mfma_f32_16x16x32_bf16 v[84:87], a[144:147], v[16:19], v[176:179]
  buffer_load_dwordx4 v4, s[4:7], s84 offen offset:3072 sc1 lds
  v_mfma_f32_16x16x32_bf16 v[84:87], a[148:151], v[20:23], v[84:87]
  s_add_u32 m0, s85, 12288
  ds_read_b128 a[184:187], v10 offset:22528
  v_cvt_pk_bf16_f32 v175, v142, v143
  v_mfma_f32_16x16x32_bf16 v[84:87], a[152:155], v[24:27], v[84:87]
  v_exp_f32 v80, v80
  v_mfma_f32_16x16x32_bf16 v[84:87], a[156:159], v[28:31], v[84:87]
  ds_read_b128 a[188:191], v10 offset:23552
  v_mfma_f32_16x16x32_bf16 v[224:227], v[240:243], v[160:163], v[224:227]
  v_exp_f32 v81, v81
  v_mfma_f32_16x16x32_bf16 v[228:231], v[240:243], v[164:167], v[228:231]
  ds_read_b128 a[128:131], v10 offset:24576
  v_cvt_pk_bf16_f32 v144, v80, v81
  v_mfma_f32_16x16x32_bf16 v[232:235], v[240:243], v[168:171], v[232:235]
  s_waitcnt lgkmcnt(8)
  v_exp_f32 v82, v82
  v_mfma_f32_16x16x32_bf16 v[236:239], v[240:243], v[172:175], v[236:239]
  s_cmp_eq_u32 s62, 0
  s_cselect_b32 s81, s81, s82
  s_cselect_b32 s14, s10, s83
  s_movk_i32 s56, 8192
  s_cselect_b32 s56, 10240, s56
  v_mfma_f32_16x16x32_bf16 a[96:99], a[160:163], v[172:175], a[96:99]
  s_add_u32 s12, s74, s81
  s_addc_u32 s13, s75, 0
  v_exp_f32 v83, v83
  v_mfma_f32_16x16x32_bf16 a[64:67], a[160:163], v[168:171], a[64:67]
  buffer_load_dwordx4 v5, s[4:7], s84 offen offset:0 sc1 lds
  v_mfma_f32_16x16x32_bf16 a[32:35], a[160:163], v[164:167], a[32:35]
  s_waitcnt lgkmcnt(7)
  ds_read_b128 a[132:135], v10 offset:25600
  v_cvt_pk_bf16_f32 v145, v82, v83
  v_mfma_f32_16x16x32_bf16 a[0:3], a[160:163], v[160:163], a[0:3]
  s_mov_b32 s15, 0x20000
  v_exp_f32 v88, v88
  v_mfma_f32_16x16x32_bf16 a[4:7], a[164:167], v[160:163], a[4:7]
  s_mul_i32 s81, s52, 14
  s_lshr_b32 s82, s76, 1
  s_add_u32 s81, s81, s82
  v_mfma_f32_16x16x32_bf16 a[36:39], a[164:167], v[164:167], a[36:39]
  s_mul_i32 s53, s81, 10240
  v_exp_f32 v89, v89
  v_mfma_f32_16x16x32_bf16 a[68:71], a[164:167], v[168:171], a[68:71]
  ds_read_b128 a[136:139], v10 offset:26624
  v_cvt_pk_bf16_f32 v148, v88, v89
  v_mfma_f32_16x16x32_bf16 a[100:103], a[164:167], v[172:175], a[100:103]
  s_waitcnt lgkmcnt(8)
  buffer_load_dwordx4 v5, s[4:7], s84 offen offset:1024 sc1 lds
  v_mfma_f32_16x16x32_bf16 a[104:107], a[168:171], v[172:175], a[104:107]
  s_mul_i32 s54, s81, s56
  v_exp_f32 v90, v90
  v_mfma_f32_16x16x32_bf16 a[72:75], a[168:171], v[168:171], a[72:75]
  s_mul_i32 s82, s62, 9216
  ds_read_b128 a[140:143], v10 offset:27648
  s_add_u32 s53, s53, s82
  v_mfma_f32_16x16x32_bf16 a[40:43], a[168:171], v[164:167], a[40:43]
  s_waitcnt lgkmcnt(8)
  v_exp_f32 v91, v91
  v_mfma_f32_16x16x32_bf16 a[8:11], a[168:171], v[160:163], a[8:11]
  s_mul_i32 s81, s52, 18
  v_cvt_pk_bf16_f32 v149, v90, v91
  s_add_u32 s81, s81, 42
  v_mfma_f32_16x16x32_bf16 a[12:15], a[172:175], v[160:163], a[12:15]
  s_mul_i32 s60, s81, 10240
  s_mul_i32 s61, s81, s56
  s_mov_b32 s55, 20480
  v_mfma_f32_16x16x32_bf16 a[44:47], a[172:175], v[164:167], a[44:47]
  s_lshl_b32 s56, s56, 1
  v_exp_f32 v104, v104
  v_mfma_f32_16x16x32_bf16 a[76:79], a[172:175], v[168:171], a[76:79]
  s_waitcnt lgkmcnt(7)
  ds_read_b128 a[144:147], v10 offset:28672
  s_mul_i32 s64, s76, 9216
  v_mfma_f32_16x16x32_bf16 a[108:111], a[172:175], v[172:175], a[108:111]
  s_cmp_eq_u32 s52, 3
  s_cselect_b32 s81, 1073741824, 0
  v_exp_f32 v105, v105
  v_mfma_f32_16x16x32_bf16 a[112:115], a[176:179], v[172:175], a[112:115]
  buffer_load_dwordx4 v5, s[4:7], s84 offen offset:2048 sc1 lds
  v_mfma_f32_16x16x32_bf16 a[80:83], a[176:179], v[168:171], a[80:83]
  s_add_u32 s57, s55, s81
  v_cvt_pk_bf16_f32 v156, v104, v105
  s_add_u32 s65, s56, s81
  v_mfma_f32_16x16x32_bf16 a[48:51], a[176:179], v[164:167], a[48:51]
  s_waitcnt lgkmcnt(7)
  v_exp_f32 v106, v106
  v_mfma_f32_16x16x32_bf16 a[16:19], a[176:179], v[160:163], a[16:19]
  s_sub_u32 s60, s60, s81
  ds_read_b128 a[148:151], v10 offset:29696
  s_sub_u32 s61, s61, s81
  v_mfma_f32_16x16x32_bf16 a[20:23], a[180:183], v[160:163], a[20:23]
  s_mov_b64 s[16:17], s[48:49]
  s_mov_b32 s18, 2621440
  s_mov_b32 s19, 0x20000
  v_mfma_f32_16x16x32_bf16 a[52:55], a[180:183], v[164:167], a[52:55]
  s_mov_b64 s[24:25], s[70:71]
  v_exp_f32 v107, v107
  v_mfma_f32_16x16x32_bf16 a[84:87], a[180:183], v[168:171], a[84:87]
  s_waitcnt lgkmcnt(7)
  v_cvt_pk_bf16_f32 v157, v106, v107
  s_mov_b32 s26, 2621440
  v_mfma_f32_16x16x32_bf16 a[116:119], a[180:183], v[172:175], a[116:119]
  s_mov_b32 s27, 0x20000
  v_exp_f32 v84, v84
  v_mfma_f32_16x16x32_bf16 a[120:123], a[184:187], v[172:175], a[120:123]
  buffer_load_dwordx4 v5, s[4:7], s84 offen offset:3072 sc1 lds
  v_mfma_f32_16x16x32_bf16 a[88:91], a[184:187], v[168:171], a[88:91]
  s_mov_b64 s[28:29], s[68:69]
  ds_read_b128 a[152:155], v10 offset:30720
  s_mov_b32 s30, 1280
  v_mfma_f32_16x16x32_bf16 a[56:59], a[184:187], v[164:167], a[56:59]
  s_waitcnt lgkmcnt(7)
  v_exp_f32 v85, v85
  v_mfma_f32_16x16x32_bf16 a[24:27], a[184:187], v[160:163], a[24:27]
  s_mov_b32 s31, 0x20000
  ds_read_b128 a[156:159], v10 offset:31744
  v_cvt_pk_bf16_f32 v146, v84, v85
  v_mfma_f32_16x16x32_bf16 a[28:31], a[188:191], v[160:163], a[28:31]
  s_add_u32 s32, s74, 73400320
  s_addc_u32 s33, s75, 0
  v_exp_f32 v86, v86
  v_mfma_f32_16x16x32_bf16 a[60:63], a[188:191], v[164:167], a[60:63]
  s_mov_b32 s34, 16777216
  s_mov_b32 s35, 0x20000
  v_mfma_f32_16x16x32_bf16 a[92:95], a[188:191], v[168:171], a[92:95]
  s_xor_b32 s85, s85, 0x10000
  v_mfma_f32_16x16x32_bf16 a[124:127], a[188:191], v[172:175], a[124:127]
  s_waitcnt lgkmcnt(7)
  v_exp_f32 v87, v87
  v_mfma_f32_16x16x32_bf16 v[112:115], a[128:131], v[16:19], v[176:179]
  s_waitcnt lgkmcnt(6)
  ds_read_b128 a[160:163], v10 offset:32768
  v_cvt_pk_bf16_f32 v147, v86, v87
  v_mfma_f32_16x16x32_bf16 v[112:115], a[132:135], v[20:23], v[112:115]
  s_waitcnt lgkmcnt(6)
  v_exp_f32 v92, v92
  v_mfma_f32_16x16x32_bf16 v[112:115], a[136:139], v[24:27], v[112:115]
  s_waitcnt lgkmcnt(5)
  ds_read_b128 a[164:167], v10 offset:33792
  v_mov_b32 v158, 0
  v_mfma_f32_16x16x32_bf16 v[112:115], a[140:143], v[28:31], v[112:115]
  v_mov_b32 v159, 0
  v_mfma_f32_16x16x32_bf16 v[120:123], a[140:143], v[44:47], v[180:183]
  v_exp_f32 v93, v93
  v_mfma_f32_16x16x32_bf16 v[120:123], a[136:139], v[40:43], v[120:123]
  ds_read_b128 a[168:171], v10 offset:34816
  v_cvt_pk_bf16_f32 v150, v92, v93
  v_mfma_f32_16x16x32_bf16 v[120:123], a[132:135], v[36:39], v[120:123]
  v_exp_f32 v94, v94
  v_mfma_f32_16x16x32_bf16 v[120:123], a[128:131], v[32:35], v[120:123]
  s_waitcnt lgkmcnt(6)
  ds_read_b128 a[172:175], v10 offset:35840
  v_mfma_f32_16x16x32_bf16 v[124:127], a[144:147], v[32:35], v[180:183]
  s_waitcnt lgkmcnt(6)
  ds_read_b128 a[176:179], v10 offset:36864
  v_mfma_f32_16x16x32_bf16 v[124:127], a[148:151], v[36:39], v[124:127]
  s_waitcnt lgkmcnt(6)
  v_exp_f32 v95, v95
  v_mfma_f32_16x16x32_bf16 v[124:127], a[152:155], v[40:43], v[124:127]
  s_waitcnt lgkmcnt(5)
  ds_read_b128 a[180:183], v10 offset:37888
  v_cvt_pk_bf16_f32 v151, v94, v95
  v_mfma_f32_16x16x32_bf16 v[124:127], a[156:159], v[44:47], v[124:127]
  v_mfma_f32_16x16x32_bf16 v[116:119], a[156:159], v[28:31], v[176:179]
  ds_read_b128 a[184:187], v10 offset:38912
  v_mfma_f32_16x16x32_bf16 v[116:119], a[152:155], v[24:27], v[116:119]
  v_mfma_f32_16x16x32_bf16 v[116:119], a[148:151], v[20:23], v[116:119]
  v_exp_f32 v112, v112
  v_mfma_f32_16x16x32_bf16 v[116:119], a[144:147], v[16:19], v[116:119]
  ds_read_b128 a[188:191], v10 offset:39936
  v_mfma_f32_16x16x32_bf16 v[224:227], v[240:243], v[144:147], v[224:227]
  v_exp_f32 v113, v113
  v_mfma_f32_16x16x32_bf16 v[228:231], v[240:243], v[148:151], v[228:231]
  ds_read_b128 a[128:131], v10 offset:40960
  v_cvt_pk_bf16_f32 v160, v112, v113
  v_mfma_f32_16x16x32_bf16 v[236:239], v[240:243], v[156:159], v[236:239]
  s_waitcnt lgkmcnt(8)
  v_mfma_f32_16x16x32_bf16 a[96:99], a[160:163], v[156:159], a[96:99]
  v_exp_f32 v114, v114
  v_mfma_f32_16x16x32_bf16 a[32:35], a[160:163], v[148:151], a[32:35]
  ds_read_b128 a[132:135], v10 offset:41984
  v_mfma_f32_16x16x32_bf16 a[0:3], a[160:163], v[144:147], a[0:3]
  s_waitcnt lgkmcnt(8)
  v_exp_f32 v115, v115
  v_mfma_f32_16x16x32_bf16 a[4:7], a[164:167], v[144:147], a[4:7]
  ds_read_b128 a[136:139], v10 offset:43008
  v_cvt_pk_bf16_f32 v161, v114, v115
  v_mfma_f32_16x16x32_bf16 a[36:39], a[164:167], v[148:151], a[36:39]
  v_mfma_f32_16x16x32_bf16 a[100:103], a[164:167], v[156:159], a[100:103]
  s_waitcnt lgkmcnt(8)
  v_exp_f32 v120, v120
  v_mfma_f32_16x16x32_bf16 a[104:107], a[168:171], v[156:159], a[104:107]
  v_mfma_f32_16x16x32_bf16 a[40:43], a[168:171], v[148:151], a[40:43]
  v_exp_f32 v121, v121
  v_mfma_f32_16x16x32_bf16 a[8:11], a[168:171], v[144:147], a[8:11]
  s_waitcnt lgkmcnt(7)
  ds_read_b128 a[140:143], v10 offset:44032
  v_cvt_pk_bf16_f32 v164, v120, v121
  v_mfma_f32_16x16x32_bf16 a[12:15], a[172:175], v[144:147], a[12:15]
  v_mfma_f32_16x16x32_bf16 a[44:47], a[172:175], v[148:151], a[44:47]
  v_exp_f32 v122, v122
  v_mfma_f32_16x16x32_bf16 a[108:111], a[172:175], v[156:159], a[108:111]
  s_waitcnt lgkmcnt(7)
  ds_read_b128 a[144:147], v10 offset:45056
  v_mfma_f32_16x16x32_bf16 a[112:115], a[176:179], v[156:159], a[112:115]
  v_exp_f32 v123, v123
  v_mfma_f32_16x16x32_bf16 a[48:51], a[176:179], v[148:151], a[48:51]
  ds_read_b128 a[148:151], v10 offset:46080
  v_cvt_pk_bf16_f32 v165, v122, v123
  v_mfma_f32_16x16x32_bf16 a[16:19], a[176:179], v[144:147], a[16:19]
  s_waitcnt lgkmcnt(8)
  v_mfma_f32_16x16x32_bf16 a[20:23], a[180:183], v[144:147], a[20:23]
  v_exp_f32 v116, v116
  v_mfma_f32_16x16x32_bf16 a[52:55], a[180:183], v[148:151], a[52:55]
  v_mfma_f32_16x16x32_bf16 a[116:119], a[180:183], v[156:159], a[116:119]
  s_waitcnt lgkmcnt(7)
  ds_read_b128 a[152:155], v10 offset:47104
  v_mfma_f32_16x16x32_bf16 a[120:123], a[184:187], v[156:159], a[120:123]
  v_exp_f32 v117, v117
  v_mfma_f32_16x16x32_bf16 a[56:59], a[184:187], v[148:151], a[56:59]
  v_cvt_pk_bf16_f32 v162, v116, v117
  v_mfma_f32_16x16x32_bf16 a[24:27], a[184:187], v[144:147], a[24:27]
  s_waitcnt lgkmcnt(7)
  v_exp_f32 v118, v118
  v_mfma_f32_16x16x32_bf16 a[28:31], a[188:191], v[144:147], a[28:31]
  ds_read_b128 a[156:159], v10 offset:48128
  v_mfma_f32_16x16x32_bf16 a[60:63], a[188:191], v[148:151], a[60:63]
  v_mfma_f32_16x16x32_bf16 a[124:127], a[188:191], v[156:159], a[124:127]
  s_waitcnt lgkmcnt(7)
  v_exp_f32 v119, v119
  v_mfma_f32_16x16x32_bf16 v[80:83], a[128:131], v[16:19], v[192:195]
  s_waitcnt lgkmcnt(6)
  ds_read_b128 a[160:163], v10 offset:49152
  v_cvt_pk_bf16_f32 v163, v118, v119
  v_mfma_f32_16x16x32_bf16 v[80:83], a[132:135], v[20:23], v[80:83]
  s_waitcnt lgkmcnt(6)
  v_exp_f32 v124, v124
  v_mfma_f32_16x16x32_bf16 v[80:83], a[136:139], v[24:27], v[80:83]
  s_waitcnt lgkmcnt(5)
  ds_read_b128 a[164:167], v10 offset:50176
  v_mfma_f32_16x16x32_bf16 v[80:83], a[140:143], v[28:31], v[80:83]
  v_mfma_f32_16x16x32_bf16 v[88:91], a[140:143], v[44:47], v[180:183]
  v_exp_f32 v125, v125
  v_mfma_f32_16x16x32_bf16 v[88:91], a[136:139], v[40:43], v[88:91]
  ds_read_b128 a[168:171], v10 offset:51200
  v_cvt_pk_bf16_f32 v166, v124, v125
  v_mfma_f32_16x16x32_bf16 v[88:91], a[132:135], v[36:39], v[88:91]
  v_exp_f32 v126, v126
  v_mfma_f32_16x16x32_bf16 v[88:91], a[128:131], v[32:35], v[88:91]
  s_waitcnt lgkmcnt(6)
  ds_read_b128 a[172:175], v10 offset:52224
  v_mfma_f32_16x16x32_bf16 v[92:95], a[144:147], v[32:35], v[180:183]
  s_waitcnt lgkmcnt(6)
  ds_read_b128 a[176:179], v10 offset:53248
L_padA12:
  s_cbranch_execz L_warm_done
  v_mfma_f32_16x16x32_bf16 v[92:95], a[148:151], v[36:39], v[92:95]
  s_waitcnt lgkmcnt(6)
  v_exp_f32 v127, v127
  v_mfma_f32_16x16x32_bf16 v[92:95], a[152:155], v[40:43], v[92:95]
  s_waitcnt lgkmcnt(5)
  ds_read_b128 a[180:183], v10 offset:54272
  v_cvt_pk_bf16_f32 v167, v126, v127
  v_mfma_f32_16x16x32_bf16 v[92:95], a[156:159], v[44:47], v[92:95]
  v_mfma_f32_16x16x32_bf16 v[84:87], a[156:159], v[28:31], v[196:199]
  ds_read_b128 a[184:187], v10 offset:55296
  v_mfma_f32_16x16x32_bf16 v[84:87], a[152:155], v[24:27], v[84:87]
  v_mfma_f32_16x16x32_bf16 v[84:87], a[148:151], v[20:23], v[84:87]
  v_exp_f32 v80, v80
  v_mfma_f32_16x16x32_bf16 v[84:87], a[144:147], v[16:19], v[84:87]
  v_exp_f32 v81, v81
  v_mfma_f32_16x16x32_bf16 v[224:227], v[240:243], v[160:163], v[224:227]
  ds_read_b128 a[188:191], v10 offset:56320
  v_cvt_pk_bf16_f32 v144, v80, v81
  v_mfma_f32_16x16x32_bf16 v[228:231], v[240:243], v[164:167], v[228:231]
  s_waitcnt lgkmcnt(7)
  v_exp_f32 v82, v82
  v_mfma_f32_16x16x32_bf16 a[32:35], a[160:163], v[164:167], a[32:35]
  ds_read_b128 a[128:131], v10 offset:57344
  v_exp_f32 v83, v83
  v_mfma_f32_16x16x32_bf16 a[0:3], a[160:163], v[160:163], a[0:3]
  s_waitcnt lgkmcnt(7)
  ds_read_b128 a[132:135], v10 offset:58368
  v_cvt_pk_bf16_f32 v145, v82, v83
  v_mfma_f32_16x16x32_bf16 a[4:7], a[164:167], v[160:163], a[4:7]
  v_exp_f32 v88, v88
  v_mfma_f32_16x16x32_bf16 a[36:39], a[164:167], v[164:167], a[36:39]
  s_waitcnt lgkmcnt(7)
  ds_read_b128 a[136:139], v10 offset:59392
  v_exp_f32 v89, v89
  v_mfma_f32_16x16x32_bf16 a[40:43], a[168:171], v[164:167], a[40:43]
  ds_read_b128 a[140:143], v10 offset:60416
  v_cvt_pk_bf16_f32 v148, v88, v89
  v_mfma_f32_16x16x32_bf16 a[8:11], a[168:171], v[160:163], a[8:11]
  s_waitcnt lgkmcnt(8)
  v_exp_f32 v90, v90
  v_mfma_f32_16x16x32_bf16 a[12:15], a[172:175], v[160:163], a[12:15]
  ds_read_b128 a[144:147], v10 offset:61440
  v_exp_f32 v91, v91
  v_mfma_f32_16x16x32_bf16 a[44:47], a[172:175], v[164:167], a[44:47]
  s_waitcnt lgkmcnt(8)
  ds_read_b128 a[148:151], v10 offset:62464
  v_cvt_pk_bf16_f32 v149, v90, v91
  v_mfma_f32_16x16x32_bf16 a[48:51], a[176:179], v[164:167], a[48:51]
  v_exp_f32 v84, v84
  v_mfma_f32_16x16x32_bf16 a[16:19], a[176:179], v[160:163], a[16:19]
  s_waitcnt lgkmcnt(8)
  ds_read_b128 a[152:155], v10 offset:63488
  v_exp_f32 v85, v85
  v_mfma_f32_16x16x32_bf16 a[20:23], a[180:183], v[160:163], a[20:23]
  ds_read_b128 a[156:159], v10 offset:64512
  v_exp_f32 v86, v86
  v_mfma_f32_16x16x32_bf16 a[52:55], a[180:183], v[164:167], a[52:55]
  s_waitcnt lgkmcnt(9)
  v_exp_f32 v87, v87
  v_mfma_f32_16x16x32_bf16 a[56:59], a[184:187], v[164:167], a[56:59]
  v_exp_f32 v92, v92
  v_mfma_f32_16x16x32_bf16 a[24:27], a[184:187], v[160:163], a[24:27]
  s_waitcnt lgkmcnt(8)
  v_exp_f32 v93, v93
  v_mfma_f32_16x16x32_bf16 a[28:31], a[188:191], v[160:163], a[28:31]
  s_waitcnt vmcnt(0) lgkmcnt(0)
  v_cvt_pk_bf16_f32 v146, v84, v85
  v_cvt_pk_bf16_f32 v147, v86, v87
  v_cvt_pk_bf16_f32 v150, v92, v93
  v_xor_b32 v10, 0x10000, v10
  v_mfma_f32_16x16x32_bf16 a[60:63], a[188:191], v[164:167], a[60:63]
  buffer_store_dword v9, v8, s[36:39], 0 offen sc1
L_sepi:
  s_cmp_eq_u32 s52, 3
  s_cselect_b32 s82, 24, 28
  s_cmp_eq_u32 s76, 0
  s_cselect_b32 s82, s82, 0
  s_add_u32 s81, s63, 65536
  v_cmp_gt_u32 vcc, s82, v14
  v_lshl_add_u32 v214, v14, 6, s81
  v_mov_b32 v208, 2146435072
  v_mov_b32 v209, s72
  v_cndmask_b32 v208, v208, v214, vcc
  v_cndmask_b32 v209, 0, v209, vcc
  s_lshl2_add_u32 s81, s51, s52
  s_lshl_b32 s81, s81, 12
  s_add_u32 s81, s81, 196608
  s_cmp_eq_u32 s76, 0
  s_cselect_b32 s95, 64, 0
  v_cmp_gt_u32 vcc, s95, v14
  v_lshl_add_u32 v214, v14, 6, s81
  v_mov_b32 v211, 2146435072
  v_mov_b32 v212, s72
  v_cndmask_b32 v211, v211, v214, vcc
  v_cndmask_b32 v212, 0, v212, vcc
  v_mov_b32 v210, 0
  v_mov_b32 v213, 0
  s_add_u32 s81, s80, 1
  s_cmp_eq_u32 s81, s79
  s_cbranch_scc1 L_poll_now
L_poll_back:
  v_cmp_nle_f32 vcc, v232, v252
  v_rcp_f32 v232, v232
  s_or_b64 s[90:91], s[90:91], vcc
  v_cmp_nle_f32 vcc, v236, v252
  v_rcp_f32 v236, v236
  s_or_b64 s[90:91], s[90:91], vcc
  s_mul_i32 s88, s80, 1490944
  s_lshl_b32 s81, s77, 15
  s_add_u32 s88, s88, s81
  s_lshl_b32 s81, s76, 10
  s_add_u32 s88, s88, s81
  s_add_u32 s88, s88, 442368
  v_mov_b32 v233, v232
  v_mov_b32 v237, v236
  v_accvgpr_read_b32 v96, a64
  v_accvgpr_read_b32 v97, a65
  v_accvgpr_read_b32 v98, a66
  v_accvgpr_read_b32 v99, a67
  v_accvgpr_read_b32 v100, a68
  v_accvgpr_read_b32 v101, a69
  v_accvgpr_read_b32 v102, a70
  v_accvgpr_read_b32 v103, a71
  v_pk_mul_f32 v[96:97], v[96:97], v[232:233]
  v_pk_mul_f32 v[98:99], v[98:99], v[232:233]
  v_pk_mul_f32 v[100:101], v[100:101], v[232:233]
  v_pk_mul_f32 v[102:103], v[102:103], v[232:233]
  v_cvt_pk_bf16_f32 v104, v96, v97
  v_cvt_pk_bf16_f32 v105, v98, v99
  v_cvt_pk_bf16_f32 v106, v100, v101
  v_cvt_pk_bf16_f32 v107, v102, v103
  buffer_store_dwordx4 v[104:107], v1, s[20:23], s88 offen sc1
  v_accvgpr_read_b32 v128, a96
  v_accvgpr_read_b32 v129, a97
  v_accvgpr_read_b32 v130, a98
  v_accvgpr_read_b32 v131, a99
  v_accvgpr_read_b32 v132, a100
  v_accvgpr_read_b32 v133, a101
  v_accvgpr_read_b32 v134, a102
  v_accvgpr_read_b32 v135, a103
  v_pk_mul_f32 v[128:129], v[128:129], v[236:237]
  v_pk_mul_f32 v[130:131], v[130:131], v[236:237]
  v_pk_mul_f32 v[132:133], v[132:133], v[236:237]
  v_pk_mul_f32 v[134:135], v[134:135], v[236:237]
  v_cvt_pk_bf16_f32 v136, v128, v129
  v_cvt_pk_bf16_f32 v137, v130, v131
  v_cvt_pk_bf16_f32 v138, v132, v133
  v_cvt_pk_bf16_f32 v139, v134, v135
  buffer_store_dwordx4 v[136:139], v7, s[20:23], s88 offen sc1
  s_add_u32 s88, s88, 8192
  v_accvgpr_read_b32 v96, a72
  v_accvgpr_read_b32 v97, a73
  v_accvgpr_read_b32 v98, a74
  v_accvgpr_read_b32 v99, a75
  v_accvgpr_read_b32 v100, a76
  v_accvgpr_read_b32 v101, a77
  v_accvgpr_read_b32 v102, a78
  v_accvgpr_read_b32 v103, a79
  v_pk_mul_f32 v[96:97], v[96:97], v[232:233]
  v_pk_mul_f32 v[98:99], v[98:99], v[232:233]
  v_pk_mul_f32 v[100:101], v[100:101], v[232:233]
  v_pk_mul_f32 v[102:103], v[102:103], v[232:233]
  v_cvt_pk_bf16_f32 v104, v96, v97
  v_cvt_pk_bf16_f32 v105, v98, v99
  v_cvt_pk_bf16_f32 v106, v100, v101
  v_cvt_pk_bf16_f32 v107, v102, v103
  buffer_store_dwordx4 v[104:107], v1, s[20:23], s88 offen sc1
  v_accvgpr_read_b32 v128, a104
  v_accvgpr_read_b32 v129, a105
  v_accvgpr_read_b32 v130, a106
  v_accvgpr_read_b32 v131, a107
  v_accvgpr_read_b32 v132, a108
  v_accvgpr_read_b32 v133, a109
  v_accvgpr_read_b32 v134, a110
  v_accvgpr_read_b32 v135, a111
  v_pk_mul_f32 v[128:129], v[128:129], v[236:237]
  v_pk_mul_f32 v[130:131], v[130:131], v[236:237]
  v_pk_mul_f32 v[132:133], v[132:133], v[236:237]
  v_pk_mul_f32 v[134:135], v[134:135], v[236:237]
  v_cvt_pk_bf16_f32 v136, v128, v129
  v_cvt_pk_bf16_f32 v137, v130, v131
  v_cvt_pk_bf16_f32 v138, v132, v133
  v_cvt_pk_bf16_f32 v139, v134, v135
  buffer_store_dwordx4 v[136:139], v7, s[20:23], s88 offen sc1
  s_add_u32 s88, s88, 8192
  v_accvgpr_read_b32 v96, a80
  v_accvgpr_read_b32 v97, a81
  v_accvgpr_read_b32 v98, a82
  v_accvgpr_read_b32 v99, a83
  v_accvgpr_read_b32 v100, a84
  v_accvgpr_read_b32 v101, a85
  v_accvgpr_read_b32 v102, a86
  v_accvgpr_read_b32 v103, a87
  v_pk_mul_f32 v[96:97], v[96:97], v[232:233]
  v_pk_mul_f32 v[98:99], v[98:99], v[232:233]
  v_pk_mul_f32 v[100:101], v[100:101], v[232:233]
  v_pk_mul_f32 v[102:103], v[102:103], v[232:233]
  v_cvt_pk_bf16_f32 v104, v96, v97
  v_cvt_pk_bf16_f32 v105, v98, v99
  v_cvt_pk_bf16_f32 v106, v100, v101
  v_cvt_pk_bf16_f32 v107, v102, v103
  buffer_store_dwordx4 v[104:107], v1, s[20:23], s88 offen sc1
  v_accvgpr_read_b32 v128, a112
  v_accvgpr_read_b32 v129, a113
  v_accvgpr_read_b32 v130, a114
  v_accvgpr_read_b32 v131, a115
  v_accvgpr_read_b32 v132, a116
  v_accvgpr_read_b32 v133, a117
  v_accvgpr_read_b32 v134, a118
  v_accvgpr_read_b32 v135, a119
  v_pk_mul_f32 v[128:129], v[128:129], v[236:237]
  v_pk_mul_f32 v[130:131], v[130:131], v[236:237]
  v_pk_mul_f32 v[132:133], v[132:133], v[236:237]
  v_pk_mul_f32 v[134:135], v[134:135], v[236:237]
  v_cvt_pk_bf16_f32 v136, v128, v129
  v_cvt_pk_bf16_f32 v137, v130, v131
  v_cvt_pk_bf16_f32 v138, v132, v133
  v_cvt_pk_bf16_f32 v139, v134, v135
  buffer_store_dwordx4 v[136:139], v7, s[20:23], s88 offen sc1
  s_add_u32 s88, s88, 8192
  v_accvgpr_read_b32 v96, a88
  v_accvgpr_read_b32 v97, a89
  v_accvgpr_read_b32 v98, a90
  v_accvgpr_read_b32 v99, a91
  v_accvgpr_read_b32 v100, a92
  v_accvgpr_read_b32 v101, a93
  v_accvgpr_read_b32 v102, a94
  v_accvgpr_read_b32 v103, a95
  v_pk_mul_f32 v[96:97], v[96:97], v[232:233]
  v_pk_mul_f32 v[98:99], v[98:99], v[232:233]
  v_pk_mul_f32 v[100:101], v[100:101], v[232:233]
  v_pk_mul_f32 v[102:103], v[102:103], v[232:233]
  v_cvt_pk_bf16_f32 v104, v96, v97
  v_cvt_pk_bf16_f32 v105, v98, v99
  v_cvt_pk_bf16_f32 v106, v100, v101
  v_cvt_pk_bf16_f32 v107, v102, v103
  buffer_store_dwordx4 v[104:107], v1, s[20:23], s88 offen sc1
  v_accvgpr_read_b32 v128, a120
  v_accvgpr_read_b32 v129, a121
  v_accvgpr_read_b32 v130, a122
  v_accvgpr_read_b32 v131, a123
  v_accvgpr_read_b32 v132, a124
  v_accvgpr_read_b32 v133, a125
  v_accvgpr_read_b32 v134, a126
  v_accvgpr_read_b32 v135, a127
  v_pk_mul_f32 v[128:129], v[128:129], v[236:237]
  v_pk_mul_f32 v[130:131], v[130:131], v[236:237]
  v_pk_mul_f32 v[132:133], v[132:133], v[236:237]
  v_pk_mul_f32 v[134:135], v[134:135], v[236:237]
  v_cvt_pk_bf16_f32 v136, v128, v129
  v_cvt_pk_bf16_f32 v137, v130, v131
  v_cvt_pk_bf16_f32 v138, v132, v133
  v_cvt_pk_bf16_f32 v139, v134, v135
  buffer_store_dwordx4 v[136:139], v7, s[20:23], s88 offen sc1
  s_sub_u32 s86, s79, s80
  s_sub_u32 s86, s86, 2
  s_cbranch_scc1 L_lfin
  .p2align 6
L_single:
  s_cmp_eq_u32 s86, s87
  s_cbranch_scc1 L_single_dg
L_single_nd:
  s_add_u32 m0, s85, 0
  v_mfma_f32_16x16x32_bf16 v[112:115], a[128:131], v[16:19], v[176:179]
  s_barrier
  ds_read_b128 a[192:195], v10 offset:8192
  v_mfma_f32_16x16x32_bf16 v[112:115], a[132:135], v[20:23], v[112:115]
  s_add_u32 s84, s84, 0x10000
  ds_read_b128 a[196:199], v10 offset:9216
  v_mfma_f32_16x16x32_bf16 v[112:115], a[136:139], v[24:27], v[112:115]
  buffer_load_dwordx4 v2, s[4:7], s84 offen offset:0 sc1 lds
  v_mfma_f32_16x16x32_bf16 v[112:115], a[140:143], v[28:31], v[112:115]
  ds_read_b128 a[200:203], v10 offset:10240
  v_mfma_f32_16x16x32_bf16 v[120:123], a[140:143], v[44:47], v[180:183]
  ds_read_b128 a[204:207], v10 offset:11264
  v_mfma_f32_16x16x32_bf16 v[120:123], a[136:139], v[40:43], v[120:123]
  ds_read_b128 a[208:211], v10 offset:12288
  v_mfma_f32_16x16x32_bf16 v[120:123], a[132:135], v[36:39], v[120:123]
  ds_read_b128 a[212:215], v10 offset:13312
  v_mfma_f32_16x16x32_bf16 v[120:123], a[128:131], v[32:35], v[120:123]
  buffer_load_dwordx4 v2, s[4:7], s84 offen offset:1024 sc1 lds
  v_mfma_f32_16x16x32_bf16 v[124:127], a[144:147], v[32:35], v[180:183]
  v_exp_f32 v94, v94
  v_mfma_f32_16x16x32_bf16 v[124:127], a[148:151], v[36:39], v[124:127]
  v_exp_f32 v112, v112
  v_mfma_f32_16x16x32_bf16 v[124:127], a[152:155], v[40:43], v[124:127]
  v_exp_f32 v113, v113
  v_mfma_f32_16x16x32_bf16 v[124:127], a[156:159], v[44:47], v[124:127]
  v_exp_f32 v95, v95
  v_mfma_f32_16x16x32_bf16 v[116:119], a[156:159], v[28:31], v[176:179]
  v_exp_f32 v114, v114
  v_mfma_f32_16x16x32_bf16 v[116:119], a[152:155], v[24:27], v[116:119]
  v_exp_f32 v115, v115
  v_mfma_f32_16x16x32_bf16 v[116:119], a[148:151], v[20:23], v[116:119]
  buffer_load_dwordx4 v2, s[4:7], s84 offen offset:2048 sc1 lds
  v_mfma_f32_16x16x32_bf16 v[116:119], a[144:147], v[16:19], v[116:119]
  s_waitcnt lgkmcnt(5)
  v_exp_f32 v120, v120
  v_mfma_f32_16x16x32_bf16 v[80:83], a[192:195], v[16:19], v[176:179]
  s_waitcnt lgkmcnt(4)
  ds_read_b128 a[216:219], v10 offset:14336
  v_exp_f32 v121, v121
  v_mfma_f32_16x16x32_bf16 v[80:83], a[196:199], v[20:23], v[80:83]
  s_waitcnt lgkmcnt(4)
  ds_read_b128 a[220:223], v10 offset:15360
  v_exp_f32 v122, v122
  v_mfma_f32_16x16x32_bf16 v[80:83], a[200:203], v[24:27], v[80:83]
  s_waitcnt lgkmcnt(4)
  v_exp_f32 v123, v123
  v_mfma_f32_16x16x32_bf16 v[80:83], a[204:207], v[28:31], v[80:83]
  v_exp_f32 v116, v116
  v_mfma_f32_16x16x32_bf16 v[88:91], a[204:207], v[44:47], v[180:183]
  v_exp_f32 v117, v117
  v_mfma_f32_16x16x32_bf16 v[88:91], a[200:203], v[40:43], v[88:91]
  v_exp_f32 v118, v118
  v_mfma_f32_16x16x32_bf16 v[88:91], a[196:199], v[36:39], v[88:91]
  v_exp_f32 v119, v119
  v_mfma_f32_16x16x32_bf16 v[88:91], a[192:195], v[32:35], v[88:91]
  s_waitcnt lgkmcnt(3)
  ds_read_b128 a[224:227], v10 offset:16384
  v_cvt_pk_bf16_f32 v151, v94, v95
  v_mfma_f32_16x16x32_bf16 v[92:95], a[208:211], v[32:35], v[180:183]
  s_waitcnt lgkmcnt(3)
  v_exp_f32 v124, v124
  v_mfma_f32_16x16x32_bf16 v[92:95], a[212:215], v[36:39], v[92:95]
  s_waitcnt lgkmcnt(2)
  v_exp_f32 v125, v125
  v_mfma_f32_16x16x32_bf16 v[92:95], a[216:219], v[40:43], v[92:95]
  s_waitcnt lgkmcnt(1)
  v_exp_f32 v126, v126
  v_mfma_f32_16x16x32_bf16 v[92:95], a[220:223], v[44:47], v[92:95]
  ds_read_b128 a[160:163], v10 offset:0
  v_cvt_pk_bf16_f32 v160, v112, v113
  v_mfma_f32_16x16x32_bf16 v[84:87], a[220:223], v[28:31], v[176:179]
  v_exp_f32 v127, v127
  v_mfma_f32_16x16x32_bf16 v[84:87], a[216:219], v[24:27], v[84:87]
  v_cvt_pk_bf16_f32 v161, v114, v115
  v_cvt_pk_bf16_f32 v162, v116, v117
  v_mfma_f32_16x16x32_bf16 v[84:87], a[212:215], v[20:23], v[84:87]
  ds_read_b128 a[228:231], v10 offset:17408
  v_cvt_pk_bf16_f32 v163, v118, v119
  v_mfma_f32_16x16x32_bf16 v[84:87], a[208:211], v[16:19], v[84:87]
  ds_read_b128 a[164:167], v10 offset:1024
  v_cvt_pk_bf16_f32 v164, v120, v121
  v_mfma_f32_16x16x32_bf16 v[224:227], v[240:243], v[144:147], v[224:227]
  v_cvt_pk_bf16_f32 v165, v122, v123
  v_cvt_pk_bf16_f32 v166, v124, v125
  v_cvt_pk_bf16_f32 v167, v126, v127
  v_mfma_f32_16x16x32_bf16 v[224:227], v[240:243], v[160:163], v[224:227]
  v_exp_f32 v80, v80
  v_mfma_f32_16x16x32_bf16 v[228:231], v[240:243], v[148:151], v[228:231]
  ds_read_b128 a[232:235], v10 offset:18432
  v_mfma_f32_16x16x32_bf16 v[228:231], v[240:243], v[164:167], v[228:231]
  s_waitcnt lgkmcnt(4)
  ds_read_b128 a[168:171], v10 offset:2048
  v_exp_f32 v81, v81
  v_mfma_f32_16x16x32_bf16 a[32:35], a[224:227], v[164:167], a[32:35]
  s_waitcnt lgkmcnt(4)
  buffer_load_dwordx4 v2, s[4:7], s84 offen offset:3072 sc1 lds
  v_mfma_f32_16x16x32_bf16 a[32:35], a[160:163], v[148:151], a[32:35]
  s_add_u32 m0, s85, 4096
  v_exp_f32 v82, v82
  v_mfma_f32_16x16x32_bf16 a[0:3], a[160:163], v[144:147], a[0:3]
  ds_read_b128 a[236:239], v10 offset:19456
  v_cvt_pk_bf16_f32 v152, v80, v81
  v_mfma_f32_16x16x32_bf16 a[0:3], a[224:227], v[160:163], a[0:3]
  s_waitcnt lgkmcnt(4)
  ds_read_b128 a[172:175], v10 offset:3072
  v_mfma_f32_16x16x32_bf16 a[4:7], a[228:231], v[160:163], a[4:7]
  s_waitcnt lgkmcnt(4)
  buffer_load_dwordx4 v3, s[4:7], s84 offen offset:0 sc1 lds
  v_mfma_f32_16x16x32_bf16 a[4:7], a[164:167], v[144:147], a[4:7]
  v_exp_f32 v83, v83
  v_mfma_f32_16x16x32_bf16 a[36:39], a[164:167], v[148:151], a[36:39]
  ds_read_b128 a[240:243], v10 offset:20480
  v_cvt_pk_bf16_f32 v153, v82, v83
  v_mfma_f32_16x16x32_bf16 a[36:39], a[228:231], v[164:167], a[36:39]
  s_waitcnt lgkmcnt(4)
  ds_read_b128 a[176:179], v10 offset:4096
  v_exp_f32 v88, v88
  v_mfma_f32_16x16x32_bf16 a[40:43], a[232:235], v[164:167], a[40:43]
  s_waitcnt lgkmcnt(4)
  buffer_load_dwordx4 v3, s[4:7], s84 offen offset:1024 sc1 lds
  v_mfma_f32_16x16x32_bf16 a[40:43], a[168:171], v[148:151], a[40:43]
  v_exp_f32 v89, v89
  v_mfma_f32_16x16x32_bf16 a[8:11], a[168:171], v[144:147], a[8:11]
  ds_read_b128 a[244:247], v10 offset:21504
  v_cvt_pk_bf16_f32 v156, v88, v89
  v_mfma_f32_16x16x32_bf16 a[8:11], a[232:235], v[160:163], a[8:11]
  s_waitcnt lgkmcnt(4)
  ds_read_b128 a[180:183], v10 offset:5120
  v_mfma_f32_16x16x32_bf16 a[12:15], a[236:239], v[160:163], a[12:15]
  s_waitcnt lgkmcnt(4)
  buffer_load_dwordx4 v3, s[4:7], s84 offen offset:2048 sc1 lds
  v_mfma_f32_16x16x32_bf16 a[12:15], a[172:175], v[144:147], a[12:15]
  v_exp_f32 v90, v90
  v_mfma_f32_16x16x32_bf16 a[44:47], a[172:175], v[148:151], a[44:47]
  ds_read_b128 a[248:251], v10 offset:22528
  v_exp_f32 v91, v91
  v_mfma_f32_16x16x32_bf16 a[44:47], a[236:239], v[164:167], a[44:47]
  s_waitcnt lgkmcnt(4)
  ds_read_b128 a[184:187], v10 offset:6144
  v_cvt_pk_bf16_f32 v157, v90, v91
  v_mfma_f32_16x16x32_bf16 a[48:51], a[240:243], v[164:167], a[48:51]
  s_waitcnt lgkmcnt(4)
  buffer_load_dwordx4 v3, s[4:7], s84 offen offset:3072 sc1 lds
  v_mfma_f32_16x16x32_bf16 a[48:51], a[176:179], v[148:151], a[48:51]
  s_add_u32 m0, s85, 8192
  v_exp_f32 v84, v84
  v_mfma_f32_16x16x32_bf16 a[16:19], a[176:179], v[144:147], a[16:19]
  ds_read_b128 a[252:255], v10 offset:23552
  v_mfma_f32_16x16x32_bf16 a[16:19], a[240:243], v[160:163], a[16:19]
  s_waitcnt lgkmcnt(4)
  ds_read_b128 a[188:191], v10 offset:7168
  v_exp_f32 v85, v85
  v_mfma_f32_16x16x32_bf16 a[20:23], a[244:247], v[160:163], a[20:23]
  s_waitcnt lgkmcnt(4)
  buffer_load_dwordx4 v4, s[4:7], s84 offen offset:0 sc1 lds
  v_mfma_f32_16x16x32_bf16 a[20:23], a[180:183], v[144:147], a[20:23]
  v_exp_f32 v86, v86
  v_mfma_f32_16x16x32_bf16 a[52:55], a[180:183], v[148:151], a[52:55]
  ds_read_b128 a[128:131], v10 offset:24576
  v_cvt_pk_bf16_f32 v154, v84, v85
  v_mfma_f32_16x16x32_bf16 a[52:55], a[244:247], v[164:167], a[52:55]
  s_waitcnt lgkmcnt(4)
  ds_read_b128 a[132:135], v10 offset:25600
  v_mfma_f32_16x16x32_bf16 a[56:59], a[248:251], v[164:167], a[56:59]
  s_waitcnt lgkmcnt(4)
  ds_read_b128 a[136:139], v10 offset:26624
  v_exp_f32 v87, v87
  v_mfma_f32_16x16x32_bf16 a[56:59], a[184:187], v[148:151], a[56:59]
  ds_read_b128 a[140:143], v10 offset:27648
  v_cvt_pk_bf16_f32 v155, v86, v87
  v_mfma_f32_16x16x32_bf16 a[24:27], a[184:187], v[144:147], a[24:27]
  buffer_load_dwordx4 v4, s[4:7], s84 offen offset:1024 sc1 lds
  v_mfma_f32_16x16x32_bf16 a[24:27], a[248:251], v[160:163], a[24:27]
  s_waitcnt lgkmcnt(5)
  v_exp_f32 v92, v92
  v_mfma_f32_16x16x32_bf16 a[28:31], a[252:255], v[160:163], a[28:31]
  s_waitcnt lgkmcnt(4)
  buffer_load_dwordx4 v4, s[4:7], s84 offen offset:2048 sc1 lds
  v_mfma_f32_16x16x32_bf16 a[28:31], a[188:191], v[144:147], a[28:31]
  v_exp_f32 v93, v93
  v_mfma_f32_16x16x32_bf16 a[60:63], a[188:191], v[148:151], a[60:63]
  ds_read_b128 a[144:147], v10 offset:28672
  v_cvt_pk_bf16_f32 v158, v92, v93
  v_mfma_f32_16x16x32_bf16 a[60:63], a[252:255], v[164:167], a[60:63]
  s_waitcnt lgkmcnt(4)
  ds_read_b128 a[148:151], v10 offset:29696
  v_mfma_f32_16x16x32_bf16 v[112:115], a[128:131], v[16:19], v[176:179]
  s_waitcnt lgkmcnt(4)
  ds_read_b128 a[152:155], v10 offset:30720
  v_exp_f32 v94, v94
  v_mfma_f32_16x16x32_bf16 v[112:115], a[132:135], v[20:23], v[112:115]
  s_waitcnt lgkmcnt(4)
  ds_read_b128 a[156:159], v10 offset:31744
  v_mfma_f32_16x16x32_bf16 v[112:115], a[136:139], v[24:27], v[112:115]
  s_waitcnt lgkmcnt(4)
  buffer_load_dwordx4 v4, s[4:7], s84 offen offset:3072 sc1 lds
  v_mfma_f32_16x16x32_bf16 v[112:115], a[140:143], v[28:31], v[112:115]
  s_add_u32 m0, s85, 12288
  v_exp_f32 v95, v95
  v_mfma_f32_16x16x32_bf16 v[120:123], a[140:143], v[44:47], v[180:183]
  buffer_load_dwordx4 v5, s[4:7], s84 offen offset:0 sc1 lds
  v_mfma_f32_16x16x32_bf16 v[120:123], a[136:139], v[40:43], v[120:123]
  ds_read_b128 a[192:195], v10 offset:40960
  v_cvt_pk_bf16_f32 v159, v94, v95
  v_mfma_f32_16x16x32_bf16 v[120:123], a[132:135], v[36:39], v[120:123]
  buffer_load_dwordx4 v5, s[4:7], s84 offen offset:1024 sc1 lds
  v_mfma_f32_16x16x32_bf16 v[120:123], a[128:131], v[32:35], v[120:123]
  s_waitcnt lgkmcnt(4)
  ds_read_b128 a[196:199], v10 offset:41984
  v_mfma_f32_16x16x32_bf16 v[124:127], a[144:147], v[32:35], v[180:183]
  s_waitcnt lgkmcnt(4)
  ds_read_b128 a[200:203], v10 offset:43008
  v_exp_f32 v112, v112
  v_mfma_f32_16x16x32_bf16 v[124:127], a[148:151], v[36:39], v[124:127]
  s_waitcnt lgkmcnt(4)
  ds_read_b128 a[204:207], v10 offset:44032
  v_exp_f32 v113, v113
  v_mfma_f32_16x16x32_bf16 v[124:127], a[152:155], v[40:43], v[124:127]
  s_waitcnt lgkmcnt(4)
  v_exp_f32 v114, v114
  v_mfma_f32_16x16x32_bf16 v[124:127], a[156:159], v[44:47], v[124:127]
  v_exp_f32 v115, v115
  v_mfma_f32_16x16x32_bf16 v[116:119], a[156:159], v[28:31], v[176:179]
  buffer_load_dwordx4 v5, s[4:7], s84 offen offset:2048 sc1 lds
  v_mfma_f32_16x16x32_bf16 v[116:119], a[152:155], v[24:27], v[116:119]
  v_exp_f32 v120, v120
  v_mfma_f32_16x16x32_bf16 v[116:119], a[148:151], v[20:23], v[116:119]
  ds_read_b128 a[208:211], v10 offset:45056
  v_cvt_pk_bf16_f32 v160, v112, v113
  v_mfma_f32_16x16x32_bf16 v[116:119], a[144:147], v[16:19], v[116:119]
  s_waitcnt lgkmcnt(4)
  ds_read_b128 a[212:215], v10 offset:46080
  v_exp_f32 v121, v121
  v_mfma_f32_16x16x32_bf16 v[80:83], a[192:195], v[16:19], v[192:195]
  s_waitcnt lgkmcnt(4)
  ds_read_b128 a[216:219], v10 offset:47104
  v_exp_f32 v122, v122
  v_mfma_f32_16x16x32_bf16 v[80:83], a[196:199], v[20:23], v[80:83]
  s_waitcnt lgkmcnt(4)
  ds_read_b128 a[220:223], v10 offset:48128
  v_cvt_pk_bf16_f32 v161, v114, v115
  v_mfma_f32_16x16x32_bf16 v[80:83], a[200:203], v[24:27], v[80:83]
  s_waitcnt lgkmcnt(4)
  buffer_load_dwordx4 v5, s[4:7], s84 offen offset:3072 sc1 lds
  v_mfma_f32_16x16x32_bf16 v[80:83], a[204:207], v[28:31], v[80:83]
  s_xor_b32 s85, s85, 0x10000
  v_exp_f32 v123, v123
  v_mfma_f32_16x16x32_bf16 v[88:91], a[204:207], v[44:47], v[180:183]
  v_exp_f32 v116, v116
  v_mfma_f32_16x16x32_bf16 v[88:91], a[200:203], v[40:43], v[88:91]
  v_exp_f32 v117, v117
  v_mfma_f32_16x16x32_bf16 v[88:91], a[196:199], v[36:39], v[88:91]
  v_exp_f32 v118, v118
  v_mfma_f32_16x16x32_bf16 v[88:91], a[192:195], v[32:35], v[88:91]
  s_waitcnt lgkmcnt(3)
  v_exp_f32 v119, v119
  v_mfma_f32_16x16x32_bf16 v[92:95], a[208:211], v[32:35], v[180:183]
  s_waitcnt lgkmcnt(2)
  v_exp_f32 v124, v124
  v_mfma_f32_16x16x32_bf16 v[92:95], a[212:215], v[36:39], v[92:95]
  s_waitcnt lgkmcnt(1)
  v_exp_f32 v125, v125
  v_mfma_f32_16x16x32_bf16 v[92:95], a[216:219], v[40:43], v[92:95]
  s_waitcnt lgkmcnt(0)
  ds_read_b128 a[224:227], v10 offset:49152
  v_cvt_pk_bf16_f32 v162, v116, v117
  v_mfma_f32_16x16x32_bf16 v[92:95], a[220:223], v[44:47], v[92:95]
  ds_read_b128 a[160:163], v10 offset:32768
  v_cvt_pk_bf16_f32 v163, v118, v119
  v_mfma_f32_16x16x32_bf16 v[84:87], a[220:223], v[28:31], v[196:199]
  v_exp_f32 v126, v126
  v_mfma_f32_16x16x32_bf16 v[84:87], a[216:219], v[24:27], v[84:87]
  v_exp_f32 v127, v127
  v_mfma_f32_16x16x32_bf16 v[84:87], a[212:215], v[20:23], v[84:87]
  ds_read_b128 a[228:231], v10 offset:50176
  v_cvt_pk_bf16_f32 v164, v120, v121
  v_mfma_f32_16x16x32_bf16 v[84:87], a[208:211], v[16:19], v[84:87]
  ds_read_b128 a[164:167], v10 offset:33792
  v_cvt_pk_bf16_f32 v165, v122, v123
  v_mfma_f32_16x16x32_bf16 v[224:227], v[240:243], v[152:155], v[224:227]
  v_cvt_pk_bf16_f32 v166, v124, v125
  v_cvt_pk_bf16_f32 v167, v126, v127
  v_mfma_f32_16x16x32_bf16 v[224:227], v[240:243], v[160:163], v[224:227]
  v_exp_f32 v80, v80
  v_mfma_f32_16x16x32_bf16 v[228:231], v[240:243], v[156:159], v[228:231]
  ds_read_b128 a[232:235], v10 offset:51200
  v_mfma_f32_16x16x32_bf16 v[228:231], v[240:243], v[164:167], v[228:231]
  s_waitcnt lgkmcnt(4)
  ds_read_b128 a[168:171], v10 offset:34816
  v_exp_f32 v81, v81
  v_mfma_f32_16x16x32_bf16 a[32:35], a[224:227], v[164:167], a[32:35]
  s_waitcnt lgkmcnt(4)
  v_exp_f32 v82, v82
  v_mfma_f32_16x16x32_bf16 a[32:35], a[160:163], v[156:159], a[32:35]
  ds_read_b128 a[236:239], v10 offset:52224
  v_cvt_pk_bf16_f32 v144, v80, v81
  v_mfma_f32_16x16x32_bf16 a[0:3], a[160:163], v[152:155], a[0:3]
  ds_read_b128 a[172:175], v10 offset:35840
  v_mfma_f32_16x16x32_bf16 a[0:3], a[224:227], v[160:163], a[0:3]
  s_waitcnt lgkmcnt(5)
  v_exp_f32 v83, v83
  v_mfma_f32_16x16x32_bf16 a[4:7], a[228:231], v[160:163], a[4:7]
  s_waitcnt lgkmcnt(4)
  ds_read_b128 a[240:243], v10 offset:53248
  v_cvt_pk_bf16_f32 v145, v82, v83
  v_mfma_f32_16x16x32_bf16 a[4:7], a[164:167], v[152:155], a[4:7]
  v_exp_f32 v88, v88
  v_mfma_f32_16x16x32_bf16 a[36:39], a[164:167], v[156:159], a[36:39]
  ds_read_b128 a[176:179], v10 offset:36864
  v_mfma_f32_16x16x32_bf16 a[36:39], a[228:231], v[164:167], a[36:39]
  s_waitcnt lgkmcnt(5)
  ds_read_b128 a[244:247], v10 offset:54272
  v_mfma_f32_16x16x32_bf16 a[40:43], a[232:235], v[164:167], a[40:43]
  s_waitcnt lgkmcnt(5)
  v_exp_f32 v89, v89
  v_mfma_f32_16x16x32_bf16 a[40:43], a[168:171], v[156:159], a[40:43]
  ds_read_b128 a[180:183], v10 offset:37888
  v_cvt_pk_bf16_f32 v148, v88, v89
  v_mfma_f32_16x16x32_bf16 a[8:11], a[168:171], v[152:155], a[8:11]
  v_exp_f32 v90, v90
  v_mfma_f32_16x16x32_bf16 a[8:11], a[232:235], v[160:163], a[8:11]
  s_waitcnt lgkmcnt(5)
  ds_read_b128 a[128:131], v10 offset:57344
  v_mfma_f32_16x16x32_bf16 a[12:15], a[236:239], v[160:163], a[12:15]
  s_waitcnt lgkmcnt(5)
  ds_read_b128 a[132:135], v10 offset:58368
  v_mfma_f32_16x16x32_bf16 a[12:15], a[172:175], v[152:155], a[12:15]
  v_exp_f32 v91, v91
  v_mfma_f32_16x16x32_bf16 a[44:47], a[172:175], v[156:159], a[44:47]
  ds_read_b128 a[248:251], v10 offset:55296
  v_cvt_pk_bf16_f32 v149, v90, v91
  v_mfma_f32_16x16x32_bf16 a[44:47], a[236:239], v[164:167], a[44:47]
  s_waitcnt lgkmcnt(6)
  ds_read_b128 a[184:187], v10 offset:38912
  v_mfma_f32_16x16x32_bf16 a[48:51], a[240:243], v[164:167], a[48:51]
  s_waitcnt lgkmcnt(6)
  ds_read_b128 a[136:139], v10 offset:59392
  v_exp_f32 v84, v84
  v_mfma_f32_16x16x32_bf16 a[48:51], a[176:179], v[156:159], a[48:51]
  ds_read_b128 a[140:143], v10 offset:60416
  v_mfma_f32_16x16x32_bf16 a[16:19], a[176:179], v[152:155], a[16:19]
  ds_read_b128 a[252:255], v10 offset:56320
  v_exp_f32 v85, v85
  v_mfma_f32_16x16x32_bf16 a[16:19], a[240:243], v[160:163], a[16:19]
  s_waitcnt lgkmcnt(8)
  ds_read_b128 a[188:191], v10 offset:39936
  v_cvt_pk_bf16_f32 v146, v84, v85
  v_mfma_f32_16x16x32_bf16 a[20:23], a[244:247], v[160:163], a[20:23]
  s_waitcnt lgkmcnt(8)
  ds_read_b128 a[144:147], v10 offset:61440
  v_mfma_f32_16x16x32_bf16 a[20:23], a[180:183], v[152:155], a[20:23]
  v_exp_f32 v86, v86
  v_mfma_f32_16x16x32_bf16 a[52:55], a[180:183], v[156:159], a[52:55]
  ds_read_b128 a[148:151], v10 offset:62464
  v_mfma_f32_16x16x32_bf16 a[52:55], a[244:247], v[164:167], a[52:55]
  s_waitcnt lgkmcnt(7)
  v_exp_f32 v87, v87
  v_mfma_f32_16x16x32_bf16 a[56:59], a[248:251], v[164:167], a[56:59]
  s_waitcnt lgkmcnt(6)
  ds_read_b128 a[152:155], v10 offset:63488
  v_cvt_pk_bf16_f32 v147, v86, v87
  v_mfma_f32_16x16x32_bf16 a[56:59], a[184:187], v[156:159], a[56:59]
  s_sub_u32 s86, s86, 1
  v_exp_f32 v92, v92
  v_mfma_f32_16x16x32_bf16 a[24:27], a[184:187], v[152:155], a[24:27]
  ds_read_b128 a[156:159], v10 offset:64512
  v_mfma_f32_16x16x32_bf16 a[24:27], a[248:251], v[160:163], a[24:27]
  s_waitcnt lgkmcnt(5)
  v_exp_f32 v93, v93
  v_mfma_f32_16x16x32_bf16 a[28:31], a[252:255], v[160:163], a[28:31]
  s_waitcnt lgkmcnt(4)
  v_cvt_pk_bf16_f32 v150, v92, v93
  v_xor_b32 v10, 0x10000, v10
  v_mfma_f32_16x16x32_bf16 a[28:31], a[188:191], v[152:155], a[28:31]
  v_mfma_f32_16x16x32_bf16 a[60:63], a[188:191], v[156:159], a[60:63]
  s_waitcnt vmcnt(0) lgkmcnt(0)
  v_mfma_f32_16x16x32_bf16 a[60:63], a[252:255], v[164:167], a[60:63]
  s_cbranch_scc0 L_single
L_lfin:
  s_waitcnt vmcnt(8)
  v_cmp_ne_u32 vcc, v210, v209
  v_cmp_ne_u32 s[94:95], v213, v212
  s_nop 0
  s_or_b64 vcc, vcc, s[94:95]
  s_cbranch_vccnz L_hw_spin
L_hw_ok:
  s_cmp_eq_u32 s76, 0
  s_cbranch_scc1 L_lfin0
  s_cmp_eq_u32 s76, 1
  s_cbranch_scc1 L_lfin1
  s_cmp_eq_u32 s76, 2
  s_cbranch_scc1 L_lfin2
  v_sub_f32 v200, v244, v248
  v_sub_f32 v201, v245, v248
  v_sub_f32 v202, v246, v248
  v_sub_f32 v203, v247, v248
  v_mfma_f32_16x16x32_bf16 v[112:115], a[128:131], v[16:19], v[176:179]
  s_barrier
  ds_read_b128 a[160:163], v10 offset:0
  s_add_u32 m0, s64, 73728
  v_mfma_f32_16x16x32_bf16 v[112:115], a[132:135], v[20:23], v[112:115]
  ds_read_b128 a[164:167], v10 offset:1024
  v_mfma_f32_16x16x32_bf16 v[112:115], a[136:139], v[24:27], v[112:115]
  buffer_load_dwordx4 v1, s[8:11], s53 offen sc1 lds
  v_mfma_f32_16x16x32_bf16 v[112:115], a[140:143], v[28:31], v[112:115]
  s_add_u32 s53, s53, s55
  ds_read_b128 a[168:171], v10 offset:2048
  v_mfma_f32_16x16x32_bf16 v[120:123], a[140:143], v[44:47], v[180:183]
  ds_read_b128 a[172:175], v10 offset:3072
  v_mfma_f32_16x16x32_bf16 v[120:123], a[136:139], v[40:43], v[120:123]
  buffer_load_dwordx4 v1, s[12:15], s54 offen offset:1024 sc1 lds
  v_mfma_f32_16x16x32_bf16 v[120:123], a[132:135], v[36:39], v[120:123]
  ds_read_b128 a[176:179], v10 offset:4096
  v_mfma_f32_16x16x32_bf16 v[120:123], a[128:131], v[32:35], v[120:123]
  ds_read_b128 a[180:183], v10 offset:5120
  v_mfma_f32_16x16x32_bf16 v[124:127], a[144:147], v[32:35], v[180:183]
  v_exp_f32 v94, v94
  v_mfma_f32_16x16x32_bf16 v[124:127], a[148:151], v[36:39], v[124:127]
  ds_read_b128 a[184:187], v10 offset:6144
  v_sub_f32 v204, v244, v249
  v_mfma_f32_16x16x32_bf16 v[124:127], a[152:155], v[40:43], v[124:127]
  ds_read_b128 a[188:191], v10 offset:7168
  v_sub_f32 v205, v245, v249
  v_mfma_f32_16x16x32_bf16 v[124:127], a[156:159], v[44:47], v[124:127]
  s_mul_i32 s81, s62, 5120
  v_exp_f32 v95, v95
  v_mfma_f32_16x16x32_bf16 v[116:119], a[156:159], v[28:31], v[200:203]
  buffer_load_dwordx4 v1, s[12:15], s54 offen offset:2048 sc1 lds
  v_mfma_f32_16x16x32_bf16 v[116:119], a[152:155], v[24:27], v[116:119]
  buffer_load_dwordx4 v1, s[12:15], s54 offen offset:3072 sc1 lds
  v_mfma_f32_16x16x32_bf16 v[116:119], a[148:151], v[20:23], v[116:119]
  v_exp_f32 v112, v112
  v_mfma_f32_16x16x32_bf16 v[116:119], a[144:147], v[16:19], v[116:119]
  s_add_u32 m0, s64, 77824
  v_cvt_pk_bf16_f32 v151, v94, v95
  v_sub_f32 v206, v246, v249
  v_mfma_f32_16x16x32_bf16 v[224:227], v[240:243], v[144:147], v[224:227]
  v_exp_f32 v113, v113
  v_mfma_f32_16x16x32_bf16 v[228:231], v[240:243], v[148:151], v[228:231]
  s_waitcnt lgkmcnt(7)
  v_exp_f32 v114, v114
  v_mfma_f32_16x16x32_bf16 a[32:35], a[160:163], v[148:151], a[32:35]
  ds_read_b128 a[128:131], v10 offset:8192
  v_sub_f32 v207, v247, v249
  v_mfma_f32_16x16x32_bf16 a[0:3], a[160:163], v[144:147], a[0:3]
  s_waitcnt lgkmcnt(7)
  v_exp_f32 v115, v115
  v_mfma_f32_16x16x32_bf16 a[4:7], a[164:167], v[144:147], a[4:7]
  ds_read_b128 a[132:135], v10 offset:9216
  v_cvt_pk_bf16_f32 v160, v112, v113
  v_mfma_f32_16x16x32_bf16 a[36:39], a[164:167], v[148:151], a[36:39]
  s_waitcnt lgkmcnt(7)
  buffer_load_dwordx4 v3, s[12:15], s54 offen offset:0 sc1 lds
  v_mfma_f32_16x16x32_bf16 a[40:43], a[168:171], v[148:151], a[40:43]
  ds_read_b128 a[136:139], v10 offset:10240
  v_exp_f32 v120, v120
  v_mfma_f32_16x16x32_bf16 a[8:11], a[168:171], v[144:147], a[8:11]
  s_waitcnt lgkmcnt(7)
  v_exp_f32 v121, v121
  v_mfma_f32_16x16x32_bf16 a[12:15], a[172:175], v[144:147], a[12:15]
  ds_read_b128 a[140:143], v10 offset:11264
  v_exp_f32 v122, v122
  v_mfma_f32_16x16x32_bf16 a[44:47], a[172:175], v[148:151], a[44:47]
  s_waitcnt lgkmcnt(7)
  buffer_load_dwordx4 v3, s[12:15], s54 offen offset:1024 sc1 lds
  v_mfma_f32_16x16x32_bf16 a[48:51], a[176:179], v[148:151], a[48:51]
  v_exp_f32 v123, v123
  v_mfma_f32_16x16x32_bf16 a[16:19], a[176:179], v[144:147], a[16:19]
  s_waitcnt lgkmcnt(6)
  ds_read_b128 a[144:147], v10 offset:12288
  v_exp_f32 v116, v116
  v_mfma_f32_16x16x32_bf16 a[20:23], a[180:183], v[144:147], a[20:23]
  v_exp_f32 v117, v117
  v_mfma_f32_16x16x32_bf16 a[52:55], a[180:183], v[148:151], a[52:55]
  s_waitcnt lgkmcnt(6)
  ds_read_b128 a[148:151], v10 offset:13312
  v_exp_f32 v118, v118
  v_mfma_f32_16x16x32_bf16 a[56:59], a[184:187], v[148:151], a[56:59]
  buffer_load_dwordx4 v3, s[12:15], s54 offen offset:2048 sc1 lds
  v_mfma_f32_16x16x32_bf16 a[24:27], a[184:187], v[144:147], a[24:27]
  s_waitcnt lgkmcnt(6)
  ds_read_b128 a[152:155], v10 offset:14336
  v_exp_f32 v119, v119
  v_mfma_f32_16x16x32_bf16 a[28:31], a[188:191], v[144:147], a[28:31]
  s_waitcnt lgkmcnt(6)
  buffer_load_dwordx4 v3, s[12:15], s54 offen offset:3072 sc1 lds
  v_mfma_f32_16x16x32_bf16 a[60:63], a[188:191], v[148:151], a[60:63]
  s_add_u32 m0, s64, 81920
  ds_read_b128 a[156:159], v10 offset:15360
  v_exp_f32 v124, v124
  v_mfma_f32_16x16x32_bf16 v[88:91], a[128:131], v[32:35], v[204:207]
  s_waitcnt lgkmcnt(6)
  ds_read_b128 a[160:163], v10 offset:16384
  ds_read_b128 a[164:167], v10 offset:17408
  v_exp_f32 v125, v125
  v_mfma_f32_16x16x32_bf16 v[88:91], a[132:135], v[36:39], v[88:91]
  s_waitcnt lgkmcnt(7)
  ds_read_b128 a[168:171], v10 offset:18432
  ds_read_b128 a[172:175], v10 offset:19456
  v_exp_f32 v126, v126
  v_mfma_f32_16x16x32_bf16 v[88:91], a[136:139], v[40:43], v[88:91]
  s_waitcnt lgkmcnt(8)
  ds_read_b128 a[176:179], v10 offset:20480
  v_exp_f32 v127, v127
  v_cvt_pk_bf16_f32 v161, v114, v115
  v_cvt_pk_bf16_f32 v162, v116, v117
  v_cvt_pk_bf16_f32 v163, v118, v119
  v_mfma_f32_16x16x32_bf16 v[88:91], a[140:143], v[44:47], v[88:91]
  ds_read_b128 a[180:183], v10 offset:21504
  v_cvt_pk_bf16_f32 v164, v120, v121
  v_cvt_pk_bf16_f32 v165, v122, v123
  v_cvt_pk_bf16_f32 v166, v124, v125
  v_cvt_pk_bf16_f32 v167, v126, v127
  v_mfma_f32_16x16x32_bf16 v[224:227], v[240:243], v[160:163], v[224:227]
  ds_read_b128 a[184:187], v10 offset:22528
  v_add_u32 v12, s81, v1
  v_mfma_f32_16x16x32_bf16 v[228:231], v[240:243], v[164:167], v[228:231]
  s_waitcnt lgkmcnt(6)
  ds_read_b128 a[188:191], v10 offset:23552
  v_add_u32 v13, 73728, v12
  v_mfma_f32_16x16x32_bf16 a[32:35], a[160:163], v[164:167], a[32:35]
  s_waitcnt lgkmcnt(6)
  buffer_load_dwordx4 v4, s[12:15], s54 offen sc1 lds
  v_mfma_f32_16x16x32_bf16 a[0:3], a[160:163], v[160:163], a[0:3]
  s_add_u32 s54, s54, s56
  v_exp_f32 v88, v88
  v_mfma_f32_16x16x32_bf16 a[4:7], a[164:167], v[160:163], a[4:7]
  s_waitcnt lgkmcnt(5)
  v_exp_f32 v89, v89
  v_mfma_f32_16x16x32_bf16 a[36:39], a[164:167], v[164:167], a[36:39]
  s_add_u32 m0, s64, 110592
  v_cvt_pk_bf16_f32 v148, v88, v89
  s_and_b32 s82, s76, 2
  v_mfma_f32_16x16x32_bf16 a[40:43], a[168:171], v[164:167], a[40:43]
  s_waitcnt lgkmcnt(4)
  buffer_load_dwordx4 v1, s[8:11], s53 offen sc1 lds
  v_mfma_f32_16x16x32_bf16 a[8:11], a[168:171], v[160:163], a[8:11]
  s_add_u32 s53, s53, s55
  s_lshl1_add_u32 s82, s82, 10
  s_add_u32 s81, s52, 0
  v_mfma_f32_16x16x32_bf16 a[12:15], a[172:175], v[160:163], a[12:15]
  buffer_load_dwordx4 v1, s[12:15], s54 offen offset:1024 sc1 lds
  v_mfma_f32_16x16x32_bf16 a[44:47], a[172:175], v[164:167], a[44:47]
  s_waitcnt lgkmcnt(3)
  buffer_load_dwordx4 v1, s[12:15], s54 offen offset:2048 sc1 lds
  v_mfma_f32_16x16x32_bf16 a[48:51], a[176:179], v[164:167], a[48:51]
  s_and_b32 s81, s81, 3
  v_exp_f32 v90, v90
  v_mfma_f32_16x16x32_bf16 a[16:19], a[176:179], v[160:163], a[16:19]
  s_waitcnt lgkmcnt(2)
  buffer_load_dwordx4 v1, s[12:15], s54 offen offset:3072 sc1 lds
  v_mfma_f32_16x16x32_bf16 a[20:23], a[180:183], v[160:163], a[20:23]
  s_add_u32 m0, s64, 114688
  s_add_u32 s81, s81, s82
  v_mfma_f32_16x16x32_bf16 a[52:55], a[180:183], v[164:167], a[52:55]
  s_waitcnt lgkmcnt(1)
  buffer_load_dwordx4 v3, s[12:15], s54 offen offset:0 sc1 lds
  v_mfma_f32_16x16x32_bf16 a[56:59], a[184:187], v[164:167], a[56:59]
  s_lshl_b32 s81, s81, 10
  v_exp_f32 v91, v91
  v_mfma_f32_16x16x32_bf16 a[24:27], a[184:187], v[160:163], a[24:27]
  s_waitcnt lgkmcnt(0)
  buffer_load_dwordx4 v3, s[12:15], s54 offen offset:1024 sc1 lds
  v_mfma_f32_16x16x32_bf16 a[28:31], a[188:191], v[160:163], a[28:31]
  v_cvt_pk_bf16_f32 v149, v90, v91
  v_add_u32 v232, s81, v1
  v_mfma_f32_16x16x32_bf16 a[60:63], a[188:191], v[164:167], a[60:63]
  v_add_u32 v233, 73728, v232
  s_add_u32 s81, s52, 1
  ds_read_b128 a[160:163], v10 offset:32768
  v_mov_b32 v150, 0
  ds_read_b128 a[164:167], v10 offset:33792
  v_mov_b32 v151, 0
  ds_read_b128 a[168:171], v10 offset:34816
  ds_read_b128 a[172:175], v10 offset:35840
  ds_read_b128 a[176:179], v10 offset:36864
  ds_read_b128 a[180:183], v10 offset:37888
  v_mfma_f32_16x16x32_bf16 v[228:231], v[240:243], v[148:151], v[228:231]
  s_waitcnt lgkmcnt(4)
  ds_read_b128 a[184:187], v10 offset:38912
  s_and_b32 s81, s81, 3
  v_mfma_f32_16x16x32_bf16 a[32:35], a[160:163], v[148:151], a[32:35]
  s_add_u32 s81, s81, s82
  ds_read_b128 a[188:191], v10 offset:39936
  s_lshl_b32 s81, s81, 10
  v_mfma_f32_16x16x32_bf16 a[36:39], a[164:167], v[148:151], a[36:39]
  s_waitcnt lgkmcnt(5)
  buffer_load_dwordx4 v3, s[12:15], s54 offen offset:2048 sc1 lds
  v_mfma_f32_16x16x32_bf16 a[40:43], a[168:171], v[148:151], a[40:43]
  s_waitcnt lgkmcnt(4)
  buffer_load_dwordx4 v3, s[12:15], s54 offen offset:3072 sc1 lds
  v_mfma_f32_16x16x32_bf16 a[44:47], a[172:175], v[148:151], a[44:47]
  s_waitcnt lgkmcnt(3)
  s_add_u32 m0, s64, 118784
  v_add_u32 v234, s81, v1
  v_mfma_f32_16x16x32_bf16 a[48:51], a[176:179], v[148:151], a[48:51]
  s_waitcnt lgkmcnt(1)
  buffer_load_dwordx4 v4, s[12:15], s54 offen sc1 lds
  v_mfma_f32_16x16x32_bf16 a[52:55], a[180:183], v[148:151], a[52:55]
  s_add_u32 s54, s54, s56
  v_add_u32 v235, 73728, v234
  s_add_u32 s81, s52, 2
  v_mfma_f32_16x16x32_bf16 a[56:59], a[184:187], v[148:151], a[56:59]
  s_and_b32 s81, s81, 3
  s_add_u32 s81, s81, s82
  s_lshl_b32 s81, s81, 10
  s_waitcnt lgkmcnt(0)
  v_mfma_f32_16x16x32_bf16 a[60:63], a[188:191], v[148:151], a[60:63]
  v_add_u32 v236, s81, v1
  v_add_u32 v237, 73728, v236
  s_add_u32 s81, s52, 3
  s_and_b32 s81, s81, 3
  s_add_u32 s81, s81, s82
  s_lshl_b32 s81, s81, 10
  v_add_u32 v238, s81, v1
  v_add_u32 v239, 73728, v238
L_lepi:
  s_nop 4
  v_cmp_nle_f32 vcc, v224, v252
  v_rcp_f32 v224, v224
  s_or_b64 s[90:91], s[90:91], vcc
  v_cmp_nle_f32 vcc, v228, v252
  v_rcp_f32 v228, v228
  s_or_b64 s[90:91], s[90:91], vcc
  s_mul_i32 s88, s79, 1490944
  s_lshl_b32 s81, s77, 15
  s_add_u32 s88, s88, s81
  s_lshl_b32 s81, s76, 10
  s_add_u32 s88, s88, s81
  s_add_u32 s88, s88, 442368
  v_mov_b32 v225, v224
  v_mov_b32 v229, v228
  s_cmp_lg_u64 s[90:91], 0
  s_cselect_b32 s81, 1, 0
  s_lshl2_add_u32 s82, s76, 159744
  v_mov_b32 v216, s81
  v_mov_b32 v217, s82
  v_mov_b32 v218, 159744
  ds_write_b32 v217, v216
  v_accvgpr_read_b32 v96, a0
  v_accvgpr_read_b32 v97, a1
  v_accvgpr_read_b32 v98, a2
  v_accvgpr_read_b32 v99, a3
  v_accvgpr_read_b32 v100, a4
  v_accvgpr_read_b32 v101, a5
  v_accvgpr_read_b32 v102, a6
  v_accvgpr_read_b32 v103, a7
  v_pk_mul_f32 v[96:97], v[96:97], v[224:225]
  v_pk_mul_f32 v[98:99], v[98:99], v[224:225]
  v_pk_mul_f32 v[100:101], v[100:101], v[224:225]
  v_pk_mul_f32 v[102:103], v[102:103], v[224:225]
  v_cvt_pk_bf16_f32 v104, v96, v97
  v_cvt_pk_bf16_f32 v105, v98, v99
  v_cvt_pk_bf16_f32 v106, v100, v101
  v_cvt_pk_bf16_f32 v107, v102, v103
  buffer_store_dwordx4 v[104:107], v1, s[20:23], s88 offen sc1
  v_accvgpr_read_b32 v128, a32
  v_accvgpr_read_b32 v129, a33
  v_accvgpr_read_b32 v130, a34
  v_accvgpr_read_b32 v131, a35
  v_accvgpr_read_b32 v132, a36
  v_accvgpr_read_b32 v133, a37
  v_accvgpr_read_b32 v134, a38
  v_accvgpr_read_b32 v135, a39
  v_pk_mul_f32 v[128:129], v[128:129], v[228:229]
  v_pk_mul_f32 v[130:131], v[130:131], v[228:229]
  v_pk_mul_f32 v[132:133], v[132:133], v[228:229]
  v_pk_mul_f32 v[134:135], v[134:135], v[228:229]
  v_cvt_pk_bf16_f32 v136, v128, v129
  v_cvt_pk_bf16_f32 v137, v130, v131
  v_cvt_pk_bf16_f32 v138, v132, v133
  v_cvt_pk_bf16_f32 v139, v134, v135
  buffer_store_dwordx4 v[136:139], v7, s[20:23], s88 offen sc1
  s_add_u32 s88, s88, 8192
  v_accvgpr_read_b32 v96, a8
  v_accvgpr_read_b32 v97, a9
  v_accvgpr_read_b32 v98, a10
  v_accvgpr_read_b32 v99, a11
  v_accvgpr_read_b32 v100, a12
  v_accvgpr_read_b32 v101, a13
  v_accvgpr_read_b32 v102, a14
  v_accvgpr_read_b32 v103, a15
  v_pk_mul_f32 v[96:97], v[96:97], v[224:225]
  v_pk_mul_f32 v[98:99], v[98:99], v[224:225]
  v_pk_mul_f32 v[100:101], v[100:101], v[224:225]
  v_pk_mul_f32 v[102:103], v[102:103], v[224:225]
  v_cvt_pk_bf16_f32 v104, v96, v97
  v_cvt_pk_bf16_f32 v105, v98, v99
  v_cvt_pk_bf16_f32 v106, v100, v101
  v_cvt_pk_bf16_f32 v107, v102, v103
  buffer_store_dwordx4 v[104:107], v1, s[20:23], s88 offen sc1
  v_accvgpr_read_b32 v128, a40
  v_accvgpr_read_b32 v129, a41
  v_accvgpr_read_b32 v130, a42
  v_accvgpr_read_b32 v131, a43
  v_accvgpr_read_b32 v132, a44
  v_accvgpr_read_b32 v133, a45
  v_accvgpr_read_b32 v134, a46
  v_accvgpr_read_b32 v135, a47
  v_pk_mul_f32 v[128:129], v[128:129], v[228:229]
  v_pk_mul_f32 v[130:131], v[130:131], v[228:229]
  v_pk_mul_f32 v[132:133], v[132:133], v[228:229]
  v_pk_mul_f32 v[134:135], v[134:135], v[228:229]
  v_cvt_pk_bf16_f32 v136, v128, v129
  v_cvt_pk_bf16_f32 v137, v130, v131
  v_cvt_pk_bf16_f32 v138, v132, v133
  v_cvt_pk_bf16_f32 v139, v134, v135
  buffer_store_dwordx4 v[136:139], v7, s[20:23], s88 offen sc1
  s_add_u32 s88, s88, 8192
  v_accvgpr_read_b32 v96, a16
  v_accvgpr_read_b32 v97, a17
  v_accvgpr_read_b32 v98, a18
  v_accvgpr_read_b32 v99, a19
  v_accvgpr_read_b32 v100, a20
  v_accvgpr_read_b32 v101, a21
  v_accvgpr_read_b32 v102, a22
  v_accvgpr_read_b32 v103, a23
  v_pk_mul_f32 v[96:97], v[96:97], v[224:225]
  v_pk_mul_f32 v[98:99], v[98:99], v[224:225]
  v_pk_mul_f32 v[100:101], v[100:101], v[224:225]
  v_pk_mul_f32 v[102:103], v[102:103], v[224:225]
  v_cvt_pk_bf16_f32 v104, v96, v97
  v_cvt_pk_bf16_f32 v105, v98, v99
  v_cvt_pk_bf16_f32 v106, v100, v101
  v_cvt_pk_bf16_f32 v107, v102, v103
  buffer_store_dwordx4 v[104:107], v1, s[20:23], s88 offen sc1
  v_accvgpr_read_b32 v128, a48
  v_accvgpr_read_b32 v129, a49
  v_accvgpr_read_b32 v130, a50
  v_accvgpr_read_b32 v131, a51
  v_accvgpr_read_b32 v132, a52
  v_accvgpr_read_b32 v133, a53
  v_accvgpr_read_b32 v134, a54
  v_accvgpr_read_b32 v135, a55
  v_pk_mul_f32 v[128:129], v[128:129], v[228:229]
  v_pk_mul_f32 v[130:131], v[130:131], v[228:229]
  v_pk_mul_f32 v[132:133], v[132:133], v[228:229]
  v_pk_mul_f32 v[134:135], v[134:135], v[228:229]
  v_cvt_pk_bf16_f32 v136, v128, v129
  v_cvt_pk_bf16_f32 v137, v130, v131
  v_cvt_pk_bf16_f32 v138, v132, v133
  v_cvt_pk_bf16_f32 v139, v134, v135
  buffer_store_dwordx4 v[136:139], v7, s[20:23], s88 offen sc1
  s_add_u32 s88, s88, 8192
  v_accvgpr_read_b32 v96, a24
  v_accvgpr_read_b32 v97, a25
  v_accvgpr_read_b32 v98, a26
  v_accvgpr_read_b32 v99, a27
  v_accvgpr_read_b32 v100, a28
  v_accvgpr_read_b32 v101, a29
  v_accvgpr_read_b32 v102, a30
  v_accvgpr_read_b32 v103, a31
  v_pk_mul_f32 v[96:97], v[96:97], v[224:225]
  v_pk_mul_f32 v[98:99], v[98:99], v[224:225]
  v_pk_mul_f32 v[100:101], v[100:101], v[224:225]
  v_pk_mul_f32 v[102:103], v[102:103], v[224:225]
  v_cvt_pk_bf16_f32 v104, v96, v97
  v_cvt_pk_bf16_f32 v105, v98, v99
  v_cvt_pk_bf16_f32 v106, v100, v101
  v_cvt_pk_bf16_f32 v107, v102, v103
  buffer_store_dwordx4 v[104:107], v1, s[20:23], s88 offen sc1
  v_accvgpr_read_b32 v128, a56
  v_accvgpr_read_b32 v129, a57
  v_accvgpr_read_b32 v130, a58
  v_accvgpr_read_b32 v131, a59
  v_accvgpr_read_b32 v132, a60
  v_accvgpr_read_b32 v133, a61
  v_accvgpr_read_b32 v134, a62
  v_accvgpr_read_b32 v135, a63
  v_pk_mul_f32 v[128:129], v[128:129], v[228:229]
  v_pk_mul_f32 v[130:131], v[130:131], v[228:229]
  v_pk_mul_f32 v[132:133], v[132:133], v[228:229]
  v_pk_mul_f32 v[134:135], v[134:135], v[228:229]
  v_cvt_pk_bf16_f32 v136, v128, v129
  v_cvt_pk_bf16_f32 v137, v130, v131
  v_cvt_pk_bf16_f32 v138, v132, v133
  v_cvt_pk_bf16_f32 v139, v134, v135
  buffer_store_dwordx4 v[136:139], v7, s[20:23], s88 offen sc1
  s_waitcnt vmcnt(17) lgkmcnt(0)
  s_barrier
  ds_read_b128 v[220:223], v218
  ds_read_b128 a[0:3], v233 offset:0
  s_add_u32 m0, s64, 0
  s_nop 0
  buffer_load_dwordx4 v1, s[8:11], s53 offen sc1 lds
  s_add_u32 s53, s53, s55
  ds_read_b128 a[36:39], v233 offset:18432
  ds_read_b128 a[16:19], v13 offset:0
  buffer_load_dwordx4 v1, s[12:15], s54 offen offset:1024 sc1 lds
  ds_read_b128 a[52:55], v13 offset:18432
  ds_read_b128 a[20:23], v13 offset:1024
  buffer_load_dwordx4 v1, s[12:15], s54 offen offset:2048 sc1 lds
  ds_read_b128 a[56:59], v13 offset:19456
  ds_read_b128 a[24:27], v13 offset:2048
  buffer_load_dwordx4 v1, s[12:15], s54 offen offset:3072 sc1 lds
  ds_read_b128 a[60:63], v13 offset:20480
  ds_read_b128 a[28:31], v13 offset:3072
  s_add_u32 m0, s64, 4096
  s_nop 0
  buffer_load_dwordx4 v3, s[12:15], s54 offen offset:0 sc1 lds
  ds_read_b128 a[64:67], v13 offset:21504
  ds_read_b128 a[32:35], v13 offset:4096
  buffer_load_dwordx4 v3, s[12:15], s54 offen offset:1024 sc1 lds
  ds_read_b128 a[68:71], v13 offset:22528
  s_waitcnt lgkmcnt(12)
  v_or3_b32 v220, v220, v221, v222
  v_or_b32 v220, v220, v223
  s_nop 0
  v_readfirstlane_b32 s83, v220
  s_nop 0
  s_cmp_gt_u32 s83, s92
  s_cbranch_scc1 L_redo
  s_waitcnt lgkmcnt(0)
  v_mfma_f32_16x16x32_bf16 v[16:19], a[16:19], a[0:3], 0
  ds_read_b128 a[4:7], v235 offset:0
  v_mfma_f32_16x16x32_bf16 v[16:19], a[52:55], a[36:39], v[16:19]
  buffer_load_dwordx4 v3, s[12:15], s54 offen offset:2048 sc1 lds
  v_mfma_f32_16x16x32_bf16 v[20:23], a[56:59], a[36:39], 0
  ds_read_b128 a[40:43], v235 offset:18432
  v_lshrrev_b32 v187, 4, v14
  v_mfma_f32_16x16x32_bf16 v[20:23], a[20:23], a[0:3], v[20:23]
  v_cmp_eq_u32 vcc, 2, v187
  v_mov_b32 v188, 2146435072
  v_mfma_f32_16x16x32_bf16 v[24:27], a[24:27], a[0:3], 0
  ds_read_b128 a[8:11], v237 offset:0
  v_mov_b32 v189, s72
  v_mfma_f32_16x16x32_bf16 v[24:27], a[60:63], a[36:39], v[24:27]
  buffer_load_dwordx4 v3, s[12:15], s54 offen offset:3072 sc1 lds
  v_mfma_f32_16x16x32_bf16 v[28:31], a[64:67], a[36:39], 0
  ds_read_b128 a[44:47], v237 offset:18432
  v_cndmask_b32 v188, v188, v0, vcc
  v_mfma_f32_16x16x32_bf16 v[28:31], a[28:31], a[0:3], v[28:31]
  s_add_u32 s81, s63, 131072
  s_cmp_eq_u32 s76, 0
  s_cselect_b32 s95, 32, 0
  v_mfma_f32_16x16x32_bf16 v[32:35], a[32:35], a[0:3], 0
  s_add_u32 m0, s64, 8192
  ds_read_b128 a[12:15], v239 offset:0
  v_cmp_gt_u32 vcc, s95, v14
  v_mfma_f32_16x16x32_bf16 v[32:35], a[68:71], a[36:39], v[32:35]
  s_waitcnt lgkmcnt(3)
  buffer_load_dwordx4 v4, s[12:15], s54 offen sc1 lds
  v_mfma_f32_16x16x32_bf16 v[52:55], a[68:71], a[40:43], 0
  ds_read_b128 a[48:51], v239 offset:18432
  s_add_u32 s54, s54, s56
  v_mfma_f32_16x16x32_bf16 v[52:55], a[32:35], a[4:7], v[52:55]
  v_lshl_add_u32 v187, v14, 6, s81
  v_mov_b32 v185, 2146435072
  v_mfma_f32_16x16x32_bf16 v[48:51], a[28:31], a[4:7], 0
  v_mov_b32 v186, s72
  v_cndmask_b32 v185, v185, v187, vcc
  v_mfma_f32_16x16x32_bf16 v[48:51], a[64:67], a[40:43], v[48:51]
  v_cndmask_b32 v186, 0, v186, vcc
  v_mfma_f32_16x16x32_bf16 v[44:47], a[60:63], a[40:43], 0
  v_mfma_f32_16x16x32_bf16 v[44:47], a[24:27], a[4:7], v[44:47]
  v_mfma_f32_16x16x32_bf16 v[40:43], a[20:23], a[4:7], 0
  v_mfma_f32_16x16x32_bf16 v[40:43], a[56:59], a[40:43], v[40:43]
  s_waitcnt vmcnt(17)
  v_mfma_f32_16x16x32_bf16 v[36:39], a[52:55], a[40:43], 0
  s_waitcnt lgkmcnt(0)
  v_mfma_f32_16x16x32_bf16 v[36:39], a[16:19], a[4:7], v[36:39]
  s_barrier
  v_mfma_f32_16x16x32_bf16 v[56:59], a[16:19], a[8:11], 0
  s_add_u32 m0, s64, 36864
  ds_read_b128 a[72:75], v233 offset:36864
  v_mfma_f32_16x16x32_bf16 v[56:59], a[52:55], a[44:47], v[56:59]
  buffer_load_dwordx4 v1, s[8:11], s53 offen sc1 lds
  v_mfma_f32_16x16x32_bf16 v[60:63], a[56:59], a[44:47], 0
  s_waitcnt vmcnt(10)
  ds_read_b128 a[108:111], v233 offset:55296
  s_add_u32 s53, s53, s55
  v_mfma_f32_16x16x32_bf16 v[60:63], a[20:23], a[8:11], v[60:63]
  ds_read_b128 a[88:91], v13 offset:36864
  v_mfma_f32_16x16x32_bf16 v[64:67], a[24:27], a[8:11], 0
  buffer_load_dwordx4 v1, s[12:15], s54 offen offset:1024 sc1 lds
  v_mfma_f32_16x16x32_bf16 v[64:67], a[60:63], a[44:47], v[64:67]
  ds_read_b128 a[124:127], v13 offset:55296
  buffer_store_dword v189, v188, s[36:39], 0 offen sc1
  v_mfma_f32_16x16x32_bf16 v[68:71], a[64:67], a[44:47], 0
  ds_read_b128 a[92:95], v13 offset:37888
  v_mfma_f32_16x16x32_bf16 v[68:71], a[28:31], a[8:11], v[68:71]
  buffer_load_dwordx4 v1, s[12:15], s54 offen offset:2048 sc1 lds
  v_mfma_f32_16x16x32_bf16 v[72:75], a[32:35], a[8:11], 0
  ds_read_b128 a[128:131], v13 offset:56320
  v_mfma_f32_16x16x32_bf16 v[72:75], a[68:71], a[44:47], v[72:75]
  ds_read_b128 a[96:99], v13 offset:38912
  v_mfma_f32_16x16x32_bf16 v[92:95], a[68:71], a[48:51], 0
  buffer_load_dwordx4 v1, s[12:15], s54 offen offset:3072 sc1 lds
  v_mfma_f32_16x16x32_bf16 v[92:95], a[32:35], a[12:15], v[92:95]
  ds_read_b128 a[132:135], v13 offset:57344
  v_mfma_f32_16x16x32_bf16 v[88:91], a[28:31], a[12:15], 0
  s_add_u32 m0, s64, 40960
  ds_read_b128 a[100:103], v13 offset:39936
  v_mfma_f32_16x16x32_bf16 v[88:91], a[64:67], a[48:51], v[88:91]
  buffer_load_dwordx4 v3, s[12:15], s54 offen offset:0 sc1 lds
  v_mfma_f32_16x16x32_bf16 v[84:87], a[60:63], a[48:51], 0
  ds_read_b128 a[136:139], v13 offset:58368
  v_mfma_f32_16x16x32_bf16 v[84:87], a[24:27], a[12:15], v[84:87]
  ds_read_b128 a[104:107], v13 offset:40960
  v_mfma_f32_16x16x32_bf16 v[80:83], a[20:23], a[12:15], 0
  buffer_load_dwordx4 v3, s[12:15], s54 offen offset:1024 sc1 lds
  v_mfma_f32_16x16x32_bf16 v[80:83], a[56:59], a[48:51], v[80:83]
  ds_read_b128 a[140:143], v13 offset:59392
  v_mfma_f32_16x16x32_bf16 v[76:79], a[52:55], a[48:51], 0
  v_mfma_f32_16x16x32_bf16 v[76:79], a[16:19], a[12:15], v[76:79]
  s_waitcnt lgkmcnt(9)
  buffer_load_dwordx4 v3, s[12:15], s54 offen offset:2048 sc1 lds
  v_mfma_f32_16x16x32_bf16 v[16:19], a[88:91], a[72:75], v[16:19]
  s_waitcnt lgkmcnt(8)
  ds_read_b128 a[76:79], v235 offset:36864
  v_mfma_f32_16x16x32_bf16 v[16:19], a[124:127], a[108:111], v[16:19]
  s_waitcnt lgkmcnt(7)
  v_mfma_f32_16x16x32_bf16 v[20:23], a[128:131], a[108:111], v[20:23]
  buffer_load_dwordx4 v3, s[12:15], s54 offen offset:3072 sc1 lds
  v_mfma_f32_16x16x32_bf16 v[20:23], a[92:95], a[72:75], v[20:23]
  s_waitcnt lgkmcnt(5)
  ds_read_b128 a[112:115], v235 offset:55296
  v_mfma_f32_16x16x32_bf16 v[24:27], a[96:99], a[72:75], v[24:27]
  s_add_u32 m0, s64, 45056
  ds_read_b128 a[80:83], v237 offset:36864
  v_mfma_f32_16x16x32_bf16 v[24:27], a[132:135], a[108:111], v[24:27]
  s_waitcnt lgkmcnt(5)
  buffer_load_dwordx4 v4, s[12:15], s54 offen sc1 lds
  v_mfma_f32_16x16x32_bf16 v[28:31], a[136:139], a[108:111], v[28:31]
  s_waitcnt lgkmcnt(4)
  ds_read_b128 a[116:119], v237 offset:55296
  s_add_u32 s54, s54, s56
  v_mfma_f32_16x16x32_bf16 v[28:31], a[100:103], a[72:75], v[28:31]
  s_add_u32 m0, s64, 73728
  v_mfma_f32_16x16x32_bf16 v[32:35], a[104:107], a[72:75], v[32:35]
  s_waitcnt lgkmcnt(2)
  buffer_load_dwordx4 v1, s[8:11], s53 offen sc1 lds
  v_mfma_f32_16x16x32_bf16 v[32:35], a[140:143], a[108:111], v[32:35]
  s_add_u32 s53, s53, s55
  ds_read_b128 a[84:87], v239 offset:36864
  v_mfma_f32_16x16x32_bf16 v[52:55], a[140:143], a[112:115], v[52:55]
  ds_read_b128 a[120:123], v239 offset:55296
  v_mfma_f32_16x16x32_bf16 v[52:55], a[104:107], a[76:79], v[52:55]
  buffer_load_dwordx4 v1, s[12:15], s54 offen offset:1024 sc1 lds
  v_mfma_f32_16x16x32_bf16 v[48:51], a[100:103], a[76:79], v[48:51]
  v_mfma_f32_16x16x32_bf16 v[48:51], a[136:139], a[112:115], v[48:51]
  v_mfma_f32_16x16x32_bf16 v[44:47], a[132:135], a[112:115], v[44:47]
  buffer_load_dwordx4 v1, s[12:15], s54 offen offset:2048 sc1 lds
  v_mfma_f32_16x16x32_bf16 v[44:47], a[96:99], a[76:79], v[44:47]
  v_mfma_f32_16x16x32_bf16 v[40:43], a[92:95], a[76:79], v[40:43]
  v_mfma_f32_16x16x32_bf16 v[40:43], a[128:131], a[112:115], v[40:43]
  s_waitcnt vmcnt(13)
  v_mfma_f32_16x16x32_bf16 v[36:39], a[124:127], a[112:115], v[36:39]
  s_waitcnt lgkmcnt(0)
  v_mfma_f32_16x16x32_bf16 v[36:39], a[88:91], a[76:79], v[36:39]
  s_barrier
  v_mfma_f32_16x16x32_bf16 v[56:59], a[88:91], a[80:83], v[56:59]
  ds_read_b128 a[0:3], v232 offset:0
  v_mfma_f32_16x16x32_bf16 v[56:59], a[124:127], a[116:119], v[56:59]
  buffer_load_dwordx4 v1, s[12:15], s54 offen offset:3072 sc1 lds
  v_mfma_f32_16x16x32_bf16 v[60:63], a[128:131], a[116:119], v[60:63]
  ds_read_b128 a[36:39], v232 offset:18432
  s_lshl_b32 s81, s50, 3
  v_mfma_f32_16x16x32_bf16 v[60:63], a[92:95], a[80:83], v[60:63]
  s_add_u32 m0, s64, 77824
  ds_read_b128 a[16:19], v12 offset:0
  s_and_b32 s82, s76, 2
  v_mfma_f32_16x16x32_bf16 v[64:67], a[96:99], a[80:83], v[64:67]
  buffer_load_dwordx4 v3, s[12:15], s54 offen offset:0 sc1 lds
  v_mfma_f32_16x16x32_bf16 v[64:67], a[132:135], a[116:119], v[64:67]
  s_lshl1_add_u32 s81, s82, s81
  ds_read_b128 a[52:55], v12 offset:18432
  s_add_u32 s81, s81, s52
  v_mfma_f32_16x16x32_bf16 v[68:71], a[136:139], a[116:119], v[68:71]
  ds_read_b128 a[20:23], v12 offset:1024
  s_mul_i32 s81, s81, 20480
  v_mfma_f32_16x16x32_bf16 v[68:71], a[100:103], a[80:83], v[68:71]
  buffer_load_dwordx4 v3, s[12:15], s54 offen offset:1024 sc1 lds
  v_mfma_f32_16x16x32_bf16 v[72:75], a[104:107], a[80:83], v[72:75]
  s_lshl1_add_u32 s82, s51, s62
  ds_read_b128 a[56:59], v12 offset:19456
  s_mul_i32 s82, s82, 160
  v_mfma_f32_16x16x32_bf16 v[72:75], a[140:143], a[116:119], v[72:75]
  ds_read_b128 a[24:27], v12 offset:2048
  v_lshrrev_b32 v183, 4, v14
  v_mfma_f32_16x16x32_bf16 v[92:95], a[140:143], a[120:123], v[92:95]
  buffer_load_dwordx4 v3, s[12:15], s54 offen offset:2048 sc1 lds
  v_mfma_f32_16x16x32_bf16 v[92:95], a[104:107], a[84:87], v[92:95]
  ds_read_b128 a[60:63], v12 offset:20480
  v_lshlrev_b32 v183, 3, v183
  v_mfma_f32_16x16x32_bf16 v[88:91], a[100:103], a[84:87], v[88:91]
  ds_read_b128 a[28:31], v12 offset:3072
  v_add_u32 v183, s82, v183
  v_mfma_f32_16x16x32_bf16 v[88:91], a[136:139], a[120:123], v[88:91]
  buffer_load_dwordx4 v3, s[12:15], s54 offen offset:3072 sc1 lds
  v_mfma_f32_16x16x32_bf16 v[84:87], a[132:135], a[120:123], v[84:87]
  ds_read_b128 a[64:67], v12 offset:21504
  v_and_b32 v182, 15, v14
  v_mfma_f32_16x16x32_bf16 v[84:87], a[96:99], a[84:87], v[84:87]
  s_add_u32 m0, s64, 81920
  ds_read_b128 a[32:35], v12 offset:4096
  v_mul_u32_u24 v182, 1280, v182
  v_mfma_f32_16x16x32_bf16 v[80:83], a[92:95], a[84:87], v[80:83]
  buffer_load_dwordx4 v4, s[12:15], s54 offen sc1 lds
  v_mfma_f32_16x16x32_bf16 v[80:83], a[128:131], a[120:123], v[80:83]
  s_add_u32 s54, s54, s56
  ds_read_b128 a[68:71], v12 offset:22528
  v_add_u32 v182, s81, v182
  v_mfma_f32_16x16x32_bf16 v[76:79], a[124:127], a[120:123], v[76:79]
  s_add_u32 m0, s64, 110592
  v_add_u32 v182, v182, v183
  v_mfma_f32_16x16x32_bf16 v[76:79], a[88:91], a[84:87], v[76:79]
  s_waitcnt lgkmcnt(8)
  buffer_load_dwordx4 v1, s[8:11], s53 offen sc1 lds
  v_mfma_f32_16x16x32_bf16 v[16:19], a[16:19], a[0:3], v[16:19]
  s_add_u32 s53, s53, s57
  ds_read_b128 a[4:7], v234 offset:0
  v_mfma_f32_16x16x32_bf16 v[16:19], a[52:55], a[36:39], v[16:19]
  s_waitcnt lgkmcnt(7)
  v_mfma_f32_16x16x32_bf16 v[20:23], a[56:59], a[36:39], v[20:23]
  buffer_load_dwordx4 v1, s[12:15], s54 offen offset:1024 sc1 lds
  v_mfma_f32_16x16x32_bf16 v[20:23], a[20:23], a[0:3], v[20:23]
  s_waitcnt lgkmcnt(6)
  ds_read_b128 a[40:43], v234 offset:18432
  v_mfma_f32_16x16x32_bf16 v[24:27], a[24:27], a[0:3], v[24:27]
  s_waitcnt lgkmcnt(6)
  ds_read_b128 a[8:11], v236 offset:0
  v_mfma_f32_16x16x32_bf16 v[24:27], a[60:63], a[36:39], v[24:27]
  s_waitcnt lgkmcnt(5)
  buffer_load_dwordx4 v1, s[12:15], s54 offen offset:2048 sc1 lds
  v_mfma_f32_16x16x32_bf16 v[28:31], a[64:67], a[36:39], v[28:31]
  ds_read_b128 a[44:47], v236 offset:18432
  v_mfma_f32_16x16x32_bf16 v[28:31], a[28:31], a[0:3], v[28:31]
  s_waitcnt lgkmcnt(5)
  v_mfma_f32_16x16x32_bf16 v[32:35], a[32:35], a[0:3], v[32:35]
  s_waitcnt lgkmcnt(4)
  buffer_load_dwordx4 v1, s[12:15], s54 offen offset:3072 sc1 lds
  v_mfma_f32_16x16x32_bf16 v[32:35], a[68:71], a[36:39], v[32:35]
  s_waitcnt lgkmcnt(2)
  ds_read_b128 a[12:15], v238 offset:0
  v_mfma_f32_16x16x32_bf16 v[52:55], a[68:71], a[40:43], v[52:55]
  ds_read_b128 a[48:51], v238 offset:18432
  s_add_u32 m0, s64, 114688
  v_mfma_f32_16x16x32_bf16 v[52:55], a[32:35], a[4:7], v[52:55]
  buffer_load_dwordx4 v3, s[12:15], s54 offen offset:0 sc1 lds
  v_mfma_f32_16x16x32_bf16 v[48:51], a[28:31], a[4:7], v[48:51]
  v_mfma_f32_16x16x32_bf16 v[48:51], a[64:67], a[40:43], v[48:51]
  v_mfma_f32_16x16x32_bf16 v[44:47], a[60:63], a[40:43], v[44:47]
  buffer_load_dwordx4 v3, s[12:15], s54 offen offset:1024 sc1 lds
  v_mfma_f32_16x16x32_bf16 v[44:47], a[24:27], a[4:7], v[44:47]
  v_mfma_f32_16x16x32_bf16 v[40:43], a[20:23], a[4:7], v[40:43]
  v_mfma_f32_16x16x32_bf16 v[40:43], a[56:59], a[40:43], v[40:43]
  s_waitcnt vmcnt(15)
  v_mfma_f32_16x16x32_bf16 v[36:39], a[52:55], a[40:43], v[36:39]
  s_waitcnt lgkmcnt(0)
  v_mfma_f32_16x16x32_bf16 v[36:39], a[16:19], a[4:7], v[36:39]
  s_barrier
  v_mfma_f32_16x16x32_bf16 v[56:59], a[16:19], a[8:11], v[56:59]
  ds_read_b128 a[72:75], v232 offset:36864
  v_mfma_f32_16x16x32_bf16 v[56:59], a[52:55], a[44:47], v[56:59]
  buffer_load_dwordx4 v3, s[12:15], s54 offen offset:2048 sc1 lds
  v_mfma_f32_16x16x32_bf16 v[60:63], a[56:59], a[44:47], v[60:63]
  ds_read_b128 a[108:111], v232 offset:55296
  v_mfma_f32_16x16x32_bf16 v[60:63], a[20:23], a[8:11], v[60:63]
  ds_read_b128 a[88:91], v12 offset:36864
  v_mfma_f32_16x16x32_bf16 v[64:67], a[24:27], a[8:11], v[64:67]
  buffer_load_dwordx4 v3, s[12:15], s54 offen offset:3072 sc1 lds
  v_mfma_f32_16x16x32_bf16 v[64:67], a[60:63], a[44:47], v[64:67]
  ds_read_b128 a[124:127], v12 offset:55296
  v_mfma_f32_16x16x32_bf16 v[68:71], a[64:67], a[44:47], v[68:71]
  ds_read_b128 a[92:95], v12 offset:37888
  s_add_u32 m0, s64, 118784
  v_mfma_f32_16x16x32_bf16 v[68:71], a[28:31], a[8:11], v[68:71]
  buffer_load_dwordx4 v4, s[12:15], s54 offen sc1 lds
  v_mfma_f32_16x16x32_bf16 v[72:75], a[32:35], a[8:11], v[72:75]
  s_add_u32 s54, s54, s65
  ds_read_b128 a[128:131], v12 offset:56320
  v_mfma_f32_16x16x32_bf16 v[72:75], a[68:71], a[44:47], v[72:75]
  s_add_u32 m0, s64, 0
  ds_read_b128 a[96:99], v12 offset:38912
  v_mfma_f32_16x16x32_bf16 v[92:95], a[68:71], a[48:51], v[92:95]
  buffer_load_dwordx4 v1, s[8:11], s53 offen sc1 lds
  v_mfma_f32_16x16x32_bf16 v[92:95], a[32:35], a[12:15], v[92:95]
  s_add_u32 s53, s53, s60
  ds_read_b128 a[132:135], v12 offset:57344
  v_mfma_f32_16x16x32_bf16 v[88:91], a[28:31], a[12:15], v[88:91]
  ds_read_b128 a[100:103], v12 offset:39936
  v_mfma_f32_16x16x32_bf16 v[88:91], a[64:67], a[48:51], v[88:91]
  buffer_load_dwordx4 v1, s[12:15], s54 offen offset:1024 sc1 lds
  v_mfma_f32_16x16x32_bf16 v[84:87], a[60:63], a[48:51], v[84:87]
  ds_read_b128 a[136:139], v12 offset:58368
  v_mfma_f32_16x16x32_bf16 v[84:87], a[24:27], a[12:15], v[84:87]
  buffer_load_dword v187, v185, s[36:39], 0 offen sc1
  v_mfma_f32_16x16x32_bf16 v[80:83], a[20:23], a[12:15], v[80:83]
  ds_read_b128 a[104:107], v12 offset:40960
  v_mfma_f32_16x16x32_bf16 v[80:83], a[56:59], a[48:51], v[80:83]
  ds_read_b128 a[140:143], v12 offset:59392
  v_mfma_f32_16x16x32_bf16 v[76:79], a[52:55], a[48:51], v[76:79]
  buffer_load_dwordx4 v1, s[12:15], s54 offen offset:2048 sc1 lds
  v_mfma_f32_16x16x32_bf16 v[76:79], a[16:19], a[12:15], v[76:79]
  s_waitcnt lgkmcnt(9)
  buffer_load_dwordx4 v1, s[12:15], s54 offen offset:3072 sc1 lds
  v_mfma_f32_16x16x32_bf16 v[16:19], a[88:91], a[72:75], v[16:19]
  s_waitcnt lgkmcnt(6)
  ds_read_b128 a[76:79], v234 offset:36864
  v_mfma_f32_16x16x32_bf16 v[16:19], a[124:127], a[108:111], v[16:19]
  s_add_u32 m0, s64, 4096
  v_mfma_f32_16x16x32_bf16 v[20:23], a[128:131], a[108:111], v[20:23]
  buffer_load_dwordx4 v3, s[12:15], s54 offen offset:0 sc1 lds
  v_mfma_f32_16x16x32_bf16 v[20:23], a[92:95], a[72:75], v[20:23]
  s_waitcnt lgkmcnt(6)
  ds_read_b128 a[112:115], v234 offset:55296
  v_mfma_f32_16x16x32_bf16 v[24:27], a[96:99], a[72:75], v[24:27]
  s_waitcnt lgkmcnt(6)
  ds_read_b128 a[80:83], v236 offset:36864
  v_mfma_f32_16x16x32_bf16 v[24:27], a[132:135], a[108:111], v[24:27]
  s_waitcnt lgkmcnt(5)
  buffer_load_dwordx4 v3, s[12:15], s54 offen offset:1024 sc1 lds
  v_mfma_f32_16x16x32_bf16 v[28:31], a[136:139], a[108:111], v[28:31]
  ds_read_b128 a[116:119], v236 offset:55296
  v_mfma_f32_16x16x32_bf16 v[28:31], a[100:103], a[72:75], v[28:31]
  s_waitcnt lgkmcnt(5)
  v_mfma_f32_16x16x32_bf16 v[32:35], a[104:107], a[72:75], v[32:35]
  s_waitcnt lgkmcnt(4)
  buffer_load_dwordx4 v3, s[12:15], s54 offen offset:2048 sc1 lds
  v_mfma_f32_16x16x32_bf16 v[32:35], a[140:143], a[108:111], v[32:35]
  s_waitcnt lgkmcnt(2)
  ds_read_b128 a[84:87], v238 offset:36864
  v_mfma_f32_16x16x32_bf16 v[52:55], a[140:143], a[112:115], v[52:55]
  ds_read_b128 a[120:123], v238 offset:55296
  v_mfma_f32_16x16x32_bf16 v[52:55], a[104:107], a[76:79], v[52:55]
  buffer_load_dwordx4 v3, s[12:15], s54 offen offset:3072 sc1 lds
  v_mfma_f32_16x16x32_bf16 v[48:51], a[100:103], a[76:79], v[48:51]
  v_mfma_f32_16x16x32_bf16 v[48:51], a[136:139], a[112:115], v[48:51]
  s_add_u32 m0, s64, 8192
  v_mfma_f32_16x16x32_bf16 v[44:47], a[132:135], a[112:115], v[44:47]
  buffer_load_dwordx4 v4, s[12:15], s54 offen sc1 lds
  v_mfma_f32_16x16x32_bf16 v[44:47], a[96:99], a[76:79], v[44:47]
  s_add_u32 s54, s54, s61
  s_waitcnt vmcnt(7)
  v_cmp_ne_u32 vcc, v187, v186
  v_mfma_f32_16x16x32_bf16 v[40:43], a[92:95], a[76:79], v[40:43]
  s_cbranch_vccnz L_ctx_spin
L_ctx_ok:
  v_mfma_f32_16x16x32_bf16 v[40:43], a[128:131], a[112:115], v[40:43]
  v_mfma_f32_16x16x32_bf16 v[36:39], a[124:127], a[112:115], v[36:39]
  s_waitcnt lgkmcnt(0)
  v_mfma_f32_16x16x32_bf16 v[36:39], a[88:91], a[76:79], v[36:39]
  s_barrier
  v_mfma_f32_16x16x32_bf16 v[56:59], a[88:91], a[80:83], v[56:59]
  s_add_u32 m0, s64, 36864
  ds_read_b128 a[0:3], v233 offset:0
  v_mfma_f32_16x16x32_bf16 v[56:59], a[124:127], a[116:119], v[56:59]
  ds_read_b128 a[36:39], v233 offset:18432
  v_mfma_f32_16x16x32_bf16 v[60:63], a[128:131], a[116:119], v[60:63]
  buffer_load_dwordx4 v1, s[8:11], s53 offen sc1 lds
  v_mfma_f32_16x16x32_bf16 v[60:63], a[92:95], a[80:83], v[60:63]
  s_add_u32 s53, s53, s55
  ds_read_b128 a[16:19], v13 offset:0
  v_lshlrev_b32 v184, 3, v14
  v_mfma_f32_16x16x32_bf16 v[64:67], a[96:99], a[80:83], v[64:67]
  s_lshl2_add_u32 s94, s50, s51
  ds_read_b128 a[52:55], v13 offset:18432
  s_lshl_b32 s94, s94, 6
  v_mfma_f32_16x16x32_bf16 v[64:67], a[132:135], a[116:119], v[64:67]
  buffer_load_dwordx4 v1, s[12:15], s54 offen offset:1024 sc1 lds
  v_mfma_f32_16x16x32_bf16 v[68:71], a[136:139], a[116:119], v[68:71]
  ds_read_b128 a[20:23], v13 offset:1024
  s_add_u32 s94, s94, s76
  v_mfma_f32_16x16x32_bf16 v[68:71], a[100:103], a[80:83], v[68:71]
  s_add_u32 s95, s52, 1
  ds_read_b128 a[56:59], v13 offset:19456
  s_and_b32 s95, s95, 3
  v_mfma_f32_16x16x32_bf16 v[72:75], a[104:107], a[80:83], v[72:75]
  s_lshl2_add_u32 s81, s95, s52
  s_lshl2_add_u32 s81, s81, s94
  s_lshl_b32 s81, s81, 12
  v_mfma_f32_16x16x32_bf16 v[72:75], a[140:143], a[116:119], v[72:75]
  s_lshl2_add_u32 s60, s52, s95
  ds_read_b128 a[24:27], v13 offset:2048
  s_lshl2_add_u32 s60, s60, s94
  v_mfma_f32_16x16x32_bf16 v[92:95], a[140:143], a[120:123], v[92:95]
  ds_read_b128 a[60:63], v13 offset:20480
  s_lshl_b32 s60, s60, 12
  v_mfma_f32_16x16x32_bf16 v[92:95], a[104:107], a[84:87], v[92:95]
  buffer_load_dwordx4 v1, s[12:15], s54 offen offset:2048 sc1 lds
  v_mfma_f32_16x16x32_bf16 v[88:91], a[100:103], a[84:87], v[88:91]
  ds_read_b128 a[28:31], v13 offset:3072
  v_mov_b32 v139, s72
  v_mfma_f32_16x16x32_bf16 v[88:91], a[136:139], a[120:123], v[88:91]
  ds_read_b128 a[64:67], v13 offset:21504
  v_mov_b32 v143, s72
  v_mfma_f32_16x16x32_bf16 v[84:87], a[132:135], a[120:123], v[84:87]
  buffer_load_dwordx4 v1, s[12:15], s54 offen offset:3072 sc1 lds
  v_mfma_f32_16x16x32_bf16 v[84:87], a[96:99], a[84:87], v[84:87]
  s_add_u32 m0, s64, 40960
  ds_read_b128 a[32:35], v13 offset:4096
  v_mov_b32 v147, s72
  v_mfma_f32_16x16x32_bf16 v[80:83], a[92:95], a[84:87], v[80:83]
  ds_read_b128 a[68:71], v13 offset:22528
  v_mov_b32 v149, s72
  v_mfma_f32_16x16x32_bf16 v[80:83], a[128:131], a[120:123], v[80:83]
  buffer_load_dwordx4 v3, s[12:15], s54 offen offset:0 sc1 lds
  v_mfma_f32_16x16x32_bf16 v[76:79], a[124:127], a[120:123], v[76:79]
  s_waitcnt lgkmcnt(9)
  s_add_u32 s95, s52, 2
  s_and_b32 s95, s95, 3
  v_mfma_f32_16x16x32_bf16 v[76:79], a[88:91], a[84:87], v[76:79]
  s_lshl2_add_u32 s82, s95, s52
  s_lshl2_add_u32 s82, s82, s94
  s_lshl_b32 s82, s82, 12
  v_mfma_f32_16x16x32_bf16 v[16:19], a[16:19], a[0:3], v[16:19]
  s_lshl2_add_u32 s61, s52, s95
  ds_read_b128 a[4:7], v235 offset:0
  s_lshl2_add_u32 s61, s61, s94
  s_waitcnt lgkmcnt(9)
  v_mfma_f32_16x16x32_bf16 v[16:19], a[52:55], a[36:39], v[16:19]
  s_waitcnt lgkmcnt(7)
  buffer_load_dwordx4 v3, s[12:15], s54 offen offset:1024 sc1 lds
  v_mfma_f32_16x16x32_bf16 v[20:23], a[56:59], a[36:39], v[20:23]
  ds_read_b128 a[40:43], v235 offset:18432
  s_lshl_b32 s61, s61, 12
  v_mfma_f32_16x16x32_bf16 v[20:23], a[20:23], a[0:3], v[20:23]
  s_waitcnt lgkmcnt(7)
  v_mov_b32 v153, s72
  v_mov_b32 v157, s72
  v_mfma_f32_16x16x32_bf16 v[24:27], a[24:27], a[0:3], v[24:27]
  s_waitcnt lgkmcnt(6)
  ds_read_b128 a[8:11], v237 offset:0
  v_mov_b32 v161, s72
  v_mfma_f32_16x16x32_bf16 v[24:27], a[60:63], a[36:39], v[24:27]
  s_waitcnt lgkmcnt(5)
  buffer_load_dwordx4 v3, s[12:15], s54 offen offset:2048 sc1 lds
  v_mfma_f32_16x16x32_bf16 v[28:31], a[64:67], a[36:39], v[28:31]
  s_waitcnt lgkmcnt(4)
  ds_read_b128 a[44:47], v237 offset:18432
  v_mov_b32 v163, s72
  v_mfma_f32_16x16x32_bf16 v[28:31], a[28:31], a[0:3], v[28:31]
  s_add_u32 s95, s52, 3
  s_and_b32 s95, s95, 3
  s_lshl2_add_u32 s83, s95, s52
  v_mfma_f32_16x16x32_bf16 v[32:35], a[32:35], a[0:3], v[32:35]
  s_lshl2_add_u32 s83, s83, s94
  ds_read_b128 a[12:15], v239 offset:0
  s_lshl_b32 s83, s83, 12
  s_waitcnt lgkmcnt(5)
  v_mfma_f32_16x16x32_bf16 v[32:35], a[68:71], a[36:39], v[32:35]
  s_waitcnt lgkmcnt(3)
  buffer_load_dwordx4 v3, s[12:15], s54 offen offset:3072 sc1 lds
  v_mfma_f32_16x16x32_bf16 v[52:55], a[68:71], a[40:43], v[52:55]
  s_add_u32 m0, s64, 45056
  ds_read_b128 a[48:51], v239 offset:18432
  s_lshl2_add_u32 s57, s52, s95
  v_mfma_f32_16x16x32_bf16 v[52:55], a[32:35], a[4:7], v[52:55]
  s_lshl2_add_u32 s57, s57, s94
  s_lshl_b32 s57, s57, 12
  v_mov_b32 v167, s72
  v_mfma_f32_16x16x32_bf16 v[48:51], a[28:31], a[4:7], v[48:51]
  v_mov_b32 v171, s72
  v_mov_b32 v175, s72
  v_mfma_f32_16x16x32_bf16 v[48:51], a[64:67], a[40:43], v[48:51]
  buffer_load_dwordx4 v4, s[12:15], s54 offen sc1 lds
  v_mfma_f32_16x16x32_bf16 v[44:47], a[60:63], a[40:43], v[44:47]
  s_add_u32 s54, s54, s56
  v_mov_b32 v177, s72
  v_mov_b32 v185, 2146435072
  v_mfma_f32_16x16x32_bf16 v[44:47], a[24:27], a[4:7], v[44:47]
  v_mov_b32 v186, 0
  s_add_u32 s95, s60, 3580
  v_mfma_f32_16x16x32_bf16 v[40:43], a[20:23], a[4:7], v[40:43]
  v_writelane_b32 v185, s95, 0
  v_writelane_b32 v186, s72, 0
  v_mfma_f32_16x16x32_bf16 v[40:43], a[56:59], a[40:43], v[40:43]
  s_add_u32 s95, s61, 3580
  v_writelane_b32 v185, s95, 1
  v_mfma_f32_16x16x32_bf16 v[36:39], a[52:55], a[40:43], v[36:39]
  s_waitcnt lgkmcnt(0)
  v_writelane_b32 v186, s72, 1
  s_add_u32 s95, s57, 3580
  v_mfma_f32_16x16x32_bf16 v[36:39], a[16:19], a[4:7], v[36:39]
  s_barrier
  v_writelane_b32 v185, s95, 2
  v_writelane_b32 v186, s72, 2
  buffer_load_dword v187, v185, s[32:35], 0 offen sc1
  s_mov_b32 s86, 3
  .p2align 6
L_pc_loop:
  v_mfma_f32_16x16x32_bf16 v[56:59], a[16:19], a[8:11], v[56:59]
  s_add_u32 m0, s64, 73728
  ds_read_b128 a[72:75], v233 offset:36864
  v_mfma_f32_16x16x32_bf16 v[56:59], a[52:55], a[44:47], v[56:59]
  ds_read_b128 a[108:111], v233 offset:55296
  v_mfma_f32_16x16x32_bf16 v[60:63], a[56:59], a[44:47], v[60:63]
  buffer_load_dwordx4 v1, s[8:11], s53 offen sc1 lds
  v_mfma_f32_16x16x32_bf16 v[60:63], a[20:23], a[8:11], v[60:63]
  s_add_u32 s53, s53, s55
  ds_read_b128 a[88:91], v13 offset:36864
  v_mfma_f32_16x16x32_bf16 v[64:67], a[24:27], a[8:11], v[64:67]
  ds_read_b128 a[124:127], v13 offset:55296
  v_mfma_f32_16x16x32_bf16 v[64:67], a[60:63], a[44:47], v[64:67]
  buffer_load_dwordx4 v1, s[12:15], s54 offen offset:1024 sc1 lds
  v_mfma_f32_16x16x32_bf16 v[68:71], a[64:67], a[44:47], v[68:71]
  ds_read_b128 a[92:95], v13 offset:37888
  v_mfma_f32_16x16x32_bf16 v[68:71], a[28:31], a[8:11], v[68:71]
  ds_read_b128 a[128:131], v13 offset:56320
  v_mfma_f32_16x16x32_bf16 v[72:75], a[32:35], a[8:11], v[72:75]
  v_mfma_f32_16x16x32_bf16 v[72:75], a[68:71], a[44:47], v[72:75]
  ds_read_b128 a[96:99], v13 offset:38912
  v_mfma_f32_16x16x32_bf16 v[92:95], a[68:71], a[48:51], v[92:95]
  ds_read_b128 a[132:135], v13 offset:57344
  v_mfma_f32_16x16x32_bf16 v[92:95], a[32:35], a[12:15], v[92:95]
  buffer_load_dwordx4 v1, s[12:15], s54 offen offset:2048 sc1 lds
  v_mfma_f32_16x16x32_bf16 v[88:91], a[28:31], a[12:15], v[88:91]
  ds_read_b128 a[100:103], v13 offset:39936
  v_mfma_f32_16x16x32_bf16 v[88:91], a[64:67], a[48:51], v[88:91]
  ds_read_b128 a[136:139], v13 offset:58368
  v_mfma_f32_16x16x32_bf16 v[84:87], a[60:63], a[48:51], v[84:87]
  buffer_load_dwordx4 v1, s[12:15], s54 offen offset:3072 sc1 lds
  v_mfma_f32_16x16x32_bf16 v[84:87], a[24:27], a[12:15], v[84:87]
  s_add_u32 m0, s64, 77824
  ds_read_b128 a[104:107], v13 offset:40960
  v_mfma_f32_16x16x32_bf16 v[80:83], a[20:23], a[12:15], v[80:83]
  ds_read_b128 a[140:143], v13 offset:59392
  v_mfma_f32_16x16x32_bf16 v[80:83], a[56:59], a[48:51], v[80:83]
  buffer_load_dwordx4 v3, s[12:15], s54 offen offset:0 sc1 lds
  v_mfma_f32_16x16x32_bf16 v[76:79], a[52:55], a[48:51], v[76:79]
  v_mfma_f32_16x16x32_bf16 v[76:79], a[16:19], a[12:15], v[76:79]
  s_waitcnt lgkmcnt(9)
  v_mfma_f32_16x16x32_bf16 v[16:19], a[88:91], a[72:75], v[16:19]
  s_waitcnt lgkmcnt(8)
  ds_read_b128 a[76:79], v235 offset:36864
  v_mfma_f32_16x16x32_bf16 v[16:19], a[124:127], a[108:111], v[16:19]
  s_waitcnt lgkmcnt(7)
  buffer_load_dwordx4 v3, s[12:15], s54 offen offset:1024 sc1 lds
  v_mfma_f32_16x16x32_bf16 v[20:23], a[128:131], a[108:111], v[20:23]
  ds_read_b128 a[112:115], v235 offset:55296
  v_mfma_f32_16x16x32_bf16 v[20:23], a[92:95], a[72:75], v[20:23]
  s_waitcnt lgkmcnt(7)
  v_mfma_f32_16x16x32_bf16 v[24:27], a[96:99], a[72:75], v[24:27]
  s_waitcnt lgkmcnt(6)
  ds_read_b128 a[80:83], v237 offset:36864
  v_mfma_f32_16x16x32_bf16 v[24:27], a[132:135], a[108:111], v[24:27]
  s_waitcnt lgkmcnt(5)
  buffer_load_dwordx4 v3, s[12:15], s54 offen offset:2048 sc1 lds
  v_mfma_f32_16x16x32_bf16 v[28:31], a[136:139], a[108:111], v[28:31]
  ds_read_b128 a[116:119], v237 offset:55296
  v_mfma_f32_16x16x32_bf16 v[28:31], a[100:103], a[72:75], v[28:31]
  s_waitcnt lgkmcnt(5)
  v_mfma_f32_16x16x32_bf16 v[32:35], a[104:107], a[72:75], v[32:35]
  s_waitcnt lgkmcnt(4)
  ds_read_b128 a[84:87], v239 offset:36864
  v_mfma_f32_16x16x32_bf16 v[32:35], a[140:143], a[108:111], v[32:35]
  s_waitcnt lgkmcnt(3)
  buffer_load_dwordx4 v3, s[12:15], s54 offen offset:3072 sc1 lds
  v_mfma_f32_16x16x32_bf16 v[52:55], a[140:143], a[112:115], v[52:55]
  s_add_u32 m0, s64, 81920
  ds_read_b128 a[120:123], v239 offset:55296
  v_mfma_f32_16x16x32_bf16 v[52:55], a[104:107], a[76:79], v[52:55]
  v_mfma_f32_16x16x32_bf16 v[48:51], a[100:103], a[76:79], v[48:51]
  v_mfma_f32_16x16x32_bf16 v[48:51], a[136:139], a[112:115], v[48:51]
  buffer_load_dwordx4 v4, s[12:15], s54 offen sc1 lds
  v_mfma_f32_16x16x32_bf16 v[44:47], a[132:135], a[112:115], v[44:47]
  s_add_u32 s54, s54, s56
  v_mfma_f32_16x16x32_bf16 v[44:47], a[96:99], a[76:79], v[44:47]
  v_mfma_f32_16x16x32_bf16 v[40:43], a[92:95], a[76:79], v[40:43]
  v_mfma_f32_16x16x32_bf16 v[40:43], a[128:131], a[112:115], v[40:43]
  v_mfma_f32_16x16x32_bf16 v[36:39], a[124:127], a[112:115], v[36:39]
  s_waitcnt vmcnt(18) lgkmcnt(0)
  v_mfma_f32_16x16x32_bf16 v[36:39], a[88:91], a[76:79], v[36:39]
  s_barrier
  v_mfma_f32_16x16x32_bf16 v[56:59], a[88:91], a[80:83], v[56:59]
  s_add_u32 m0, s64, 110592
  ds_read_b128 a[0:3], v232 offset:0
  v_mfma_f32_16x16x32_bf16 v[56:59], a[124:127], a[116:119], v[56:59]
  ds_read_b128 a[36:39], v232 offset:18432
  v_mfma_f32_16x16x32_bf16 v[60:63], a[128:131], a[116:119], v[60:63]
  buffer_load_dwordx4 v1, s[8:11], s53 offen sc1 lds
  v_mfma_f32_16x16x32_bf16 v[60:63], a[92:95], a[80:83], v[60:63]
  s_add_u32 s53, s53, s55
  ds_read_b128 a[16:19], v12 offset:0
  v_mfma_f32_16x16x32_bf16 v[64:67], a[96:99], a[80:83], v[64:67]
  ds_read_b128 a[52:55], v12 offset:18432
  v_mfma_f32_16x16x32_bf16 v[64:67], a[132:135], a[116:119], v[64:67]
  buffer_load_dwordx4 v1, s[12:15], s54 offen offset:1024 sc1 lds
  v_mfma_f32_16x16x32_bf16 v[68:71], a[136:139], a[116:119], v[68:71]
  ds_read_b128 a[20:23], v12 offset:1024
  v_mfma_f32_16x16x32_bf16 v[68:71], a[100:103], a[80:83], v[68:71]
  ds_read_b128 a[56:59], v12 offset:19456
  v_mfma_f32_16x16x32_bf16 v[72:75], a[104:107], a[80:83], v[72:75]
  v_mfma_f32_16x16x32_bf16 v[72:75], a[140:143], a[116:119], v[72:75]
  ds_read_b128 a[24:27], v12 offset:2048
  v_mfma_f32_16x16x32_bf16 v[92:95], a[140:143], a[120:123], v[92:95]
  ds_read_b128 a[60:63], v12 offset:20480
  v_mfma_f32_16x16x32_bf16 v[92:95], a[104:107], a[84:87], v[92:95]
  buffer_load_dwordx4 v1, s[12:15], s54 offen offset:2048 sc1 lds
  v_mfma_f32_16x16x32_bf16 v[88:91], a[100:103], a[84:87], v[88:91]
  ds_read_b128 a[28:31], v12 offset:3072
  v_mfma_f32_16x16x32_bf16 v[88:91], a[136:139], a[120:123], v[88:91]
  ds_read_b128 a[64:67], v12 offset:21504
  v_mfma_f32_16x16x32_bf16 v[84:87], a[132:135], a[120:123], v[84:87]
  buffer_load_dwordx4 v1, s[12:15], s54 offen offset:3072 sc1 lds
  v_mfma_f32_16x16x32_bf16 v[84:87], a[96:99], a[84:87], v[84:87]
  s_add_u32 m0, s64, 114688
  ds_read_b128 a[32:35], v12 offset:4096
  v_mfma_f32_16x16x32_bf16 v[80:83], a[92:95], a[84:87], v[80:83]
  ds_read_b128 a[68:71], v12 offset:22528
  v_mfma_f32_16x16x32_bf16 v[80:83], a[128:131], a[120:123], v[80:83]
  buffer_load_dwordx4 v3, s[12:15], s54 offen offset:0 sc1 lds
  v_mfma_f32_16x16x32_bf16 v[76:79], a[124:127], a[120:123], v[76:79]
  v_mfma_f32_16x16x32_bf16 v[76:79], a[88:91], a[84:87], v[76:79]
  s_waitcnt lgkmcnt(9)
  v_mfma_f32_16x16x32_bf16 v[16:19], a[16:19], a[0:3], v[16:19]
  s_waitcnt lgkmcnt(8)
  ds_read_b128 a[4:7], v234 offset:0
  v_mfma_f32_16x16x32_bf16 v[16:19], a[52:55], a[36:39], v[16:19]
  s_waitcnt lgkmcnt(7)
  buffer_load_dwordx4 v3, s[12:15], s54 offen offset:1024 sc1 lds
  v_mfma_f32_16x16x32_bf16 v[20:23], a[56:59], a[36:39], v[20:23]
  ds_read_b128 a[40:43], v234 offset:18432
  v_mfma_f32_16x16x32_bf16 v[20:23], a[20:23], a[0:3], v[20:23]
  s_waitcnt lgkmcnt(7)
  v_mfma_f32_16x16x32_bf16 v[24:27], a[24:27], a[0:3], v[24:27]
  s_waitcnt lgkmcnt(6)
  ds_read_b128 a[8:11], v236 offset:0
  v_mfma_f32_16x16x32_bf16 v[24:27], a[60:63], a[36:39], v[24:27]
  s_waitcnt lgkmcnt(5)
  buffer_load_dwordx4 v3, s[12:15], s54 offen offset:2048 sc1 lds
  v_mfma_f32_16x16x32_bf16 v[28:31], a[64:67], a[36:39], v[28:31]
  ds_read_b128 a[44:47], v236 offset:18432
  v_mfma_f32_16x16x32_bf16 v[28:31], a[28:31], a[0:3], v[28:31]
  s_waitcnt lgkmcnt(5)
  v_mfma_f32_16x16x32_bf16 v[32:35], a[32:35], a[0:3], v[32:35]
  s_waitcnt lgkmcnt(4)
  ds_read_b128 a[12:15], v238 offset:0
  v_mfma_f32_16x16x32_bf16 v[32:35], a[68:71], a[36:39], v[32:35]
  s_waitcnt lgkmcnt(3)
  buffer_load_dwordx4 v3, s[12:15], s54 offen offset:3072 sc1 lds
  v_mfma_f32_16x16x32_bf16 v[52:55], a[68:71], a[40:43], v[52:55]
  s_add_u32 m0, s64, 118784
  ds_read_b128 a[48:51], v238 offset:18432
  v_mfma_f32_16x16x32_bf16 v[52:55], a[32:35], a[4:7], v[52:55]
  v_mfma_f32_16x16x32_bf16 v[48:51], a[28:31], a[4:7], v[48:51]
  v_mfma_f32_16x16x32_bf16 v[48:51], a[64:67], a[40:43], v[48:51]
  buffer_load_dwordx4 v4, s[12:15], s54 offen sc1 lds
  v_mfma_f32_16x16x32_bf16 v[44:47], a[60:63], a[40:43], v[44:47]
  s_add_u32 s54, s54, s56
  v_mfma_f32_16x16x32_bf16 v[44:47], a[24:27], a[4:7], v[44:47]
  v_mfma_f32_16x16x32_bf16 v[40:43], a[20:23], a[4:7], v[40:43]
  v_mfma_f32_16x16x32_bf16 v[40:43], a[56:59], a[40:43], v[40:43]
  v_mfma_f32_16x16x32_bf16 v[36:39], a[52:55], a[40:43], v[36:39]
  s_waitcnt vmcnt(18) lgkmcnt(0)
  v_mfma_f32_16x16x32_bf16 v[36:39], a[16:19], a[4:7], v[36:39]
  s_barrier
  v_mfma_f32_16x16x32_bf16 v[56:59], a[16:19], a[8:11], v[56:59]
  s_add_u32 m0, s64, 0
  ds_read_b128 a[72:75], v232 offset:36864
  v_mfma_f32_16x16x32_bf16 v[56:59], a[52:55], a[44:47], v[56:59]
  ds_read_b128 a[108:111], v232 offset:55296
  v_mfma_f32_16x16x32_bf16 v[60:63], a[56:59], a[44:47], v[60:63]
  buffer_load_dwordx4 v1, s[8:11], s53 offen sc1 lds
  v_mfma_f32_16x16x32_bf16 v[60:63], a[20:23], a[8:11], v[60:63]
  s_add_u32 s53, s53, s55
  ds_read_b128 a[88:91], v12 offset:36864
  v_mfma_f32_16x16x32_bf16 v[64:67], a[24:27], a[8:11], v[64:67]
  ds_read_b128 a[124:127], v12 offset:55296
  v_mfma_f32_16x16x32_bf16 v[64:67], a[60:63], a[44:47], v[64:67]
  buffer_load_dwordx4 v1, s[12:15], s54 offen offset:1024 sc1 lds
  v_mfma_f32_16x16x32_bf16 v[68:71], a[64:67], a[44:47], v[68:71]
  ds_read_b128 a[92:95], v12 offset:37888
  v_mfma_f32_16x16x32_bf16 v[68:71], a[28:31], a[8:11], v[68:71]
  ds_read_b128 a[128:131], v12 offset:56320
  v_mfma_f32_16x16x32_bf16 v[72:75], a[32:35], a[8:11], v[72:75]
  v_mfma_f32_16x16x32_bf16 v[72:75], a[68:71], a[44:47], v[72:75]
  ds_read_b128 a[96:99], v12 offset:38912
  v_mfma_f32_16x16x32_bf16 v[92:95], a[68:71], a[48:51], v[92:95]
  ds_read_b128 a[132:135], v12 offset:57344
  v_mfma_f32_16x16x32_bf16 v[92:95], a[32:35], a[12:15], v[92:95]
  buffer_load_dwordx4 v1, s[12:15], s54 offen offset:2048 sc1 lds
  v_mfma_f32_16x16x32_bf16 v[88:91], a[28:31], a[12:15], v[88:91]
  ds_read_b128 a[100:103], v12 offset:39936
  v_mfma_f32_16x16x32_bf16 v[88:91], a[64:67], a[48:51], v[88:91]
  ds_read_b128 a[136:139], v12 offset:58368
  v_mfma_f32_16x16x32_bf16 v[84:87], a[60:63], a[48:51], v[84:87]
  buffer_load_dwordx4 v1, s[12:15], s54 offen offset:3072 sc1 lds
  v_mfma_f32_16x16x32_bf16 v[84:87], a[24:27], a[12:15], v[84:87]
  s_add_u32 m0, s64, 4096
  ds_read_b128 a[104:107], v12 offset:40960
  v_mfma_f32_16x16x32_bf16 v[80:83], a[20:23], a[12:15], v[80:83]
  ds_read_b128 a[140:143], v12 offset:59392
  v_mfma_f32_16x16x32_bf16 v[80:83], a[56:59], a[48:51], v[80:83]
  buffer_load_dwordx4 v3, s[12:15], s54 offen offset:0 sc1 lds
  v_mfma_f32_16x16x32_bf16 v[76:79], a[52:55], a[48:51], v[76:79]
  v_mfma_f32_16x16x32_bf16 v[76:79], a[16:19], a[12:15], v[76:79]
  s_waitcnt lgkmcnt(9)
  v_mfma_f32_16x16x32_bf16 v[16:19], a[88:91], a[72:75], v[16:19]
  s_waitcnt lgkmcnt(8)
  ds_read_b128 a[76:79], v234 offset:36864
  v_mfma_f32_16x16x32_bf16 v[16:19], a[124:127], a[108:111], v[16:19]
  s_waitcnt lgkmcnt(7)
  buffer_load_dwordx4 v3, s[12:15], s54 offen offset:1024 sc1 lds
  v_mfma_f32_16x16x32_bf16 v[20:23], a[128:131], a[108:111], v[20:23]
  ds_read_b128 a[112:115], v234 offset:55296
  v_mfma_f32_16x16x32_bf16 v[20:23], a[92:95], a[72:75], v[20:23]
  s_waitcnt lgkmcnt(7)
  v_mfma_f32_16x16x32_bf16 v[24:27], a[96:99], a[72:75], v[24:27]
  s_waitcnt lgkmcnt(6)
  ds_read_b128 a[80:83], v236 offset:36864
  v_mfma_f32_16x16x32_bf16 v[24:27], a[132:135], a[108:111], v[24:27]
  s_waitcnt lgkmcnt(5)
  buffer_load_dwordx4 v3, s[12:15], s54 offen offset:2048 sc1 lds
  v_mfma_f32_16x16x32_bf16 v[28:31], a[136:139], a[108:111], v[28:31]
  ds_read_b128 a[116:119], v236 offset:55296
  v_mfma_f32_16x16x32_bf16 v[28:31], a[100:103], a[72:75], v[28:31]
  s_waitcnt lgkmcnt(5)
  v_mfma_f32_16x16x32_bf16 v[32:35], a[104:107], a[72:75], v[32:35]
  s_waitcnt lgkmcnt(4)
  ds_read_b128 a[84:87], v238 offset:36864
  v_mfma_f32_16x16x32_bf16 v[32:35], a[140:143], a[108:111], v[32:35]
  s_waitcnt lgkmcnt(3)
  buffer_load_dwordx4 v3, s[12:15], s54 offen offset:3072 sc1 lds
  v_mfma_f32_16x16x32_bf16 v[52:55], a[140:143], a[112:115], v[52:55]
  s_add_u32 m0, s64, 8192
  ds_read_b128 a[120:123], v238 offset:55296
  v_mfma_f32_16x16x32_bf16 v[52:55], a[104:107], a[76:79], v[52:55]
  v_mfma_f32_16x16x32_bf16 v[48:51], a[100:103], a[76:79], v[48:51]
  v_mfma_f32_16x16x32_bf16 v[48:51], a[136:139], a[112:115], v[48:51]
  buffer_load_dwordx4 v4, s[12:15], s54 offen sc1 lds
  v_mfma_f32_16x16x32_bf16 v[44:47], a[132:135], a[112:115], v[44:47]
  s_add_u32 s54, s54, s56
  v_mfma_f32_16x16x32_bf16 v[44:47], a[96:99], a[76:79], v[44:47]
  v_mfma_f32_16x16x32_bf16 v[40:43], a[92:95], a[76:79], v[40:43]
  v_mfma_f32_16x16x32_bf16 v[40:43], a[128:131], a[112:115], v[40:43]
  v_mfma_f32_16x16x32_bf16 v[36:39], a[124:127], a[112:115], v[36:39]
  s_waitcnt vmcnt(18) lgkmcnt(0)
  v_mfma_f32_16x16x32_bf16 v[36:39], a[88:91], a[76:79], v[36:39]
  s_barrier
  v_mfma_f32_16x16x32_bf16 v[56:59], a[88:91], a[80:83], v[56:59]
  s_add_u32 m0, s64, 36864
  ds_read_b128 a[0:3], v233 offset:0
  v_mfma_f32_16x16x32_bf16 v[56:59], a[124:127], a[116:119], v[56:59]
  ds_read_b128 a[36:39], v233 offset:18432
  v_mfma_f32_16x16x32_bf16 v[60:63], a[128:131], a[116:119], v[60:63]
  buffer_load_dwordx4 v1, s[8:11], s53 offen sc1 lds
  v_mfma_f32_16x16x32_bf16 v[60:63], a[92:95], a[80:83], v[60:63]
  s_add_u32 s53, s53, s55
  ds_read_b128 a[16:19], v13 offset:0
  v_mfma_f32_16x16x32_bf16 v[64:67], a[96:99], a[80:83], v[64:67]
  ds_read_b128 a[52:55], v13 offset:18432
  v_mfma_f32_16x16x32_bf16 v[64:67], a[132:135], a[116:119], v[64:67]
  buffer_load_dwordx4 v1, s[12:15], s54 offen offset:1024 sc1 lds
  v_mfma_f32_16x16x32_bf16 v[68:71], a[136:139], a[116:119], v[68:71]
  ds_read_b128 a[20:23], v13 offset:1024
  v_mfma_f32_16x16x32_bf16 v[68:71], a[100:103], a[80:83], v[68:71]
  ds_read_b128 a[56:59], v13 offset:19456
  v_mfma_f32_16x16x32_bf16 v[72:75], a[104:107], a[80:83], v[72:75]
  v_mfma_f32_16x16x32_bf16 v[72:75], a[140:143], a[116:119], v[72:75]
  ds_read_b128 a[24:27], v13 offset:2048
  v_mfma_f32_16x16x32_bf16 v[92:95], a[140:143], a[120:123], v[92:95]
  ds_read_b128 a[60:63], v13 offset:20480
  v_mfma_f32_16x16x32_bf16 v[92:95], a[104:107], a[84:87], v[92:95]
  buffer_load_dwordx4 v1, s[12:15], s54 offen offset:2048 sc1 lds
  v_mfma_f32_16x16x32_bf16 v[88:91], a[100:103], a[84:87], v[88:91]
  ds_read_b128 a[28:31], v13 offset:3072
  v_mfma_f32_16x16x32_bf16 v[88:91], a[136:139], a[120:123], v[88:91]
  ds_read_b128 a[64:67], v13 offset:21504
  v_mfma_f32_16x16x32_bf16 v[84:87], a[132:135], a[120:123], v[84:87]
  buffer_load_dwordx4 v1, s[12:15], s54 offen offset:3072 sc1 lds
  v_mfma_f32_16x16x32_bf16 v[84:87], a[96:99], a[84:87], v[84:87]
  s_add_u32 m0, s64, 40960
  ds_read_b128 a[32:35], v13 offset:4096
  v_mfma_f32_16x16x32_bf16 v[80:83], a[92:95], a[84:87], v[80:83]
  ds_read_b128 a[68:71], v13 offset:22528
  v_mfma_f32_16x16x32_bf16 v[80:83], a[128:131], a[120:123], v[80:83]
  buffer_load_dwordx4 v3, s[12:15], s54 offen offset:0 sc1 lds
  v_mfma_f32_16x16x32_bf16 v[76:79], a[124:127], a[120:123], v[76:79]
  v_mfma_f32_16x16x32_bf16 v[76:79], a[88:91], a[84:87], v[76:79]
  s_waitcnt lgkmcnt(9)
  v_mfma_f32_16x16x32_bf16 v[16:19], a[16:19], a[0:3], v[16:19]
  s_waitcnt lgkmcnt(8)
  ds_read_b128 a[4:7], v235 offset:0
  v_mfma_f32_16x16x32_bf16 v[16:19], a[52:55], a[36:39], v[16:19]
  s_waitcnt lgkmcnt(7)
  buffer_load_dwordx4 v3, s[12:15], s54 offen offset:1024 sc1 lds
  v_mfma_f32_16x16x32_bf16 v[20:23], a[56:59], a[36:39], v[20:23]
  ds_read_b128 a[40:43], v235 offset:18432
  v_mfma_f32_16x16x32_bf16 v[20:23], a[20:23], a[0:3], v[20:23]
  s_waitcnt lgkmcnt(7)
  v_mfma_f32_16x16x32_bf16 v[24:27], a[24:27], a[0:3], v[24:27]
  s_waitcnt lgkmcnt(6)
  ds_read_b128 a[8:11], v237 offset:0
  v_mfma_f32_16x16x32_bf16 v[24:27], a[60:63], a[36:39], v[24:27]
  s_waitcnt lgkmcnt(5)
  buffer_load_dwordx4 v3, s[12:15], s54 offen offset:2048 sc1 lds
  v_mfma_f32_16x16x32_bf16 v[28:31], a[64:67], a[36:39], v[28:31]
  ds_read_b128 a[44:47], v237 offset:18432
  v_mfma_f32_16x16x32_bf16 v[28:31], a[28:31], a[0:3], v[28:31]
  s_waitcnt lgkmcnt(5)
  v_mfma_f32_16x16x32_bf16 v[32:35], a[32:35], a[0:3], v[32:35]
  s_waitcnt lgkmcnt(4)
  ds_read_b128 a[12:15], v239 offset:0
  v_mfma_f32_16x16x32_bf16 v[32:35], a[68:71], a[36:39], v[32:35]
  s_waitcnt lgkmcnt(3)
  buffer_load_dwordx4 v3, s[12:15], s54 offen offset:3072 sc1 lds
  v_mfma_f32_16x16x32_bf16 v[52:55], a[68:71], a[40:43], v[52:55]
  s_add_u32 m0, s64, 45056
  ds_read_b128 a[48:51], v239 offset:18432
  v_mfma_f32_16x16x32_bf16 v[52:55], a[32:35], a[4:7], v[52:55]
  v_mfma_f32_16x16x32_bf16 v[48:51], a[28:31], a[4:7], v[48:51]
  v_mfma_f32_16x16x32_bf16 v[48:51], a[64:67], a[40:43], v[48:51]
  buffer_load_dwordx4 v4, s[12:15], s54 offen sc1 lds
  v_mfma_f32_16x16x32_bf16 v[44:47], a[60:63], a[40:43], v[44:47]
  s_add_u32 s54, s54, s56
  v_mfma_f32_16x16x32_bf16 v[44:47], a[24:27], a[4:7], v[44:47]
  v_mfma_f32_16x16x32_bf16 v[40:43], a[20:23], a[4:7], v[40:43]
  v_mfma_f32_16x16x32_bf16 v[40:43], a[56:59], a[40:43], v[40:43]
  v_mfma_f32_16x16x32_bf16 v[36:39], a[52:55], a[40:43], v[36:39]
  s_waitcnt vmcnt(18) lgkmcnt(0)
  v_mfma_f32_16x16x32_bf16 v[36:39], a[16:19], a[4:7], v[36:39]
  s_barrier
  s_sub_u32 s86, s86, 1
  s_cbranch_scc0 L_pc_loop
  v_mfma_f32_16x16x32_bf16 v[56:59], a[16:19], a[8:11], v[56:59]
  ds_read_b128 a[72:75], v233 offset:36864
  v_mfma_f32_16x16x32_bf16 v[56:59], a[52:55], a[44:47], v[56:59]
  ds_read_b128 a[108:111], v233 offset:55296
  v_mfma_f32_16x16x32_bf16 v[60:63], a[56:59], a[44:47], v[60:63]
  buffer_load_dwordx2 v[96:97], v182, s[16:19], 0 offen offset:0
  v_mfma_f32_16x16x32_bf16 v[60:63], a[20:23], a[8:11], v[60:63]
  ds_read_b128 a[88:91], v13 offset:36864
  v_mfma_f32_16x16x32_bf16 v[64:67], a[24:27], a[8:11], v[64:67]
  ds_read_b128 a[124:127], v13 offset:55296
  v_mfma_f32_16x16x32_bf16 v[64:67], a[60:63], a[44:47], v[64:67]
  buffer_load_dwordx2 v[106:107], v183, s[28:31], 0 offen offset:0
  v_mfma_f32_16x16x32_bf16 v[68:71], a[64:67], a[44:47], v[68:71]
  ds_read_b128 a[92:95], v13 offset:37888
  v_mfma_f32_16x16x32_bf16 v[68:71], a[28:31], a[8:11], v[68:71]
  ds_read_b128 a[128:131], v13 offset:56320
  v_mfma_f32_16x16x32_bf16 v[72:75], a[32:35], a[8:11], v[72:75]
  buffer_load_dwordx2 v[98:99], v182, s[16:19], 0 offen offset:32
  v_mfma_f32_16x16x32_bf16 v[72:75], a[68:71], a[44:47], v[72:75]
  ds_read_b128 a[96:99], v13 offset:38912
  v_mfma_f32_16x16x32_bf16 v[92:95], a[68:71], a[48:51], v[92:95]
  ds_read_b128 a[132:135], v13 offset:57344
  v_mfma_f32_16x16x32_bf16 v[92:95], a[32:35], a[12:15], v[92:95]
  buffer_load_dwordx2 v[108:109], v183, s[28:31], 0 offen offset:32
  v_mfma_f32_16x16x32_bf16 v[88:91], a[28:31], a[12:15], v[88:91]
  ds_read_b128 a[100:103], v13 offset:39936
  v_mfma_f32_16x16x32_bf16 v[88:91], a[64:67], a[48:51], v[88:91]
  ds_read_b128 a[136:139], v13 offset:58368
  v_mfma_f32_16x16x32_bf16 v[84:87], a[60:63], a[48:51], v[84:87]
  buffer_load_dwordx2 v[100:101], v182, s[16:19], 0 offen offset:64
  v_mfma_f32_16x16x32_bf16 v[84:87], a[24:27], a[12:15], v[84:87]
  ds_read_b128 a[104:107], v13 offset:40960
  v_mfma_f32_16x16x32_bf16 v[80:83], a[20:23], a[12:15], v[80:83]
  ds_read_b128 a[140:143], v13 offset:59392
  v_mfma_f32_16x16x32_bf16 v[80:83], a[56:59], a[48:51], v[80:83]
  buffer_load_dwordx2 v[110:111], v183, s[28:31], 0 offen offset:64
  v_mfma_f32_16x16x32_bf16 v[76:79], a[52:55], a[48:51], v[76:79]
  v_mfma_f32_16x16x32_bf16 v[76:79], a[16:19], a[12:15], v[76:79]
  s_waitcnt lgkmcnt(9)
  buffer_load_dwordx2 v[102:103], v182, s[16:19], 0 offen offset:96
  v_mfma_f32_16x16x32_bf16 v[16:19], a[88:91], a[72:75], v[16:19]
  s_waitcnt lgkmcnt(8)
  ds_read_b128 a[76:79], v235 offset:36864
  v_mfma_f32_16x16x32_bf16 v[16:19], a[124:127], a[108:111], v[16:19]
  s_waitcnt lgkmcnt(7)
  v_mfma_f32_16x16x32_bf16 v[20:23], a[128:131], a[108:111], v[20:23]
  ds_read_b128 a[112:115], v235 offset:55296
  v_mfma_f32_16x16x32_bf16 v[20:23], a[92:95], a[72:75], v[20:23]
  s_waitcnt lgkmcnt(7)
  buffer_load_dwordx2 v[112:113], v183, s[28:31], 0 offen offset:96
  v_mfma_f32_16x16x32_bf16 v[24:27], a[96:99], a[72:75], v[24:27]
  s_waitcnt lgkmcnt(6)
  ds_read_b128 a[80:83], v237 offset:36864
  v_mfma_f32_16x16x32_bf16 v[24:27], a[132:135], a[108:111], v[24:27]
  s_waitcnt lgkmcnt(5)
  buffer_load_dwordx2 v[104:105], v182, s[16:19], 0 offen offset:128
  v_mfma_f32_16x16x32_bf16 v[28:31], a[136:139], a[108:111], v[28:31]
  ds_read_b128 a[116:119], v237 offset:55296
  v_mfma_f32_16x16x32_bf16 v[28:31], a[100:103], a[72:75], v[28:31]
  s_waitcnt lgkmcnt(5)
  v_mfma_f32_16x16x32_bf16 v[32:35], a[104:107], a[72:75], v[32:35]
  s_waitcnt lgkmcnt(4)
  ds_read_b128 a[84:87], v239 offset:36864
  v_mfma_f32_16x16x32_bf16 v[32:35], a[140:143], a[108:111], v[32:35]
  s_waitcnt lgkmcnt(3)
  buffer_load_dwordx2 v[114:115], v183, s[28:31], 0 offen offset:128
  v_mfma_f32_16x16x32_bf16 v[52:55], a[140:143], a[112:115], v[52:55]
  ds_read_b128 a[120:123], v239 offset:55296
  v_mfma_f32_16x16x32_bf16 v[52:55], a[104:107], a[76:79], v[52:55]
  v_mfma_f32_16x16x32_bf16 v[48:51], a[100:103], a[76:79], v[48:51]
  v_mfma_f32_16x16x32_bf16 v[48:51], a[136:139], a[112:115], v[48:51]
  v_mfma_f32_16x16x32_bf16 v[44:47], a[132:135], a[112:115], v[44:47]
  v_mfma_f32_16x16x32_bf16 v[44:47], a[96:99], a[76:79], v[44:47]
  v_mfma_f32_16x16x32_bf16 v[40:43], a[92:95], a[76:79], v[40:43]
  v_mfma_f32_16x16x32_bf16 v[40:43], a[128:131], a[112:115], v[40:43]
  v_mfma_f32_16x16x32_bf16 v[36:39], a[124:127], a[112:115], v[36:39]
  s_waitcnt vmcnt(19) lgkmcnt(0)
  v_mfma_f32_16x16x32_bf16 v[36:39], a[88:91], a[76:79], v[36:39]
  s_barrier
  v_mfma_f32_16x16x32_bf16 v[56:59], a[88:91], a[80:83], v[56:59]
  ds_read_b128 a[4:7], v234 offset:0
  v_mfma_f32_16x16x32_bf16 v[56:59], a[124:127], a[116:119], v[56:59]
  ds_read_b128 a[40:43], v234 offset:18432
  v_mfma_f32_16x16x32_bf16 v[60:63], a[128:131], a[116:119], v[60:63]
  s_waitcnt vmcnt(9)
  v_lshlrev_b32 v116, 16, v96
  v_and_b32 v117, 0xffff0000, v96
  v_mfma_f32_16x16x32_bf16 v[60:63], a[92:95], a[80:83], v[60:63]
  ds_read_b128 a[16:19], v12 offset:0
  s_waitcnt vmcnt(8)
  v_lshlrev_b32 v96, 16, v106
  v_mfma_f32_16x16x32_bf16 v[64:67], a[96:99], a[80:83], v[64:67]
  ds_read_b128 a[52:55], v12 offset:18432
  v_and_b32 v106, 0xffff0000, v106
  v_mfma_f32_16x16x32_bf16 v[64:67], a[132:135], a[116:119], v[64:67]
  v_add_f32 v116, v116, v96
  v_add_f32 v117, v117, v106
  v_mfma_f32_16x16x32_bf16 v[68:71], a[136:139], a[116:119], v[68:71]
  ds_read_b128 a[20:23], v12 offset:1024
  v_lshlrev_b32 v118, 16, v97
  v_mfma_f32_16x16x32_bf16 v[68:71], a[100:103], a[80:83], v[68:71]
  ds_read_b128 a[56:59], v12 offset:19456
  v_and_b32 v119, 0xffff0000, v97
  v_mfma_f32_16x16x32_bf16 v[72:75], a[104:107], a[80:83], v[72:75]
  v_lshlrev_b32 v97, 16, v107
  v_and_b32 v107, 0xffff0000, v107
  v_mfma_f32_16x16x32_bf16 v[72:75], a[140:143], a[116:119], v[72:75]
  ds_read_b128 a[24:27], v12 offset:2048
  v_add_f32 v118, v118, v97
  v_mfma_f32_16x16x32_bf16 v[92:95], a[140:143], a[120:123], v[92:95]
  ds_read_b128 a[60:63], v12 offset:20480
  v_add_f32 v119, v119, v107
  v_mfma_f32_16x16x32_bf16 v[92:95], a[104:107], a[84:87], v[92:95]
  s_waitcnt vmcnt(7)
  v_lshlrev_b32 v120, 16, v98
  v_and_b32 v121, 0xffff0000, v98
  v_mfma_f32_16x16x32_bf16 v[88:91], a[100:103], a[84:87], v[88:91]
  ds_read_b128 a[28:31], v12 offset:3072
  s_waitcnt vmcnt(6)
  v_lshlrev_b32 v98, 16, v108
  v_mfma_f32_16x16x32_bf16 v[88:91], a[136:139], a[120:123], v[88:91]
  ds_read_b128 a[64:67], v12 offset:21504
  v_and_b32 v108, 0xffff0000, v108
  v_mfma_f32_16x16x32_bf16 v[84:87], a[132:135], a[120:123], v[84:87]
  v_add_f32 v120, v120, v98
  v_add_f32 v121, v121, v108
  v_mfma_f32_16x16x32_bf16 v[84:87], a[96:99], a[84:87], v[84:87]
  ds_read_b128 a[32:35], v12 offset:4096
  v_lshlrev_b32 v122, 16, v99
  v_mfma_f32_16x16x32_bf16 v[80:83], a[92:95], a[84:87], v[80:83]
  ds_read_b128 a[68:71], v12 offset:22528
  v_and_b32 v123, 0xffff0000, v99
  v_mfma_f32_16x16x32_bf16 v[80:83], a[128:131], a[120:123], v[80:83]
  v_lshlrev_b32 v99, 16, v109
  v_and_b32 v109, 0xffff0000, v109
  v_mfma_f32_16x16x32_bf16 v[76:79], a[124:127], a[120:123], v[76:79]
  v_add_f32 v122, v122, v99
  v_add_f32 v123, v123, v109
  v_mfma_f32_16x16x32_bf16 v[76:79], a[88:91], a[84:87], v[76:79]
  s_waitcnt lgkmcnt(9)
  s_waitcnt vmcnt(5)
  v_lshlrev_b32 v124, 16, v100
  v_and_b32 v125, 0xffff0000, v100
  v_mfma_f32_16x16x32_bf16 v[36:39], a[16:19], a[4:7], v[36:39]
  s_waitcnt lgkmcnt(8)
  ds_read_b128 a[8:11], v236 offset:0
  s_waitcnt vmcnt(4)
  v_lshlrev_b32 v100, 16, v110
  v_mfma_f32_16x16x32_bf16 v[36:39], a[52:55], a[40:43], v[36:39]
  s_waitcnt lgkmcnt(7)
  v_and_b32 v110, 0xffff0000, v110
  v_add_f32 v124, v124, v100
  v_mfma_f32_16x16x32_bf16 v[40:43], a[56:59], a[40:43], v[40:43]
  ds_read_b128 a[44:47], v236 offset:18432
  v_add_f32 v125, v125, v110
  v_mfma_f32_16x16x32_bf16 v[40:43], a[20:23], a[4:7], v[40:43]
  s_waitcnt lgkmcnt(7)
  v_lshlrev_b32 v126, 16, v101
  v_and_b32 v127, 0xffff0000, v101
  v_mfma_f32_16x16x32_bf16 v[44:47], a[24:27], a[4:7], v[44:47]
  s_waitcnt lgkmcnt(6)
  ds_read_b128 a[12:15], v238 offset:0
  v_lshlrev_b32 v101, 16, v111
  v_mfma_f32_16x16x32_bf16 v[44:47], a[60:63], a[40:43], v[44:47]
  s_waitcnt lgkmcnt(5)
  v_and_b32 v111, 0xffff0000, v111
  v_add_f32 v126, v126, v101
  v_mfma_f32_16x16x32_bf16 v[48:51], a[64:67], a[40:43], v[48:51]
  ds_read_b128 a[48:51], v238 offset:18432
  v_add_f32 v127, v127, v111
  v_mfma_f32_16x16x32_bf16 v[48:51], a[28:31], a[4:7], v[48:51]
  s_waitcnt lgkmcnt(5)
  s_waitcnt vmcnt(3)
  v_lshlrev_b32 v128, 16, v102
  v_and_b32 v129, 0xffff0000, v102
  v_mfma_f32_16x16x32_bf16 v[52:55], a[32:35], a[4:7], v[52:55]
  s_waitcnt lgkmcnt(4)
  ds_read_b128 a[0:3], v232 offset:0
  s_waitcnt vmcnt(2)
  v_lshlrev_b32 v102, 16, v112
  v_mfma_f32_16x16x32_bf16 v[52:55], a[68:71], a[40:43], v[52:55]
  s_waitcnt lgkmcnt(3)
  v_and_b32 v112, 0xffff0000, v112
  v_add_f32 v128, v128, v102
  v_mfma_f32_16x16x32_bf16 v[72:75], a[68:71], a[44:47], v[72:75]
  ds_read_b128 a[36:39], v232 offset:18432
  v_add_f32 v129, v129, v112
  v_mfma_f32_16x16x32_bf16 v[72:75], a[32:35], a[8:11], v[72:75]
  v_lshlrev_b32 v130, 16, v103
  v_and_b32 v131, 0xffff0000, v103
  v_mfma_f32_16x16x32_bf16 v[68:71], a[28:31], a[8:11], v[68:71]
  v_lshlrev_b32 v103, 16, v113
  v_and_b32 v113, 0xffff0000, v113
  v_mfma_f32_16x16x32_bf16 v[68:71], a[64:67], a[44:47], v[68:71]
  v_add_f32 v130, v130, v103
  v_add_f32 v131, v131, v113
  v_mfma_f32_16x16x32_bf16 v[64:67], a[60:63], a[44:47], v[64:67]
  s_waitcnt vmcnt(1)
  v_lshlrev_b32 v132, 16, v104
  v_and_b32 v133, 0xffff0000, v104
  v_mfma_f32_16x16x32_bf16 v[64:67], a[24:27], a[8:11], v[64:67]
  s_waitcnt vmcnt(0)
  v_lshlrev_b32 v104, 16, v114
  v_and_b32 v114, 0xffff0000, v114
  v_mfma_f32_16x16x32_bf16 v[60:63], a[20:23], a[8:11], v[60:63]
  v_add_f32 v132, v132, v104
  v_add_f32 v133, v133, v114
  v_mfma_f32_16x16x32_bf16 v[60:63], a[56:59], a[44:47], v[60:63]
  v_lshlrev_b32 v134, 16, v105
  v_and_b32 v135, 0xffff0000, v105
  v_lshlrev_b32 v105, 16, v115
  v_and_b32 v115, 0xffff0000, v115
  v_add_f32 v134, v134, v105
  v_add_f32 v135, v135, v115
  v_mfma_f32_16x16x32_bf16 v[56:59], a[52:55], a[44:47], v[56:59]
  v_cvt_pk_bf16_f32 v136, v36, v37
  v_cvt_pk_bf16_f32 v137, v38, v39
  v_mfma_f32_16x16x32_bf16 v[56:59], a[16:19], a[8:11], v[56:59]
  s_waitcnt lgkmcnt(3)
  v_cvt_pk_bf16_f32 v138, v40, v41
  v_cvt_pk_bf16_f32 v140, v42, v43
  v_mfma_f32_16x16x32_bf16 v[76:79], a[16:19], a[12:15], v[76:79]
  s_waitcnt lgkmcnt(2)
  buffer_store_dwordx4 v[136:139], v1, s[32:35], s81 offen offset:0 sc1
  v_mfma_f32_16x16x32_bf16 v[76:79], a[52:55], a[48:51], v[76:79]
  v_cvt_pk_bf16_f32 v141, v44, v45
  v_cvt_pk_bf16_f32 v142, v46, v47
  v_mfma_f32_16x16x32_bf16 v[80:83], a[56:59], a[48:51], v[80:83]
  v_cvt_pk_bf16_f32 v144, v48, v49
  v_mfma_f32_16x16x32_bf16 v[80:83], a[20:23], a[12:15], v[80:83]
  buffer_store_dwordx4 v[140:143], v1, s[32:35], s81 offen offset:1024 sc1
  v_mfma_f32_16x16x32_bf16 v[84:87], a[24:27], a[12:15], v[84:87]
  v_cvt_pk_bf16_f32 v145, v50, v51
  v_cvt_pk_bf16_f32 v146, v52, v53
  v_mfma_f32_16x16x32_bf16 v[84:87], a[60:63], a[48:51], v[84:87]
  v_cvt_pk_bf16_f32 v148, v54, v55
  v_mfma_f32_16x16x32_bf16 v[88:91], a[64:67], a[48:51], v[88:91]
  buffer_store_dwordx4 v[144:147], v1, s[32:35], s81 offen offset:2048 sc1
  v_mfma_f32_16x16x32_bf16 v[88:91], a[28:31], a[12:15], v[88:91]
  buffer_store_dwordx2 v[148:149], v184, s[32:35], s81 offen offset:3072 sc1
  v_mfma_f32_16x16x32_bf16 v[92:95], a[32:35], a[12:15], v[92:95]
  v_cvt_pk_bf16_f32 v150, v56, v57
  v_cvt_pk_bf16_f32 v151, v58, v59
  v_mfma_f32_16x16x32_bf16 v[92:95], a[68:71], a[48:51], v[92:95]
  s_waitcnt lgkmcnt(0)
  v_cvt_pk_bf16_f32 v152, v60, v61
  v_cvt_pk_bf16_f32 v154, v62, v63
  v_mfma_f32_16x16x32_bf16 v[32:35], a[68:71], a[36:39], v[32:35]
  buffer_store_dwordx4 v[150:153], v1, s[32:35], s82 offen offset:0 sc1
  v_mfma_f32_16x16x32_bf16 v[32:35], a[32:35], a[0:3], v[32:35]
  v_cvt_pk_bf16_f32 v155, v64, v65
  v_cvt_pk_bf16_f32 v156, v66, v67
  v_mfma_f32_16x16x32_bf16 v[28:31], a[28:31], a[0:3], v[28:31]
  v_cvt_pk_bf16_f32 v158, v68, v69
  v_mfma_f32_16x16x32_bf16 v[28:31], a[64:67], a[36:39], v[28:31]
  buffer_store_dwordx4 v[154:157], v1, s[32:35], s82 offen offset:1024 sc1
  v_mfma_f32_16x16x32_bf16 v[24:27], a[60:63], a[36:39], v[24:27]
  v_cvt_pk_bf16_f32 v159, v70, v71
  v_cvt_pk_bf16_f32 v160, v72, v73
  v_mfma_f32_16x16x32_bf16 v[24:27], a[24:27], a[0:3], v[24:27]
  v_cvt_pk_bf16_f32 v162, v74, v75
  v_mfma_f32_16x16x32_bf16 v[20:23], a[20:23], a[0:3], v[20:23]
  buffer_store_dwordx4 v[158:161], v1, s[32:35], s82 offen offset:2048 sc1
  v_mfma_f32_16x16x32_bf16 v[20:23], a[56:59], a[36:39], v[20:23]
  buffer_store_dwordx2 v[162:163], v184, s[32:35], s82 offen offset:3072 sc1
  v_mfma_f32_16x16x32_bf16 v[16:19], a[52:55], a[36:39], v[16:19]
  v_cvt_pk_bf16_f32 v164, v76, v77
  v_cvt_pk_bf16_f32 v165, v78, v79
  v_mfma_f32_16x16x32_bf16 v[16:19], a[16:19], a[0:3], v[16:19]
  v_cvt_pk_bf16_f32 v166, v80, v81
  v_cvt_pk_bf16_f32 v168, v82, v83
  buffer_store_dwordx4 v[164:167], v1, s[32:35], s83 offen offset:0 sc1
  v_cvt_pk_bf16_f32 v169, v84, v85
  v_cvt_pk_bf16_f32 v170, v86, v87
  v_cvt_pk_bf16_f32 v172, v88, v89
  buffer_store_dwordx4 v[168:171], v1, s[32:35], s83 offen offset:1024 sc1
  v_cvt_pk_bf16_f32 v173, v90, v91
  v_cvt_pk_bf16_f32 v174, v92, v93
  v_cvt_pk_bf16_f32 v176, v94, v95
  buffer_store_dwordx4 v[172:175], v1, s[32:35], s83 offen offset:2048 sc1
  buffer_store_dwordx2 v[176:177], v184, s[32:35], s83 offen offset:3072 sc1
  buffer_load_dword v187, v185, s[32:35], 0 offen sc1
  v_add_f32 v16, v16, v116
  v_add_f32 v17, v17, v117
  v_add_f32 v18, v18, v118
  v_add_f32 v19, v19, v119
  v_add_f32 v20, v20, v120
  v_add_f32 v21, v21, v121
  v_add_f32 v22, v22, v122
  v_add_f32 v23, v23, v123
  v_add_f32 v24, v24, v124
  v_add_f32 v25, v25, v125
  v_add_f32 v26, v26, v126
  v_add_f32 v27, v27, v127
  v_add_f32 v28, v28, v128
  v_add_f32 v29, v29, v129
  v_add_f32 v30, v30, v130
  v_add_f32 v31, v31, v131
  v_add_f32 v32, v32, v132
  v_add_f32 v33, v33, v133
  v_add_f32 v34, v34, v134
  v_add_f32 v35, v35, v135
  s_waitcnt vmcnt(0)
  v_cmp_ne_u32 vcc, v187, v186
  s_nop 1
  s_cbranch_vccnz L_pxp_spin
L_pxp_ok:
  buffer_load_dwordx4 v[190:193], v1, s[32:35], s60 offen offset:0 sc1
  buffer_load_dwordx4 v[194:197], v1, s[32:35], s60 offen offset:1024 sc1
  buffer_load_dwordx4 v[198:201], v1, s[32:35], s60 offen offset:2048 sc1
  buffer_load_dwordx2 v[202:203], v184, s[32:35], s60 offen offset:3072 sc1
  buffer_load_dwordx4 v[204:207], v1, s[32:35], s61 offen offset:0 sc1
  buffer_load_dwordx4 v[208:211], v1, s[32:35], s61 offen offset:1024 sc1
  buffer_load_dwordx4 v[212:215], v1, s[32:35], s61 offen offset:2048 sc1
  buffer_load_dwordx2 v[216:217], v184, s[32:35], s61 offen offset:3072 sc1
  buffer_load_dwordx4 v[218:221], v1, s[32:35], s57 offen offset:0 sc1
  buffer_load_dwordx4 v[222:225], v1, s[32:35], s57 offen offset:1024 sc1
  buffer_load_dwordx4 v[226:229], v1, s[32:35], s57 offen offset:2048 sc1
  buffer_load_dwordx2 v[230:231], v184, s[32:35], s57 offen offset:3072 sc1
  s_waitcnt vmcnt(8)
  v_xor_b32 v188, s72, v193
  v_xor_b32 v189, s72, v197
  v_xor_b32 v187, s72, v201
  v_xor_b32 v183, s72, v203
  v_or3_b32 v188, v188, v189, v187
  v_or_b32 v188, v188, v183
  v_cmp_ne_u32 vcc, 0, v188
  s_nop 1
  s_cbranch_vccnz L_px0_spin
L_px0_ok:
  v_lshlrev_b32 v116, 16, v190
  v_and_b32 v117, 0xffff0000, v190
  v_lshlrev_b32 v118, 16, v191
  v_and_b32 v119, 0xffff0000, v191
  v_lshlrev_b32 v120, 16, v192
  v_and_b32 v121, 0xffff0000, v192
  v_lshlrev_b32 v122, 16, v194
  v_and_b32 v123, 0xffff0000, v194
  v_lshlrev_b32 v124, 16, v195
  v_and_b32 v125, 0xffff0000, v195
  v_lshlrev_b32 v126, 16, v196
  v_and_b32 v127, 0xffff0000, v196
  v_lshlrev_b32 v128, 16, v198
  v_and_b32 v129, 0xffff0000, v198
  v_lshlrev_b32 v130, 16, v199
  v_and_b32 v131, 0xffff0000, v199
  v_lshlrev_b32 v132, 16, v200
  v_and_b32 v133, 0xffff0000, v200
  v_lshlrev_b32 v134, 16, v202
  v_and_b32 v135, 0xffff0000, v202
  v_pk_add_f32 v[16:17], v[16:17], v[116:117]
  v_pk_add_f32 v[18:19], v[18:19], v[118:119]
  v_pk_add_f32 v[20:21], v[20:21], v[120:121]
  v_pk_add_f32 v[22:23], v[22:23], v[122:123]
  v_pk_add_f32 v[24:25], v[24:25], v[124:125]
  v_pk_add_f32 v[26:27], v[26:27], v[126:127]
  v_pk_add_f32 v[28:29], v[28:29], v[128:129]
  v_pk_add_f32 v[30:31], v[30:31], v[130:131]
  v_pk_add_f32 v[32:33], v[32:33], v[132:133]
  v_pk_add_f32 v[34:35], v[34:35], v[134:135]
  s_waitcnt vmcnt(4)
  v_xor_b32 v188, s72, v207
  v_xor_b32 v189, s72, v211
  v_xor_b32 v187, s72, v215
  v_xor_b32 v183, s72, v217
  v_or3_b32 v188, v188, v189, v187
  v_or_b32 v188, v188, v183
  v_cmp_ne_u32 vcc, 0, v188
  s_nop 1
  s_cbranch_vccnz L_px1_spin
L_px1_ok:
  v_lshlrev_b32 v116, 16, v204
  v_and_b32 v117, 0xffff0000, v204
  v_lshlrev_b32 v118, 16, v205
  v_and_b32 v119, 0xffff0000, v205
  v_lshlrev_b32 v120, 16, v206
  v_and_b32 v121, 0xffff0000, v206
  v_lshlrev_b32 v122, 16, v208
  v_and_b32 v123, 0xffff0000, v208
  v_lshlrev_b32 v124, 16, v209
  v_and_b32 v125, 0xffff0000, v209
  v_lshlrev_b32 v126, 16, v210
  v_and_b32 v127, 0xffff0000, v210
  v_lshlrev_b32 v128, 16, v212
  v_and_b32 v129, 0xffff0000, v212
  v_lshlrev_b32 v130, 16, v213
  v_and_b32 v131, 0xffff0000, v213
  v_lshlrev_b32 v132, 16, v214
  v_and_b32 v133, 0xffff0000, v214
  v_lshlrev_b32 v134, 16, v216
  v_and_b32 v135, 0xffff0000, v216
  v_pk_add_f32 v[16:17], v[16:17], v[116:117]
  v_pk_add_f32 v[18:19], v[18:19], v[118:119]
  v_pk_add_f32 v[20:21], v[20:21], v[120:121]
  v_pk_add_f32 v[22:23], v[22:23], v[122:123]
  v_pk_add_f32 v[24:25], v[24:25], v[124:125]
  v_pk_add_f32 v[26:27], v[26:27], v[126:127]
  v_pk_add_f32 v[28:29], v[28:29], v[128:129]
  v_pk_add_f32 v[30:31], v[30:31], v[130:131]
  v_pk_add_f32 v[32:33], v[32:33], v[132:133]
  v_pk_add_f32 v[34:35], v[34:35], v[134:135]
  s_waitcnt vmcnt(0)
  v_xor_b32 v188, s72, v221
  v_xor_b32 v189, s72, v225
  v_xor_b32 v187, s72, v229
  v_xor_b32 v183, s72, v231
  v_or3_b32 v188, v188, v189, v187
  v_or_b32 v188, v188, v183
  v_cmp_ne_u32 vcc, 0, v188
  s_nop 1
  s_cbranch_vccnz L_px2_spin
L_px2_ok:
  v_lshlrev_b32 v116, 16, v218
  v_and_b32 v117, 0xffff0000, v218
  v_lshlrev_b32 v118, 16, v219
  v_and_b32 v119, 0xffff0000, v219
  v_lshlrev_b32 v120, 16, v220
  v_and_b32 v121, 0xffff0000, v220
  v_lshlrev_b32 v122, 16, v222
  v_and_b32 v123, 0xffff0000, v222
  v_lshlrev_b32 v124, 16, v223
  v_and_b32 v125, 0xffff0000, v223
  v_lshlrev_b32 v126, 16, v224
  v_and_b32 v127, 0xffff0000, v224
  v_lshlrev_b32 v128, 16, v226
  v_and_b32 v129, 0xffff0000, v226
  v_lshlrev_b32 v130, 16, v227
  v_and_b32 v131, 0xffff0000, v227
  v_lshlrev_b32 v132, 16, v228
  v_and_b32 v133, 0xffff0000, v228
  v_lshlrev_b32 v134, 16, v230
  v_and_b32 v135, 0xffff0000, v230
  v_pk_add_f32 v[16:17], v[16:17], v[116:117]
  v_pk_add_f32 v[18:19], v[18:19], v[118:119]
  v_pk_add_f32 v[20:21], v[20:21], v[120:121]
  v_pk_add_f32 v[22:23], v[22:23], v[122:123]
  v_pk_add_f32 v[24:25], v[24:25], v[124:125]
  v_pk_add_f32 v[26:27], v[26:27], v[126:127]
  v_pk_add_f32 v[28:29], v[28:29], v[128:129]
  v_pk_add_f32 v[30:31], v[30:31], v[130:131]
  v_pk_add_f32 v[32:33], v[32:33], v[132:133]
  v_pk_add_f32 v[34:35], v[34:35], v[134:135]
  v_cvt_pk_bf16_f32 v16, v16, v17
  v_cvt_pk_bf16_f32 v17, v18, v19
  buffer_store_dwordx2 v[16:17], v182, s[24:27], 0 offen offset:0
  v_cvt_pk_bf16_f32 v20, v20, v21
  v_cvt_pk_bf16_f32 v21, v22, v23
  buffer_store_dwordx2 v[20:21], v182, s[24:27], 0 offen offset:32
  v_cvt_pk_bf16_f32 v24, v24, v25
  v_cvt_pk_bf16_f32 v25, v26, v27
  buffer_store_dwordx2 v[24:25], v182, s[24:27], 0 offen offset:64
  v_cvt_pk_bf16_f32 v28, v28, v29
  v_cvt_pk_bf16_f32 v29, v30, v31
  buffer_store_dwordx2 v[28:29], v182, s[24:27], 0 offen offset:96
  v_cvt_pk_bf16_f32 v32, v32, v33
  v_cvt_pk_bf16_f32 v33, v34, v35
  buffer_store_dwordx2 v[32:33], v182, s[24:27], 0 offen offset:128
L_exit:
  s_endpgm
L_sfin0:
  v_mov_b32 v192, v176
  v_mov_b32 v193, v176
  v_mov_b32 v194, v176
  v_mov_b32 v195, v176
  v_mov_b32 v196, v176
  v_mov_b32 v197, v176
  v_mov_b32 v198, v176
  v_mov_b32 v199, v176
  s_add_u32 s81, s80, 1
  s_cmp_lg_u32 s81, s79
  s_cbranch_scc1 L_sfin0_nd
  v_sub_f32 v192, v244, v248
  v_mov_b32 v196, 0xff800000
  v_sub_f32 v193, v245, v248
  v_mov_b32 v197, 0xff800000
  v_sub_f32 v194, v246, v248
  v_mov_b32 v198, 0xff800000
  v_sub_f32 v195, v247, v248
  v_mov_b32 v199, 0xff800000
L_sfin0_nd:
  s_add_u32 m0, s85, 0
  v_mfma_f32_16x16x32_bf16 v[112:115], a[128:131], v[16:19], v[176:179]
  s_barrier
  ds_read_b128 a[160:163], v10 offset:0
  v_mfma_f32_16x16x32_bf16 v[112:115], a[132:135], v[20:23], v[112:115]
  s_add_u32 s84, s84, 0x10000
  ds_read_b128 a[164:167], v10 offset:1024
  v_mfma_f32_16x16x32_bf16 v[112:115], a[136:139], v[24:27], v[112:115]
  buffer_load_dwordx4 v2, s[4:7], s84 offen offset:0 sc1 lds
  v_mfma_f32_16x16x32_bf16 v[112:115], a[140:143], v[28:31], v[112:115]
  ds_read_b128 a[168:171], v10 offset:2048
  v_mfma_f32_16x16x32_bf16 v[120:123], a[140:143], v[44:47], v[180:183]
  ds_read_b128 a[172:175], v10 offset:3072
  v_mfma_f32_16x16x32_bf16 v[120:123], a[136:139], v[40:43], v[120:123]
  ds_read_b128 a[176:179], v10 offset:4096
  v_mfma_f32_16x16x32_bf16 v[120:123], a[132:135], v[36:39], v[120:123]
  ds_read_b128 a[180:183], v10 offset:5120
  v_mfma_f32_16x16x32_bf16 v[120:123], a[128:131], v[32:35], v[120:123]
  ds_read_b128 a[184:187], v10 offset:6144
  v_mfma_f32_16x16x32_bf16 v[136:139], a[128:131], v[64:67], v[188:191]
  v_exp_f32 v108, v108
  v_mfma_f32_16x16x32_bf16 v[136:139], a[132:135], v[68:71], v[136:139]
  buffer_load_dwordx4 v2, s[4:7], s84 offen offset:1024 sc1 lds
  v_mfma_f32_16x16x32_bf16 v[136:139], a[136:139], v[72:75], v[136:139]
  ds_read_b128 a[188:191], v10 offset:7168
  v_sub_f32 v220, v244, v251
  v_mfma_f32_16x16x32_bf16 v[136:139], a[140:143], v[76:79], v[136:139]
  v_exp_f32 v109, v109
  v_mfma_f32_16x16x32_bf16 v[140:143], a[156:159], v[76:79], v[188:191]
  s_bfe_u32 s52, s2, 0x20001
  v_cvt_pk_bf16_f32 v158, v108, v109
  v_sub_f32 v221, v245, v251
  v_mfma_f32_16x16x32_bf16 v[140:143], a[152:155], v[72:75], v[140:143]
  s_and_b32 s50, s2, 1
  v_sub_f32 v222, v246, v251
  v_sub_f32 v223, v247, v251
  v_mfma_f32_16x16x32_bf16 v[140:143], a[148:151], v[68:71], v[140:143]
  v_exp_f32 v110, v110
  v_mfma_f32_16x16x32_bf16 v[140:143], a[144:147], v[64:67], v[140:143]
  s_lshl_b32 s50, s50, 3
  s_bfe_u32 s51, s2, 0x30003
  s_add_u32 s50, s50, s51
  v_mfma_f32_16x16x32_bf16 v[124:127], a[144:147], v[32:35], v[180:183]
  s_lshr_b32 s51, s2, 6
  s_sub_u32 s81, 15, s50
  s_min_u32 s81, s81, s50
  v_mfma_f32_16x16x32_bf16 v[124:127], a[148:151], v[36:39], v[124:127]
  s_lshl_b32 s81, s81, 2
  v_exp_f32 v111, v111
  v_mfma_f32_16x16x32_bf16 v[124:127], a[152:155], v[40:43], v[124:127]
  buffer_load_dwordx4 v2, s[4:7], s84 offen offset:2048 sc1 lds
  v_mfma_f32_16x16x32_bf16 v[124:127], a[156:159], v[44:47], v[124:127]
  s_add_u32 s81, s81, s52
  v_cvt_pk_bf16_f32 v159, v110, v111
  s_lshl_b32 s63, s81, 11
  v_mfma_f32_16x16x32_bf16 v[116:119], a[156:159], v[28:31], v[176:179]
  s_mul_i32 s81, s51, 1863680
  s_add_u32 s81, s81, 65011712
  v_mfma_f32_16x16x32_bf16 v[116:119], a[152:155], v[24:27], v[116:119]
  s_add_u32 s8, s74, s81
  s_addc_u32 s9, s75, 0
  v_exp_f32 v112, v112
  v_mfma_f32_16x16x32_bf16 v[116:119], a[148:151], v[20:23], v[116:119]
  s_mov_b32 s11, 0x20000
  s_lshl_b32 s83, s52, 5
  v_mfma_f32_16x16x32_bf16 v[116:119], a[144:147], v[16:19], v[116:119]
  s_add_u32 s83, s83, 86
  v_exp_f32 v113, v113
  v_mfma_f32_16x16x32_bf16 v[224:227], v[240:243], v[144:147], v[224:227]
  s_mul_i32 s10, s83, 10240
  ds_read_b128 a[128:131], v10 offset:8192
  v_cvt_pk_bf16_f32 v160, v112, v113
  v_mfma_f32_16x16x32_bf16 v[228:231], v[240:243], v[148:151], v[228:231]
  s_lshl_b32 s83, s83, 13
  v_exp_f32 v114, v114
  v_mfma_f32_16x16x32_bf16 v[232:235], v[240:243], v[152:155], v[232:235]
  s_waitcnt lgkmcnt(8)
  buffer_load_dwordx4 v2, s[4:7], s84 offen offset:3072 sc1 lds
  v_mfma_f32_16x16x32_bf16 v[236:239], v[240:243], v[156:159], v[236:239]
  s_add_u32 s83, s83, 1024
  s_mul_i32 s82, s50, 1490944
  s_add_u32 s82, s82, 39844864
  v_mfma_f32_16x16x32_bf16 a[96:99], a[160:163], v[156:159], a[96:99]
  s_and_b32 s62, s76, 1
  v_exp_f32 v115, v115
  v_mfma_f32_16x16x32_bf16 a[64:67], a[160:163], v[152:155], a[64:67]
  s_add_u32 m0, s85, 4096
  ds_read_b128 a[132:135], v10 offset:9216
  v_cvt_pk_bf16_f32 v161, v114, v115
  v_mfma_f32_16x16x32_bf16 a[32:35], a[160:163], v[148:151], a[32:35]
  s_waitcnt lgkmcnt(8)
  v_exp_f32 v120, v120
  v_mfma_f32_16x16x32_bf16 a[0:3], a[160:163], v[144:147], a[0:3]
  s_cmp_eq_u32 s62, 0
  s_cselect_b32 s81, s81, s82
  s_cselect_b32 s14, s10, s83
  s_movk_i32 s56, 8192
  s_cselect_b32 s56, 10240, s56
  v_mfma_f32_16x16x32_bf16 a[4:7], a[164:167], v[144:147], a[4:7]
  buffer_load_dwordx4 v3, s[4:7], s84 offen offset:0 sc1 lds
  v_mfma_f32_16x16x32_bf16 a[36:39], a[164:167], v[148:151], a[36:39]
  s_add_u32 s12, s74, s81
  s_addc_u32 s13, s75, 0
  v_exp_f32 v121, v121
  v_mfma_f32_16x16x32_bf16 a[68:71], a[164:167], v[152:155], a[68:71]
  s_waitcnt lgkmcnt(7)
  ds_read_b128 a[136:139], v10 offset:10240
  v_cvt_pk_bf16_f32 v164, v120, v121
  v_mfma_f32_16x16x32_bf16 a[100:103], a[164:167], v[156:159], a[100:103]
  s_mov_b32 s15, 0x20000
  v_exp_f32 v122, v122
  v_mfma_f32_16x16x32_bf16 a[104:107], a[168:171], v[156:159], a[104:107]
  s_mul_i32 s81, s52, 14
  s_lshr_b32 s82, s76, 1
  s_add_u32 s81, s81, s82
  v_mfma_f32_16x16x32_bf16 a[72:75], a[168:171], v[152:155], a[72:75]
  s_mul_i32 s53, s81, 10240
  ds_read_b128 a[140:143], v10 offset:11264
  s_mul_i32 s54, s81, s56
  v_mfma_f32_16x16x32_bf16 a[40:43], a[168:171], v[148:151], a[40:43]
  s_waitcnt lgkmcnt(8)
  v_exp_f32 v123, v123
  v_mfma_f32_16x16x32_bf16 a[8:11], a[168:171], v[144:147], a[8:11]
  s_mul_i32 s82, s62, 9216
  v_cvt_pk_bf16_f32 v165, v122, v123
  s_add_u32 s53, s53, s82
  v_mfma_f32_16x16x32_bf16 a[12:15], a[172:175], v[144:147], a[12:15]
  s_mul_i32 s81, s52, 18
  v_exp_f32 v136, v136
  v_mfma_f32_16x16x32_bf16 a[44:47], a[172:175], v[148:151], a[44:47]
  buffer_load_dwordx4 v3, s[4:7], s84 offen offset:1024 sc1 lds
  v_mfma_f32_16x16x32_bf16 a[76:79], a[172:175], v[152:155], a[76:79]
  s_waitcnt lgkmcnt(7)
  ds_read_b128 a[144:147], v10 offset:12288
  s_add_u32 s81, s81, 42
  v_mfma_f32_16x16x32_bf16 a[108:111], a[172:175], v[156:159], a[108:111]
  s_mul_i32 s60, s81, 10240
  v_exp_f32 v137, v137
  v_mfma_f32_16x16x32_bf16 a[112:115], a[176:179], v[156:159], a[112:115]
  s_mul_i32 s61, s81, s56
  v_cvt_pk_bf16_f32 v172, v136, v137
  s_mov_b32 s55, 20480
  v_mfma_f32_16x16x32_bf16 a[80:83], a[176:179], v[152:155], a[80:83]
  s_lshl_b32 s56, s56, 1
  v_exp_f32 v138, v138
  v_mfma_f32_16x16x32_bf16 a[48:51], a[176:179], v[148:151], a[48:51]
  s_waitcnt lgkmcnt(7)
  ds_read_b128 a[148:151], v10 offset:13312
  s_mul_i32 s64, s76, 9216
  v_mfma_f32_16x16x32_bf16 a[16:19], a[176:179], v[144:147], a[16:19]
  s_cmp_eq_u32 s52, 3
  s_cselect_b32 s81, 1073741824, 0
  s_add_u32 s57, s55, s81
  v_mfma_f32_16x16x32_bf16 a[20:23], a[180:183], v[144:147], a[20:23]
  s_add_u32 s65, s56, s81
  v_exp_f32 v139, v139
  v_mfma_f32_16x16x32_bf16 a[52:55], a[180:183], v[148:151], a[52:55]
  buffer_load_dwordx4 v3, s[4:7], s84 offen offset:2048 sc1 lds
  v_mfma_f32_16x16x32_bf16 a[84:87], a[180:183], v[152:155], a[84:87]
  s_waitcnt lgkmcnt(7)
  v_exp_f32 v116, v116
  v_mfma_f32_16x16x32_bf16 a[116:119], a[180:183], v[156:159], a[116:119]
  s_sub_u32 s60, s60, s81
  ds_read_b128 a[152:155], v10 offset:14336
  v_cvt_pk_bf16_f32 v173, v138, v139
  v_mfma_f32_16x16x32_bf16 a[120:123], a[184:187], v[156:159], a[120:123]
  s_sub_u32 s61, s61, s81
  v_exp_f32 v117, v117
  v_mfma_f32_16x16x32_bf16 a[88:91], a[184:187], v[152:155], a[88:91]
  s_mov_b64 s[16:17], s[48:49]
  v_cvt_pk_bf16_f32 v162, v116, v117
  s_mov_b32 s18, 2621440
  v_mfma_f32_16x16x32_bf16 a[56:59], a[184:187], v[148:151], a[56:59]
  s_waitcnt lgkmcnt(7)
  s_mov_b32 s19, 0x20000
  s_mov_b64 s[24:25], s[70:71]
  v_mfma_f32_16x16x32_bf16 a[24:27], a[184:187], v[144:147], a[24:27]
  s_mov_b32 s26, 2621440
  v_exp_f32 v118, v118
  v_mfma_f32_16x16x32_bf16 a[28:31], a[188:191], v[144:147], a[28:31]
  buffer_load_dwordx4 v3, s[4:7], s84 offen offset:3072 sc1 lds
  s_add_u32 m0, s85, 8192
  v_mfma_f32_16x16x32_bf16 a[60:63], a[188:191], v[148:151], a[60:63]
  s_mov_b32 s27, 0x20000
  ds_read_b128 a[156:159], v10 offset:15360
  s_mov_b64 s[28:29], s[68:69]
  v_mfma_f32_16x16x32_bf16 a[92:95], a[188:191], v[152:155], a[92:95]
  s_waitcnt lgkmcnt(7)
  v_exp_f32 v119, v119
  v_mfma_f32_16x16x32_bf16 a[124:127], a[188:191], v[156:159], a[124:127]
  s_mov_b32 s30, 1280
  v_cvt_pk_bf16_f32 v163, v118, v119
  s_mov_b32 s31, 0x20000
  v_mfma_f32_16x16x32_bf16 v[80:83], a[128:131], v[16:19], v[176:179]
  s_add_u32 s32, s74, 73400320
  s_addc_u32 s33, s75, 0
  v_exp_f32 v124, v124
  s_waitcnt lgkmcnt(6)
  v_mfma_f32_16x16x32_bf16 v[80:83], a[132:135], v[20:23], v[80:83]
  s_mov_b32 s34, 16777216
  ds_read_b128 a[160:163], v10 offset:16384
  s_mov_b32 s35, 0x20000
  s_waitcnt lgkmcnt(6)
  v_mfma_f32_16x16x32_bf16 v[80:83], a[136:139], v[24:27], v[80:83]
  s_waitcnt lgkmcnt(5)
  v_exp_f32 v125, v125
  v_mfma_f32_16x16x32_bf16 v[80:83], a[140:143], v[28:31], v[80:83]
  buffer_load_dwordx4 v4, s[4:7], s84 offen offset:0 sc1 lds
  v_mfma_f32_16x16x32_bf16 v[88:91], a[140:143], v[44:47], v[180:183]
  ds_read_b128 a[164:167], v10 offset:17408
  v_cvt_pk_bf16_f32 v166, v124, v125
  v_mfma_f32_16x16x32_bf16 v[88:91], a[136:139], v[40:43], v[88:91]
  v_exp_f32 v126, v126
  v_mfma_f32_16x16x32_bf16 v[88:91], a[132:135], v[36:39], v[88:91]
  ds_read_b128 a[168:171], v10 offset:18432
  v_mfma_f32_16x16x32_bf16 v[88:91], a[128:131], v[32:35], v[88:91]
  v_exp_f32 v127, v127
  v_mfma_f32_16x16x32_bf16 v[104:107], a[128:131], v[64:67], v[188:191]
  v_cvt_pk_bf16_f32 v167, v126, v127
  v_mfma_f32_16x16x32_bf16 v[104:107], a[132:135], v[68:71], v[104:107]
  ds_read_b128 a[172:175], v10 offset:19456
  v_mfma_f32_16x16x32_bf16 v[104:107], a[136:139], v[72:75], v[104:107]
  v_exp_f32 v140, v140
  v_mfma_f32_16x16x32_bf16 v[104:107], a[140:143], v[76:79], v[104:107]
  s_waitcnt lgkmcnt(4)
  buffer_load_dwordx4 v4, s[4:7], s84 offen offset:1024 sc1 lds
  v_mfma_f32_16x16x32_bf16 v[108:111], a[156:159], v[76:79], v[188:191]
  v_exp_f32 v141, v141
  v_mfma_f32_16x16x32_bf16 v[108:111], a[152:155], v[72:75], v[108:111]
  ds_read_b128 a[176:179], v10 offset:20480
  v_cvt_pk_bf16_f32 v174, v140, v141
  v_mfma_f32_16x16x32_bf16 v[108:111], a[148:151], v[68:71], v[108:111]
  v_mfma_f32_16x16x32_bf16 v[108:111], a[144:147], v[64:67], v[108:111]
  v_exp_f32 v142, v142
  v_mfma_f32_16x16x32_bf16 v[92:95], a[144:147], v[32:35], v[180:183]
  ds_read_b128 a[180:183], v10 offset:21504
  v_mfma_f32_16x16x32_bf16 v[92:95], a[148:151], v[36:39], v[92:95]
  v_exp_f32 v143, v143
  v_mfma_f32_16x16x32_bf16 v[92:95], a[152:155], v[40:43], v[92:95]
  buffer_load_dwordx4 v4, s[4:7], s84 offen offset:2048 sc1 lds
  v_mfma_f32_16x16x32_bf16 v[92:95], a[156:159], v[44:47], v[92:95]
  ds_read_b128 a[184:187], v10 offset:22528
  v_cvt_pk_bf16_f32 v175, v142, v143
  v_mfma_f32_16x16x32_bf16 v[84:87], a[156:159], v[28:31], v[176:179]
  v_mfma_f32_16x16x32_bf16 v[84:87], a[152:155], v[24:27], v[84:87]
  v_exp_f32 v80, v80
  v_mfma_f32_16x16x32_bf16 v[84:87], a[148:151], v[20:23], v[84:87]
  ds_read_b128 a[188:191], v10 offset:23552
  v_mfma_f32_16x16x32_bf16 v[84:87], a[144:147], v[16:19], v[84:87]
  v_exp_f32 v81, v81
  v_mfma_f32_16x16x32_bf16 v[224:227], v[240:243], v[160:163], v[224:227]
  ds_read_b128 a[128:131], v10 offset:24576
  v_cvt_pk_bf16_f32 v144, v80, v81
  v_mfma_f32_16x16x32_bf16 v[228:231], v[240:243], v[164:167], v[228:231]
  v_exp_f32 v82, v82
  v_mfma_f32_16x16x32_bf16 v[236:239], v[240:243], v[172:175], v[236:239]
  s_waitcnt lgkmcnt(8)
  buffer_load_dwordx4 v4, s[4:7], s84 offen offset:3072 sc1 lds
  v_mfma_f32_16x16x32_bf16 a[96:99], a[160:163], v[172:175], a[96:99]
  s_add_u32 m0, s85, 12288
  v_exp_f32 v83, v83
  v_mfma_f32_16x16x32_bf16 a[32:35], a[160:163], v[164:167], a[32:35]
  ds_read_b128 a[132:135], v10 offset:25600
  v_cvt_pk_bf16_f32 v145, v82, v83
  v_mfma_f32_16x16x32_bf16 a[0:3], a[160:163], v[160:163], a[0:3]
  s_waitcnt lgkmcnt(8)
  v_exp_f32 v88, v88
  v_mfma_f32_16x16x32_bf16 a[4:7], a[164:167], v[160:163], a[4:7]
  ds_read_b128 a[136:139], v10 offset:26624
  v_mfma_f32_16x16x32_bf16 a[36:39], a[164:167], v[164:167], a[36:39]
  v_exp_f32 v89, v89
  v_mfma_f32_16x16x32_bf16 a[100:103], a[164:167], v[172:175], a[100:103]
  s_waitcnt lgkmcnt(8)
  v_cvt_pk_bf16_f32 v148, v88, v89
  v_mfma_f32_16x16x32_bf16 a[104:107], a[168:171], v[172:175], a[104:107]
  v_exp_f32 v90, v90
  v_mfma_f32_16x16x32_bf16 a[40:43], a[168:171], v[164:167], a[40:43]
  buffer_load_dwordx4 v5, s[4:7], s84 offen offset:0 sc1 lds
  v_mfma_f32_16x16x32_bf16 a[8:11], a[168:171], v[160:163], a[8:11]
  s_waitcnt lgkmcnt(7)
  v_exp_f32 v91, v91
  v_mfma_f32_16x16x32_bf16 a[12:15], a[172:175], v[160:163], a[12:15]
  ds_read_b128 a[140:143], v10 offset:27648
  v_cvt_pk_bf16_f32 v149, v90, v91
  v_mfma_f32_16x16x32_bf16 a[44:47], a[172:175], v[164:167], a[44:47]
  v_exp_f32 v104, v104
  v_mfma_f32_16x16x32_bf16 a[108:111], a[172:175], v[172:175], a[108:111]
  s_waitcnt lgkmcnt(7)
  ds_read_b128 a[144:147], v10 offset:28672
  v_mfma_f32_16x16x32_bf16 a[112:115], a[176:179], v[172:175], a[112:115]
  v_exp_f32 v105, v105
  v_mfma_f32_16x16x32_bf16 a[48:51], a[176:179], v[164:167], a[48:51]
  ds_read_b128 a[148:151], v10 offset:29696
  v_cvt_pk_bf16_f32 v156, v104, v105
  v_mfma_f32_16x16x32_bf16 a[16:19], a[176:179], v[160:163], a[16:19]
  s_waitcnt lgkmcnt(8)
  v_exp_f32 v106, v106
  v_mfma_f32_16x16x32_bf16 a[20:23], a[180:183], v[160:163], a[20:23]
  buffer_load_dwordx4 v5, s[4:7], s84 offen offset:1024 sc1 lds
  v_mfma_f32_16x16x32_bf16 a[52:55], a[180:183], v[164:167], a[52:55]
  v_exp_f32 v107, v107
  v_mfma_f32_16x16x32_bf16 a[116:119], a[180:183], v[172:175], a[116:119]
  s_waitcnt lgkmcnt(7)
  ds_read_b128 a[152:155], v10 offset:30720
  v_cvt_pk_bf16_f32 v157, v106, v107
  v_mfma_f32_16x16x32_bf16 a[120:123], a[184:187], v[172:175], a[120:123]
  v_mfma_f32_16x16x32_bf16 a[56:59], a[184:187], v[164:167], a[56:59]
  v_exp_f32 v84, v84
  v_mfma_f32_16x16x32_bf16 a[24:27], a[184:187], v[160:163], a[24:27]
  s_waitcnt lgkmcnt(7)
  ds_read_b128 a[156:159], v10 offset:31744
  v_mfma_f32_16x16x32_bf16 a[28:31], a[188:191], v[160:163], a[28:31]
  v_exp_f32 v85, v85
  v_mfma_f32_16x16x32_bf16 a[60:63], a[188:191], v[164:167], a[60:63]
  buffer_load_dwordx4 v5, s[4:7], s84 offen offset:2048 sc1 lds
  v_mfma_f32_16x16x32_bf16 a[124:127], a[188:191], v[172:175], a[124:127]
  s_waitcnt lgkmcnt(7)
  v_exp_f32 v86, v86
  v_mfma_f32_16x16x32_bf16 v[112:115], a[128:131], v[16:19], v[176:179]
  s_waitcnt lgkmcnt(6)
  ds_read_b128 a[160:163], v10 offset:32768
  v_cvt_pk_bf16_f32 v146, v84, v85
  v_mfma_f32_16x16x32_bf16 v[112:115], a[132:135], v[20:23], v[112:115]
  s_waitcnt lgkmcnt(6)
  v_exp_f32 v87, v87
  v_mfma_f32_16x16x32_bf16 v[112:115], a[136:139], v[24:27], v[112:115]
  s_waitcnt lgkmcnt(5)
  v_cvt_pk_bf16_f32 v147, v86, v87
  v_mfma_f32_16x16x32_bf16 v[112:115], a[140:143], v[28:31], v[112:115]
  v_exp_f32 v92, v92
  v_mfma_f32_16x16x32_bf16 v[120:123], a[140:143], v[44:47], v[180:183]
  ds_read_b128 a[164:167], v10 offset:33792
  v_mfma_f32_16x16x32_bf16 v[120:123], a[136:139], v[40:43], v[120:123]
  v_exp_f32 v93, v93
  v_mfma_f32_16x16x32_bf16 v[120:123], a[132:135], v[36:39], v[120:123]
  buffer_load_dwordx4 v5, s[4:7], s84 offen offset:3072 sc1 lds
  v_mfma_f32_16x16x32_bf16 v[120:123], a[128:131], v[32:35], v[120:123]
  s_xor_b32 s85, s85, 0x10000
  v_exp_f32 v94, v94
  v_mfma_f32_16x16x32_bf16 v[136:139], a[128:131], v[64:67], v[188:191]
  ds_read_b128 a[168:171], v10 offset:34816
  v_cvt_pk_bf16_f32 v150, v92, v93
  v_mfma_f32_16x16x32_bf16 v[136:139], a[132:135], v[68:71], v[136:139]
  v_exp_f32 v95, v95
  v_mfma_f32_16x16x32_bf16 v[136:139], a[136:139], v[72:75], v[136:139]
  ds_read_b128 a[172:175], v10 offset:35840
  v_cvt_pk_bf16_f32 v151, v94, v95
  v_mfma_f32_16x16x32_bf16 v[136:139], a[140:143], v[76:79], v[136:139]
  s_waitcnt lgkmcnt(4)
  v_exp_f32 v108, v108
  v_mfma_f32_16x16x32_bf16 v[140:143], a[156:159], v[76:79], v[220:223]
  ds_read_b128 a[176:179], v10 offset:36864
  v_mfma_f32_16x16x32_bf16 v[140:143], a[152:155], v[72:75], v[140:143]
  v_exp_f32 v109, v109
  v_mfma_f32_16x16x32_bf16 v[140:143], a[148:151], v[68:71], v[140:143]
  v_cvt_pk_bf16_f32 v158, v108, v109
  v_mfma_f32_16x16x32_bf16 v[140:143], a[144:147], v[64:67], v[140:143]
  v_exp_f32 v110, v110
  v_mfma_f32_16x16x32_bf16 v[124:127], a[144:147], v[32:35], v[180:183]
  ds_read_b128 a[180:183], v10 offset:37888
  v_mfma_f32_16x16x32_bf16 v[124:127], a[148:151], v[36:39], v[124:127]
  v_exp_f32 v111, v111
  v_mfma_f32_16x16x32_bf16 v[124:127], a[152:155], v[40:43], v[124:127]
  ds_read_b128 a[184:187], v10 offset:38912
  v_cvt_pk_bf16_f32 v159, v110, v111
  v_mfma_f32_16x16x32_bf16 v[124:127], a[156:159], v[44:47], v[124:127]
  v_mfma_f32_16x16x32_bf16 v[116:119], a[156:159], v[28:31], v[176:179]
  v_mfma_f32_16x16x32_bf16 v[116:119], a[152:155], v[24:27], v[116:119]
  v_exp_f32 v112, v112
  v_mfma_f32_16x16x32_bf16 v[116:119], a[148:151], v[20:23], v[116:119]
  v_exp_f32 v113, v113
  v_mfma_f32_16x16x32_bf16 v[116:119], a[144:147], v[16:19], v[116:119]
  ds_read_b128 a[188:191], v10 offset:39936
  v_cvt_pk_bf16_f32 v160, v112, v113
  v_mfma_f32_16x16x32_bf16 v[224:227], v[240:243], v[144:147], v[224:227]
  v_exp_f32 v114, v114
  v_mfma_f32_16x16x32_bf16 v[228:231], v[240:243], v[148:151], v[228:231]
  ds_read_b128 a[128:131], v10 offset:40960
  v_mfma_f32_16x16x32_bf16 v[236:239], v[240:243], v[156:159], v[236:239]
  s_waitcnt lgkmcnt(8)
  v_exp_f32 v115, v115
  v_mfma_f32_16x16x32_bf16 a[96:99], a[160:163], v[156:159], a[96:99]
  ds_read_b128 a[132:135], v10 offset:41984
  v_cvt_pk_bf16_f32 v161, v114, v115
  v_mfma_f32_16x16x32_bf16 a[32:35], a[160:163], v[148:151], a[32:35]
  v_exp_f32 v120, v120
  v_mfma_f32_16x16x32_bf16 a[0:3], a[160:163], v[144:147], a[0:3]
  s_waitcnt lgkmcnt(8)
  v_exp_f32 v121, v121
  v_mfma_f32_16x16x32_bf16 a[4:7], a[164:167], v[144:147], a[4:7]
  ds_read_b128 a[136:139], v10 offset:43008
  v_cvt_pk_bf16_f32 v164, v120, v121
  v_mfma_f32_16x16x32_bf16 a[36:39], a[164:167], v[148:151], a[36:39]
  v_exp_f32 v122, v122
  v_mfma_f32_16x16x32_bf16 a[100:103], a[164:167], v[156:159], a[100:103]
  s_waitcnt lgkmcnt(8)
  v_mfma_f32_16x16x32_bf16 a[104:107], a[168:171], v[156:159], a[104:107]
  v_exp_f32 v123, v123
  v_mfma_f32_16x16x32_bf16 a[40:43], a[168:171], v[148:151], a[40:43]
  ds_read_b128 a[140:143], v10 offset:44032
  v_cvt_pk_bf16_f32 v165, v122, v123
  v_mfma_f32_16x16x32_bf16 a[8:11], a[168:171], v[144:147], a[8:11]
  s_waitcnt lgkmcnt(8)
  v_exp_f32 v136, v136
  v_mfma_f32_16x16x32_bf16 a[12:15], a[172:175], v[144:147], a[12:15]
  v_exp_f32 v137, v137
  v_mfma_f32_16x16x32_bf16 a[44:47], a[172:175], v[148:151], a[44:47]
  ds_read_b128 a[144:147], v10 offset:45056
  v_cvt_pk_bf16_f32 v172, v136, v137
  v_mfma_f32_16x16x32_bf16 a[108:111], a[172:175], v[156:159], a[108:111]
  s_waitcnt lgkmcnt(8)
  v_exp_f32 v138, v138
  v_mfma_f32_16x16x32_bf16 a[112:115], a[176:179], v[156:159], a[112:115]
  v_mfma_f32_16x16x32_bf16 a[48:51], a[176:179], v[148:151], a[48:51]
  v_exp_f32 v139, v139
  v_mfma_f32_16x16x32_bf16 a[16:19], a[176:179], v[144:147], a[16:19]
  s_waitcnt lgkmcnt(7)
  ds_read_b128 a[148:151], v10 offset:46080
  v_cvt_pk_bf16_f32 v173, v138, v139
  v_mfma_f32_16x16x32_bf16 a[20:23], a[180:183], v[144:147], a[20:23]
  v_exp_f32 v116, v116
  v_mfma_f32_16x16x32_bf16 a[52:55], a[180:183], v[148:151], a[52:55]
  v_exp_f32 v117, v117
  v_mfma_f32_16x16x32_bf16 a[116:119], a[180:183], v[156:159], a[116:119]
  s_waitcnt lgkmcnt(7)
  ds_read_b128 a[152:155], v10 offset:47104
  v_cvt_pk_bf16_f32 v162, v116, v117
  v_mfma_f32_16x16x32_bf16 a[120:123], a[184:187], v[156:159], a[120:123]
  v_exp_f32 v118, v118
  v_mfma_f32_16x16x32_bf16 a[56:59], a[184:187], v[148:151], a[56:59]
  v_mfma_f32_16x16x32_bf16 a[24:27], a[184:187], v[144:147], a[24:27]
  s_waitcnt lgkmcnt(7)
  v_exp_f32 v119, v119
  v_mfma_f32_16x16x32_bf16 a[28:31], a[188:191], v[144:147], a[28:31]
  ds_read_b128 a[156:159], v10 offset:48128
  v_cvt_pk_bf16_f32 v163, v118, v119
  v_mfma_f32_16x16x32_bf16 a[60:63], a[188:191], v[148:151], a[60:63]
  v_exp_f32 v124, v124
  v_mfma_f32_16x16x32_bf16 a[124:127], a[188:191], v[156:159], a[124:127]
  s_waitcnt lgkmcnt(7)
  v_exp_f32 v125, v125
  v_mfma_f32_16x16x32_bf16 v[80:83], a[128:131], v[16:19], v[192:195]
  s_waitcnt lgkmcnt(6)
  ds_read_b128 a[160:163], v10 offset:49152
  v_cvt_pk_bf16_f32 v166, v124, v125
  v_mfma_f32_16x16x32_bf16 v[80:83], a[132:135], v[20:23], v[80:83]
  s_waitcnt lgkmcnt(6)
  v_exp_f32 v126, v126
  v_mfma_f32_16x16x32_bf16 v[80:83], a[136:139], v[24:27], v[80:83]
  s_waitcnt lgkmcnt(5)
  ds_read_b128 a[164:167], v10 offset:50176
  v_mfma_f32_16x16x32_bf16 v[80:83], a[140:143], v[28:31], v[80:83]
  v_exp_f32 v127, v127
  v_mfma_f32_16x16x32_bf16 v[88:91], a[140:143], v[44:47], v[180:183]
  ds_read_b128 a[168:171], v10 offset:51200
  v_cvt_pk_bf16_f32 v167, v126, v127
  v_mfma_f32_16x16x32_bf16 v[88:91], a[136:139], v[40:43], v[88:91]
  v_exp_f32 v140, v140
  v_mfma_f32_16x16x32_bf16 v[88:91], a[132:135], v[36:39], v[88:91]
  v_exp_f32 v141, v141
  v_mfma_f32_16x16x32_bf16 v[88:91], a[128:131], v[32:35], v[88:91]
  s_waitcnt lgkmcnt(6)
  ds_read_b128 a[172:175], v10 offset:52224
  v_cvt_pk_bf16_f32 v174, v140, v141
  v_mfma_f32_16x16x32_bf16 v[92:95], a[144:147], v[32:35], v[180:183]
  s_waitcnt lgkmcnt(6)
  v_exp_f32 v142, v142
  v_mfma_f32_16x16x32_bf16 v[92:95], a[148:151], v[36:39], v[92:95]
  s_waitcnt lgkmcnt(5)
  ds_read_b128 a[176:179], v10 offset:53248
  v_mfma_f32_16x16x32_bf16 v[92:95], a[152:155], v[40:43], v[92:95]
  s_waitcnt lgkmcnt(5)
  v_exp_f32 v143, v143
  v_mfma_f32_16x16x32_bf16 v[92:95], a[156:159], v[44:47], v[92:95]
  ds_read_b128 a[180:183], v10 offset:54272
  v_cvt_pk_bf16_f32 v175, v142, v143
  v_mfma_f32_16x16x32_bf16 v[84:87], a[156:159], v[28:31], v[196:199]
  ds_read_b128 a[184:187], v10 offset:55296
  v_mfma_f32_16x16x32_bf16 v[84:87], a[152:155], v[24:27], v[84:87]
  v_mfma_f32_16x16x32_bf16 v[84:87], a[148:151], v[20:23], v[84:87]
  v_exp_f32 v80, v80
  v_mfma_f32_16x16x32_bf16 v[84:87], a[144:147], v[16:19], v[84:87]
  v_exp_f32 v81, v81
  v_mfma_f32_16x16x32_bf16 v[224:227], v[240:243], v[160:163], v[224:227]
  ds_read_b128 a[188:191], v10 offset:56320
  v_cvt_pk_bf16_f32 v144, v80, v81
  v_mfma_f32_16x16x32_bf16 v[228:231], v[240:243], v[164:167], v[228:231]
  v_exp_f32 v82, v82
  v_mfma_f32_16x16x32_bf16 v[236:239], v[240:243], v[172:175], v[236:239]
  s_waitcnt lgkmcnt(7)
  ds_read_b128 a[128:131], v10 offset:57344
  v_mfma_f32_16x16x32_bf16 a[96:99], a[160:163], v[172:175], a[96:99]
  v_exp_f32 v83, v83
  v_mfma_f32_16x16x32_bf16 a[32:35], a[160:163], v[164:167], a[32:35]
  ds_read_b128 a[132:135], v10 offset:58368
  v_cvt_pk_bf16_f32 v145, v82, v83
  v_mfma_f32_16x16x32_bf16 a[0:3], a[160:163], v[160:163], a[0:3]
  s_waitcnt lgkmcnt(8)
  v_exp_f32 v88, v88
  v_mfma_f32_16x16x32_bf16 a[4:7], a[164:167], v[160:163], a[4:7]
  ds_read_b128 a[136:139], v10 offset:59392
  v_mfma_f32_16x16x32_bf16 a[36:39], a[164:167], v[164:167], a[36:39]
  v_exp_f32 v89, v89
  v_mfma_f32_16x16x32_bf16 a[100:103], a[164:167], v[172:175], a[100:103]
  s_waitcnt lgkmcnt(8)
  ds_read_b128 a[140:143], v10 offset:60416
  v_cvt_pk_bf16_f32 v148, v88, v89
  v_mfma_f32_16x16x32_bf16 a[104:107], a[168:171], v[172:175], a[104:107]
  v_exp_f32 v90, v90
  v_mfma_f32_16x16x32_bf16 a[40:43], a[168:171], v[164:167], a[40:43]
  ds_read_b128 a[144:147], v10 offset:61440
  v_mfma_f32_16x16x32_bf16 a[8:11], a[168:171], v[160:163], a[8:11]
  s_waitcnt lgkmcnt(9)
  v_exp_f32 v91, v91
  v_mfma_f32_16x16x32_bf16 a[12:15], a[172:175], v[160:163], a[12:15]
  v_cvt_pk_bf16_f32 v149, v90, v91
  v_mfma_f32_16x16x32_bf16 a[44:47], a[172:175], v[164:167], a[44:47]
  v_exp_f32 v84, v84
  v_mfma_f32_16x16x32_bf16 a[108:111], a[172:175], v[172:175], a[108:111]
  s_waitcnt lgkmcnt(8)
  ds_read_b128 a[148:151], v10 offset:62464
  v_mfma_f32_16x16x32_bf16 a[112:115], a[176:179], v[172:175], a[112:115]
  v_exp_f32 v85, v85
  v_mfma_f32_16x16x32_bf16 a[48:51], a[176:179], v[164:167], a[48:51]
  ds_read_b128 a[152:155], v10 offset:63488
  v_cvt_pk_bf16_f32 v146, v84, v85
  v_mfma_f32_16x16x32_bf16 a[16:19], a[176:179], v[160:163], a[16:19]
  s_waitcnt lgkmcnt(9)
  v_exp_f32 v86, v86
  v_mfma_f32_16x16x32_bf16 a[20:23], a[180:183], v[160:163], a[20:23]
  ds_read_b128 a[156:159], v10 offset:64512
  v_mfma_f32_16x16x32_bf16 a[52:55], a[180:183], v[164:167], a[52:55]
  v_exp_f32 v87, v87
  v_mfma_f32_16x16x32_bf16 a[116:119], a[180:183], v[172:175], a[116:119]
  s_waitcnt lgkmcnt(9)
  v_cvt_pk_bf16_f32 v147, v86, v87
  v_xor_b32 v10, 0x10000, v10
  v_mfma_f32_16x16x32_bf16 a[120:123], a[184:187], v[172:175], a[120:123]
  v_exp_f32 v92, v92
  v_mfma_f32_16x16x32_bf16 a[56:59], a[184:187], v[164:167], a[56:59]
  v_mfma_f32_16x16x32_bf16 a[24:27], a[184:187], v[160:163], a[24:27]
  s_waitcnt lgkmcnt(8)
  v_exp_f32 v93, v93
  v_mfma_f32_16x16x32_bf16 a[28:31], a[188:191], v[160:163], a[28:31]
  v_cvt_pk_bf16_f32 v150, v92, v93
  v_mfma_f32_16x16x32_bf16 a[60:63], a[188:191], v[164:167], a[60:63]
  s_waitcnt vmcnt(0) lgkmcnt(0)
  v_mfma_f32_16x16x32_bf16 a[124:127], a[188:191], v[172:175], a[124:127]
  buffer_store_dword v9, v8, s[36:39], 0 offen sc1
  s_branch L_sepi
L_sfin1:
  v_mov_b32 v192, v176
  v_mov_b32 v193, v176
  v_mov_b32 v194, v176
  v_mov_b32 v195, v176
  v_mov_b32 v196, v176
  v_mov_b32 v197, v176
  v_mov_b32 v198, v176
  v_mov_b32 v199, v176
  s_add_u32 s81, s80, 1
  s_cmp_lg_u32 s81, s79
  s_cbranch_scc1 L_sfin1_nd
  v_sub_f32 v196, v244, v248
  v_sub_f32 v197, v245, v248
  v_sub_f32 v198, v246, v248
  v_sub_f32 v199, v247, v248
L_sfin1_nd:
  s_add_u32 m0, s85, 0
  v_mfma_f32_16x16x32_bf16 v[112:115], a[128:131], v[16:19], v[176:179]
  s_barrier
  ds_read_b128 a[160:163], v10 offset:0
  v_mfma_f32_16x16x32_bf16 v[112:115], a[132:135], v[20:23], v[112:115]
  s_add_u32 s84, s84, 0x10000
  ds_read_b128 a[164:167], v10 offset:1024
  v_mfma_f32_16x16x32_bf16 v[112:115], a[136:139], v[24:27], v[112:115]
  buffer_load_dwordx4 v2, s[4:7], s84 offen offset:0 sc1 lds
  v_mfma_f32_16x16x32_bf16 v[112:115], a[140:143], v[28:31], v[112:115]
  ds_read_b128 a[168:171], v10 offset:2048
  v_mfma_f32_16x16x32_bf16 v[120:123], a[140:143], v[44:47], v[180:183]
  ds_read_b128 a[172:175], v10 offset:3072
  v_mfma_f32_16x16x32_bf16 v[120:123], a[136:139], v[40:43], v[120:123]
  ds_read_b128 a[176:179], v10 offset:4096
  v_mfma_f32_16x16x32_bf16 v[120:123], a[132:135], v[36:39], v[120:123]
  ds_read_b128 a[180:183], v10 offset:5120
  v_mfma_f32_16x16x32_bf16 v[120:123], a[128:131], v[32:35], v[120:123]
  ds_read_b128 a[184:187], v10 offset:6144
  v_mfma_f32_16x16x32_bf16 v[136:139], a[128:131], v[64:67], v[188:191]
  v_exp_f32 v108, v108
  v_mfma_f32_16x16x32_bf16 v[136:139], a[132:135], v[68:71], v[136:139]
  buffer_load_dwordx4 v2, s[4:7], s84 offen offset:1024 sc1 lds
  v_mfma_f32_16x16x32_bf16 v[136:139], a[136:139], v[72:75], v[136:139]
  ds_read_b128 a[188:191], v10 offset:7168
  v_sub_f32 v220, v244, v251
  v_mfma_f32_16x16x32_bf16 v[136:139], a[140:143], v[76:79], v[136:139]
  v_exp_f32 v109, v109
  v_mfma_f32_16x16x32_bf16 v[140:143], a[156:159], v[76:79], v[188:191]
  s_bfe_u32 s52, s2, 0x20001
  v_cvt_pk_bf16_f32 v158, v108, v109
  v_sub_f32 v221, v245, v251
  v_mfma_f32_16x16x32_bf16 v[140:143], a[152:155], v[72:75], v[140:143]
  s_and_b32 s50, s2, 1
  v_sub_f32 v222, v246, v251
  v_sub_f32 v223, v247, v251
  v_mfma_f32_16x16x32_bf16 v[140:143], a[148:151], v[68:71], v[140:143]
  v_exp_f32 v110, v110
  v_mfma_f32_16x16x32_bf16 v[140:143], a[144:147], v[64:67], v[140:143]
  s_lshl_b32 s50, s50, 3
  s_bfe_u32 s51, s2, 0x30003
  s_add_u32 s50, s50, s51
  v_mfma_f32_16x16x32_bf16 v[124:127], a[144:147], v[32:35], v[180:183]
  s_lshr_b32 s51, s2, 6
  s_sub_u32 s81, 15, s50
  s_min_u32 s81, s81, s50
  v_mfma_f32_16x16x32_bf16 v[124:127], a[148:151], v[36:39], v[124:127]
  s_lshl_b32 s81, s81, 2
  v_exp_f32 v111, v111
  v_mfma_f32_16x16x32_bf16 v[124:127], a[152:155], v[40:43], v[124:127]
  buffer_load_dwordx4 v2, s[4:7], s84 offen offset:2048 sc1 lds
  v_mfma_f32_16x16x32_bf16 v[124:127], a[156:159], v[44:47], v[124:127]
  s_add_u32 s81, s81, s52
  v_cvt_pk_bf16_f32 v159, v110, v111
  s_lshl_b32 s63, s81, 11
  v_mfma_f32_16x16x32_bf16 v[116:119], a[156:159], v[28:31], v[176:179]
  s_mul_i32 s81, s51, 1863680
  s_add_u32 s81, s81, 65011712
  v_mfma_f32_16x16x32_bf16 v[116:119], a[152:155], v[24:27], v[116:119]
  s_add_u32 s8, s74, s81
  s_addc_u32 s9, s75, 0
  v_exp_f32 v112, v112
  v_mfma_f32_16x16x32_bf16 v[116:119], a[148:151], v[20:23], v[116:119]
  s_mov_b32 s11, 0x20000
  s_lshl_b32 s83, s52, 5
  v_mfma_f32_16x16x32_bf16 v[116:119], a[144:147], v[16:19], v[116:119]
  s_add_u32 s83, s83, 86
  v_exp_f32 v113, v113
  v_mfma_f32_16x16x32_bf16 v[224:227], v[240:243], v[144:147], v[224:227]
  buffer_load_dwordx4 v2, s[4:7], s84 offen offset:3072 sc1 lds
  s_add_u32 m0, s85, 4096
  v_mfma_f32_16x16x32_bf16 v[228:231], v[240:243], v[148:151], v[228:231]
  s_mul_i32 s10, s83, 10240
  v_exp_f32 v114, v114
  v_mfma_f32_16x16x32_bf16 v[232:235], v[240:243], v[152:155], v[232:235]
  s_waitcnt lgkmcnt(7)
  ds_read_b128 a[128:131], v10 offset:8192
  v_cvt_pk_bf16_f32 v160, v112, v113
  v_mfma_f32_16x16x32_bf16 v[236:239], v[240:243], v[156:159], v[236:239]
  s_lshl_b32 s83, s83, 13
  s_add_u32 s83, s83, 1024
  s_mul_i32 s82, s50, 1490944
  v_mfma_f32_16x16x32_bf16 a[96:99], a[160:163], v[156:159], a[96:99]
  s_add_u32 s82, s82, 39844864
  v_exp_f32 v115, v115
  v_mfma_f32_16x16x32_bf16 a[64:67], a[160:163], v[152:155], a[64:67]
  s_and_b32 s62, s76, 1
  ds_read_b128 a[132:135], v10 offset:9216
  v_cvt_pk_bf16_f32 v161, v114, v115
  v_mfma_f32_16x16x32_bf16 a[32:35], a[160:163], v[148:151], a[32:35]
  s_waitcnt lgkmcnt(8)
  v_exp_f32 v120, v120
  v_mfma_f32_16x16x32_bf16 a[0:3], a[160:163], v[144:147], a[0:3]
  s_cmp_eq_u32 s62, 0
  s_cselect_b32 s81, s81, s82
  s_cselect_b32 s14, s10, s83
  s_movk_i32 s56, 8192
  s_cselect_b32 s56, 10240, s56
  v_mfma_f32_16x16x32_bf16 a[4:7], a[164:167], v[144:147], a[4:7]
  buffer_load_dwordx4 v3, s[4:7], s84 offen offset:0 sc1 lds
  v_mfma_f32_16x16x32_bf16 a[36:39], a[164:167], v[148:151], a[36:39]
  s_add_u32 s12, s74, s81
  s_addc_u32 s13, s75, 0
  v_exp_f32 v121, v121
  v_mfma_f32_16x16x32_bf16 a[68:71], a[164:167], v[152:155], a[68:71]
  s_waitcnt lgkmcnt(7)
  ds_read_b128 a[136:139], v10 offset:10240
  v_cvt_pk_bf16_f32 v164, v120, v121
  v_mfma_f32_16x16x32_bf16 a[100:103], a[164:167], v[156:159], a[100:103]
  s_mov_b32 s15, 0x20000
  v_exp_f32 v122, v122
  v_mfma_f32_16x16x32_bf16 a[104:107], a[168:171], v[156:159], a[104:107]
  s_mul_i32 s81, s52, 14
  s_lshr_b32 s82, s76, 1
  s_add_u32 s81, s81, s82
  v_mfma_f32_16x16x32_bf16 a[72:75], a[168:171], v[152:155], a[72:75]
  s_mul_i32 s53, s81, 10240
  ds_read_b128 a[140:143], v10 offset:11264
  s_mul_i32 s54, s81, s56
  v_mfma_f32_16x16x32_bf16 a[40:43], a[168:171], v[148:151], a[40:43]
  v_exp_f32 v123, v123
  v_mfma_f32_16x16x32_bf16 a[8:11], a[168:171], v[144:147], a[8:11]
  s_waitcnt lgkmcnt(8)
  buffer_load_dwordx4 v3, s[4:7], s84 offen offset:1024 sc1 lds
  v_mfma_f32_16x16x32_bf16 a[12:15], a[172:175], v[144:147], a[12:15]
  s_mul_i32 s82, s62, 9216
  v_exp_f32 v136, v136
  v_mfma_f32_16x16x32_bf16 a[44:47], a[172:175], v[148:151], a[44:47]
  s_add_u32 s53, s53, s82
  v_cvt_pk_bf16_f32 v165, v122, v123
  s_mul_i32 s81, s52, 18
  v_mfma_f32_16x16x32_bf16 a[76:79], a[172:175], v[152:155], a[76:79]
  s_waitcnt lgkmcnt(7)
  ds_read_b128 a[144:147], v10 offset:12288
  s_add_u32 s81, s81, 42
  v_mfma_f32_16x16x32_bf16 a[108:111], a[172:175], v[156:159], a[108:111]
  s_mul_i32 s60, s81, 10240
  v_exp_f32 v137, v137
  v_mfma_f32_16x16x32_bf16 a[112:115], a[176:179], v[156:159], a[112:115]
  s_mul_i32 s61, s81, s56
  v_cvt_pk_bf16_f32 v172, v136, v137
  s_mov_b32 s55, 20480
  v_mfma_f32_16x16x32_bf16 a[80:83], a[176:179], v[152:155], a[80:83]
  s_lshl_b32 s56, s56, 1
  v_exp_f32 v138, v138
  v_mfma_f32_16x16x32_bf16 a[48:51], a[176:179], v[148:151], a[48:51]
  ds_read_b128 a[148:151], v10 offset:13312
  s_mul_i32 s64, s76, 9216
  v_mfma_f32_16x16x32_bf16 a[16:19], a[176:179], v[144:147], a[16:19]
  s_waitcnt lgkmcnt(8)
  buffer_load_dwordx4 v3, s[4:7], s84 offen offset:2048 sc1 lds
  v_mfma_f32_16x16x32_bf16 a[20:23], a[180:183], v[144:147], a[20:23]
  s_cmp_eq_u32 s52, 3
  s_cselect_b32 s81, 1073741824, 0
  v_exp_f32 v139, v139
  v_mfma_f32_16x16x32_bf16 a[52:55], a[180:183], v[148:151], a[52:55]
  s_add_u32 s57, s55, s81
  v_cvt_pk_bf16_f32 v173, v138, v139
  s_add_u32 s65, s56, s81
  v_mfma_f32_16x16x32_bf16 a[84:87], a[180:183], v[152:155], a[84:87]
  s_waitcnt lgkmcnt(7)
  v_exp_f32 v116, v116
  v_mfma_f32_16x16x32_bf16 a[116:119], a[180:183], v[156:159], a[116:119]
  s_sub_u32 s60, s60, s81
  ds_read_b128 a[152:155], v10 offset:14336
  s_sub_u32 s61, s61, s81
  v_mfma_f32_16x16x32_bf16 a[120:123], a[184:187], v[156:159], a[120:123]
  s_mov_b64 s[16:17], s[48:49]
  v_exp_f32 v117, v117
  v_mfma_f32_16x16x32_bf16 a[88:91], a[184:187], v[152:155], a[88:91]
  s_mov_b32 s18, 2621440
  v_cvt_pk_bf16_f32 v162, v116, v117
  s_mov_b32 s19, 0x20000
  v_mfma_f32_16x16x32_bf16 a[56:59], a[184:187], v[148:151], a[56:59]
  s_waitcnt lgkmcnt(7)
  buffer_load_dwordx4 v3, s[4:7], s84 offen offset:3072 sc1 lds
  s_add_u32 m0, s85, 8192
  v_mfma_f32_16x16x32_bf16 a[24:27], a[184:187], v[144:147], a[24:27]
  s_mov_b64 s[24:25], s[70:71]
  v_exp_f32 v118, v118
  v_mfma_f32_16x16x32_bf16 a[28:31], a[188:191], v[144:147], a[28:31]
  s_mov_b32 s26, 2621440
  ds_read_b128 a[156:159], v10 offset:15360
  s_mov_b32 s27, 0x20000
  v_mfma_f32_16x16x32_bf16 a[60:63], a[188:191], v[148:151], a[60:63]
  s_mov_b64 s[28:29], s[68:69]
  v_exp_f32 v119, v119
  v_mfma_f32_16x16x32_bf16 a[92:95], a[188:191], v[152:155], a[92:95]
  s_waitcnt lgkmcnt(7)
  v_cvt_pk_bf16_f32 v163, v118, v119
  s_mov_b32 s30, 1280
  v_mfma_f32_16x16x32_bf16 a[124:127], a[188:191], v[156:159], a[124:127]
  s_mov_b32 s31, 0x20000
  s_add_u32 s32, s74, 73400320
  s_addc_u32 s33, s75, 0
  v_mfma_f32_16x16x32_bf16 v[80:83], a[128:131], v[16:19], v[176:179]
  s_mov_b32 s34, 16777216
  v_exp_f32 v124, v124
  s_waitcnt lgkmcnt(6)
  v_mfma_f32_16x16x32_bf16 v[80:83], a[132:135], v[20:23], v[80:83]
  s_mov_b32 s35, 0x20000
  ds_read_b128 a[160:163], v10 offset:16384
  s_waitcnt lgkmcnt(6)
  v_mfma_f32_16x16x32_bf16 v[80:83], a[136:139], v[24:27], v[80:83]
  s_waitcnt lgkmcnt(5)
  v_exp_f32 v125, v125
  v_mfma_f32_16x16x32_bf16 v[80:83], a[140:143], v[28:31], v[80:83]
  buffer_load_dwordx4 v4, s[4:7], s84 offen offset:0 sc1 lds
  v_mfma_f32_16x16x32_bf16 v[88:91], a[140:143], v[44:47], v[180:183]
  ds_read_b128 a[164:167], v10 offset:17408
  v_cvt_pk_bf16_f32 v166, v124, v125
  v_mfma_f32_16x16x32_bf16 v[88:91], a[136:139], v[40:43], v[88:91]
  v_exp_f32 v126, v126
  v_mfma_f32_16x16x32_bf16 v[88:91], a[132:135], v[36:39], v[88:91]
  ds_read_b128 a[168:171], v10 offset:18432
  v_mfma_f32_16x16x32_bf16 v[88:91], a[128:131], v[32:35], v[88:91]
  v_exp_f32 v127, v127
  v_mfma_f32_16x16x32_bf16 v[104:107], a[128:131], v[64:67], v[188:191]
  v_cvt_pk_bf16_f32 v167, v126, v127
  v_mfma_f32_16x16x32_bf16 v[104:107], a[132:135], v[68:71], v[104:107]
  buffer_load_dwordx4 v4, s[4:7], s84 offen offset:1024 sc1 lds
  v_mfma_f32_16x16x32_bf16 v[104:107], a[136:139], v[72:75], v[104:107]
  v_exp_f32 v140, v140
  v_mfma_f32_16x16x32_bf16 v[104:107], a[140:143], v[76:79], v[104:107]
  s_waitcnt lgkmcnt(3)
  ds_read_b128 a[172:175], v10 offset:19456
  v_mfma_f32_16x16x32_bf16 v[108:111], a[156:159], v[76:79], v[188:191]
  v_exp_f32 v141, v141
  v_mfma_f32_16x16x32_bf16 v[108:111], a[152:155], v[72:75], v[108:111]
  ds_read_b128 a[176:179], v10 offset:20480
  v_cvt_pk_bf16_f32 v174, v140, v141
  v_mfma_f32_16x16x32_bf16 v[108:111], a[148:151], v[68:71], v[108:111]
  v_mfma_f32_16x16x32_bf16 v[108:111], a[144:147], v[64:67], v[108:111]
  v_exp_f32 v142, v142
  v_mfma_f32_16x16x32_bf16 v[92:95], a[144:147], v[32:35], v[180:183]
  ds_read_b128 a[180:183], v10 offset:21504
  v_mfma_f32_16x16x32_bf16 v[92:95], a[148:151], v[36:39], v[92:95]
  v_exp_f32 v143, v143
  v_mfma_f32_16x16x32_bf16 v[92:95], a[152:155], v[40:43], v[92:95]
  buffer_load_dwordx4 v4, s[4:7], s84 offen offset:2048 sc1 lds
  v_mfma_f32_16x16x32_bf16 v[92:95], a[156:159], v[44:47], v[92:95]
  ds_read_b128 a[184:187], v10 offset:22528
  v_cvt_pk_bf16_f32 v175, v142, v143
  v_mfma_f32_16x16x32_bf16 v[84:87], a[156:159], v[28:31], v[176:179]
  v_mfma_f32_16x16x32_bf16 v[84:87], a[152:155], v[24:27], v[84:87]
  v_exp_f32 v80, v80
  v_mfma_f32_16x16x32_bf16 v[84:87], a[148:151], v[20:23], v[84:87]
  v_exp_f32 v81, v81
  v_mfma_f32_16x16x32_bf16 v[84:87], a[144:147], v[16:19], v[84:87]
  ds_read_b128 a[188:191], v10 offset:23552
  v_cvt_pk_bf16_f32 v144, v80, v81
  v_mfma_f32_16x16x32_bf16 v[224:227], v[240:243], v[160:163], v[224:227]
  v_exp_f32 v82, v82
  v_mfma_f32_16x16x32_bf16 v[228:231], v[240:243], v[164:167], v[228:231]
  buffer_load_dwordx4 v4, s[4:7], s84 offen offset:3072 sc1 lds
  v_mfma_f32_16x16x32_bf16 v[236:239], v[240:243], v[172:175], v[236:239]
  s_waitcnt lgkmcnt(7)
  ds_read_b128 a[128:131], v10 offset:24576
  v_mfma_f32_16x16x32_bf16 a[96:99], a[160:163], v[172:175], a[96:99]
  s_add_u32 m0, s85, 12288
  v_exp_f32 v83, v83
  v_mfma_f32_16x16x32_bf16 a[32:35], a[160:163], v[164:167], a[32:35]
  v_exp_f32 v88, v88
  v_mfma_f32_16x16x32_bf16 a[0:3], a[160:163], v[160:163], a[0:3]
  s_waitcnt lgkmcnt(7)
  ds_read_b128 a[132:135], v10 offset:25600
  v_cvt_pk_bf16_f32 v145, v82, v83
  v_mfma_f32_16x16x32_bf16 a[4:7], a[164:167], v[160:163], a[4:7]
  v_exp_f32 v89, v89
  v_mfma_f32_16x16x32_bf16 a[36:39], a[164:167], v[164:167], a[36:39]
  ds_read_b128 a[136:139], v10 offset:26624
  v_cvt_pk_bf16_f32 v148, v88, v89
  v_mfma_f32_16x16x32_bf16 a[100:103], a[164:167], v[172:175], a[100:103]
  s_waitcnt lgkmcnt(8)
  v_exp_f32 v90, v90
  v_mfma_f32_16x16x32_bf16 a[104:107], a[168:171], v[172:175], a[104:107]
  buffer_load_dwordx4 v5, s[4:7], s84 offen offset:0 sc1 lds
  v_mfma_f32_16x16x32_bf16 a[40:43], a[168:171], v[164:167], a[40:43]
  v_exp_f32 v91, v91
  v_mfma_f32_16x16x32_bf16 a[8:11], a[168:171], v[160:163], a[8:11]
  s_waitcnt lgkmcnt(7)
  ds_read_b128 a[140:143], v10 offset:27648
  v_cvt_pk_bf16_f32 v149, v90, v91
  v_mfma_f32_16x16x32_bf16 a[12:15], a[172:175], v[160:163], a[12:15]
  v_exp_f32 v104, v104
  v_mfma_f32_16x16x32_bf16 a[44:47], a[172:175], v[164:167], a[44:47]
  ds_read_b128 a[144:147], v10 offset:28672
  v_mfma_f32_16x16x32_bf16 a[108:111], a[172:175], v[172:175], a[108:111]
  s_waitcnt lgkmcnt(8)
  v_exp_f32 v105, v105
  v_mfma_f32_16x16x32_bf16 a[112:115], a[176:179], v[172:175], a[112:115]
  buffer_load_dwordx4 v5, s[4:7], s84 offen offset:1024 sc1 lds
  v_mfma_f32_16x16x32_bf16 a[48:51], a[176:179], v[164:167], a[48:51]
  v_exp_f32 v106, v106
  v_mfma_f32_16x16x32_bf16 a[16:19], a[176:179], v[160:163], a[16:19]
  s_waitcnt lgkmcnt(7)
  ds_read_b128 a[148:151], v10 offset:29696
  v_cvt_pk_bf16_f32 v156, v104, v105
  v_mfma_f32_16x16x32_bf16 a[20:23], a[180:183], v[160:163], a[20:23]
  v_exp_f32 v107, v107
  v_mfma_f32_16x16x32_bf16 a[52:55], a[180:183], v[164:167], a[52:55]
  v_cvt_pk_bf16_f32 v157, v106, v107
  v_mfma_f32_16x16x32_bf16 a[116:119], a[180:183], v[172:175], a[116:119]
  s_waitcnt lgkmcnt(7)
  v_exp_f32 v84, v84
  v_mfma_f32_16x16x32_bf16 a[120:123], a[184:187], v[172:175], a[120:123]
  v_exp_f32 v85, v85
  v_mfma_f32_16x16x32_bf16 a[56:59], a[184:187], v[164:167], a[56:59]
  ds_read_b128 a[152:155], v10 offset:30720
  v_cvt_pk_bf16_f32 v146, v84, v85
  v_mfma_f32_16x16x32_bf16 a[24:27], a[184:187], v[160:163], a[24:27]
  s_waitcnt lgkmcnt(7)
  v_exp_f32 v86, v86
  v_mfma_f32_16x16x32_bf16 a[28:31], a[188:191], v[160:163], a[28:31]
  buffer_load_dwordx4 v5, s[4:7], s84 offen offset:2048 sc1 lds
  v_mfma_f32_16x16x32_bf16 a[60:63], a[188:191], v[164:167], a[60:63]
  ds_read_b128 a[156:159], v10 offset:31744
  v_mfma_f32_16x16x32_bf16 a[124:127], a[188:191], v[172:175], a[124:127]
  s_waitcnt lgkmcnt(7)
  v_exp_f32 v87, v87
  v_mfma_f32_16x16x32_bf16 v[112:115], a[128:131], v[16:19], v[176:179]
  s_waitcnt lgkmcnt(6)
  v_exp_f32 v92, v92
  v_mfma_f32_16x16x32_bf16 v[112:115], a[132:135], v[20:23], v[112:115]
  s_waitcnt lgkmcnt(5)
  ds_read_b128 a[160:163], v10 offset:32768
  v_cvt_pk_bf16_f32 v147, v86, v87
  v_mfma_f32_16x16x32_bf16 v[112:115], a[136:139], v[24:27], v[112:115]
  s_waitcnt lgkmcnt(5)
  v_exp_f32 v93, v93
  v_mfma_f32_16x16x32_bf16 v[112:115], a[140:143], v[28:31], v[112:115]
  ds_read_b128 a[164:167], v10 offset:33792
  v_cvt_pk_bf16_f32 v150, v92, v93
  v_mfma_f32_16x16x32_bf16 v[120:123], a[140:143], v[44:47], v[180:183]
  v_exp_f32 v94, v94
  v_mfma_f32_16x16x32_bf16 v[120:123], a[136:139], v[40:43], v[120:123]
  buffer_load_dwordx4 v5, s[4:7], s84 offen offset:3072 sc1 lds
  v_mfma_f32_16x16x32_bf16 v[120:123], a[132:135], v[36:39], v[120:123]
  s_xor_b32 s85, s85, 0x10000
  v_exp_f32 v95, v95
  v_mfma_f32_16x16x32_bf16 v[120:123], a[128:131], v[32:35], v[120:123]
  ds_read_b128 a[168:171], v10 offset:34816
  v_cvt_pk_bf16_f32 v151, v94, v95
  v_mfma_f32_16x16x32_bf16 v[136:139], a[128:131], v[64:67], v[220:223]
  v_exp_f32 v108, v108
  v_mfma_f32_16x16x32_bf16 v[136:139], a[132:135], v[68:71], v[136:139]
  ds_read_b128 a[172:175], v10 offset:35840
  v_mfma_f32_16x16x32_bf16 v[136:139], a[136:139], v[72:75], v[136:139]
  v_exp_f32 v109, v109
  v_mfma_f32_16x16x32_bf16 v[136:139], a[140:143], v[76:79], v[136:139]
  s_waitcnt lgkmcnt(4)
  ds_read_b128 a[176:179], v10 offset:36864
  v_cvt_pk_bf16_f32 v158, v108, v109
  v_mfma_f32_16x16x32_bf16 v[124:127], a[156:159], v[44:47], v[180:183]
  v_exp_f32 v110, v110
  v_mfma_f32_16x16x32_bf16 v[124:127], a[152:155], v[40:43], v[124:127]
  ds_read_b128 a[180:183], v10 offset:37888
  v_mfma_f32_16x16x32_bf16 v[124:127], a[148:151], v[36:39], v[124:127]
  v_exp_f32 v111, v111
  v_mfma_f32_16x16x32_bf16 v[124:127], a[144:147], v[32:35], v[124:127]
  ds_read_b128 a[184:187], v10 offset:38912
  v_cvt_pk_bf16_f32 v159, v110, v111
  v_mfma_f32_16x16x32_bf16 v[116:119], a[144:147], v[16:19], v[176:179]
  v_mfma_f32_16x16x32_bf16 v[116:119], a[148:151], v[20:23], v[116:119]
  v_exp_f32 v112, v112
  v_mfma_f32_16x16x32_bf16 v[116:119], a[152:155], v[24:27], v[116:119]
  ds_read_b128 a[188:191], v10 offset:39936
  v_mfma_f32_16x16x32_bf16 v[116:119], a[156:159], v[28:31], v[116:119]
  v_exp_f32 v113, v113
  v_mfma_f32_16x16x32_bf16 v[224:227], v[240:243], v[144:147], v[224:227]
  ds_read_b128 a[128:131], v10 offset:40960
  v_cvt_pk_bf16_f32 v160, v112, v113
  v_mfma_f32_16x16x32_bf16 v[228:231], v[240:243], v[148:151], v[228:231]
  v_exp_f32 v114, v114
  v_mfma_f32_16x16x32_bf16 v[236:239], v[240:243], v[156:159], v[236:239]
  s_waitcnt lgkmcnt(8)
  v_mfma_f32_16x16x32_bf16 a[96:99], a[160:163], v[156:159], a[96:99]
  v_exp_f32 v115, v115
  v_mfma_f32_16x16x32_bf16 a[32:35], a[160:163], v[148:151], a[32:35]
  ds_read_b128 a[132:135], v10 offset:41984
  v_cvt_pk_bf16_f32 v161, v114, v115
  v_mfma_f32_16x16x32_bf16 a[0:3], a[160:163], v[144:147], a[0:3]
  s_waitcnt lgkmcnt(8)
  v_exp_f32 v120, v120
  v_mfma_f32_16x16x32_bf16 a[4:7], a[164:167], v[144:147], a[4:7]
  ds_read_b128 a[136:139], v10 offset:43008
  v_mfma_f32_16x16x32_bf16 a[36:39], a[164:167], v[148:151], a[36:39]
  v_exp_f32 v121, v121
  v_mfma_f32_16x16x32_bf16 a[100:103], a[164:167], v[156:159], a[100:103]
  s_waitcnt lgkmcnt(8)
  v_cvt_pk_bf16_f32 v164, v120, v121
  v_mfma_f32_16x16x32_bf16 a[104:107], a[168:171], v[156:159], a[104:107]
  v_exp_f32 v122, v122
  v_mfma_f32_16x16x32_bf16 a[40:43], a[168:171], v[148:151], a[40:43]
  ds_read_b128 a[140:143], v10 offset:44032
  v_mfma_f32_16x16x32_bf16 a[8:11], a[168:171], v[144:147], a[8:11]
  s_waitcnt lgkmcnt(8)
  v_exp_f32 v123, v123
  v_mfma_f32_16x16x32_bf16 a[12:15], a[172:175], v[144:147], a[12:15]
  v_cvt_pk_bf16_f32 v165, v122, v123
  v_mfma_f32_16x16x32_bf16 a[44:47], a[172:175], v[148:151], a[44:47]
  v_exp_f32 v136, v136
  v_mfma_f32_16x16x32_bf16 a[108:111], a[172:175], v[156:159], a[108:111]
  s_waitcnt lgkmcnt(7)
  ds_read_b128 a[144:147], v10 offset:45056
  v_mfma_f32_16x16x32_bf16 a[112:115], a[176:179], v[156:159], a[112:115]
  v_exp_f32 v137, v137
  v_mfma_f32_16x16x32_bf16 a[48:51], a[176:179], v[148:151], a[48:51]
  ds_read_b128 a[148:151], v10 offset:46080
  v_cvt_pk_bf16_f32 v172, v136, v137
  v_mfma_f32_16x16x32_bf16 a[16:19], a[176:179], v[144:147], a[16:19]
  s_waitcnt lgkmcnt(8)
  v_mfma_f32_16x16x32_bf16 a[20:23], a[180:183], v[144:147], a[20:23]
  v_exp_f32 v138, v138
  v_mfma_f32_16x16x32_bf16 a[52:55], a[180:183], v[148:151], a[52:55]
  v_mfma_f32_16x16x32_bf16 a[116:119], a[180:183], v[156:159], a[116:119]
  s_waitcnt lgkmcnt(7)
  v_exp_f32 v139, v139
  v_mfma_f32_16x16x32_bf16 a[120:123], a[184:187], v[156:159], a[120:123]
  ds_read_b128 a[152:155], v10 offset:47104
  v_cvt_pk_bf16_f32 v173, v138, v139
  v_mfma_f32_16x16x32_bf16 a[56:59], a[184:187], v[148:151], a[56:59]
  v_exp_f32 v116, v116
  v_mfma_f32_16x16x32_bf16 a[24:27], a[184:187], v[144:147], a[24:27]
  s_waitcnt lgkmcnt(7)
  ds_read_b128 a[156:159], v10 offset:48128
  v_mfma_f32_16x16x32_bf16 a[28:31], a[188:191], v[144:147], a[28:31]
  v_exp_f32 v117, v117
  v_mfma_f32_16x16x32_bf16 a[60:63], a[188:191], v[148:151], a[60:63]
  v_cvt_pk_bf16_f32 v162, v116, v117
  v_mfma_f32_16x16x32_bf16 a[124:127], a[188:191], v[156:159], a[124:127]
  s_waitcnt lgkmcnt(7)
  v_exp_f32 v118, v118
  v_mfma_f32_16x16x32_bf16 v[80:83], a[128:131], v[16:19], v[192:195]
  s_waitcnt lgkmcnt(6)
  ds_read_b128 a[160:163], v10 offset:49152
  v_mov_b32 v174, 0
  v_mfma_f32_16x16x32_bf16 v[80:83], a[132:135], v[20:23], v[80:83]
  s_waitcnt lgkmcnt(6)
  v_exp_f32 v119, v119
  v_mfma_f32_16x16x32_bf16 v[80:83], a[136:139], v[24:27], v[80:83]
  s_waitcnt lgkmcnt(5)
  ds_read_b128 a[164:167], v10 offset:50176
  v_cvt_pk_bf16_f32 v163, v118, v119
  v_mfma_f32_16x16x32_bf16 v[80:83], a[140:143], v[28:31], v[80:83]
  v_exp_f32 v124, v124
  v_mfma_f32_16x16x32_bf16 v[88:91], a[140:143], v[44:47], v[180:183]
  ds_read_b128 a[168:171], v10 offset:51200
  v_mov_b32 v175, 0
  v_mfma_f32_16x16x32_bf16 v[88:91], a[136:139], v[40:43], v[88:91]
  v_exp_f32 v125, v125
  v_mfma_f32_16x16x32_bf16 v[88:91], a[132:135], v[36:39], v[88:91]
  ds_read_b128 a[172:175], v10 offset:52224
  v_cvt_pk_bf16_f32 v166, v124, v125
  v_mfma_f32_16x16x32_bf16 v[88:91], a[128:131], v[32:35], v[88:91]
  s_waitcnt lgkmcnt(7)
  v_exp_f32 v126, v126
  v_mfma_f32_16x16x32_bf16 v[92:95], a[144:147], v[32:35], v[180:183]
  s_waitcnt lgkmcnt(6)
  ds_read_b128 a[176:179], v10 offset:53248
  v_mfma_f32_16x16x32_bf16 v[92:95], a[148:151], v[36:39], v[92:95]
  s_waitcnt lgkmcnt(6)
  v_exp_f32 v127, v127
  v_mfma_f32_16x16x32_bf16 v[92:95], a[152:155], v[40:43], v[92:95]
  s_waitcnt lgkmcnt(5)
  ds_read_b128 a[180:183], v10 offset:54272
  v_cvt_pk_bf16_f32 v167, v126, v127
  v_mfma_f32_16x16x32_bf16 v[92:95], a[156:159], v[44:47], v[92:95]
  v_mfma_f32_16x16x32_bf16 v[84:87], a[156:159], v[28:31], v[196:199]
  ds_read_b128 a[184:187], v10 offset:55296
  v_mfma_f32_16x16x32_bf16 v[84:87], a[152:155], v[24:27], v[84:87]
  v_mfma_f32_16x16x32_bf16 v[84:87], a[148:151], v[20:23], v[84:87]
  v_exp_f32 v80, v80
  v_mfma_f32_16x16x32_bf16 v[84:87], a[144:147], v[16:19], v[84:87]
  v_exp_f32 v81, v81
  v_mfma_f32_16x16x32_bf16 v[224:227], v[240:243], v[160:163], v[224:227]
  ds_read_b128 a[188:191], v10 offset:56320
  v_cvt_pk_bf16_f32 v144, v80, v81
  v_mfma_f32_16x16x32_bf16 v[228:231], v[240:243], v[164:167], v[228:231]
  v_exp_f32 v82, v82
  v_mfma_f32_16x16x32_bf16 v[236:239], v[240:243], v[172:175], v[236:239]
  s_waitcnt lgkmcnt(7)
  ds_read_b128 a[128:131], v10 offset:57344
  v_mfma_f32_16x16x32_bf16 a[96:99], a[160:163], v[172:175], a[96:99]
  v_exp_f32 v83, v83
  v_mfma_f32_16x16x32_bf16 a[32:35], a[160:163], v[164:167], a[32:35]
  ds_read_b128 a[132:135], v10 offset:58368
  v_cvt_pk_bf16_f32 v145, v82, v83
  v_mfma_f32_16x16x32_bf16 a[0:3], a[160:163], v[160:163], a[0:3]
  s_waitcnt lgkmcnt(8)
  v_exp_f32 v88, v88
  v_mfma_f32_16x16x32_bf16 a[4:7], a[164:167], v[160:163], a[4:7]
  ds_read_b128 a[136:139], v10 offset:59392
  v_mfma_f32_16x16x32_bf16 a[36:39], a[164:167], v[164:167], a[36:39]
  v_exp_f32 v89, v89
  v_mfma_f32_16x16x32_bf16 a[100:103], a[164:167], v[172:175], a[100:103]
  s_waitcnt lgkmcnt(8)
  ds_read_b128 a[140:143], v10 offset:60416
  v_cvt_pk_bf16_f32 v148, v88, v89
  v_mfma_f32_16x16x32_bf16 a[104:107], a[168:171], v[172:175], a[104:107]
  v_exp_f32 v90, v90
  v_mfma_f32_16x16x32_bf16 a[40:43], a[168:171], v[164:167], a[40:43]
  ds_read_b128 a[144:147], v10 offset:61440
  v_mfma_f32_16x16x32_bf16 a[8:11], a[168:171], v[160:163], a[8:11]
  s_waitcnt lgkmcnt(9)
  v_exp_f32 v91, v91
  v_mfma_f32_16x16x32_bf16 a[12:15], a[172:175], v[160:163], a[12:15]
  v_cvt_pk_bf16_f32 v149, v90, v91
  v_mfma_f32_16x16x32_bf16 a[44:47], a[172:175], v[164:167], a[44:47]
  v_exp_f32 v84, v84
  v_mfma_f32_16x16x32_bf16 a[108:111], a[172:175], v[172:175], a[108:111]
  s_waitcnt lgkmcnt(8)
  ds_read_b128 a[148:151], v10 offset:62464
  v_mfma_f32_16x16x32_bf16 a[112:115], a[176:179], v[172:175], a[112:115]
  v_exp_f32 v85, v85
  v_mfma_f32_16x16x32_bf16 a[48:51], a[176:179], v[164:167], a[48:51]
  ds_read_b128 a[152:155], v10 offset:63488
  v_cvt_pk_bf16_f32 v146, v84, v85
  v_mfma_f32_16x16x32_bf16 a[16:19], a[176:179], v[160:163], a[16:19]
  s_waitcnt lgkmcnt(9)
  v_exp_f32 v86, v86
  v_mfma_f32_16x16x32_bf16 a[20:23], a[180:183], v[160:163], a[20:23]
  ds_read_b128 a[156:159], v10 offset:64512
  v_mfma_f32_16x16x32_bf16 a[52:55], a[180:183], v[164:167], a[52:55]
  v_exp_f32 v87, v87
  v_mfma_f32_16x16x32_bf16 a[116:119], a[180:183], v[172:175], a[116:119]
  s_waitcnt lgkmcnt(9)
  v_cvt_pk_bf16_f32 v147, v86, v87
  v_xor_b32 v10, 0x10000, v10
  v_mfma_f32_16x16x32_bf16 a[120:123], a[184:187], v[172:175], a[120:123]
  v_exp_f32 v92, v92
  v_mfma_f32_16x16x32_bf16 a[56:59], a[184:187], v[164:167], a[56:59]
  v_mfma_f32_16x16x32_bf16 a[24:27], a[184:187], v[160:163], a[24:27]
  s_waitcnt lgkmcnt(8)
  v_exp_f32 v93, v93
  v_mfma_f32_16x16x32_bf16 a[28:31], a[188:191], v[160:163], a[28:31]
  v_cvt_pk_bf16_f32 v150, v92, v93
  v_mfma_f32_16x16x32_bf16 a[60:63], a[188:191], v[164:167], a[60:63]
  s_waitcnt vmcnt(0) lgkmcnt(0)
  v_mfma_f32_16x16x32_bf16 a[124:127], a[188:191], v[172:175], a[124:127]
  buffer_store_dword v9, v8, s[36:39], 0 offen sc1
  s_branch L_sepi
L_sfin2:
  v_sub_f32 v216, v244, v250
  v_sub_f32 v217, v245, v250
  v_sub_f32 v218, v246, v250
  v_sub_f32 v219, v247, v250
  s_add_u32 m0, s85, 0
  v_mfma_f32_16x16x32_bf16 v[112:115], a[128:131], v[16:19], v[176:179]
  s_barrier
  ds_read_b128 a[160:163], v10 offset:0
  v_mfma_f32_16x16x32_bf16 v[112:115], a[132:135], v[20:23], v[112:115]
  s_add_u32 s84, s84, 0x10000
  ds_read_b128 a[164:167], v10 offset:1024
  v_mfma_f32_16x16x32_bf16 v[112:115], a[136:139], v[24:27], v[112:115]
  buffer_load_dwordx4 v2, s[4:7], s84 offen offset:0 sc1 lds
  v_mfma_f32_16x16x32_bf16 v[112:115], a[140:143], v[28:31], v[112:115]
  ds_read_b128 a[168:171], v10 offset:2048
  v_mfma_f32_16x16x32_bf16 v[120:123], a[140:143], v[44:47], v[180:183]
  ds_read_b128 a[172:175], v10 offset:3072
  v_mfma_f32_16x16x32_bf16 v[120:123], a[136:139], v[40:43], v[120:123]
  ds_read_b128 a[176:179], v10 offset:4096
  v_mfma_f32_16x16x32_bf16 v[120:123], a[132:135], v[36:39], v[120:123]
  ds_read_b128 a[180:183], v10 offset:5120
  v_mfma_f32_16x16x32_bf16 v[120:123], a[128:131], v[32:35], v[120:123]
  ds_read_b128 a[184:187], v10 offset:6144
  v_mfma_f32_16x16x32_bf16 v[128:131], a[128:131], v[48:51], v[216:219]
  v_exp_f32 v108, v108
  v_mfma_f32_16x16x32_bf16 v[128:131], a[132:135], v[52:55], v[128:131]
  buffer_load_dwordx4 v2, s[4:7], s84 offen offset:1024 sc1 lds
  v_mfma_f32_16x16x32_bf16 v[128:131], a[136:139], v[56:59], v[128:131]
  ds_read_b128 a[188:191], v10 offset:7168
  v_sub_f32 v220, v244, v251
  v_mfma_f32_16x16x32_bf16 v[128:131], a[140:143], v[60:63], v[128:131]
  v_sub_f32 v221, v245, v251
  v_sub_f32 v222, v246, v251
  v_mfma_f32_16x16x32_bf16 v[136:139], a[140:143], v[76:79], v[188:191]
  s_bfe_u32 s52, s2, 0x20001
  v_exp_f32 v109, v109
  v_mfma_f32_16x16x32_bf16 v[136:139], a[136:139], v[72:75], v[136:139]
  s_and_b32 s50, s2, 1
  v_cvt_pk_bf16_f32 v158, v108, v109
  v_sub_f32 v223, v247, v251
  v_mfma_f32_16x16x32_bf16 v[136:139], a[132:135], v[68:71], v[136:139]
  v_mov_b32 v192, v176
  v_mov_b32 v193, v176
  v_mfma_f32_16x16x32_bf16 v[136:139], a[128:131], v[64:67], v[136:139]
  s_lshl_b32 s50, s50, 3
  v_mov_b32 v194, v176
  v_mov_b32 v195, v176
  v_mfma_f32_16x16x32_bf16 v[140:143], a[144:147], v[64:67], v[188:191]
  s_bfe_u32 s51, s2, 0x30003
  v_exp_f32 v110, v110
  v_mfma_f32_16x16x32_bf16 v[140:143], a[148:151], v[68:71], v[140:143]
  buffer_load_dwordx4 v2, s[4:7], s84 offen offset:2048 sc1 lds
  v_mfma_f32_16x16x32_bf16 v[140:143], a[152:155], v[72:75], v[140:143]
  v_mov_b32 v196, v176
  v_mov_b32 v197, v176
  v_mfma_f32_16x16x32_bf16 v[140:143], a[156:159], v[76:79], v[140:143]
  s_add_u32 s50, s50, s51
  v_mov_b32 v198, v176
  v_mov_b32 v199, v176
  v_mfma_f32_16x16x32_bf16 v[124:127], a[156:159], v[44:47], v[180:183]
  s_lshr_b32 s51, s2, 6
  v_exp_f32 v111, v111
  v_mfma_f32_16x16x32_bf16 v[124:127], a[152:155], v[40:43], v[124:127]
  s_sub_u32 s81, 15, s50
  v_cvt_pk_bf16_f32 v159, v110, v111
  s_min_u32 s81, s81, s50
  v_mfma_f32_16x16x32_bf16 v[124:127], a[148:151], v[36:39], v[124:127]
  s_lshl_b32 s81, s81, 2
  s_add_u32 s81, s81, s52
  v_mfma_f32_16x16x32_bf16 v[124:127], a[144:147], v[32:35], v[124:127]
  s_lshl_b32 s63, s81, 11
  s_mul_i32 s81, s51, 1863680
  s_add_u32 s81, s81, 65011712
  v_mfma_f32_16x16x32_bf16 v[116:119], a[144:147], v[16:19], v[176:179]
  s_add_u32 s8, s74, s81
  s_addc_u32 s9, s75, 0
  v_exp_f32 v112, v112
  v_mfma_f32_16x16x32_bf16 v[116:119], a[148:151], v[20:23], v[116:119]
  buffer_load_dwordx4 v2, s[4:7], s84 offen offset:3072 sc1 lds
  v_mfma_f32_16x16x32_bf16 v[116:119], a[152:155], v[24:27], v[116:119]
  s_add_u32 m0, s85, 4096
  v_exp_f32 v113, v113
  v_mfma_f32_16x16x32_bf16 v[116:119], a[156:159], v[28:31], v[116:119]
  s_mov_b32 s11, 0x20000
  v_cvt_pk_bf16_f32 v160, v112, v113
  s_lshl_b32 s83, s52, 5
  v_mfma_f32_16x16x32_bf16 v[224:227], v[240:243], v[144:147], v[224:227]
  s_add_u32 s83, s83, 86
  v_exp_f32 v114, v114
  v_mfma_f32_16x16x32_bf16 v[228:231], v[240:243], v[148:151], v[228:231]
  s_mul_i32 s10, s83, 10240
  ds_read_b128 a[128:131], v10 offset:8192
  s_lshl_b32 s83, s83, 13
  v_mfma_f32_16x16x32_bf16 v[232:235], v[240:243], v[152:155], v[232:235]
  s_waitcnt lgkmcnt(8)
  v_exp_f32 v115, v115
  v_mfma_f32_16x16x32_bf16 v[236:239], v[240:243], v[156:159], v[236:239]
  s_add_u32 s83, s83, 1024
  v_cvt_pk_bf16_f32 v161, v114, v115
  s_mul_i32 s82, s50, 1490944
  v_mfma_f32_16x16x32_bf16 a[96:99], a[160:163], v[156:159], a[96:99]
  s_add_u32 s82, s82, 39844864
  v_exp_f32 v120, v120
  v_mfma_f32_16x16x32_bf16 a[64:67], a[160:163], v[152:155], a[64:67]
  buffer_load_dwordx4 v3, s[4:7], s84 offen offset:0 sc1 lds
  v_mfma_f32_16x16x32_bf16 a[32:35], a[160:163], v[148:151], a[32:35]
  ds_read_b128 a[132:135], v10 offset:9216
  s_and_b32 s62, s76, 1
  v_mfma_f32_16x16x32_bf16 a[0:3], a[160:163], v[144:147], a[0:3]
  s_waitcnt lgkmcnt(8)
  v_exp_f32 v121, v121
  v_mfma_f32_16x16x32_bf16 a[4:7], a[164:167], v[144:147], a[4:7]
  v_exp_f32 v122, v122
  v_mfma_f32_16x16x32_bf16 a[36:39], a[164:167], v[148:151], a[36:39]
  ds_read_b128 a[136:139], v10 offset:10240
  v_cvt_pk_bf16_f32 v164, v120, v121
  v_mfma_f32_16x16x32_bf16 a[68:71], a[164:167], v[152:155], a[68:71]
  v_mfma_f32_16x16x32_bf16 a[100:103], a[164:167], v[156:159], a[100:103]
  s_waitcnt lgkmcnt(8)
  v_exp_f32 v123, v123
  v_mfma_f32_16x16x32_bf16 a[104:107], a[168:171], v[156:159], a[104:107]
  buffer_load_dwordx4 v3, s[4:7], s84 offen offset:1024 sc1 lds
  v_mfma_f32_16x16x32_bf16 a[72:75], a[168:171], v[152:155], a[72:75]
  v_exp_f32 v128, v128
  v_mfma_f32_16x16x32_bf16 a[40:43], a[168:171], v[148:151], a[40:43]
  ds_read_b128 a[140:143], v10 offset:11264
  v_cvt_pk_bf16_f32 v165, v122, v123
  v_mfma_f32_16x16x32_bf16 a[8:11], a[168:171], v[144:147], a[8:11]
  s_waitcnt lgkmcnt(8)
  v_exp_f32 v129, v129
  v_mfma_f32_16x16x32_bf16 a[12:15], a[172:175], v[144:147], a[12:15]
  v_cvt_pk_bf16_f32 v168, v128, v129
  v_mfma_f32_16x16x32_bf16 a[44:47], a[172:175], v[148:151], a[44:47]
  v_exp_f32 v130, v130
  v_mfma_f32_16x16x32_bf16 a[76:79], a[172:175], v[152:155], a[76:79]
  ds_read_b128 a[144:147], v10 offset:12288
  v_mfma_f32_16x16x32_bf16 a[108:111], a[172:175], v[156:159], a[108:111]
  s_waitcnt lgkmcnt(8)
  v_exp_f32 v131, v131
  v_mfma_f32_16x16x32_bf16 a[112:115], a[176:179], v[156:159], a[112:115]
  buffer_load_dwordx4 v3, s[4:7], s84 offen offset:2048 sc1 lds
  v_mfma_f32_16x16x32_bf16 a[80:83], a[176:179], v[152:155], a[80:83]
  v_exp_f32 v136, v136
  v_mfma_f32_16x16x32_bf16 a[48:51], a[176:179], v[148:151], a[48:51]
  ds_read_b128 a[148:151], v10 offset:13312
  v_cvt_pk_bf16_f32 v169, v130, v131
  v_mfma_f32_16x16x32_bf16 a[16:19], a[176:179], v[144:147], a[16:19]
  s_waitcnt lgkmcnt(8)
  v_exp_f32 v137, v137
  v_mfma_f32_16x16x32_bf16 a[20:23], a[180:183], v[144:147], a[20:23]
  v_cvt_pk_bf16_f32 v172, v136, v137
  v_mfma_f32_16x16x32_bf16 a[52:55], a[180:183], v[148:151], a[52:55]
  s_cmp_eq_u32 s62, 0
  s_cselect_b32 s81, s81, s82
  s_cselect_b32 s14, s10, s83
  s_movk_i32 s56, 8192
  s_cselect_b32 s56, 10240, s56
  v_mfma_f32_16x16x32_bf16 a[84:87], a[180:183], v[152:155], a[84:87]
  v_exp_f32 v138, v138
  v_mfma_f32_16x16x32_bf16 a[116:119], a[180:183], v[156:159], a[116:119]
  s_waitcnt lgkmcnt(7)
  buffer_load_dwordx4 v3, s[4:7], s84 offen offset:3072 sc1 lds
  v_mfma_f32_16x16x32_bf16 a[120:123], a[184:187], v[156:159], a[120:123]
  s_add_u32 s12, s74, s81
  s_addc_u32 s13, s75, 0
  v_exp_f32 v139, v139
  v_mfma_f32_16x16x32_bf16 a[88:91], a[184:187], v[152:155], a[88:91]
  s_mov_b32 s15, 0x20000
  ds_read_b128 a[152:155], v10 offset:14336
  v_cvt_pk_bf16_f32 v173, v138, v139
  v_mfma_f32_16x16x32_bf16 a[56:59], a[184:187], v[148:151], a[56:59]
  s_waitcnt lgkmcnt(7)
  v_exp_f32 v116, v116
  v_mfma_f32_16x16x32_bf16 a[24:27], a[184:187], v[144:147], a[24:27]
  s_mul_i32 s81, s52, 14
  ds_read_b128 a[156:159], v10 offset:15360
  s_lshr_b32 s82, s76, 1
  v_mfma_f32_16x16x32_bf16 a[28:31], a[188:191], v[144:147], a[28:31]
  s_add_u32 s81, s81, s82
  v_exp_f32 v117, v117
  v_mfma_f32_16x16x32_bf16 a[60:63], a[188:191], v[148:151], a[60:63]
  s_mul_i32 s53, s81, 10240
  v_cvt_pk_bf16_f32 v162, v116, v117
  s_mul_i32 s54, s81, s56
  v_mfma_f32_16x16x32_bf16 a[92:95], a[188:191], v[152:155], a[92:95]
  s_add_u32 m0, s85, 8192
  v_exp_f32 v118, v118
  v_mfma_f32_16x16x32_bf16 a[124:127], a[188:191], v[156:159], a[124:127]
  s_waitcnt lgkmcnt(6)
  buffer_load_dwordx4 v4, s[4:7], s84 offen offset:0 sc1 lds
  v_mfma_f32_16x16x32_bf16 v[80:83], a[128:131], v[16:19], v[176:179]
  s_mul_i32 s82, s62, 9216
  v_exp_f32 v119, v119
  v_mfma_f32_16x16x32_bf16 v[80:83], a[132:135], v[20:23], v[80:83]
  s_add_u32 s53, s53, s82
  ds_read_b128 a[160:163], v10 offset:16384
  v_cvt_pk_bf16_f32 v163, v118, v119
  s_waitcnt lgkmcnt(6)
  v_mfma_f32_16x16x32_bf16 v[80:83], a[136:139], v[24:27], v[80:83]
  s_waitcnt lgkmcnt(5)
  v_exp_f32 v124, v124
  v_mfma_f32_16x16x32_bf16 v[80:83], a[140:143], v[28:31], v[80:83]
  s_mul_i32 s81, s52, 18
  ds_read_b128 a[164:167], v10 offset:17408
  v_mov_b32 v170, 0
  v_mfma_f32_16x16x32_bf16 v[88:91], a[140:143], v[44:47], v[180:183]
  s_add_u32 s81, s81, 42
  v_mov_b32 v171, 0
  s_mul_i32 s60, s81, 10240
  v_mfma_f32_16x16x32_bf16 v[88:91], a[136:139], v[40:43], v[88:91]
  s_mul_i32 s61, s81, s56
  v_exp_f32 v125, v125
  v_mfma_f32_16x16x32_bf16 v[88:91], a[132:135], v[36:39], v[88:91]
  buffer_load_dwordx4 v4, s[4:7], s84 offen offset:1024 sc1 lds
  v_mfma_f32_16x16x32_bf16 v[88:91], a[128:131], v[32:35], v[88:91]
  s_mov_b32 s55, 20480
  v_exp_f32 v126, v126
  v_mfma_f32_16x16x32_bf16 v[104:107], a[128:131], v[64:67], v[188:191]
  s_lshl_b32 s56, s56, 1
  ds_read_b128 a[168:171], v10 offset:18432
  v_cvt_pk_bf16_f32 v166, v124, v125
  v_mfma_f32_16x16x32_bf16 v[104:107], a[132:135], v[68:71], v[104:107]
  s_mul_i32 s64, s76, 9216
  v_exp_f32 v127, v127
  v_mfma_f32_16x16x32_bf16 v[104:107], a[136:139], v[72:75], v[104:107]
  s_waitcnt lgkmcnt(3)
  ds_read_b128 a[172:175], v10 offset:19456
  v_cvt_pk_bf16_f32 v167, v126, v127
  v_mfma_f32_16x16x32_bf16 v[104:107], a[140:143], v[76:79], v[104:107]
  s_cmp_eq_u32 s52, 3
  s_cselect_b32 s81, 1073741824, 0
  v_exp_f32 v140, v140
  v_mfma_f32_16x16x32_bf16 v[108:111], a[156:159], v[76:79], v[220:223]
  s_add_u32 s57, s55, s81
  ds_read_b128 a[176:179], v10 offset:20480
  s_add_u32 s65, s56, s81
  v_mfma_f32_16x16x32_bf16 v[108:111], a[152:155], v[72:75], v[108:111]
  s_sub_u32 s60, s60, s81
  v_exp_f32 v141, v141
  v_mfma_f32_16x16x32_bf16 v[108:111], a[148:151], v[68:71], v[108:111]
  buffer_load_dwordx4 v4, s[4:7], s84 offen offset:2048 sc1 lds
  v_mfma_f32_16x16x32_bf16 v[108:111], a[144:147], v[64:67], v[108:111]
  s_sub_u32 s61, s61, s81
  v_exp_f32 v142, v142
  v_mfma_f32_16x16x32_bf16 v[92:95], a[144:147], v[32:35], v[180:183]
  s_mov_b64 s[16:17], s[48:49]
  ds_read_b128 a[180:183], v10 offset:21504
  v_cvt_pk_bf16_f32 v174, v140, v141
  v_mfma_f32_16x16x32_bf16 v[92:95], a[148:151], v[36:39], v[92:95]
  s_mov_b32 s18, 2621440
  v_exp_f32 v143, v143
  v_mfma_f32_16x16x32_bf16 v[92:95], a[152:155], v[40:43], v[92:95]
  ds_read_b128 a[184:187], v10 offset:22528
  v_cvt_pk_bf16_f32 v175, v142, v143
  v_mfma_f32_16x16x32_bf16 v[92:95], a[156:159], v[44:47], v[92:95]
  s_mov_b32 s19, 0x20000
  s_mov_b64 s[24:25], s[70:71]
  s_mov_b32 s26, 2621440
  v_mfma_f32_16x16x32_bf16 v[84:87], a[156:159], v[28:31], v[176:179]
  buffer_load_dwordx4 v4, s[4:7], s84 offen offset:3072 sc1 lds
  v_mfma_f32_16x16x32_bf16 v[84:87], a[152:155], v[24:27], v[84:87]
  s_mov_b32 s27, 0x20000
  v_exp_f32 v80, v80
  v_mfma_f32_16x16x32_bf16 v[84:87], a[148:151], v[20:23], v[84:87]
  s_add_u32 m0, s85, 12288
  ds_read_b128 a[188:191], v10 offset:23552
  s_mov_b64 s[28:29], s[68:69]
  v_mfma_f32_16x16x32_bf16 v[84:87], a[144:147], v[16:19], v[84:87]
  s_mov_b32 s30, 1280
  v_exp_f32 v81, v81
  v_mfma_f32_16x16x32_bf16 v[224:227], v[240:243], v[160:163], v[224:227]
  s_mov_b32 s31, 0x20000
  ds_read_b128 a[128:131], v10 offset:24576
  v_cvt_pk_bf16_f32 v144, v80, v81
  v_mfma_f32_16x16x32_bf16 v[228:231], v[240:243], v[164:167], v[228:231]
  s_add_u32 s32, s74, 73400320
  s_addc_u32 s33, s75, 0
  v_exp_f32 v82, v82
  v_mfma_f32_16x16x32_bf16 v[232:235], v[240:243], v[168:171], v[232:235]
  s_mov_b32 s34, 16777216
  s_mov_b32 s35, 0x20000
  v_mfma_f32_16x16x32_bf16 v[236:239], v[240:243], v[172:175], v[236:239]
  s_waitcnt lgkmcnt(8)
  v_exp_f32 v83, v83
  v_mfma_f32_16x16x32_bf16 a[96:99], a[160:163], v[172:175], a[96:99]
  buffer_load_dwordx4 v5, s[4:7], s84 offen offset:0 sc1 lds
  v_mfma_f32_16x16x32_bf16 a[64:67], a[160:163], v[168:171], a[64:67]
  v_exp_f32 v88, v88
  v_mfma_f32_16x16x32_bf16 a[32:35], a[160:163], v[164:167], a[32:35]
  ds_read_b128 a[132:135], v10 offset:25600
  v_cvt_pk_bf16_f32 v145, v82, v83
  v_mfma_f32_16x16x32_bf16 a[0:3], a[160:163], v[160:163], a[0:3]
  s_waitcnt lgkmcnt(8)
  v_exp_f32 v89, v89
  v_mfma_f32_16x16x32_bf16 a[4:7], a[164:167], v[160:163], a[4:7]
  v_cvt_pk_bf16_f32 v148, v88, v89
  v_mfma_f32_16x16x32_bf16 a[36:39], a[164:167], v[164:167], a[36:39]
  v_exp_f32 v90, v90
  v_mfma_f32_16x16x32_bf16 a[68:71], a[164:167], v[168:171], a[68:71]
  ds_read_b128 a[136:139], v10 offset:26624
  v_mfma_f32_16x16x32_bf16 a[100:103], a[164:167], v[172:175], a[100:103]
  s_waitcnt lgkmcnt(8)
  v_exp_f32 v91, v91
  v_mfma_f32_16x16x32_bf16 a[104:107], a[168:171], v[172:175], a[104:107]
  buffer_load_dwordx4 v5, s[4:7], s84 offen offset:1024 sc1 lds
  v_mfma_f32_16x16x32_bf16 a[72:75], a[168:171], v[168:171], a[72:75]
  ds_read_b128 a[140:143], v10 offset:27648
  v_cvt_pk_bf16_f32 v149, v90, v91
  v_mfma_f32_16x16x32_bf16 a[40:43], a[168:171], v[164:167], a[40:43]
  v_exp_f32 v104, v104
  v_mfma_f32_16x16x32_bf16 a[8:11], a[168:171], v[160:163], a[8:11]
  s_waitcnt lgkmcnt(8)
  v_mfma_f32_16x16x32_bf16 a[12:15], a[172:175], v[160:163], a[12:15]
  v_exp_f32 v105, v105
  v_mfma_f32_16x16x32_bf16 a[44:47], a[172:175], v[164:167], a[44:47]
  v_cvt_pk_bf16_f32 v156, v104, v105
  v_mfma_f32_16x16x32_bf16 a[76:79], a[172:175], v[168:171], a[76:79]
  v_exp_f32 v106, v106
  v_mfma_f32_16x16x32_bf16 a[108:111], a[172:175], v[172:175], a[108:111]
  s_waitcnt lgkmcnt(7)
  buffer_load_dwordx4 v5, s[4:7], s84 offen offset:2048 sc1 lds
  v_mfma_f32_16x16x32_bf16 a[112:115], a[176:179], v[172:175], a[112:115]
  ds_read_b128 a[144:147], v10 offset:28672
  v_mfma_f32_16x16x32_bf16 a[80:83], a[176:179], v[168:171], a[80:83]
  v_exp_f32 v107, v107
  v_mfma_f32_16x16x32_bf16 a[48:51], a[176:179], v[164:167], a[48:51]
  v_exp_f32 v84, v84
  v_mfma_f32_16x16x32_bf16 a[16:19], a[176:179], v[160:163], a[16:19]
  s_waitcnt lgkmcnt(7)
  ds_read_b128 a[148:151], v10 offset:29696
  v_cvt_pk_bf16_f32 v157, v106, v107
  v_mfma_f32_16x16x32_bf16 a[20:23], a[180:183], v[160:163], a[20:23]
  v_exp_f32 v85, v85
  v_mfma_f32_16x16x32_bf16 a[52:55], a[180:183], v[164:167], a[52:55]
  v_cvt_pk_bf16_f32 v146, v84, v85
  v_mfma_f32_16x16x32_bf16 a[84:87], a[180:183], v[168:171], a[84:87]
  v_exp_f32 v86, v86
  v_mfma_f32_16x16x32_bf16 a[116:119], a[180:183], v[172:175], a[116:119]
  s_waitcnt lgkmcnt(7)
  buffer_load_dwordx4 v5, s[4:7], s84 offen offset:3072 sc1 lds
  v_mfma_f32_16x16x32_bf16 a[120:123], a[184:187], v[172:175], a[120:123]
  s_xor_b32 s85, s85, 0x10000
  v_exp_f32 v87, v87
  v_mfma_f32_16x16x32_bf16 a[88:91], a[184:187], v[168:171], a[88:91]
  ds_read_b128 a[152:155], v10 offset:30720
  v_cvt_pk_bf16_f32 v147, v86, v87
  v_mfma_f32_16x16x32_bf16 a[56:59], a[184:187], v[164:167], a[56:59]
  v_mfma_f32_16x16x32_bf16 a[24:27], a[184:187], v[160:163], a[24:27]
  s_waitcnt lgkmcnt(7)
  v_exp_f32 v92, v92
  v_mfma_f32_16x16x32_bf16 a[28:31], a[188:191], v[160:163], a[28:31]
  ds_read_b128 a[156:159], v10 offset:31744
  v_mfma_f32_16x16x32_bf16 a[60:63], a[188:191], v[164:167], a[60:63]
  v_exp_f32 v93, v93
  v_mfma_f32_16x16x32_bf16 a[92:95], a[188:191], v[168:171], a[92:95]
  v_cvt_pk_bf16_f32 v150, v92, v93
  v_mfma_f32_16x16x32_bf16 a[124:127], a[188:191], v[172:175], a[124:127]
  s_waitcnt lgkmcnt(7)
  v_exp_f32 v94, v94
  v_mfma_f32_16x16x32_bf16 v[112:115], a[128:131], v[16:19], v[176:179]
  s_waitcnt lgkmcnt(6)
  ds_read_b128 a[160:163], v10 offset:32768
  v_mfma_f32_16x16x32_bf16 v[112:115], a[132:135], v[20:23], v[112:115]
  s_waitcnt lgkmcnt(6)
  v_exp_f32 v95, v95
  v_mfma_f32_16x16x32_bf16 v[112:115], a[136:139], v[24:27], v[112:115]
  s_waitcnt lgkmcnt(5)
  ds_read_b128 a[164:167], v10 offset:33792
  v_cvt_pk_bf16_f32 v151, v94, v95
  v_mfma_f32_16x16x32_bf16 v[112:115], a[140:143], v[28:31], v[112:115]
  v_exp_f32 v108, v108
  v_mfma_f32_16x16x32_bf16 v[120:123], a[140:143], v[44:47], v[180:183]
  ds_read_b128 a[168:171], v10 offset:34816
  v_mfma_f32_16x16x32_bf16 v[120:123], a[136:139], v[40:43], v[120:123]
  v_exp_f32 v109, v109
  v_mfma_f32_16x16x32_bf16 v[120:123], a[132:135], v[36:39], v[120:123]
  ds_read_b128 a[172:175], v10 offset:35840
  v_cvt_pk_bf16_f32 v158, v108, v109
  v_mfma_f32_16x16x32_bf16 v[120:123], a[128:131], v[32:35], v[120:123]
  s_waitcnt lgkmcnt(7)
  v_exp_f32 v110, v110
  v_mfma_f32_16x16x32_bf16 v[124:127], a[144:147], v[32:35], v[180:183]
  s_waitcnt lgkmcnt(6)
  ds_read_b128 a[176:179], v10 offset:36864
  v_mfma_f32_16x16x32_bf16 v[124:127], a[148:151], v[36:39], v[124:127]
  s_waitcnt lgkmcnt(6)
  v_exp_f32 v111, v111
  v_mfma_f32_16x16x32_bf16 v[124:127], a[152:155], v[40:43], v[124:127]
  s_waitcnt lgkmcnt(5)
  ds_read_b128 a[180:183], v10 offset:37888
  v_cvt_pk_bf16_f32 v159, v110, v111
  v_mfma_f32_16x16x32_bf16 v[124:127], a[156:159], v[44:47], v[124:127]
  v_mfma_f32_16x16x32_bf16 v[116:119], a[156:159], v[28:31], v[176:179]
  ds_read_b128 a[184:187], v10 offset:38912
  v_mfma_f32_16x16x32_bf16 v[116:119], a[152:155], v[24:27], v[116:119]
  v_mfma_f32_16x16x32_bf16 v[116:119], a[148:151], v[20:23], v[116:119]
  v_exp_f32 v112, v112
  v_mfma_f32_16x16x32_bf16 v[116:119], a[144:147], v[16:19], v[116:119]
  ds_read_b128 a[188:191], v10 offset:39936
  v_mfma_f32_16x16x32_bf16 v[224:227], v[240:243], v[144:147], v[224:227]
  v_exp_f32 v113, v113
  v_mfma_f32_16x16x32_bf16 v[228:231], v[240:243], v[148:151], v[228:231]
  ds_read_b128 a[128:131], v10 offset:40960
  v_cvt_pk_bf16_f32 v160, v112, v113
  v_mfma_f32_16x16x32_bf16 v[236:239], v[240:243], v[156:159], v[236:239]
  s_waitcnt lgkmcnt(8)
  v_mfma_f32_16x16x32_bf16 a[96:99], a[160:163], v[156:159], a[96:99]
  v_exp_f32 v114, v114
  v_mfma_f32_16x16x32_bf16 a[32:35], a[160:163], v[148:151], a[32:35]
  ds_read_b128 a[132:135], v10 offset:41984
  v_mfma_f32_16x16x32_bf16 a[0:3], a[160:163], v[144:147], a[0:3]
  s_waitcnt lgkmcnt(8)
  v_exp_f32 v115, v115
  v_mfma_f32_16x16x32_bf16 a[4:7], a[164:167], v[144:147], a[4:7]
  ds_read_b128 a[136:139], v10 offset:43008
  v_cvt_pk_bf16_f32 v161, v114, v115
  v_mfma_f32_16x16x32_bf16 a[36:39], a[164:167], v[148:151], a[36:39]
  v_mfma_f32_16x16x32_bf16 a[100:103], a[164:167], v[156:159], a[100:103]
  s_waitcnt lgkmcnt(8)
  v_exp_f32 v120, v120
  v_mfma_f32_16x16x32_bf16 a[104:107], a[168:171], v[156:159], a[104:107]
  v_mfma_f32_16x16x32_bf16 a[40:43], a[168:171], v[148:151], a[40:43]
  v_exp_f32 v121, v121
  v_mfma_f32_16x16x32_bf16 a[8:11], a[168:171], v[144:147], a[8:11]
  s_waitcnt lgkmcnt(7)
  ds_read_b128 a[140:143], v10 offset:44032
  v_cvt_pk_bf16_f32 v164, v120, v121
  v_mfma_f32_16x16x32_bf16 a[12:15], a[172:175], v[144:147], a[12:15]
  v_mfma_f32_16x16x32_bf16 a[44:47], a[172:175], v[148:151], a[44:47]
  v_exp_f32 v122, v122
  v_mfma_f32_16x16x32_bf16 a[108:111], a[172:175], v[156:159], a[108:111]
  s_waitcnt lgkmcnt(7)
  ds_read_b128 a[144:147], v10 offset:45056
  v_mfma_f32_16x16x32_bf16 a[112:115], a[176:179], v[156:159], a[112:115]
  v_exp_f32 v123, v123
  v_mfma_f32_16x16x32_bf16 a[48:51], a[176:179], v[148:151], a[48:51]
  ds_read_b128 a[148:151], v10 offset:46080
  v_cvt_pk_bf16_f32 v165, v122, v123
  v_mfma_f32_16x16x32_bf16 a[16:19], a[176:179], v[144:147], a[16:19]
  s_waitcnt lgkmcnt(8)
  v_mfma_f32_16x16x32_bf16 a[20:23], a[180:183], v[144:147], a[20:23]
  v_exp_f32 v116, v116
  v_mfma_f32_16x16x32_bf16 a[52:55], a[180:183], v[148:151], a[52:55]
  v_mfma_f32_16x16x32_bf16 a[116:119], a[180:183], v[156:159], a[116:119]
  s_waitcnt lgkmcnt(7)
  ds_read_b128 a[152:155], v10 offset:47104
  v_mfma_f32_16x16x32_bf16 a[120:123], a[184:187], v[156:159], a[120:123]
  v_exp_f32 v117, v117
  v_mfma_f32_16x16x32_bf16 a[56:59], a[184:187], v[148:151], a[56:59]
  v_cvt_pk_bf16_f32 v162, v116, v117
  v_mfma_f32_16x16x32_bf16 a[24:27], a[184:187], v[144:147], a[24:27]
  s_waitcnt lgkmcnt(7)
  v_exp_f32 v118, v118
  v_mfma_f32_16x16x32_bf16 a[28:31], a[188:191], v[144:147], a[28:31]
  ds_read_b128 a[156:159], v10 offset:48128
  v_mfma_f32_16x16x32_bf16 a[60:63], a[188:191], v[148:151], a[60:63]
  v_mfma_f32_16x16x32_bf16 a[124:127], a[188:191], v[156:159], a[124:127]
  s_waitcnt lgkmcnt(7)
  v_exp_f32 v119, v119
  v_mfma_f32_16x16x32_bf16 v[80:83], a[128:131], v[16:19], v[192:195]
  s_waitcnt lgkmcnt(6)
  ds_read_b128 a[160:163], v10 offset:49152
  v_cvt_pk_bf16_f32 v163, v118, v119
  v_mfma_f32_16x16x32_bf16 v[80:83], a[132:135], v[20:23], v[80:83]
  s_waitcnt lgkmcnt(6)
  v_exp_f32 v124, v124
  v_mfma_f32_16x16x32_bf16 v[80:83], a[136:139], v[24:27], v[80:83]
  s_waitcnt lgkmcnt(5)
  ds_read_b128 a[164:167], v10 offset:50176
  v_mfma_f32_16x16x32_bf16 v[80:83], a[140:143], v[28:31], v[80:83]
  v_mfma_f32_16x16x32_bf16 v[88:91], a[140:143], v[44:47], v[180:183]
  v_exp_f32 v125, v125
  v_mfma_f32_16x16x32_bf16 v[88:91], a[136:139], v[40:43], v[88:91]
  ds_read_b128 a[168:171], v10 offset:51200
  v_cvt_pk_bf16_f32 v166, v124, v125
  v_mfma_f32_16x16x32_bf16 v[88:91], a[132:135], v[36:39], v[88:91]
  v_exp_f32 v126, v126
  v_mfma_f32_16x16x32_bf16 v[88:91], a[128:131], v[32:35], v[88:91]
  s_waitcnt lgkmcnt(6)
  ds_read_b128 a[172:175], v10 offset:52224
  v_mfma_f32_16x16x32_bf16 v[92:95], a[144:147], v[32:35], v[180:183]
  s_waitcnt lgkmcnt(6)
  ds_read_b128 a[176:179], v10 offset:53248
  v_mfma_f32_16x16x32_bf16 v[92:95], a[148:151], v[36:39], v[92:95]
  s_waitcnt lgkmcnt(6)
  v_exp_f32 v127, v127
  v_mfma_f32_16x16x32_bf16 v[92:95], a[152:155], v[40:43], v[92:95]
  s_waitcnt lgkmcnt(5)
  ds_read_b128 a[180:183], v10 offset:54272
  v_cvt_pk_bf16_f32 v167, v126, v127
  v_mfma_f32_16x16x32_bf16 v[92:95], a[156:159], v[44:47], v[92:95]
  v_mfma_f32_16x16x32_bf16 v[84:87], a[156:159], v[28:31], v[196:199]
  ds_read_b128 a[184:187], v10 offset:55296
  v_mfma_f32_16x16x32_bf16 v[84:87], a[152:155], v[24:27], v[84:87]
  v_mfma_f32_16x16x32_bf16 v[84:87], a[148:151], v[20:23], v[84:87]
  v_exp_f32 v80, v80
  v_mfma_f32_16x16x32_bf16 v[84:87], a[144:147], v[16:19], v[84:87]
  v_exp_f32 v81, v81
  v_mfma_f32_16x16x32_bf16 v[224:227], v[240:243], v[160:163], v[224:227]
  ds_read_b128 a[188:191], v10 offset:56320
  v_cvt_pk_bf16_f32 v144, v80, v81
  v_mfma_f32_16x16x32_bf16 v[228:231], v[240:243], v[164:167], v[228:231]
  s_waitcnt lgkmcnt(7)
  v_exp_f32 v82, v82
  v_mfma_f32_16x16x32_bf16 a[32:35], a[160:163], v[164:167], a[32:35]
  ds_read_b128 a[128:131], v10 offset:57344
  v_exp_f32 v83, v83
  v_mfma_f32_16x16x32_bf16 a[0:3], a[160:163], v[160:163], a[0:3]
  s_waitcnt lgkmcnt(7)
  ds_read_b128 a[132:135], v10 offset:58368
  v_cvt_pk_bf16_f32 v145, v82, v83
  v_mfma_f32_16x16x32_bf16 a[4:7], a[164:167], v[160:163], a[4:7]
  v_exp_f32 v88, v88
  v_mfma_f32_16x16x32_bf16 a[36:39], a[164:167], v[164:167], a[36:39]
  s_waitcnt lgkmcnt(7)
  ds_read_b128 a[136:139], v10 offset:59392
  v_exp_f32 v89, v89
  v_mfma_f32_16x16x32_bf16 a[40:43], a[168:171], v[164:167], a[40:43]
  ds_read_b128 a[140:143], v10 offset:60416
  v_cvt_pk_bf16_f32 v148, v88, v89
  v_mfma_f32_16x16x32_bf16 a[8:11], a[168:171], v[160:163], a[8:11]
  s_waitcnt lgkmcnt(8)
  v_exp_f32 v90, v90
  v_mfma_f32_16x16x32_bf16 a[12:15], a[172:175], v[160:163], a[12:15]
  ds_read_b128 a[144:147], v10 offset:61440
  v_exp_f32 v91, v91
  v_mfma_f32_16x16x32_bf16 a[44:47], a[172:175], v[164:167], a[44:47]
  s_waitcnt lgkmcnt(8)
  ds_read_b128 a[148:151], v10 offset:62464
  v_cvt_pk_bf16_f32 v149, v90, v91
  v_mfma_f32_16x16x32_bf16 a[48:51], a[176:179], v[164:167], a[48:51]
  v_exp_f32 v84, v84
  v_mfma_f32_16x16x32_bf16 a[16:19], a[176:179], v[160:163], a[16:19]
  s_waitcnt lgkmcnt(8)
  ds_read_b128 a[152:155], v10 offset:63488
  v_exp_f32 v85, v85
  v_mfma_f32_16x16x32_bf16 a[20:23], a[180:183], v[160:163], a[20:23]
  ds_read_b128 a[156:159], v10 offset:64512
  v_exp_f32 v86, v86
  v_mfma_f32_16x16x32_bf16 a[52:55], a[180:183], v[164:167], a[52:55]
  s_waitcnt lgkmcnt(9)
  v_exp_f32 v87, v87
  v_mfma_f32_16x16x32_bf16 a[56:59], a[184:187], v[164:167], a[56:59]
  v_exp_f32 v92, v92
  v_mfma_f32_16x16x32_bf16 a[24:27], a[184:187], v[160:163], a[24:27]
  s_waitcnt lgkmcnt(8)
  v_exp_f32 v93, v93
  v_mfma_f32_16x16x32_bf16 a[28:31], a[188:191], v[160:163], a[28:31]
  s_waitcnt vmcnt(0) lgkmcnt(0)
  v_cvt_pk_bf16_f32 v146, v84, v85
  v_cvt_pk_bf16_f32 v147, v86, v87
  v_cvt_pk_bf16_f32 v150, v92, v93
  v_xor_b32 v10, 0x10000, v10
  v_mfma_f32_16x16x32_bf16 a[60:63], a[188:191], v[164:167], a[60:63]
  buffer_store_dword v9, v8, s[36:39], 0 offen sc1
  s_branch L_sepi
L_lfin0:
  v_mfma_f32_16x16x32_bf16 v[120:123], a[128:131], v[32:35], v[180:183]
  s_barrier
  ds_read_b128 a[160:163], v10 offset:0
  s_add_u32 m0, s64, 73728
  v_mfma_f32_16x16x32_bf16 v[120:123], a[132:135], v[36:39], v[120:123]
  ds_read_b128 a[164:167], v10 offset:1024
  v_mfma_f32_16x16x32_bf16 v[120:123], a[136:139], v[40:43], v[120:123]
  buffer_load_dwordx4 v1, s[8:11], s53 offen sc1 lds
  v_mfma_f32_16x16x32_bf16 v[120:123], a[140:143], v[44:47], v[120:123]
  s_add_u32 s53, s53, s55
  ds_read_b128 a[168:171], v10 offset:2048
  v_mfma_f32_16x16x32_bf16 v[124:127], a[156:159], v[44:47], v[180:183]
  ds_read_b128 a[172:175], v10 offset:3072
  v_mfma_f32_16x16x32_bf16 v[124:127], a[152:155], v[40:43], v[124:127]
  v_exp_f32 v94, v94
  v_mfma_f32_16x16x32_bf16 v[124:127], a[148:151], v[36:39], v[124:127]
  ds_read_b128 a[176:179], v10 offset:4096
  v_exp_f32 v95, v95
  v_mfma_f32_16x16x32_bf16 v[124:127], a[144:147], v[32:35], v[124:127]
  ds_read_b128 a[180:183], v10 offset:5120
  v_cvt_pk_bf16_f32 v151, v94, v95
  v_mfma_f32_16x16x32_bf16 v[224:227], v[240:243], v[144:147], v[224:227]
  ds_read_b128 a[184:187], v10 offset:6144
  v_sub_f32 v204, v244, v249
  v_mfma_f32_16x16x32_bf16 v[228:231], v[240:243], v[148:151], v[228:231]
  s_waitcnt lgkmcnt(6)
  ds_read_b128 a[188:191], v10 offset:7168
  v_exp_f32 v120, v120
  v_mfma_f32_16x16x32_bf16 a[32:35], a[160:163], v[148:151], a[32:35]
  ds_read_b128 a[128:131], v10 offset:8192
  v_sub_f32 v205, v245, v249
  v_mfma_f32_16x16x32_bf16 a[0:3], a[160:163], v[144:147], a[0:3]
  s_waitcnt lgkmcnt(7)
  buffer_load_dwordx4 v1, s[12:15], s54 offen offset:1024 sc1 lds
  v_mfma_f32_16x16x32_bf16 a[4:7], a[164:167], v[144:147], a[4:7]
  s_mul_i32 s81, s62, 5120
  ds_read_b128 a[132:135], v10 offset:9216
  v_exp_f32 v121, v121
  v_mfma_f32_16x16x32_bf16 a[36:39], a[164:167], v[148:151], a[36:39]
  s_waitcnt lgkmcnt(7)
  buffer_load_dwordx4 v1, s[12:15], s54 offen offset:2048 sc1 lds
  v_mfma_f32_16x16x32_bf16 a[40:43], a[168:171], v[148:151], a[40:43]
  ds_read_b128 a[136:139], v10 offset:10240
  v_exp_f32 v122, v122
  v_mfma_f32_16x16x32_bf16 a[8:11], a[168:171], v[144:147], a[8:11]
  s_waitcnt lgkmcnt(7)
  buffer_load_dwordx4 v1, s[12:15], s54 offen offset:3072 sc1 lds
  v_mfma_f32_16x16x32_bf16 a[12:15], a[172:175], v[144:147], a[12:15]
  s_add_u32 m0, s64, 77824
  ds_read_b128 a[140:143], v10 offset:11264
  v_cvt_pk_bf16_f32 v164, v120, v121
  v_mfma_f32_16x16x32_bf16 a[44:47], a[172:175], v[148:151], a[44:47]
  s_waitcnt lgkmcnt(7)
  v_exp_f32 v123, v123
  v_mfma_f32_16x16x32_bf16 a[48:51], a[176:179], v[148:151], a[48:51]
  v_exp_f32 v124, v124
  v_mfma_f32_16x16x32_bf16 a[16:19], a[176:179], v[144:147], a[16:19]
  s_waitcnt lgkmcnt(6)
  ds_read_b128 a[144:147], v10 offset:12288
  v_cvt_pk_bf16_f32 v165, v122, v123
  v_mfma_f32_16x16x32_bf16 a[20:23], a[180:183], v[144:147], a[20:23]
  buffer_load_dwordx4 v3, s[12:15], s54 offen offset:0 sc1 lds
  v_mfma_f32_16x16x32_bf16 a[52:55], a[180:183], v[148:151], a[52:55]
  s_waitcnt lgkmcnt(6)
  ds_read_b128 a[148:151], v10 offset:13312
  v_sub_f32 v206, v246, v249
  v_mfma_f32_16x16x32_bf16 a[56:59], a[184:187], v[148:151], a[56:59]
  v_exp_f32 v125, v125
  v_mfma_f32_16x16x32_bf16 a[24:27], a[184:187], v[144:147], a[24:27]
  s_waitcnt lgkmcnt(6)
  ds_read_b128 a[152:155], v10 offset:14336
  v_cvt_pk_bf16_f32 v166, v124, v125
  v_mfma_f32_16x16x32_bf16 a[28:31], a[188:191], v[144:147], a[28:31]
  buffer_load_dwordx4 v3, s[12:15], s54 offen offset:1024 sc1 lds
  v_mfma_f32_16x16x32_bf16 a[60:63], a[188:191], v[148:151], a[60:63]
  s_waitcnt lgkmcnt(6)
  ds_read_b128 a[156:159], v10 offset:15360
  v_sub_f32 v207, v247, v249
  v_mfma_f32_16x16x32_bf16 v[88:91], a[128:131], v[32:35], v[180:183]
  s_waitcnt lgkmcnt(6)
  v_exp_f32 v126, v126
  v_mfma_f32_16x16x32_bf16 v[88:91], a[132:135], v[36:39], v[88:91]
  s_waitcnt lgkmcnt(5)
  buffer_load_dwordx4 v3, s[12:15], s54 offen offset:2048 sc1 lds
  v_mfma_f32_16x16x32_bf16 v[88:91], a[136:139], v[40:43], v[88:91]
  s_waitcnt lgkmcnt(4)
  ds_read_b128 a[160:163], v10 offset:16384
  v_add_u32 v12, s81, v1
  v_mfma_f32_16x16x32_bf16 v[88:91], a[140:143], v[44:47], v[88:91]
  s_waitcnt lgkmcnt(1)
  ds_read_b128 a[164:167], v10 offset:17408
  v_exp_f32 v127, v127
  v_mfma_f32_16x16x32_bf16 v[92:95], a[156:159], v[44:47], v[180:183]
  ds_read_b128 a[168:171], v10 offset:18432
  v_cvt_pk_bf16_f32 v167, v126, v127
  v_mfma_f32_16x16x32_bf16 v[92:95], a[152:155], v[40:43], v[92:95]
  ds_read_b128 a[172:175], v10 offset:19456
  v_add_u32 v13, 73728, v12
  v_mfma_f32_16x16x32_bf16 v[92:95], a[148:151], v[36:39], v[92:95]
  s_and_b32 s82, s76, 2
  ds_read_b128 a[176:179], v10 offset:20480
  s_lshl1_add_u32 s82, s82, 10
  v_mfma_f32_16x16x32_bf16 v[92:95], a[144:147], v[32:35], v[92:95]
  s_add_u32 s81, s52, 0
  ds_read_b128 a[180:183], v10 offset:21504
  s_and_b32 s81, s81, 3
  v_mfma_f32_16x16x32_bf16 v[228:231], v[240:243], v[164:167], v[228:231]
  s_waitcnt lgkmcnt(4)
  ds_read_b128 a[184:187], v10 offset:22528
  s_add_u32 s81, s81, s82
  v_mfma_f32_16x16x32_bf16 a[32:35], a[160:163], v[164:167], a[32:35]
  s_lshl_b32 s81, s81, 10
  ds_read_b128 a[188:191], v10 offset:23552
  v_exp_f32 v88, v88
  v_mfma_f32_16x16x32_bf16 a[36:39], a[164:167], v[164:167], a[36:39]
  s_waitcnt lgkmcnt(5)
  ds_read_b128 a[128:131], v10 offset:24576
  v_exp_f32 v89, v89
  v_mfma_f32_16x16x32_bf16 a[40:43], a[168:171], v[164:167], a[40:43]
  s_waitcnt lgkmcnt(5)
  ds_read_b128 a[132:135], v10 offset:25600
  v_cvt_pk_bf16_f32 v148, v88, v89
  v_mfma_f32_16x16x32_bf16 a[44:47], a[172:175], v[164:167], a[44:47]
  s_waitcnt lgkmcnt(5)
  ds_read_b128 a[136:139], v10 offset:26624
  v_exp_f32 v90, v90
  v_mfma_f32_16x16x32_bf16 a[48:51], a[176:179], v[164:167], a[48:51]
  s_waitcnt lgkmcnt(5)
  ds_read_b128 a[140:143], v10 offset:27648
  v_add_u32 v232, s81, v1
  v_mfma_f32_16x16x32_bf16 a[52:55], a[180:183], v[164:167], a[52:55]
  s_waitcnt lgkmcnt(5)
  ds_read_b128 a[144:147], v10 offset:28672
  v_exp_f32 v91, v91
  v_mfma_f32_16x16x32_bf16 a[56:59], a[184:187], v[164:167], a[56:59]
  s_waitcnt lgkmcnt(5)
  ds_read_b128 a[148:151], v10 offset:29696
  v_cvt_pk_bf16_f32 v149, v90, v91
  v_mfma_f32_16x16x32_bf16 a[60:63], a[188:191], v[164:167], a[60:63]
  s_waitcnt lgkmcnt(5)
  ds_read_b128 a[152:155], v10 offset:30720
  v_exp_f32 v92, v92
  v_mfma_f32_16x16x32_bf16 v[120:123], a[128:131], v[32:35], v[180:183]
  s_waitcnt lgkmcnt(5)
  ds_read_b128 a[156:159], v10 offset:31744
  v_exp_f32 v93, v93
  v_mfma_f32_16x16x32_bf16 v[120:123], a[132:135], v[36:39], v[120:123]
  s_waitcnt lgkmcnt(4)
  buffer_load_dwordx4 v3, s[12:15], s54 offen offset:3072 sc1 lds
  v_mfma_f32_16x16x32_bf16 v[120:123], a[136:139], v[40:43], v[120:123]
  s_add_u32 m0, s64, 81920
  ds_read_b128 a[160:163], v10 offset:32768
  v_exp_f32 v94, v94
  v_mfma_f32_16x16x32_bf16 v[120:123], a[140:143], v[44:47], v[120:123]
  s_waitcnt lgkmcnt(1)
  ds_read_b128 a[164:167], v10 offset:33792
  v_cvt_pk_bf16_f32 v150, v92, v93
  v_mfma_f32_16x16x32_bf16 v[124:127], a[156:159], v[44:47], v[204:207]
  ds_read_b128 a[168:171], v10 offset:34816
  v_exp_f32 v95, v95
  v_mfma_f32_16x16x32_bf16 v[124:127], a[152:155], v[40:43], v[124:127]
  ds_read_b128 a[172:175], v10 offset:35840
  v_cvt_pk_bf16_f32 v151, v94, v95
  v_mfma_f32_16x16x32_bf16 v[124:127], a[148:151], v[36:39], v[124:127]
  ds_read_b128 a[176:179], v10 offset:36864
  v_add_u32 v233, 73728, v232
  v_mfma_f32_16x16x32_bf16 v[124:127], a[144:147], v[32:35], v[124:127]
  s_waitcnt lgkmcnt(4)
  ds_read_b128 a[180:183], v10 offset:37888
  s_add_u32 s81, s52, 1
  v_mfma_f32_16x16x32_bf16 v[228:231], v[240:243], v[148:151], v[228:231]
  s_and_b32 s81, s81, 3
  ds_read_b128 a[184:187], v10 offset:38912
  s_add_u32 s81, s81, s82
  v_mfma_f32_16x16x32_bf16 a[32:35], a[160:163], v[148:151], a[32:35]
  s_lshl_b32 s81, s81, 10
  ds_read_b128 a[188:191], v10 offset:39936
  v_exp_f32 v120, v120
  s_waitcnt lgkmcnt(6)
  v_mfma_f32_16x16x32_bf16 a[36:39], a[164:167], v[148:151], a[36:39]
  s_waitcnt lgkmcnt(5)
  buffer_load_dwordx4 v4, s[12:15], s54 offen sc1 lds
  v_mfma_f32_16x16x32_bf16 a[40:43], a[168:171], v[148:151], a[40:43]
  s_waitcnt lgkmcnt(3)
  v_exp_f32 v121, v121
  v_mfma_f32_16x16x32_bf16 a[44:47], a[172:175], v[148:151], a[44:47]
  s_add_u32 s54, s54, s56
  v_exp_f32 v122, v122
  v_mfma_f32_16x16x32_bf16 a[48:51], a[176:179], v[148:151], a[48:51]
  s_add_u32 m0, s64, 110592
  v_exp_f32 v123, v123
  s_waitcnt lgkmcnt(2)
  v_mfma_f32_16x16x32_bf16 a[52:55], a[180:183], v[148:151], a[52:55]
  s_waitcnt lgkmcnt(1)
  buffer_load_dwordx4 v1, s[8:11], s53 offen sc1 lds
  v_mfma_f32_16x16x32_bf16 a[56:59], a[184:187], v[148:151], a[56:59]
  s_waitcnt lgkmcnt(0)
  v_exp_f32 v124, v124
  v_mfma_f32_16x16x32_bf16 a[60:63], a[188:191], v[148:151], a[60:63]
  s_add_u32 s53, s53, s55
  v_exp_f32 v125, v125
  ds_read_b128 a[160:163], v10 offset:49152
  v_cvt_pk_bf16_f32 v164, v120, v121
  ds_read_b128 a[164:167], v10 offset:50176
  v_exp_f32 v126, v126
  ds_read_b128 a[168:171], v10 offset:51200
  v_exp_f32 v127, v127
  ds_read_b128 a[172:175], v10 offset:52224
  v_cvt_pk_bf16_f32 v165, v122, v123
  ds_read_b128 a[176:179], v10 offset:53248
  v_cvt_pk_bf16_f32 v166, v124, v125
  v_cvt_pk_bf16_f32 v167, v126, v127
  ds_read_b128 a[180:183], v10 offset:54272
  v_add_u32 v234, s81, v1
  v_mfma_f32_16x16x32_bf16 v[228:231], v[240:243], v[164:167], v[228:231]
  s_waitcnt lgkmcnt(5)
  ds_read_b128 a[184:187], v10 offset:55296
  v_add_u32 v235, 73728, v234
  v_mfma_f32_16x16x32_bf16 a[32:35], a[160:163], v[164:167], a[32:35]
  s_waitcnt lgkmcnt(5)
  ds_read_b128 a[188:191], v10 offset:56320
  buffer_load_dwordx4 v1, s[12:15], s54 offen offset:1024 sc1 lds
  v_mfma_f32_16x16x32_bf16 a[36:39], a[164:167], v[164:167], a[36:39]
  s_waitcnt lgkmcnt(5)
  buffer_load_dwordx4 v1, s[12:15], s54 offen offset:2048 sc1 lds
  v_mfma_f32_16x16x32_bf16 a[40:43], a[168:171], v[164:167], a[40:43]
  s_waitcnt lgkmcnt(4)
  buffer_load_dwordx4 v1, s[12:15], s54 offen offset:3072 sc1 lds
  s_add_u32 m0, s64, 114688
  v_mfma_f32_16x16x32_bf16 a[44:47], a[172:175], v[164:167], a[44:47]
  s_waitcnt lgkmcnt(3)
  buffer_load_dwordx4 v3, s[12:15], s54 offen offset:0 sc1 lds
  v_mfma_f32_16x16x32_bf16 a[48:51], a[176:179], v[164:167], a[48:51]
  s_waitcnt lgkmcnt(2)
  buffer_load_dwordx4 v3, s[12:15], s54 offen offset:1024 sc1 lds
  v_mfma_f32_16x16x32_bf16 a[52:55], a[180:183], v[164:167], a[52:55]
  s_waitcnt lgkmcnt(1)
  buffer_load_dwordx4 v3, s[12:15], s54 offen offset:2048 sc1 lds
  v_mfma_f32_16x16x32_bf16 a[56:59], a[184:187], v[164:167], a[56:59]
  s_waitcnt lgkmcnt(0)
  buffer_load_dwordx4 v3, s[12:15], s54 offen offset:3072 sc1 lds
  s_add_u32 m0, s64, 118784
  v_mfma_f32_16x16x32_bf16 a[60:63], a[188:191], v[164:167], a[60:63]
  buffer_load_dwordx4 v4, s[12:15], s54 offen sc1 lds
  s_add_u32 s81, s52, 2
  s_and_b32 s81, s81, 3
  s_add_u32 s81, s81, s82
  s_lshl_b32 s81, s81, 10
  v_add_u32 v236, s81, v1
  v_add_u32 v237, 73728, v236
  s_add_u32 s81, s52, 3
  s_and_b32 s81, s81, 3
  s_add_u32 s81, s81, s82
  s_lshl_b32 s81, s81, 10
  v_add_u32 v238, s81, v1
  v_add_u32 v239, 73728, v238
  s_add_u32 s54, s54, s56
  s_branch L_lepi
L_lfin1:
  v_mfma_f32_16x16x32_bf16 v[120:123], a[128:131], v[32:35], v[180:183]
  s_barrier
  ds_read_b128 a[160:163], v10 offset:0
  s_add_u32 m0, s64, 73728
  v_mfma_f32_16x16x32_bf16 v[120:123], a[132:135], v[36:39], v[120:123]
  ds_read_b128 a[164:167], v10 offset:1024
  v_mfma_f32_16x16x32_bf16 v[120:123], a[136:139], v[40:43], v[120:123]
  buffer_load_dwordx4 v1, s[8:11], s53 offen sc1 lds
  v_mfma_f32_16x16x32_bf16 v[120:123], a[140:143], v[44:47], v[120:123]
  s_add_u32 s53, s53, s55
  ds_read_b128 a[168:171], v10 offset:2048
  v_mfma_f32_16x16x32_bf16 v[124:127], a[156:159], v[44:47], v[180:183]
  ds_read_b128 a[172:175], v10 offset:3072
  v_mfma_f32_16x16x32_bf16 v[124:127], a[152:155], v[40:43], v[124:127]
  v_exp_f32 v94, v94
  v_mfma_f32_16x16x32_bf16 v[124:127], a[148:151], v[36:39], v[124:127]
  ds_read_b128 a[176:179], v10 offset:4096
  v_exp_f32 v95, v95
  v_mfma_f32_16x16x32_bf16 v[124:127], a[144:147], v[32:35], v[124:127]
  ds_read_b128 a[180:183], v10 offset:5120
  v_cvt_pk_bf16_f32 v151, v94, v95
  v_mfma_f32_16x16x32_bf16 v[224:227], v[240:243], v[144:147], v[224:227]
  ds_read_b128 a[184:187], v10 offset:6144
  v_sub_f32 v204, v244, v249
  v_mfma_f32_16x16x32_bf16 v[228:231], v[240:243], v[148:151], v[228:231]
  s_waitcnt lgkmcnt(6)
  ds_read_b128 a[188:191], v10 offset:7168
  v_exp_f32 v120, v120
  v_mfma_f32_16x16x32_bf16 a[32:35], a[160:163], v[148:151], a[32:35]
  ds_read_b128 a[128:131], v10 offset:8192
  v_sub_f32 v205, v245, v249
  v_mfma_f32_16x16x32_bf16 a[0:3], a[160:163], v[144:147], a[0:3]
  s_waitcnt lgkmcnt(7)
  buffer_load_dwordx4 v1, s[12:15], s54 offen offset:1024 sc1 lds
  v_mfma_f32_16x16x32_bf16 a[4:7], a[164:167], v[144:147], a[4:7]
  s_mul_i32 s81, s62, 5120
  ds_read_b128 a[132:135], v10 offset:9216
  v_exp_f32 v121, v121
  v_mfma_f32_16x16x32_bf16 a[36:39], a[164:167], v[148:151], a[36:39]
  s_waitcnt lgkmcnt(7)
  buffer_load_dwordx4 v1, s[12:15], s54 offen offset:2048 sc1 lds
  v_mfma_f32_16x16x32_bf16 a[40:43], a[168:171], v[148:151], a[40:43]
  ds_read_b128 a[136:139], v10 offset:10240
  v_exp_f32 v122, v122
  v_mfma_f32_16x16x32_bf16 a[8:11], a[168:171], v[144:147], a[8:11]
  s_waitcnt lgkmcnt(7)
  buffer_load_dwordx4 v1, s[12:15], s54 offen offset:3072 sc1 lds
  v_mfma_f32_16x16x32_bf16 a[12:15], a[172:175], v[144:147], a[12:15]
  s_add_u32 m0, s64, 77824
  ds_read_b128 a[140:143], v10 offset:11264
  v_cvt_pk_bf16_f32 v164, v120, v121
  v_mfma_f32_16x16x32_bf16 a[44:47], a[172:175], v[148:151], a[44:47]
  s_waitcnt lgkmcnt(7)
  v_exp_f32 v123, v123
  v_mfma_f32_16x16x32_bf16 a[48:51], a[176:179], v[148:151], a[48:51]
  buffer_load_dwordx4 v3, s[12:15], s54 offen offset:0 sc1 lds
  v_mfma_f32_16x16x32_bf16 a[16:19], a[176:179], v[144:147], a[16:19]
  s_waitcnt lgkmcnt(6)
  ds_read_b128 a[144:147], v10 offset:12288
  v_cvt_pk_bf16_f32 v165, v122, v123
  v_mfma_f32_16x16x32_bf16 a[20:23], a[180:183], v[144:147], a[20:23]
  v_exp_f32 v124, v124
  v_mfma_f32_16x16x32_bf16 a[52:55], a[180:183], v[148:151], a[52:55]
  s_waitcnt lgkmcnt(6)
  ds_read_b128 a[148:151], v10 offset:13312
  v_sub_f32 v206, v246, v249
  v_mfma_f32_16x16x32_bf16 a[56:59], a[184:187], v[148:151], a[56:59]
  v_exp_f32 v125, v125
  v_mfma_f32_16x16x32_bf16 a[24:27], a[184:187], v[144:147], a[24:27]
  s_waitcnt lgkmcnt(6)
  ds_read_b128 a[152:155], v10 offset:14336
  v_cvt_pk_bf16_f32 v166, v124, v125
  v_mfma_f32_16x16x32_bf16 a[28:31], a[188:191], v[144:147], a[28:31]
  buffer_load_dwordx4 v3, s[12:15], s54 offen offset:1024 sc1 lds
  v_mfma_f32_16x16x32_bf16 a[60:63], a[188:191], v[148:151], a[60:63]
  s_waitcnt lgkmcnt(6)
  ds_read_b128 a[156:159], v10 offset:15360
  v_sub_f32 v207, v247, v249
  v_mfma_f32_16x16x32_bf16 v[88:91], a[128:131], v[32:35], v[180:183]
  s_waitcnt lgkmcnt(6)
  v_exp_f32 v126, v126
  v_mfma_f32_16x16x32_bf16 v[88:91], a[132:135], v[36:39], v[88:91]
  s_waitcnt lgkmcnt(5)
  buffer_load_dwordx4 v3, s[12:15], s54 offen offset:2048 sc1 lds
  v_mfma_f32_16x16x32_bf16 v[88:91], a[136:139], v[40:43], v[88:91]
  s_waitcnt lgkmcnt(4)
  ds_read_b128 a[160:163], v10 offset:16384
  v_add_u32 v12, s81, v1
  v_mfma_f32_16x16x32_bf16 v[88:91], a[140:143], v[44:47], v[88:91]
  s_waitcnt lgkmcnt(1)
  ds_read_b128 a[164:167], v10 offset:17408
  v_exp_f32 v127, v127
  v_mfma_f32_16x16x32_bf16 v[92:95], a[156:159], v[44:47], v[180:183]
  ds_read_b128 a[168:171], v10 offset:18432
  v_cvt_pk_bf16_f32 v167, v126, v127
  v_mfma_f32_16x16x32_bf16 v[92:95], a[152:155], v[40:43], v[92:95]
  ds_read_b128 a[172:175], v10 offset:19456
  v_add_u32 v13, 73728, v12
  v_mfma_f32_16x16x32_bf16 v[92:95], a[148:151], v[36:39], v[92:95]
  s_and_b32 s82, s76, 2
  ds_read_b128 a[176:179], v10 offset:20480
  s_lshl1_add_u32 s82, s82, 10
  v_mfma_f32_16x16x32_bf16 v[92:95], a[144:147], v[32:35], v[92:95]
  s_add_u32 s81, s52, 0
  ds_read_b128 a[180:183], v10 offset:21504
  s_and_b32 s81, s81, 3
  v_mfma_f32_16x16x32_bf16 v[228:231], v[240:243], v[164:167], v[228:231]
  s_waitcnt lgkmcnt(4)
  ds_read_b128 a[184:187], v10 offset:22528
  s_add_u32 s81, s81, s82
  v_mfma_f32_16x16x32_bf16 a[32:35], a[160:163], v[164:167], a[32:35]
  s_lshl_b32 s81, s81, 10
  ds_read_b128 a[188:191], v10 offset:23552
  v_exp_f32 v88, v88
  v_mfma_f32_16x16x32_bf16 a[36:39], a[164:167], v[164:167], a[36:39]
  s_waitcnt lgkmcnt(5)
  ds_read_b128 a[128:131], v10 offset:24576
  v_exp_f32 v89, v89
  v_mfma_f32_16x16x32_bf16 a[40:43], a[168:171], v[164:167], a[40:43]
  s_waitcnt lgkmcnt(5)
  ds_read_b128 a[132:135], v10 offset:25600
  v_exp_f32 v90, v90
  v_mfma_f32_16x16x32_bf16 a[44:47], a[172:175], v[164:167], a[44:47]
  s_waitcnt lgkmcnt(5)
  ds_read_b128 a[136:139], v10 offset:26624
  v_exp_f32 v91, v91
  v_mfma_f32_16x16x32_bf16 a[48:51], a[176:179], v[164:167], a[48:51]
  s_waitcnt lgkmcnt(5)
  ds_read_b128 a[140:143], v10 offset:27648
  v_cvt_pk_bf16_f32 v148, v88, v89
  v_mfma_f32_16x16x32_bf16 a[52:55], a[180:183], v[164:167], a[52:55]
  s_waitcnt lgkmcnt(5)
  ds_read_b128 a[144:147], v10 offset:28672
  v_exp_f32 v92, v92
  v_mfma_f32_16x16x32_bf16 a[56:59], a[184:187], v[164:167], a[56:59]
  s_waitcnt lgkmcnt(5)
  ds_read_b128 a[148:151], v10 offset:29696
  v_exp_f32 v93, v93
  v_mfma_f32_16x16x32_bf16 a[60:63], a[188:191], v[164:167], a[60:63]
  s_waitcnt lgkmcnt(5)
  ds_read_b128 a[152:155], v10 offset:30720
  v_exp_f32 v94, v94
  v_mfma_f32_16x16x32_bf16 v[120:123], a[128:131], v[32:35], v[204:207]
  s_waitcnt lgkmcnt(5)
  ds_read_b128 a[156:159], v10 offset:31744
  ds_read_b128 a[160:163], v10 offset:32768
  ds_read_b128 a[164:167], v10 offset:33792
  v_mfma_f32_16x16x32_bf16 v[120:123], a[132:135], v[36:39], v[120:123]
  s_waitcnt lgkmcnt(7)
  ds_read_b128 a[168:171], v10 offset:34816
  ds_read_b128 a[172:175], v10 offset:35840
  v_exp_f32 v95, v95
  v_mfma_f32_16x16x32_bf16 v[120:123], a[136:139], v[40:43], v[120:123]
  s_waitcnt lgkmcnt(8)
  ds_read_b128 a[176:179], v10 offset:36864
  v_cvt_pk_bf16_f32 v149, v90, v91
  v_cvt_pk_bf16_f32 v150, v92, v93
  v_cvt_pk_bf16_f32 v151, v94, v95
  v_mfma_f32_16x16x32_bf16 v[120:123], a[140:143], v[44:47], v[120:123]
  ds_read_b128 a[180:183], v10 offset:37888
  v_add_u32 v232, s81, v1
  v_mfma_f32_16x16x32_bf16 v[228:231], v[240:243], v[148:151], v[228:231]
  s_waitcnt lgkmcnt(4)
  ds_read_b128 a[184:187], v10 offset:38912
  v_add_u32 v233, 73728, v232
  v_mfma_f32_16x16x32_bf16 a[32:35], a[160:163], v[148:151], a[32:35]
  s_add_u32 s81, s52, 1
  ds_read_b128 a[188:191], v10 offset:39936
  s_and_b32 s81, s81, 3
  v_mfma_f32_16x16x32_bf16 a[36:39], a[164:167], v[148:151], a[36:39]
  s_waitcnt lgkmcnt(5)
  buffer_load_dwordx4 v3, s[12:15], s54 offen offset:3072 sc1 lds
  v_mfma_f32_16x16x32_bf16 a[40:43], a[168:171], v[148:151], a[40:43]
  s_waitcnt lgkmcnt(3)
  v_exp_f32 v120, v120
  v_mfma_f32_16x16x32_bf16 a[44:47], a[172:175], v[148:151], a[44:47]
  s_add_u32 m0, s64, 81920
  v_exp_f32 v121, v121
  v_mfma_f32_16x16x32_bf16 a[48:51], a[176:179], v[148:151], a[48:51]
  s_waitcnt lgkmcnt(1)
  buffer_load_dwordx4 v4, s[12:15], s54 offen sc1 lds
  v_mfma_f32_16x16x32_bf16 a[52:55], a[180:183], v[148:151], a[52:55]
  s_add_u32 s54, s54, s56
  v_exp_f32 v122, v122
  v_mfma_f32_16x16x32_bf16 a[56:59], a[184:187], v[148:151], a[56:59]
  s_waitcnt lgkmcnt(0)
  v_cvt_pk_bf16_f32 v164, v120, v121
  s_add_u32 m0, s64, 110592
  v_mfma_f32_16x16x32_bf16 a[60:63], a[188:191], v[148:151], a[60:63]
  buffer_load_dwordx4 v1, s[8:11], s53 offen sc1 lds
  ds_read_b128 a[160:163], v10 offset:49152
  v_mov_b32 v166, 0
  ds_read_b128 a[164:167], v10 offset:50176
  v_exp_f32 v123, v123
  ds_read_b128 a[168:171], v10 offset:51200
  v_cvt_pk_bf16_f32 v165, v122, v123
  ds_read_b128 a[172:175], v10 offset:52224
  v_mov_b32 v167, 0
  ds_read_b128 a[176:179], v10 offset:53248
  ds_read_b128 a[180:183], v10 offset:54272
  v_mfma_f32_16x16x32_bf16 v[228:231], v[240:243], v[164:167], v[228:231]
  s_waitcnt lgkmcnt(5)
  ds_read_b128 a[184:187], v10 offset:55296
  s_add_u32 s53, s53, s55
  v_mfma_f32_16x16x32_bf16 a[32:35], a[160:163], v[164:167], a[32:35]
  s_waitcnt lgkmcnt(5)
  ds_read_b128 a[188:191], v10 offset:56320
  buffer_load_dwordx4 v1, s[12:15], s54 offen offset:1024 sc1 lds
  v_mfma_f32_16x16x32_bf16 a[36:39], a[164:167], v[164:167], a[36:39]
  s_waitcnt lgkmcnt(5)
  buffer_load_dwordx4 v1, s[12:15], s54 offen offset:2048 sc1 lds
  v_mfma_f32_16x16x32_bf16 a[40:43], a[168:171], v[164:167], a[40:43]
  s_waitcnt lgkmcnt(4)
  buffer_load_dwordx4 v1, s[12:15], s54 offen offset:3072 sc1 lds
  s_add_u32 m0, s64, 114688
  v_mfma_f32_16x16x32_bf16 a[44:47], a[172:175], v[164:167], a[44:47]
  s_waitcnt lgkmcnt(3)
  buffer_load_dwordx4 v3, s[12:15], s54 offen offset:0 sc1 lds
  v_mfma_f32_16x16x32_bf16 a[48:51], a[176:179], v[164:167], a[48:51]
  s_waitcnt lgkmcnt(2)
  buffer_load_dwordx4 v3, s[12:15], s54 offen offset:1024 sc1 lds
  v_mfma_f32_16x16x32_bf16 a[52:55], a[180:183], v[164:167], a[52:55]
  s_waitcnt lgkmcnt(1)
  buffer_load_dwordx4 v3, s[12:15], s54 offen offset:2048 sc1 lds
  v_mfma_f32_16x16x32_bf16 a[56:59], a[184:187], v[164:167], a[56:59]
  s_waitcnt lgkmcnt(0)
  buffer_load_dwordx4 v3, s[12:15], s54 offen offset:3072 sc1 lds
  s_add_u32 m0, s64, 118784
  v_mfma_f32_16x16x32_bf16 a[60:63], a[188:191], v[164:167], a[60:63]
  buffer_load_dwordx4 v4, s[12:15], s54 offen sc1 lds
  s_add_u32 s81, s81, s82
  s_lshl_b32 s81, s81, 10
  v_add_u32 v234, s81, v1
  v_add_u32 v235, 73728, v234
  s_add_u32 s81, s52, 2
  s_and_b32 s81, s81, 3
  s_add_u32 s81, s81, s82
  s_lshl_b32 s81, s81, 10
  v_add_u32 v236, s81, v1
  v_add_u32 v237, 73728, v236
  s_add_u32 s81, s52, 3
  s_and_b32 s81, s81, 3
  s_add_u32 s81, s81, s82
  s_lshl_b32 s81, s81, 10
  v_add_u32 v238, s81, v1
  v_add_u32 v239, 73728, v238
  s_add_u32 s54, s54, s56
  s_branch L_lepi
L_lfin2:
  v_sub_f32 v200, v244, v248
  v_sub_f32 v201, v245, v248
  v_sub_f32 v202, v246, v248
  v_sub_f32 v203, v247, v248
  s_nop 1
  v_mfma_f32_16x16x32_bf16 v[112:115], a[128:131], v[16:19], v[200:203]
  s_barrier
  ds_read_b128 a[160:163], v10 offset:0
  s_add_u32 m0, s64, 73728
  v_mfma_f32_16x16x32_bf16 v[112:115], a[132:135], v[20:23], v[112:115]
  ds_read_b128 a[164:167], v10 offset:1024
  v_mfma_f32_16x16x32_bf16 v[112:115], a[136:139], v[24:27], v[112:115]
  buffer_load_dwordx4 v1, s[8:11], s53 offen sc1 lds
  v_mfma_f32_16x16x32_bf16 v[112:115], a[140:143], v[28:31], v[112:115]
  s_add_u32 s53, s53, s55
  ds_read_b128 a[168:171], v10 offset:2048
  v_mfma_f32_16x16x32_bf16 v[120:123], a[140:143], v[44:47], v[180:183]
  ds_read_b128 a[172:175], v10 offset:3072
  v_mfma_f32_16x16x32_bf16 v[120:123], a[136:139], v[40:43], v[120:123]
  buffer_load_dwordx4 v1, s[12:15], s54 offen offset:1024 sc1 lds
  v_mfma_f32_16x16x32_bf16 v[120:123], a[132:135], v[36:39], v[120:123]
  ds_read_b128 a[176:179], v10 offset:4096
  v_mfma_f32_16x16x32_bf16 v[120:123], a[128:131], v[32:35], v[120:123]
  ds_read_b128 a[180:183], v10 offset:5120
  v_mfma_f32_16x16x32_bf16 v[124:127], a[144:147], v[32:35], v[180:183]
  v_exp_f32 v94, v94
  v_mfma_f32_16x16x32_bf16 v[124:127], a[148:151], v[36:39], v[124:127]
  ds_read_b128 a[184:187], v10 offset:6144
  v_sub_f32 v204, v244, v249
  v_mfma_f32_16x16x32_bf16 v[124:127], a[152:155], v[40:43], v[124:127]
  ds_read_b128 a[188:191], v10 offset:7168
  v_exp_f32 v95, v95
  v_mfma_f32_16x16x32_bf16 v[124:127], a[156:159], v[44:47], v[124:127]
  s_mul_i32 s81, s62, 5120
  v_cvt_pk_bf16_f32 v151, v94, v95
  v_sub_f32 v205, v245, v249
  v_mfma_f32_16x16x32_bf16 v[224:227], v[240:243], v[144:147], v[224:227]
  v_exp_f32 v112, v112
  v_mfma_f32_16x16x32_bf16 v[228:231], v[240:243], v[148:151], v[228:231]
  s_waitcnt lgkmcnt(7)
  buffer_load_dwordx4 v1, s[12:15], s54 offen offset:2048 sc1 lds
  v_mfma_f32_16x16x32_bf16 a[32:35], a[160:163], v[148:151], a[32:35]
  ds_read_b128 a[128:131], v10 offset:8192
  v_exp_f32 v113, v113
  v_mfma_f32_16x16x32_bf16 a[0:3], a[160:163], v[144:147], a[0:3]
  s_waitcnt lgkmcnt(7)
  v_exp_f32 v114, v114
  v_mfma_f32_16x16x32_bf16 a[4:7], a[164:167], v[144:147], a[4:7]
  ds_read_b128 a[132:135], v10 offset:9216
  v_sub_f32 v206, v246, v249
  v_mfma_f32_16x16x32_bf16 a[36:39], a[164:167], v[148:151], a[36:39]
  s_waitcnt lgkmcnt(7)
  buffer_load_dwordx4 v1, s[12:15], s54 offen offset:3072 sc1 lds
  v_mfma_f32_16x16x32_bf16 a[40:43], a[168:171], v[148:151], a[40:43]
  s_waitcnt lgkmcnt(6)
  ds_read_b128 a[136:139], v10 offset:10240
  v_exp_f32 v115, v115
  v_mfma_f32_16x16x32_bf16 a[8:11], a[168:171], v[144:147], a[8:11]
  s_add_u32 m0, s64, 77824
  v_exp_f32 v120, v120
  v_mfma_f32_16x16x32_bf16 a[12:15], a[172:175], v[144:147], a[12:15]
  ds_read_b128 a[140:143], v10 offset:11264
  v_sub_f32 v207, v247, v249
  v_mfma_f32_16x16x32_bf16 a[44:47], a[172:175], v[148:151], a[44:47]
  s_waitcnt lgkmcnt(7)
  buffer_load_dwordx4 v3, s[12:15], s54 offen offset:0 sc1 lds
  v_mfma_f32_16x16x32_bf16 a[48:51], a[176:179], v[148:151], a[48:51]
  v_exp_f32 v121, v121
  v_mfma_f32_16x16x32_bf16 a[16:19], a[176:179], v[144:147], a[16:19]
  s_waitcnt lgkmcnt(6)
  ds_read_b128 a[144:147], v10 offset:12288
  v_cvt_pk_bf16_f32 v160, v112, v113
  v_mfma_f32_16x16x32_bf16 a[20:23], a[180:183], v[144:147], a[20:23]
  buffer_load_dwordx4 v3, s[12:15], s54 offen offset:1024 sc1 lds
  v_mfma_f32_16x16x32_bf16 a[52:55], a[180:183], v[148:151], a[52:55]
  s_waitcnt lgkmcnt(6)
  ds_read_b128 a[148:151], v10 offset:13312
  v_exp_f32 v122, v122
  v_mfma_f32_16x16x32_bf16 a[56:59], a[184:187], v[148:151], a[56:59]
  v_exp_f32 v123, v123
  v_mfma_f32_16x16x32_bf16 a[24:27], a[184:187], v[144:147], a[24:27]
  s_waitcnt lgkmcnt(6)
  ds_read_b128 a[152:155], v10 offset:14336
  v_cvt_pk_bf16_f32 v161, v114, v115
  v_mfma_f32_16x16x32_bf16 a[28:31], a[188:191], v[144:147], a[28:31]
  buffer_load_dwordx4 v3, s[12:15], s54 offen offset:2048 sc1 lds
  v_mfma_f32_16x16x32_bf16 a[60:63], a[188:191], v[148:151], a[60:63]
  s_waitcnt lgkmcnt(6)
  ds_read_b128 a[156:159], v10 offset:15360
  v_exp_f32 v124, v124
  v_mfma_f32_16x16x32_bf16 v[88:91], a[128:131], v[32:35], v[180:183]
  s_waitcnt lgkmcnt(6)
  v_exp_f32 v125, v125
  v_mfma_f32_16x16x32_bf16 v[88:91], a[132:135], v[36:39], v[88:91]
  s_waitcnt lgkmcnt(4)
  buffer_load_dwordx4 v3, s[12:15], s54 offen offset:3072 sc1 lds
  v_mfma_f32_16x16x32_bf16 v[88:91], a[136:139], v[40:43], v[88:91]
  s_add_u32 m0, s64, 81920
  ds_read_b128 a[160:163], v10 offset:16384
  v_exp_f32 v126, v126
  v_mfma_f32_16x16x32_bf16 v[88:91], a[140:143], v[44:47], v[88:91]
  s_waitcnt lgkmcnt(1)
  ds_read_b128 a[164:167], v10 offset:17408
  v_mov_b32 v162, 0
  v_mfma_f32_16x16x32_bf16 v[92:95], a[156:159], v[44:47], v[204:207]
  ds_read_b128 a[168:171], v10 offset:18432
  v_exp_f32 v127, v127
  v_mfma_f32_16x16x32_bf16 v[92:95], a[152:155], v[40:43], v[92:95]
  ds_read_b128 a[172:175], v10 offset:19456
  v_mov_b32 v163, 0
  v_mfma_f32_16x16x32_bf16 v[92:95], a[148:151], v[36:39], v[92:95]
  ds_read_b128 a[176:179], v10 offset:20480
  v_cvt_pk_bf16_f32 v164, v120, v121
  v_mfma_f32_16x16x32_bf16 v[92:95], a[144:147], v[32:35], v[92:95]
  ds_read_b128 a[180:183], v10 offset:21504
  v_cvt_pk_bf16_f32 v165, v122, v123
  v_cvt_pk_bf16_f32 v166, v124, v125
  v_cvt_pk_bf16_f32 v167, v126, v127
  v_mfma_f32_16x16x32_bf16 v[224:227], v[240:243], v[160:163], v[224:227]
  ds_read_b128 a[184:187], v10 offset:22528
  v_add_u32 v12, s81, v1
  v_mfma_f32_16x16x32_bf16 v[228:231], v[240:243], v[164:167], v[228:231]
  s_waitcnt lgkmcnt(6)
  ds_read_b128 a[188:191], v10 offset:23552
  v_exp_f32 v88, v88
  v_mfma_f32_16x16x32_bf16 a[32:35], a[160:163], v[164:167], a[32:35]
  s_waitcnt lgkmcnt(6)
  buffer_load_dwordx4 v4, s[12:15], s54 offen sc1 lds
  v_mfma_f32_16x16x32_bf16 a[0:3], a[160:163], v[160:163], a[0:3]
  s_add_u32 s54, s54, s56
  v_exp_f32 v89, v89
  v_mfma_f32_16x16x32_bf16 a[4:7], a[164:167], v[160:163], a[4:7]
  s_waitcnt lgkmcnt(5)
  v_exp_f32 v90, v90
  v_mfma_f32_16x16x32_bf16 a[36:39], a[164:167], v[164:167], a[36:39]
  s_add_u32 m0, s64, 110592
  v_cvt_pk_bf16_f32 v148, v88, v89
  v_add_u32 v13, 73728, v12
  v_mfma_f32_16x16x32_bf16 a[40:43], a[168:171], v[164:167], a[40:43]
  s_waitcnt lgkmcnt(4)
  buffer_load_dwordx4 v1, s[8:11], s53 offen sc1 lds
  v_mfma_f32_16x16x32_bf16 a[8:11], a[168:171], v[160:163], a[8:11]
  s_add_u32 s53, s53, s55
  v_exp_f32 v91, v91
  v_mfma_f32_16x16x32_bf16 a[12:15], a[172:175], v[160:163], a[12:15]
  buffer_load_dwordx4 v1, s[12:15], s54 offen offset:1024 sc1 lds
  v_mfma_f32_16x16x32_bf16 a[44:47], a[172:175], v[164:167], a[44:47]
  s_waitcnt lgkmcnt(3)
  buffer_load_dwordx4 v1, s[12:15], s54 offen offset:2048 sc1 lds
  v_mfma_f32_16x16x32_bf16 a[48:51], a[176:179], v[164:167], a[48:51]
  s_and_b32 s82, s76, 2
  v_exp_f32 v92, v92
  v_mfma_f32_16x16x32_bf16 a[16:19], a[176:179], v[160:163], a[16:19]
  s_waitcnt lgkmcnt(2)
  buffer_load_dwordx4 v1, s[12:15], s54 offen offset:3072 sc1 lds
  v_mfma_f32_16x16x32_bf16 a[20:23], a[180:183], v[160:163], a[20:23]
  s_waitcnt lgkmcnt(1)
  v_exp_f32 v93, v93
  v_mfma_f32_16x16x32_bf16 a[52:55], a[180:183], v[164:167], a[52:55]
  s_add_u32 m0, s64, 114688
  v_cvt_pk_bf16_f32 v149, v90, v91
  v_cvt_pk_bf16_f32 v150, v92, v93
  v_mfma_f32_16x16x32_bf16 a[56:59], a[184:187], v[164:167], a[56:59]
  s_waitcnt lgkmcnt(0)
  buffer_load_dwordx4 v3, s[12:15], s54 offen offset:0 sc1 lds
  v_mfma_f32_16x16x32_bf16 a[24:27], a[184:187], v[160:163], a[24:27]
  s_lshl1_add_u32 s82, s82, 10
  v_exp_f32 v94, v94
  v_mfma_f32_16x16x32_bf16 a[28:31], a[188:191], v[160:163], a[28:31]
  buffer_load_dwordx4 v3, s[12:15], s54 offen offset:1024 sc1 lds
  v_mfma_f32_16x16x32_bf16 a[60:63], a[188:191], v[164:167], a[60:63]
  s_add_u32 s81, s52, 0
  v_exp_f32 v95, v95
  ds_read_b128 a[160:163], v10 offset:32768
  v_cvt_pk_bf16_f32 v151, v94, v95
  ds_read_b128 a[164:167], v10 offset:33792
  ds_read_b128 a[168:171], v10 offset:34816
  ds_read_b128 a[172:175], v10 offset:35840
  ds_read_b128 a[176:179], v10 offset:36864
  ds_read_b128 a[180:183], v10 offset:37888
  v_mfma_f32_16x16x32_bf16 v[228:231], v[240:243], v[148:151], v[228:231]
  s_waitcnt lgkmcnt(4)
  ds_read_b128 a[184:187], v10 offset:38912
  s_and_b32 s81, s81, 3
  v_mfma_f32_16x16x32_bf16 a[32:35], a[160:163], v[148:151], a[32:35]
  s_add_u32 s81, s81, s82
  ds_read_b128 a[188:191], v10 offset:39936
  s_lshl_b32 s81, s81, 10
  v_mfma_f32_16x16x32_bf16 a[36:39], a[164:167], v[148:151], a[36:39]
  s_waitcnt lgkmcnt(5)
  buffer_load_dwordx4 v3, s[12:15], s54 offen offset:2048 sc1 lds
  v_mfma_f32_16x16x32_bf16 a[40:43], a[168:171], v[148:151], a[40:43]
  s_waitcnt lgkmcnt(4)
  buffer_load_dwordx4 v3, s[12:15], s54 offen offset:3072 sc1 lds
  v_mfma_f32_16x16x32_bf16 a[44:47], a[172:175], v[148:151], a[44:47]
  s_waitcnt lgkmcnt(3)
  s_add_u32 m0, s64, 118784
  v_add_u32 v232, s81, v1
  v_mfma_f32_16x16x32_bf16 a[48:51], a[176:179], v[148:151], a[48:51]
  s_waitcnt lgkmcnt(1)
  buffer_load_dwordx4 v4, s[12:15], s54 offen sc1 lds
  v_mfma_f32_16x16x32_bf16 a[52:55], a[180:183], v[148:151], a[52:55]
  s_add_u32 s54, s54, s56
  v_add_u32 v233, 73728, v232
  s_add_u32 s81, s52, 1
  v_mfma_f32_16x16x32_bf16 a[56:59], a[184:187], v[148:151], a[56:59]
  s_and_b32 s81, s81, 3
  s_add_u32 s81, s81, s82
  s_lshl_b32 s81, s81, 10
  s_waitcnt lgkmcnt(0)
  v_mfma_f32_16x16x32_bf16 a[60:63], a[188:191], v[148:151], a[60:63]
  v_add_u32 v234, s81, v1
  v_add_u32 v235, 73728, v234
  s_add_u32 s81, s52, 2
  s_and_b32 s81, s81, 3
  s_add_u32 s81, s81, s82
  s_lshl_b32 s81, s81, 10
  v_add_u32 v236, s81, v1
  v_add_u32 v237, 73728, v236
  s_add_u32 s81, s52, 3
  s_and_b32 s81, s81, 3
  s_add_u32 s81, s81, s82
  s_lshl_b32 s81, s81, 10
  v_add_u32 v238, s81, v1
  v_add_u32 v239, 73728, v238
  s_branch L_lepi
L_xn_spin:
  s_mov_b32 s81, 0
L_xn_spin1:
  s_sleep 4
  buffer_load_dword v115, v113, s[36:39], 0 offen sc1
  s_add_u32 s81, s81, 1
  s_cmp_ge_u32 s81, 1048576
  s_waitcnt vmcnt(0)
  s_cbranch_scc1 L_xn_ok
  v_cmp_ne_u32 vcc, v115, v114
  s_nop 1
  s_cbranch_vccnz L_xn_spin1
  s_branch L_xn_ok
L_kv_spin:
  s_mov_b32 s93, 0
L_kv_spin1:
  s_sleep 4
  buffer_load_dword v13, v8, s[36:39], 0 offen sc1
  s_add_u32 s93, s93, 1
  s_cmp_ge_u32 s93, 1048576
  s_waitcnt vmcnt(0)
  s_cbranch_scc1 L_kv_ok
  v_cmp_ne_u32 vcc, v13, v9
  s_nop 1
  s_cbranch_vccnz L_kv_spin1
  s_branch L_kv_ok
L_p0d:
  s_nop 7
  s_nop 3
  s_cmp_lg_u32 s76, 0
  s_cbranch_scc1 L_p0d_w1
  v_mov_b32 v208, v244
  v_mov_b32 v212, 0xff800000
  v_mov_b32 v209, v245
  v_mov_b32 v213, 0xff800000
  v_mov_b32 v210, v246
  v_mov_b32 v214, 0xff800000
  v_mov_b32 v211, v247
  v_mov_b32 v215, 0xff800000
  s_branch L_p0d_e
L_p0d_w1:
  v_mov_b32 v212, v244
  v_mov_b32 v213, v245
  v_mov_b32 v214, v246
  v_mov_b32 v215, v247
L_p0d_e:
  s_nop 1
  s_branch L_p0
L_have_m:
  s_nop 7
  s_branch L_have_m1
L_dual_dg:
  s_cmp_lg_u32 s76, 0
  s_cbranch_scc1 L_ddg_w1
  v_sub_f32 v208, v244, v250
  v_mov_b32 v212, 0xff800000
  v_sub_f32 v209, v245, v250
  v_mov_b32 v213, 0xff800000
  v_sub_f32 v210, v246, v250
  v_mov_b32 v214, 0xff800000
  v_sub_f32 v211, v247, v250
  v_mov_b32 v215, 0xff800000
  s_branch L_ddg_e
L_ddg_w1:
  v_sub_f32 v212, v244, v250
  v_sub_f32 v213, v245, v250
  v_sub_f32 v214, v246, v250
  v_sub_f32 v215, v247, v250
L_ddg_e:
  s_nop 1
  s_branch L_dual_nd
L_poll_now:
  buffer_load_dword v210, v208, s[36:39], 0 offen sc1
  buffer_load_dword v213, v211, s[36:39], 0 offen sc1
  s_branch L_poll_back
L_single_dg:
  s_cmp_lg_u32 s76, 0
  s_cbranch_scc1 L_sdg_w1
  v_sub_f32 v192, v244, v248
  v_mov_b32 v196, 0xff800000
  v_sub_f32 v193, v245, v248
  v_mov_b32 v197, 0xff800000
  v_sub_f32 v194, v246, v248
  v_mov_b32 v198, 0xff800000
  v_sub_f32 v195, v247, v248
  v_mov_b32 v199, 0xff800000
  s_branch L_sdg_e
L_sdg_w1:
  v_sub_f32 v196, v244, v248
  v_sub_f32 v197, v245, v248
  v_sub_f32 v198, v246, v248
  v_sub_f32 v199, v247, v248
L_sdg_e:
  buffer_load_dword v210, v208, s[36:39], 0 offen sc1
  buffer_load_dword v213, v211, s[36:39], 0 offen sc1
  s_nop 1
  s_branch L_single_nd
L_hw_spin:
  s_mov_b32 s93, 0
L_hw_spin1:
  buffer_load_dword v210, v208, s[36:39], 0 offen sc1
  buffer_load_dword v213, v211, s[36:39], 0 offen sc1
  s_add_u32 s93, s93, 1
  s_cmp_ge_u32 s93, 1048576
  s_waitcnt vmcnt(0)
  s_cbranch_scc1 L_hw_ok
  v_cmp_ne_u32 vcc, v210, v209
  v_cmp_ne_u32 s[94:95], v213, v212
  s_nop 0
  s_or_b64 vcc, vcc, s[94:95]
  s_cbranch_vccz L_hw_ok
  s_sleep 8
  s_branch L_hw_spin1
L_ctx_spin:
  s_mov_b32 s93, 0
L_ctx_spin1:
  s_sleep 4
  buffer_load_dword v187, v185, s[36:39], 0 offen sc1
  s_add_u32 s93, s93, 1
  s_cmp_ge_u32 s93, 1048576
  s_waitcnt vmcnt(0)
  s_cbranch_scc1 L_ctx_ok
  v_cmp_ne_u32 vcc, v187, v186
  s_nop 1
  s_cbranch_vccnz L_ctx_spin1
  s_branch L_ctx_ok
L_pxp_spin:
  s_mov_b32 s93, 0
L_pxp_spin1:
  s_sleep 4
  buffer_load_dword v187, v185, s[32:35], 0 offen sc1
  s_add_u32 s93, s93, 1
  s_cmp_ge_u32 s93, 1048576
  s_waitcnt vmcnt(0)
  s_cbranch_scc1 L_pxp_ok
  v_cmp_ne_u32 vcc, v187, v186
  s_nop 1
  s_cbranch_vccnz L_pxp_spin1
  s_branch L_pxp_ok
L_px0_spin:
  s_mov_b32 s93, 0
L_px0_spin1:
  s_sleep 4
  buffer_load_dwordx4 v[190:193], v1, s[32:35], s60 offen offset:0 sc1
  buffer_load_dwordx4 v[194:197], v1, s[32:35], s60 offen offset:1024 sc1
  buffer_load_dwordx4 v[198:201], v1, s[32:35], s60 offen offset:2048 sc1
  buffer_load_dwordx2 v[202:203], v184, s[32:35], s60 offen offset:3072 sc1
  s_add_u32 s93, s93, 1
  s_cmp_ge_u32 s93, 1048576
  s_waitcnt vmcnt(0)
  s_cbranch_scc1 L_px0_ok
  v_xor_b32 v188, s72, v193
  v_xor_b32 v189, s72, v197
  v_xor_b32 v187, s72, v201
  v_xor_b32 v183, s72, v203
  v_or3_b32 v188, v188, v189, v187
  v_or_b32 v188, v188, v183
  v_cmp_ne_u32 vcc, 0, v188
  s_nop 1
  s_cbranch_vccnz L_px0_spin1
  s_branch L_px0_ok
L_px1_spin:
  s_mov_b32 s93, 0
L_px1_spin1:
  s_sleep 4
  buffer_load_dwordx4 v[204:207], v1, s[32:35], s61 offen offset:0 sc1
  buffer_load_dwordx4 v[208:211], v1, s[32:35], s61 offen offset:1024 sc1
  buffer_load_dwordx4 v[212:215], v1, s[32:35], s61 offen offset:2048 sc1
  buffer_load_dwordx2 v[216:217], v184, s[32:35], s61 offen offset:3072 sc1
  s_add_u32 s93, s93, 1
  s_cmp_ge_u32 s93, 1048576
  s_waitcnt vmcnt(0)
  s_cbranch_scc1 L_px1_ok
  v_xor_b32 v188, s72, v207
  v_xor_b32 v189, s72, v211
  v_xor_b32 v187, s72, v215
  v_xor_b32 v183, s72, v217
  v_or3_b32 v188, v188, v189, v187
  v_or_b32 v188, v188, v183
  v_cmp_ne_u32 vcc, 0, v188
  s_nop 1
  s_cbranch_vccnz L_px1_spin1
  s_branch L_px1_ok
L_px2_spin:
  s_mov_b32 s93, 0
L_px2_spin1:
  s_sleep 4
  buffer_load_dwordx4 v[218:221], v1, s[32:35], s57 offen offset:0 sc1
  buffer_load_dwordx4 v[222:225], v1, s[32:35], s57 offen offset:1024 sc1
  buffer_load_dwordx4 v[226:229], v1, s[32:35], s57 offen offset:2048 sc1
  buffer_load_dwordx2 v[230:231], v184, s[32:35], s57 offen offset:3072 sc1
  s_add_u32 s93, s93, 1
  s_cmp_ge_u32 s93, 1048576
  s_waitcnt vmcnt(0)
  s_cbranch_scc1 L_px2_ok
  v_xor_b32 v188, s72, v221
  v_xor_b32 v189, s72, v225
  v_xor_b32 v187, s72, v229
  v_xor_b32 v183, s72, v231
  v_or3_b32 v188, v188, v189, v187
  v_or_b32 v188, v188, v183
  v_cmp_ne_u32 vcc, 0, v188
  s_nop 1
  s_cbranch_vccnz L_px2_spin1
  s_branch L_px2_ok
L_redo:
  s_waitcnt vmcnt(0) lgkmcnt(0)
  s_mov_b32 s92, 1
  s_barrier
  s_lshl_b32 s81, s79, 7
  s_lshl_b32 s82, s76, 4
  s_add_u32 s81, s81, s82
  v_and_b32 v144, 15, v14
  v_add_u32 v144, s81, v144
  v_mov_b32 v248, 0xff800000
  s_lshl_b32 s81, s79, 7
  s_lshl_b32 s82, s76, 4
  s_sub_u32 s82, 112, s82
  s_add_u32 s81, s81, s82
  v_and_b32 v145, 15, v14
  v_add_u32 v145, s81, v145
  v_mov_b32 v249, 0xff800000
  s_lshl_b32 s81, s80, 7
  s_lshl_b32 s82, s76, 4
  s_add_u32 s81, s81, s82
  v_and_b32 v146, 15, v14
  v_add_u32 v146, s81, v146
  v_mov_b32 v250, 0xff800000
  s_lshl_b32 s81, s80, 7
  s_lshl_b32 s82, s76, 4
  s_sub_u32 s82, 112, s82
  s_add_u32 s81, s81, s82
  v_and_b32 v147, 15, v14
  v_add_u32 v147, s81, v147
  v_mov_b32 v251, 0xff800000
  v_lshrrev_b32 v148, 4, v14
  v_lshlrev_b32 v148, 2, v148
  v_mov_b32 v149, 0xff800000
  s_add_u32 s86, s79, 1
  s_lshl_b32 s86, s86, 2
  s_mov_b32 s84, 8192
L_redo1:
  buffer_load_dwordx4 a[128:131], v1, s[4:7], s84 offen offset:0 sc1
  buffer_load_dwordx4 a[132:135], v1, s[4:7], s84 offen offset:1024 sc1
  buffer_load_dwordx4 a[136:139], v1, s[4:7], s84 offen offset:2048 sc1
  buffer_load_dwordx4 a[140:143], v1, s[4:7], s84 offen offset:3072 sc1
  buffer_load_dwordx4 a[144:147], v3, s[4:7], s84 offen offset:0 sc1
  buffer_load_dwordx4 a[148:151], v3, s[4:7], s84 offen offset:1024 sc1
  buffer_load_dwordx4 a[152:155], v3, s[4:7], s84 offen offset:2048 sc1
  buffer_load_dwordx4 a[156:159], v3, s[4:7], s84 offen offset:3072 sc1
  s_waitcnt vmcnt(0)
  v_mfma_f32_16x16x32_bf16 v[80:83], a[128:131], v[16:19], 0
  v_mfma_f32_16x16x32_bf16 v[80:83], a[132:135], v[20:23], v[80:83]
  v_mfma_f32_16x16x32_bf16 v[80:83], a[136:139], v[24:27], v[80:83]
  v_mfma_f32_16x16x32_bf16 v[80:83], a[140:143], v[28:31], v[80:83]
  v_mfma_f32_16x16x32_bf16 v[88:91], a[140:143], v[44:47], 0
  v_mfma_f32_16x16x32_bf16 v[88:91], a[136:139], v[40:43], v[88:91]
  v_mfma_f32_16x16x32_bf16 v[88:91], a[132:135], v[36:39], v[88:91]
  v_mfma_f32_16x16x32_bf16 v[88:91], a[128:131], v[32:35], v[88:91]
  v_mfma_f32_16x16x32_bf16 v[96:99], a[128:131], v[48:51], 0
  v_mfma_f32_16x16x32_bf16 v[96:99], a[132:135], v[52:55], v[96:99]
  v_mfma_f32_16x16x32_bf16 v[96:99], a[136:139], v[56:59], v[96:99]
  v_mfma_f32_16x16x32_bf16 v[96:99], a[140:143], v[60:63], v[96:99]
  v_mfma_f32_16x16x32_bf16 v[104:107], a[140:143], v[76:79], 0
  v_mfma_f32_16x16x32_bf16 v[104:107], a[136:139], v[72:75], v[104:107]
  v_mfma_f32_16x16x32_bf16 v[104:107], a[132:135], v[68:71], v[104:107]
  v_mfma_f32_16x16x32_bf16 v[104:107], a[128:131], v[64:67], v[104:107]
  v_mfma_f32_16x16x32_bf16 v[108:111], a[144:147], v[64:67], 0
  v_mfma_f32_16x16x32_bf16 v[108:111], a[148:151], v[68:71], v[108:111]
  v_mfma_f32_16x16x32_bf16 v[108:111], a[152:155], v[72:75], v[108:111]
  v_mfma_f32_16x16x32_bf16 v[108:111], a[156:159], v[76:79], v[108:111]
  v_mfma_f32_16x16x32_bf16 v[100:103], a[156:159], v[60:63], 0
  v_mfma_f32_16x16x32_bf16 v[100:103], a[152:155], v[56:59], v[100:103]
  v_mfma_f32_16x16x32_bf16 v[100:103], a[148:151], v[52:55], v[100:103]
  v_mfma_f32_16x16x32_bf16 v[100:103], a[144:147], v[48:51], v[100:103]
  v_mfma_f32_16x16x32_bf16 v[92:95], a[144:147], v[32:35], 0
  v_mfma_f32_16x16x32_bf16 v[92:95], a[148:151], v[36:39], v[92:95]
  v_mfma_f32_16x16x32_bf16 v[92:95], a[152:155], v[40:43], v[92:95]
  v_mfma_f32_16x16x32_bf16 v[92:95], a[156:159], v[44:47], v[92:95]
  v_mfma_f32_16x16x32_bf16 v[84:87], a[156:159], v[28:31], 0
  v_mfma_f32_16x16x32_bf16 v[84:87], a[152:155], v[24:27], v[84:87]
  v_mfma_f32_16x16x32_bf16 v[84:87], a[148:151], v[20:23], v[84:87]
  v_mfma_f32_16x16x32_bf16 v[84:87], a[144:147], v[16:19], v[84:87]
  s_nop 7
  v_add_u32 v150, 0, v148
  v_cmp_le_u32 vcc, v150, v144
  s_nop 1
  v_cndmask_b32 v80, v149, v80, vcc
  v_max_f32 v248, v248, v80
  v_cmp_le_u32 vcc, v150, v145
  s_nop 1
  v_cndmask_b32 v88, v149, v88, vcc
  v_max_f32 v249, v249, v88
  v_cmp_le_u32 vcc, v150, v146
  s_nop 1
  v_cndmask_b32 v96, v149, v96, vcc
  v_max_f32 v250, v250, v96
  v_cmp_le_u32 vcc, v150, v147
  s_nop 1
  v_cndmask_b32 v104, v149, v104, vcc
  v_max_f32 v251, v251, v104
  v_add_u32 v150, 1, v148
  v_cmp_le_u32 vcc, v150, v144
  s_nop 1
  v_cndmask_b32 v81, v149, v81, vcc
  v_max_f32 v248, v248, v81
  v_cmp_le_u32 vcc, v150, v145
  s_nop 1
  v_cndmask_b32 v89, v149, v89, vcc
  v_max_f32 v249, v249, v89
  v_cmp_le_u32 vcc, v150, v146
  s_nop 1
  v_cndmask_b32 v97, v149, v97, vcc
  v_max_f32 v250, v250, v97
  v_cmp_le_u32 vcc, v150, v147
  s_nop 1
  v_cndmask_b32 v105, v149, v105, vcc
  v_max_f32 v251, v251, v105
  v_add_u32 v150, 2, v148
  v_cmp_le_u32 vcc, v150, v144
  s_nop 1
  v_cndmask_b32 v82, v149, v82, vcc
  v_max_f32 v248, v248, v82
  v_cmp_le_u32 vcc, v150, v145
  s_nop 1
  v_cndmask_b32 v90, v149, v90, vcc
  v_max_f32 v249, v249, v90
  v_cmp_le_u32 vcc, v150, v146
  s_nop 1
  v_cndmask_b32 v98, v149, v98, vcc
  v_max_f32 v250, v250, v98
  v_cmp_le_u32 vcc, v150, v147
  s_nop 1
  v_cndmask_b32 v106, v149, v106, vcc
  v_max_f32 v251, v251, v106
  v_add_u32 v150, 3, v148
  v_cmp_le_u32 vcc, v150, v144
  s_nop 1
  v_cndmask_b32 v83, v149, v83, vcc
  v_max_f32 v248, v248, v83
  v_cmp_le_u32 vcc, v150, v145
  s_nop 1
  v_cndmask_b32 v91, v149, v91, vcc
  v_max_f32 v249, v249, v91
  v_cmp_le_u32 vcc, v150, v146
  s_nop 1
  v_cndmask_b32 v99, v149, v99, vcc
  v_max_f32 v250, v250, v99
  v_cmp_le_u32 vcc, v150, v147
  s_nop 1
  v_cndmask_b32 v107, v149, v107, vcc
  v_max_f32 v251, v251, v107
  v_add_u32 v150, 16, v148
  v_cmp_le_u32 vcc, v150, v144
  s_nop 1
  v_cndmask_b32 v84, v149, v84, vcc
  v_max_f32 v248, v248, v84
  v_cmp_le_u32 vcc, v150, v145
  s_nop 1
  v_cndmask_b32 v92, v149, v92, vcc
  v_max_f32 v249, v249, v92
  v_cmp_le_u32 vcc, v150, v146
  s_nop 1
  v_cndmask_b32 v100, v149, v100, vcc
  v_max_f32 v250, v250, v100
  v_cmp_le_u32 vcc, v150, v147
  s_nop 1
  v_cndmask_b32 v108, v149, v108, vcc
  v_max_f32 v251, v251, v108
  v_add_u32 v150, 17, v148
  v_cmp_le_u32 vcc, v150, v144
  s_nop 1
  v_cndmask_b32 v85, v149, v85, vcc
  v_max_f32 v248, v248, v85
  v_cmp_le_u32 vcc, v150, v145
  s_nop 1
  v_cndmask_b32 v93, v149, v93, vcc
  v_max_f32 v249, v249, v93
  v_cmp_le_u32 vcc, v150, v146
  s_nop 1
  v_cndmask_b32 v101, v149, v101, vcc
  v_max_f32 v250, v250, v101
  v_cmp_le_u32 vcc, v150, v147
  s_nop 1
  v_cndmask_b32 v109, v149, v109, vcc
  v_max_f32 v251, v251, v109
  v_add_u32 v150, 18, v148
  v_cmp_le_u32 vcc, v150, v144
  s_nop 1
  v_cndmask_b32 v86, v149, v86, vcc
  v_max_f32 v248, v248, v86
  v_cmp_le_u32 vcc, v150, v145
  s_nop 1
  v_cndmask_b32 v94, v149, v94, vcc
  v_max_f32 v249, v249, v94
  v_cmp_le_u32 vcc, v150, v146
  s_nop 1
  v_cndmask_b32 v102, v149, v102, vcc
  v_max_f32 v250, v250, v102
  v_cmp_le_u32 vcc, v150, v147
  s_nop 1
  v_cndmask_b32 v110, v149, v110, vcc
  v_max_f32 v251, v251, v110
  v_add_u32 v150, 19, v148
  v_cmp_le_u32 vcc, v150, v144
  s_nop 1
  v_cndmask_b32 v87, v149, v87, vcc
  v_max_f32 v248, v248, v87
  v_cmp_le_u32 vcc, v150, v145
  s_nop 1
  v_cndmask_b32 v95, v149, v95, vcc
  v_max_f32 v249, v249, v95
  v_cmp_le_u32 vcc, v150, v146
  s_nop 1
  v_cndmask_b32 v103, v149, v103, vcc
  v_max_f32 v250, v250, v103
  v_cmp_le_u32 vcc, v150, v147
  s_nop 1
  v_cndmask_b32 v111, v149, v111, vcc
  v_max_f32 v251, v251, v111
  v_add_u32 v148, 32, v148
  s_add_u32 s84, s84, 16384
  s_sub_u32 s86, s86, 1
  s_cmp_lg_u32 s86, 0
  s_cbranch_scc1 L_redo1
  v_mov_b32 v252, v248
  v_mov_b32 v253, v249
  v_mov_b32 v254, v250
  v_mov_b32 v255, v251
  v_permlane16_swap_b32 v248, v252
  v_permlane16_swap_b32 v249, v253
  v_permlane16_swap_b32 v250, v254
  v_permlane16_swap_b32 v251, v255
  v_max_f32 v248, v248, v252
  v_max_f32 v249, v249, v253
  v_max_f32 v250, v250, v254
  v_max_f32 v251, v251, v255
  v_mov_b32 v252, v248
  v_mov_b32 v253, v249
  v_mov_b32 v254, v250
  v_mov_b32 v255, v251
  v_permlane32_swap_b32 v248, v252
  v_permlane32_swap_b32 v249, v253
  v_permlane32_swap_b32 v250, v254
  v_permlane32_swap_b32 v251, v255
  v_max_f32 v248, v248, v252
  v_max_f32 v249, v249, v253
  v_max_f32 v250, v250, v254
  v_max_f32 v251, v251, v255
  s_and_b32 s85, s79, 1
  s_lshl_b32 s85, s85, 16
  v_or_b32 v10, s85, v1
  v_xor_b32 v11, 0x10000, v10
  v_add_u32 v2, 0, v1
  v_add_u32 v3, 4096, v1
  v_add_u32 v4, 8192, v1
  v_add_u32 v5, 12288, v1
  s_lshr_b32 s81, s76, 1
  s_lshl_b32 s81, s81, 14
  s_and_b32 s82, s76, 1
  s_lshl_b32 s82, s82, 12
  s_add_u32 s81, s81, s82
  s_add_u32 s81, s81, 8192
  s_xor_b32 s82, s85, 98304
  s_add_u32 m0, s81, s82
  s_lshl_b32 s84, s76, 14
  s_add_u32 s85, s85, s84
  s_add_u32 s84, s84, 32768
  buffer_load_dwordx4 v2, s[4:7], s81 offen offset:0 sc1 lds
  buffer_load_dwordx4 v2, s[4:7], s81 offen offset:1024 sc1 lds
  buffer_load_dwordx4 v2, s[4:7], s81 offen offset:2048 sc1 lds
  buffer_load_dwordx4 v2, s[4:7], s81 offen offset:3072 sc1 lds
  s_add_u32 m0, s85, 0
  s_nop 0
  buffer_load_dwordx4 v2, s[4:7], s84 offen offset:0 sc1 lds
  buffer_load_dwordx4 v2, s[4:7], s84 offen offset:1024 sc1 lds
  buffer_load_dwordx4 v2, s[4:7], s84 offen offset:2048 sc1 lds
  buffer_load_dwordx4 v2, s[4:7], s84 offen offset:3072 sc1 lds
  s_add_u32 m0, s85, 4096
  s_nop 0
  buffer_load_dwordx4 v3, s[4:7], s84 offen offset:0 sc1 lds
  buffer_load_dwordx4 v3, s[4:7], s84 offen offset:1024 sc1 lds
  buffer_load_dwordx4 v3, s[4:7], s84 offen offset:2048 sc1 lds
  buffer_load_dwordx4 v3, s[4:7], s84 offen offset:3072 sc1 lds
  s_add_u32 m0, s85, 8192
  s_nop 0
  buffer_load_dwordx4 v4, s[4:7], s84 offen offset:0 sc1 lds
  buffer_load_dwordx4 v4, s[4:7], s84 offen offset:1024 sc1 lds
  buffer_load_dwordx4 v4, s[4:7], s84 offen offset:2048 sc1 lds
  buffer_load_dwordx4 v4, s[4:7], s84 offen offset:3072 sc1 lds
  s_add_u32 m0, s85, 12288
  s_nop 0
  buffer_load_dwordx4 v5, s[4:7], s84 offen offset:0 sc1 lds
  buffer_load_dwordx4 v5, s[4:7], s84 offen offset:1024 sc1 lds
  buffer_load_dwordx4 v5, s[4:7], s84 offen offset:2048 sc1 lds
  v_accvgpr_write_b32 a0, 0
  v_accvgpr_write_b32 a1, 0
  v_accvgpr_write_b32 a2, 0
  v_accvgpr_write_b32 a3, 0
  v_accvgpr_write_b32 a4, 0
  v_accvgpr_write_b32 a5, 0
  v_accvgpr_write_b32 a6, 0
  v_accvgpr_write_b32 a7, 0
  v_accvgpr_write_b32 a8, 0
  v_accvgpr_write_b32 a9, 0
  v_accvgpr_write_b32 a10, 0
  v_accvgpr_write_b32 a11, 0
  v_accvgpr_write_b32 a12, 0
  v_accvgpr_write_b32 a13, 0
  v_accvgpr_write_b32 a14, 0
  v_accvgpr_write_b32 a15, 0
  v_accvgpr_write_b32 a16, 0
  v_accvgpr_write_b32 a17, 0
  v_accvgpr_write_b32 a18, 0
  v_accvgpr_write_b32 a19, 0
  v_accvgpr_write_b32 a20, 0
  v_accvgpr_write_b32 a21, 0
  v_accvgpr_write_b32 a22, 0
  v_accvgpr_write_b32 a23, 0
  v_accvgpr_write_b32 a24, 0
  v_accvgpr_write_b32 a25, 0
  v_accvgpr_write_b32 a26, 0
  v_accvgpr_write_b32 a27, 0
  v_accvgpr_write_b32 a28, 0
  v_accvgpr_write_b32 a29, 0
  v_accvgpr_write_b32 a30, 0
  v_accvgpr_write_b32 a31, 0
  v_accvgpr_write_b32 a32, 0
  v_accvgpr_write_b32 a33, 0
  v_accvgpr_write_b32 a34, 0
  v_accvgpr_write_b32 a35, 0
  v_accvgpr_write_b32 a36, 0
  v_accvgpr_write_b32 a37, 0
  v_accvgpr_write_b32 a38, 0
  v_accvgpr_write_b32 a39, 0
  v_accvgpr_write_b32 a40, 0
  v_accvgpr_write_b32 a41, 0
  v_accvgpr_write_b32 a42, 0
  v_accvgpr_write_b32 a43, 0
  v_accvgpr_write_b32 a44, 0
  v_accvgpr_write_b32 a45, 0
  v_accvgpr_write_b32 a46, 0
  v_accvgpr_write_b32 a47, 0
  v_accvgpr_write_b32 a48, 0
  v_accvgpr_write_b32 a49, 0
  v_accvgpr_write_b32 a50, 0
  v_accvgpr_write_b32 a51, 0
  v_accvgpr_write_b32 a52, 0
  v_accvgpr_write_b32 a53, 0
  v_accvgpr_write_b32 a54, 0
  v_accvgpr_write_b32 a55, 0
  v_accvgpr_write_b32 a56, 0
  v_accvgpr_write_b32 a57, 0
  v_accvgpr_write_b32 a58, 0
  v_accvgpr_write_b32 a59, 0
  v_accvgpr_write_b32 a60, 0
  v_accvgpr_write_b32 a61, 0
  v_accvgpr_write_b32 a62, 0
  v_accvgpr_write_b32 a63, 0
  v_accvgpr_write_b32 a64, 0
  v_accvgpr_write_b32 a65, 0
  v_accvgpr_write_b32 a66, 0
  v_accvgpr_write_b32 a67, 0
  v_accvgpr_write_b32 a68, 0
  v_accvgpr_write_b32 a69, 0
  v_accvgpr_write_b32 a70, 0
  v_accvgpr_write_b32 a71, 0
  v_accvgpr_write_b32 a72, 0
  v_accvgpr_write_b32 a73, 0
  v_accvgpr_write_b32 a74, 0
  v_accvgpr_write_b32 a75, 0
  v_accvgpr_write_b32 a76, 0
  v_accvgpr_write_b32 a77, 0
  v_accvgpr_write_b32 a78, 0
  v_accvgpr_write_b32 a79, 0
  v_accvgpr_write_b32 a80, 0
  v_accvgpr_write_b32 a81, 0
  v_accvgpr_write_b32 a82, 0
  v_accvgpr_write_b32 a83, 0
  v_accvgpr_write_b32 a84, 0
  v_accvgpr_write_b32 a85, 0
  v_accvgpr_write_b32 a86, 0
  v_accvgpr_write_b32 a87, 0
  v_accvgpr_write_b32 a88, 0
  v_accvgpr_write_b32 a89, 0
  v_accvgpr_write_b32 a90, 0
  v_accvgpr_write_b32 a91, 0
  v_accvgpr_write_b32 a92, 0
  v_accvgpr_write_b32 a93, 0
  v_accvgpr_write_b32 a94, 0
  v_accvgpr_write_b32 a95, 0
  v_accvgpr_write_b32 a96, 0
  v_accvgpr_write_b32 a97, 0
  v_accvgpr_write_b32 a98, 0
  v_accvgpr_write_b32 a99, 0
  v_accvgpr_write_b32 a100, 0
  v_accvgpr_write_b32 a101, 0
  v_accvgpr_write_b32 a102, 0
  v_accvgpr_write_b32 a103, 0
  v_accvgpr_write_b32 a104, 0
  v_accvgpr_write_b32 a105, 0
  v_accvgpr_write_b32 a106, 0
  v_accvgpr_write_b32 a107, 0
  v_accvgpr_write_b32 a108, 0
  v_accvgpr_write_b32 a109, 0
  v_accvgpr_write_b32 a110, 0
  v_accvgpr_write_b32 a111, 0
  v_accvgpr_write_b32 a112, 0
  v_accvgpr_write_b32 a113, 0
  v_accvgpr_write_b32 a114, 0
  v_accvgpr_write_b32 a115, 0
  v_accvgpr_write_b32 a116, 0
  v_accvgpr_write_b32 a117, 0
  v_accvgpr_write_b32 a118, 0
  v_accvgpr_write_b32 a119, 0
  v_accvgpr_write_b32 a120, 0
  v_accvgpr_write_b32 a121, 0
  v_accvgpr_write_b32 a122, 0
  v_accvgpr_write_b32 a123, 0
  v_accvgpr_write_b32 a124, 0
  v_accvgpr_write_b32 a125, 0
  v_accvgpr_write_b32 a126, 0
  v_accvgpr_write_b32 a127, 0
  v_mov_b32 v208, 0
  v_mov_b32 v209, 0
  v_mov_b32 v210, 0
  v_mov_b32 v211, 0
  v_mov_b32 v212, 0
  v_mov_b32 v213, 0
  v_mov_b32 v214, 0
  v_mov_b32 v215, 0
  v_mov_b32 v216, 0
  v_mov_b32 v217, 0
  v_mov_b32 v218, 0
  v_mov_b32 v219, 0
  v_mov_b32 v220, 0
  v_mov_b32 v221, 0
  v_mov_b32 v222, 0
  v_mov_b32 v223, 0
  v_mov_b32 v224, 0
  v_mov_b32 v225, 0
  v_mov_b32 v226, 0
  v_mov_b32 v227, 0
  v_mov_b32 v228, 0
  v_mov_b32 v229, 0
  v_mov_b32 v230, 0
  v_mov_b32 v231, 0
  v_mov_b32 v232, 0
  v_mov_b32 v233, 0
  v_mov_b32 v234, 0
  v_mov_b32 v235, 0
  v_mov_b32 v236, 0
  v_mov_b32 v237, 0
  v_mov_b32 v238, 0
  v_mov_b32 v239, 0
  s_waitcnt vmcnt(0)
  s_barrier
  ds_read_b128 a[128:131], v11 offset:40960
  ds_read_b128 a[132:135], v11 offset:41984
  ds_read_b128 a[136:139], v11 offset:43008
  ds_read_b128 a[140:143], v11 offset:44032
  ds_read_b128 a[144:147], v11 offset:45056
  ds_read_b128 a[148:151], v11 offset:46080
  ds_read_b128 a[152:155], v11 offset:47104
  ds_read_b128 a[156:159], v11 offset:48128
  s_branch L_att_redo
L_code_end:
  s_endpgm

.section .rodata,"a"
.p2align 6
.amdhsa_kernel parallel_sum__compressed_kv_cla__dense_activation_gelu__prompt_kernel
  .amdhsa_next_free_vgpr 512
  .amdhsa_next_free_sgpr 102
  .amdhsa_accum_offset 256
  .amdhsa_group_segment_fixed_size 0
  .amdhsa_kernarg_size 112
  .amdhsa_user_sgpr_count 2
  .amdhsa_user_sgpr_kernarg_segment_ptr 1
  .amdhsa_system_sgpr_workgroup_id_x 1
.end_amdhsa_kernel
```
